```python
import torch

def _softmax(x, axis=-1):
    return torch.softmax(x, dim=axis)
def _gelu(x):
    return torch.nn.functional.gelu(x, approximate="tanh")
def _silu(x):
    return torch.nn.functional.silu(x)
def _sigmoid(x):
    return torch.sigmoid(x)
def _layernorm(x, axis=-1, eps=1e-5):
    m = x.mean(dim=axis, keepdim=True)
    v = x.var(dim=axis, keepdim=True, unbiased=False)
    return (x - m) / torch.sqrt(v + eps)
def _scatter_add(tgt, idx, src, axis=0):
    return tgt.clone().index_add_(axis, idx, src)
def _segment_sum(src, seg, n):
    out = torch.zeros((n,) + src.shape[1:], dtype=src.dtype)
    return out.index_add_(0, seg, src)
def _pad(x, pw):
    flat = tuple(v for pair in reversed(pw) for v in pair)
    return torch.nn.functional.pad(x, flat)

kernel_name = 'gated_mix__ssm_conv_h3__compressed_kv_cla__prompt'

def setup_inputs():

    _w = (lambda a: (lambda t: t.to(torch.bfloat16) if t.is_floating_point() else t)(torch.as_tensor(a)))
    def _A_setup():
        B, S, D = 1, 2048, 576
        ks = 4
        return {
            "q": _w((lambda *s: torch.randn(*s, dtype=torch.bfloat16) * 0.05)(B, S, D)),
            "k": _w((lambda *s: torch.randn(*s, dtype=torch.bfloat16) * 0.4)(B, S, D)),
            "v": _w((lambda *s: torch.randn(*s, dtype=torch.bfloat16) * 0.4)(B, S, D)),
            "shift_k": _w((lambda *s: torch.randn(*s, dtype=torch.bfloat16) * 0.4)(D, ks) * 0.5),
            "ssm_k": _w((lambda *s: torch.randn(*s, dtype=torch.bfloat16) * 0.8)(D, S) * (1.0 / S ** 0.5)),
            "ssm_D": _w((lambda *s: torch.randn(*s, dtype=torch.bfloat16) * 0.4)(D)),
        }
    _A_in = _A_setup()

    def _B_setup():
        B, H, Sq, Sk, D, M = 1, 32, 2048, 2048, 128, 576
        Dc = 4 * D
        return {
            "x": _w((lambda *s: torch.randn(*s, dtype=torch.bfloat16) * 0.05)(B, Sq, M)),
            "c_kv": _w((lambda *s: torch.randn(*s, dtype=torch.bfloat16) * 0.4)(B, Sk, Dc)),
            "w_q": _w((lambda *s: torch.randn(*s, dtype=torch.bfloat16) * 6.4)(M, H, D) * (M ** -0.5)),
            "w_uk": _w((lambda *s: torch.randn(*s, dtype=torch.bfloat16) * 6.4)(Dc, H, D) * (Dc ** -0.5)),
            "w_uv": _w((lambda *s: torch.randn(*s, dtype=torch.bfloat16) * 0.4)(Dc, H, D) * (Dc ** -0.5)),
            "w_o": _w((lambda *s: torch.randn(*s, dtype=torch.bfloat16) * 0.4)(H, D, M) * ((H * D) ** -0.5)),
        }
    _B_in = _B_setup()

    return {
        "A_q": _A_in["q"],
        "A_k": _A_in["k"],
        "A_v": _A_in["v"],
        "A_shift_k": _A_in["shift_k"],
        "A_ssm_k": _A_in["ssm_k"],
        "A_ssm_D": _A_in["ssm_D"],
        "B_x": _B_in["x"],
        "B_c_kv": _B_in["c_kv"],
        "B_w_q": _B_in["w_q"],
        "B_w_uk": _B_in["w_uk"],
        "B_w_uv": _B_in["w_uv"],
        "B_w_o": _B_in["w_o"],
        "gate_w": _w((lambda *s: torch.randn(*s, dtype=torch.bfloat16) * 0.05)(576) * 16.0),
    }

def reference(A_q, A_k, A_v, A_shift_k, A_ssm_k, A_ssm_D, B_x, B_c_kv, B_w_q, B_w_uk, B_w_uv, B_w_o, gate_w):
    def _A_ref(q, k, v, shift_k, ssm_k, ssm_D):
        B, S, D = q.shape
        ks = shift_k.shape[-1]
        k_pad = _pad(k, ((0, 0), (ks - 1, 0), (0, 0)))
        k_shift = torch.zeros_like(k)
        for t in range(ks):
            k_shift = k_shift + k_pad[:, t:t + S, :] * shift_k[:, ks - 1 - t][None, None, :]
        kv = k_shift * v
        L = 2 * S
        kv_pad = _pad(kv, ((0, 0), (0, S), (0, 0)))
        kf_pad = _pad(ssm_k, ((0, 0), (0, S)))
        kv_f = (lambda x, axes=(-2,-1): torch.fft.rfft2(x.float(), dim=axes))(kv_pad[:, None, :, :], axes=(1, 2))
        kf_f = (lambda x, axes=(-2,-1): torch.fft.rfft2(x.float(), dim=axes))(kf_pad[:, None, :], axes=(1, 2))
        kf_f = (lambda x, *d: x.permute(*d))(kf_f, 1, 2, 0)
        y_f = kv_f * kf_f[None, :, :, :]
        y = (lambda x, s, axes=(-2,-1): torch.fft.irfft2(x, s=s, dim=axes).to(torch.bfloat16))(y_f, (1, L), axes=(1, 2))[:, 0, :S, :]
        y = y + kv * ssm_D[None, None, :]
        return q * y

    def _B_ref(x, c_kv, w_q, w_uk, w_uv, w_o):
        B, Sq, M = x.shape[0], x.shape[1], x.shape[2]
        Sk = c_kv.shape[1]
        H, D = w_q.shape[1], w_q.shape[2]
        q = torch.einsum("bqm,mhd->bhqd", x, w_q)
        k = torch.einsum("bkc,chd->bhkd", c_kv, w_uk)
        v = torch.einsum("bkc,chd->bhkd", c_kv, w_uv)
        scores = torch.einsum("bhqd,bhkd->bhqk", q, k) * (D ** -0.5)
        off = Sk - Sq
        qi = torch.arange(Sq)[:, None]
        kj = torch.arange(Sk)[None, :]
        cmask = kj <= (qi + off)
        scores = torch.where(cmask[None, None], scores, -1e9)
        p = _softmax(scores, axis=-1)
        ctx = torch.einsum("bhqk,bhkd->bhqd", p, v)
        return torch.einsum("bhqd,hdm->bqm", ctx, w_o)

    x = A_q
    g = _sigmoid((x * gate_w).sum(-1, keepdims=True))
    a = _A_ref(x, A_k, A_v, A_shift_k, A_ssm_k, A_ssm_D)
    b = _B_ref(x, B_c_kv, B_w_q, B_w_uk, B_w_uv, B_w_o)
    return g * a + (1 - g) * b
```

```asm
; @launch grid=(256,1,1) block=(256,1,1) lds=163840
.amdgcn_target "amdgcn-amd-amdhsa--gfx950"
.text
.globl gated_mix__ssm_conv_h3__compressed_kv_cla__prompt_kernel
.p2align 8
.type gated_mix__ssm_conv_h3__compressed_kv_cla__prompt_kernel,@function
gated_mix__ssm_conv_h3__compressed_kv_cla__prompt_kernel:
  s_cmp_ge_u32 s2, 256
  s_cbranch_scc1 K_end
  s_load_dwordx16 s[64:79], s[0:1], 0
  s_load_dwordx16 s[80:95], s[0:1], 64
  s_getpc_b64 s[44:45]
K_pc0:
  v_lshrrev_b32 v3, 6, v0
  v_and_b32 v0, 63, v0
  v_readfirstlane_b32 s24, v3
  s_and_b32 s25, s2, 7
  s_lshr_b32 s26, s2, 3
  s_lshl_b32 s27, s26, 2
  s_add_u32 s27, s27, s24
  s_mul_i32 s27, s27, 6
  v_min_u32 v3, 5, v0
  v_add_u32 v3, s27, v3
  v_min_u32 v3, (K_last-K_pc0)/128-1, v3
  v_lshlrev_b32 v3, 7, v3
  global_load_dword v255, v3, s[44:45]
  s_and_b32 s27, s26, 3
  s_lshl_b32 s25, s25, 2
  s_add_u32 s25, s25, s27
  s_lshr_b32 s26, s26, 2
  v_lshlrev_b32 v1, 4, v0
  v_add_u32 v2, 0x10000, v1
  v_lshrrev_b32 v16, 4, v0
  v_lshrrev_b32 v17, 3, v0
  v_and_b32 v18, 7, v0
  v_and_b32 v19, 15, v0
  v_lshrrev_b32 v21, 1, v19
  v_and_b32 v22, 1, v19
  v_add_u32 v20, 0, v16
  v_xor_b32 v20, v20, v21
  v_lshl_add_u32 v20, v20, 1, v22
  v_lshlrev_b32 v20, 4, v20
  v_lshl_add_u32 v20, v16, 13, v20
  v_add_u32 v4, 0, v20
  v_add_u32 v20, 0, v16
  v_xor_b32 v20, v20, v21
  v_lshl_add_u32 v20, v20, 1, v22
  v_lshlrev_b32 v20, 4, v20
  v_lshl_add_u32 v20, v16, 13, v20
  v_add_u32 v5, 31744, v20
  v_add_u32 v20, 4, v16
  v_xor_b32 v20, v20, v21
  v_lshl_add_u32 v20, v20, 1, v22
  v_lshlrev_b32 v20, 4, v20
  v_lshl_add_u32 v20, v16, 13, v20
  v_add_u32 v6, 63488, v20
  v_add_u32 v20, 4, v16
  v_xor_b32 v20, v20, v21
  v_lshl_add_u32 v20, v20, 1, v22
  v_lshlrev_b32 v20, 4, v20
  v_lshl_add_u32 v20, v16, 13, v20
  v_add_u32 v7, 95232, v20
  v_mul_u32_u24 v23, 1152, v17
  v_add_u32 v20, 0, v16
  v_xor_b32 v20, v20, v18
  v_lshlrev_b32 v20, 4, v20
  v_lshl_add_u32 v22, v17, 10, v20
  v_add_u32 v8, 0, v22
  v_add_u32 v20, v20, v23
  v_add_u32 v12, 0, v20
  v_add_u32 v20, 4, v16
  v_xor_b32 v20, v20, v18
  v_lshlrev_b32 v20, 4, v20
  v_lshl_add_u32 v22, v17, 10, v20
  v_add_u32 v9, 7168, v22
  v_add_u32 v20, v20, v23
  v_add_u32 v13, 8192, v20
  v_add_u32 v20, 0, v16
  v_xor_b32 v20, v20, v18
  v_lshlrev_b32 v20, 4, v20
  v_lshl_add_u32 v22, v17, 10, v20
  v_add_u32 v10, 14336, v22
  v_add_u32 v20, v20, v23
  v_add_u32 v14, 71680, v20
  v_add_u32 v20, 4, v16
  v_xor_b32 v20, v20, v18
  v_lshlrev_b32 v20, 4, v20
  v_lshl_add_u32 v22, v17, 10, v20
  v_add_u32 v11, 21504, v22
  v_add_u32 v20, v20, v23
  v_add_u32 v15, 79872, v20
  s_waitcnt lgkmcnt(0)
  s_mov_b32 s4, s78
  s_and_b32 s5, s79, 0xffff
  s_mov_b32 s6, 2097152
  s_mov_b32 s7, 0x20000
  s_mov_b32 s8, s82
  s_and_b32 s9, s83, 0xffff
  s_mov_b32 s10, 4194304
  s_mov_b32 s11, 0x20000
  s_lshl_b32 s30, s26, 18
  s_lshl_b32 s27, s24, 16
  s_add_u32 s30, s30, s27
  s_lshl_b32 s32, s24, 17
  s_lshl_b32 s27, s25, 8
  s_add_u32 s32, s32, s27
  s_lshl_b32 s33, s24, 13
  s_add_u32 s33, s33, 65536
  s_lshl_b32 s37, s24, 12
  s_add_u32 s38, s37, 0x10000
  s_add_u32 m0, s37, 49152
  s_add_u32 s34, s32, 0
  buffer_load_dwordx4 v4, s[8:11], s34 offen offset:0 lds
  buffer_load_dwordx4 v5, s[8:11], s34 offen offset:1024 lds
  buffer_load_dwordx4 v6, s[8:11], s34 offen offset:2048 lds
  buffer_load_dwordx4 v7, s[8:11], s34 offen offset:3072 lds
  s_add_u32 m0, s33, 0
  s_add_u32 s35, s30, 0
  buffer_load_dwordx4 v8, s[4:7], s35 offen offset:0 lds
  buffer_load_dwordx4 v9, s[4:7], s35 offen offset:1024 lds
  buffer_load_dwordx4 v10, s[4:7], s35 offen offset:2048 lds
  buffer_load_dwordx4 v11, s[4:7], s35 offen offset:3072 lds
  s_add_u32 m0, s33, 4096
  s_add_u32 s35, s30, 32768
  buffer_load_dwordx4 v8, s[4:7], s35 offen offset:0 lds
  buffer_load_dwordx4 v9, s[4:7], s35 offen offset:1024 lds
  buffer_load_dwordx4 v10, s[4:7], s35 offen offset:2048 lds
  buffer_load_dwordx4 v11, s[4:7], s35 offen offset:3072 lds
  s_mov_b32 s20, s94
  s_and_b32 s21, s95, 0xffff
  s_mov_b32 s22, 88080384
  s_mov_b32 s23, 0x20000
  s_lshl_b32 s27, s26, 2
  s_and_b32 s28, s25, 3
  s_add_u32 s27, s27, s28
  s_lshl_b32 s27, s27, 2
  s_add_u32 s27, s27, s24
  s_lshl_b32 s27, s27, 10
  s_and_b32 s28, s25, 28
  s_lshl_b32 s28, s28, 5
  s_add_u32 s27, s27, s28
  s_add_u32 s27, s27, 66453504
  v_and_b32 v77, 31, v0
  v_lshl_add_u32 v77, v77, 2, s27
  v_mov_b32 v76, 0
  s_lshr_b32 s27, s25, 2
  s_lshl_b32 s27, s27, 3
  s_add_u32 s27, s27, s26
  s_lshl_b32 s27, s27, 2
  s_add_u32 s27, s27, s24
  s_lshl_b32 s31, s27, 7
  s_add_u32 s31, s31, 66125824
  s_and_b32 s27, s25, 3
  s_lshl_b32 s27, s27, 2
  s_add_u32 s27, s27, s31
  v_writelane_b32 v77, s27, 60
  s_lshl_b32 s47, s25, 7
  s_lshl_b32 s27, s26, 2
  s_add_u32 s47, s47, s27
  s_add_u32 s47, s47, 66191360
  s_and_b32 s27, s24, 1
  s_lshl_b32 s27, s27, 12
  s_add_u32 s27, s27, s47
  v_writelane_b32 v77, s27, 61
  s_cmp_eq_u32 s24, 0
  s_cselect_b32 s39, s47, 0x7f000000
  s_mov_b32 s12, s64
  s_and_b32 s13, s65, 0xffff
  s_mov_b32 s14, 2359296
  s_mov_b32 s15, 0x20000
  s_mov_b32 s16, s84
  s_and_b32 s17, s85, 0xffff
  s_mov_b32 s18, 4194304
  s_mov_b32 s19, 0x20000
  s_mov_b32 s52, s66
  s_and_b32 s53, s67, 0xffff
  s_mov_b32 s54, 2359296
  s_mov_b32 s55, 0x20000
  s_mov_b32 s56, s68
  s_and_b32 s57, s69, 0xffff
  s_mov_b32 s58, 2359296
  s_mov_b32 s59, 0x20000
  s_mov_b32 s60, s70
  s_and_b32 s61, s71, 0xffff
  s_mov_b32 s62, 4608
  s_mov_b32 s63, 0x20000
  v_xor_b32 v20, v21, v16
  v_lshlrev_b32 v20, 4, v20
  v_lshl_add_u32 v20, v19, 7, v20
  v_add_u32 v240, s33, v20
  v_xor_b32 v241, 64, v240
  v_add_u32 v242, 0x10000, v240
  v_add_u32 v243, 0x10000, v241
  v_lshrrev_b32 v20, 2, v19
  v_and_b32 v21, 1, v16
  v_lshl_add_u32 v21, v21, 2, v20
  v_lshl_add_u32 v20, v16, 3, v20
  v_lshlrev_b32 v20, 8, v20
  v_and_b32 v22, 3, v0
  v_lshl_add_u32 v20, v22, 3, v20
  v_xor_b32 v22, 0, v21
  v_lshl_add_u32 v244, v22, 5, v20
  v_xor_b32 v22, 1, v21
  v_lshl_add_u32 v245, v22, 5, v20
  v_xor_b32 v22, 2, v21
  v_lshl_add_u32 v246, v22, 5, v20
  v_xor_b32 v22, 3, v21
  v_lshl_add_u32 v247, v22, 5, v20
  v_xor_b32 v22, 4, v21
  v_lshl_add_u32 v248, v22, 5, v20
  v_xor_b32 v22, 5, v21
  v_lshl_add_u32 v249, v22, 5, v20
  v_xor_b32 v22, 6, v21
  v_lshl_add_u32 v250, v22, 5, v20
  v_xor_b32 v22, 7, v21
  v_lshl_add_u32 v251, v22, 5, v20
  s_lshl_b32 s27, s24, 4
  v_add_u32 v254, s27, v19
  v_lshlrev_b32 v20, 2, v16
  v_sub_u32 v254, v254, v20
  s_lshl_b32 s27, s26, 7
  s_lshl_b32 s28, s24, 4
  s_add_u32 s48, s27, s28
  s_mul_i32 s48, s48, 1152
  s_sub_u32 s49, 1920, s27
  s_add_u32 s49, s49, s28
  s_mul_i32 s49, s49, 1152
  s_lshl_b32 s50, s25, 19
  s_lshl_b32 s27, s26, 16
  s_add_u32 s50, s50, s27
  s_lshl_b32 s27, s24, 14
  s_add_u32 s50, s50, s27
  s_add_u32 s51, s50, 16777216
  s_lshl_b32 s43, s25, 19
  s_and_b32 s27, s24, 1
  s_lshl_b32 s27, s27, 12
  s_add_u32 s43, s43, s27
  s_cmp_ge_u32 s24, 2
  s_cselect_b32 s27, 16752640, 0
  s_add_u32 s43, s43, s27
  s_add_u32 s43, s43, 49152
  s_lshl_b32 s42, s25, 19
  s_add_u32 s42, s42, s37
  s_mov_b32 s40, 0
  s_mov_b32 s41, 0x53800000
  s_and_b32 s27, s2, 7
  s_mul_i32 s27, s27, 72
  s_lshr_b32 s28, s2, 3
  s_lshl_b32 s28, s28, 1
  s_add_u32 s27, s27, s28
  s_lshr_b32 s28, s24, 1
  s_add_u32 s3, s27, s28
  s_lshl_b32 s27, s27, 1
  s_load_dword s0, s[74:75], s27
  s_lshr_b32 s27, s3, 1
  s_lshl_b32 s27, s27, 7
  s_lshl_b32 s28, s24, 2
  s_add_u32 s27, s27, s28
  s_add_u32 s27, s27, 66322432
  v_writelane_b32 v77, s27, 62
  s_add_u32 s28, s27, 512
  s_cmp_eq_u32 s26, 7
  s_cselect_b32 s27, s28, s27
  v_writelane_b32 v77, s27, 63
  s_and_b32 s44, s2, 7
  s_lshr_b32 s45, s2, 3
  s_lshl_b32 s45, s45, 2
  s_add_u32 s45, s45, s24
  s_mul_i32 s46, s44, 144
  s_mul_i32 s47, s45, 18432
  s_add_u32 s46, s46, s47
  v_lshl_add_u32 v35, v0, 2, s46
  v_cmp_gt_u32 vcc, 36, v0
  v_mov_b32 v252, 0x7f000000
  s_nop 0
  v_cndmask_b32 v35, v252, v35, vcc
  s_lshl_b32 s46, s24, 5
  s_sub_u32 s46, 131168, s46
  v_mul_u32_u24 v253, 288, v0
  v_add_u32 v253, s46, v253
  s_mul_i32 s47, s44, 576
  v_lshl_add_u32 v252, v0, 4, s47
  v_mov_b32 v78, 1
  v_lshlrev_b32 v79, 24, v0
  v_min_u32 v102, 31, v0
  v_and_b32 v103, 1, v102
  v_mul_u32_u24 v103, 3968, v103
  v_lshlrev_b32 v102, 12, v102
  v_sub_u32 v102, v102, v103
  v_mov_b32 v3, v102
  s_lshl_b32 s64, s2, 2
  s_add_u32 s64, s64, s24
  s_mul_i32 s65, s64, 2048
  v_min_u32 v102, 15, v0
  v_lshlrev_b32 v102, 7, v102
  buffer_load_dword v255, v102, s[4:7], s65 offen
  s_lshl_b32 s64, s26, 2
  s_add_u32 s64, s64, s24
  s_mul_i32 s65, s64, 131072
  s_lshl_b32 s64, s25, 8
  s_add_u32 s65, s65, s64
  v_min_u32 v102, 31, v0
  v_and_b32 v103, 1, v102
  v_mul_u32_u24 v103, 3968, v103
  v_lshlrev_b32 v102, 12, v102
  v_sub_u32 v102, v102, v103
  buffer_load_dword v255, v102, s[8:11], s65 offen
  s_lshl_b32 s64, s2, 2
  s_add_u32 s64, s64, s24
  s_mul_i32 s65, s64, 2304
  v_min_u32 v102, 17, v0
  v_lshlrev_b32 v102, 7, v102
  buffer_load_dword v255, v102, s[52:55], s65 offen
  buffer_load_dword v255, v102, s[56:59], s65 offen
  s_waitcnt lgkmcnt(0)
  s_waitcnt vmcnt(16)
  s_mov_b64 exec, 0
  s_cmp_eq_u32 s24, 0
  s_cbranch_scc1 K_hA0_0
  s_cmp_eq_u32 s24, 1
  s_cbranch_scc1 K_hA1_0
  s_cmp_eq_u32 s24, 2
  s_cbranch_scc1 K_hA2_0
  s_branch K_hA3_0
.p2align 12
K_hAr:
  s_mov_b64 exec, -1
  s_add_u32 m0, s37, 0
  s_add_u32 s34, s32, 524288
  buffer_load_dwordx4 v4, s[8:11], s34 offen offset:0 lds
  buffer_load_dwordx4 v5, s[8:11], s34 offen offset:1024 lds
  buffer_load_dwordx4 v6, s[8:11], s34 offen offset:2048 lds
  buffer_load_dwordx4 v7, s[8:11], s34 offen offset:3072 lds
  s_add_u32 m0, s33, 32768
  s_add_u32 s35, s30, 128
  buffer_load_dwordx4 v8, s[4:7], s35 offen offset:0 lds
  buffer_load_dwordx4 v9, s[4:7], s35 offen offset:1024 lds
  buffer_load_dwordx4 v10, s[4:7], s35 offen offset:2048 lds
  buffer_load_dwordx4 v11, s[4:7], s35 offen offset:3072 lds
  s_add_u32 m0, s33, 36864
  s_add_u32 s35, s30, 32896
  buffer_load_dwordx4 v8, s[4:7], s35 offen offset:0 lds
  buffer_load_dwordx4 v9, s[4:7], s35 offen offset:1024 lds
  buffer_load_dwordx4 v10, s[4:7], s35 offen offset:2048 lds
  buffer_load_dwordx4 v11, s[4:7], s35 offen offset:3072 lds
  s_waitcnt vmcnt(16)
  s_barrier
  ds_read_b128 a[0:3], v240 offset:0
  ds_read_b128 a[4:7], v240 offset:2048
  ds_read_b128 a[8:11], v240 offset:4096
  ds_read_b128 a[12:15], v240 offset:6144
  ds_read_b128 a[16:19], v241 offset:0
  ds_read_b128 a[20:23], v241 offset:2048
  ds_read_b128 a[24:27], v241 offset:4096
  ds_read_b128 a[28:31], v241 offset:6144
  ds_read_b64_tr_b16 v[208:209], v244 offset:49152
  ds_read_b64_tr_b16 v[210:211], v244 offset:50176
  ds_read_b64_tr_b16 v[212:213], v244 offset:57344
  ds_read_b64_tr_b16 v[214:215], v244 offset:58368
  ds_read_b64_tr_b16 v[216:217], v245 offset:49152
  ds_read_b64_tr_b16 v[218:219], v245 offset:50176
  ds_read_b64_tr_b16 v[220:221], v245 offset:57344
  ds_read_b64_tr_b16 v[222:223], v245 offset:58368
  ds_read_b64_tr_b16 v[224:225], v246 offset:49152
  ds_read_b64_tr_b16 v[226:227], v246 offset:50176
  ds_read_b64_tr_b16 v[228:229], v246 offset:57344
  ds_read_b64_tr_b16 v[230:231], v246 offset:58368
  ds_read_b64_tr_b16 v[232:233], v247 offset:49152
  ds_read_b64_tr_b16 v[234:235], v247 offset:50176
  ds_read_b64_tr_b16 v[236:237], v247 offset:57344
  ds_read_b64_tr_b16 v[238:239], v247 offset:58368
  s_waitcnt lgkmcnt(12)
  v_mfma_f32_16x16x32_bf16 v[80:83], v[208:211], a[0:3], 0
  v_mfma_f32_16x16x32_bf16 v[80:83], v[212:215], a[16:19], v[80:83]
  s_add_u32 m0, s37, 16384
  v_mfma_f32_16x16x32_bf16 v[84:87], v[212:215], a[20:23], 0
  s_add_u32 s34, s32, 1048576
  v_mfma_f32_16x16x32_bf16 v[84:87], v[208:211], a[4:7], v[84:87]
  buffer_load_dwordx4 v4, s[8:11], s34 offen offset:0 lds
  v_mfma_f32_16x16x32_bf16 v[88:91], v[208:211], a[8:11], 0
  buffer_load_dwordx4 v5, s[8:11], s34 offen offset:1024 lds
  v_mfma_f32_16x16x32_bf16 v[88:91], v[212:215], a[24:27], v[88:91]
  buffer_load_dwordx4 v6, s[8:11], s34 offen offset:2048 lds
  v_mfma_f32_16x16x32_bf16 v[92:95], v[212:215], a[28:31], 0
  buffer_load_dwordx4 v7, s[8:11], s34 offen offset:3072 lds
  v_mfma_f32_16x16x32_bf16 v[92:95], v[208:211], a[12:15], v[92:95]
  ds_read_b64_tr_b16 v[208:209], v248 offset:49152
  s_waitcnt lgkmcnt(9)
  v_mfma_f32_16x16x32_bf16 v[108:111], v[216:219], a[12:15], 0
  s_add_u32 m0, s33, 65536
  v_mfma_f32_16x16x32_bf16 v[108:111], v[220:223], a[28:31], v[108:111]
  ds_read_b64_tr_b16 v[210:211], v248 offset:50176
  s_add_u32 s35, s30, 256
  v_mfma_f32_16x16x32_bf16 v[104:107], v[220:223], a[24:27], 0
  buffer_load_dwordx4 v8, s[4:7], s35 offen offset:0 lds
  v_mfma_f32_16x16x32_bf16 v[104:107], v[216:219], a[8:11], v[104:107]
  ds_read_b64_tr_b16 v[212:213], v248 offset:57344
  buffer_load_dwordx4 v9, s[4:7], s35 offen offset:1024 lds
  v_mfma_f32_16x16x32_bf16 v[100:103], v[216:219], a[4:7], 0
  buffer_load_dwordx4 v10, s[4:7], s35 offen offset:2048 lds
  v_mfma_f32_16x16x32_bf16 v[100:103], v[220:223], a[20:23], v[100:103]
  ds_read_b64_tr_b16 v[214:215], v248 offset:58368
  buffer_load_dwordx4 v11, s[4:7], s35 offen offset:3072 lds
  v_mfma_f32_16x16x32_bf16 v[96:99], v[220:223], a[16:19], 0
  v_mfma_f32_16x16x32_bf16 v[96:99], v[216:219], a[0:3], v[96:99]
  ds_read_b64_tr_b16 v[216:217], v249 offset:49152
  s_add_u32 m0, s33, 69632
  s_waitcnt lgkmcnt(9)
  v_mfma_f32_16x16x32_bf16 v[112:115], v[224:227], a[0:3], 0
  v_mfma_f32_16x16x32_bf16 v[112:115], v[228:231], a[16:19], v[112:115]
  ds_read_b64_tr_b16 v[218:219], v249 offset:50176
  s_add_u32 s35, s30, 33024
  v_mfma_f32_16x16x32_bf16 v[116:119], v[228:231], a[20:23], 0
  v_mfma_f32_16x16x32_bf16 v[116:119], v[224:227], a[4:7], v[116:119]
  ds_read_b64_tr_b16 v[220:221], v249 offset:57344
  v_mfma_f32_16x16x32_bf16 v[120:123], v[224:227], a[8:11], 0
  buffer_load_dwordx4 v8, s[4:7], s35 offen offset:0 lds
  v_mfma_f32_16x16x32_bf16 v[120:123], v[228:231], a[24:27], v[120:123]
  ds_read_b64_tr_b16 v[222:223], v249 offset:58368
  v_mfma_f32_16x16x32_bf16 v[124:127], v[228:231], a[28:31], 0
  buffer_load_dwordx4 v9, s[4:7], s35 offen offset:1024 lds
  v_mfma_f32_16x16x32_bf16 v[124:127], v[224:227], a[12:15], v[124:127]
  ds_read_b64_tr_b16 v[224:225], v250 offset:49152
  s_waitcnt lgkmcnt(9)
  v_mfma_f32_16x16x32_bf16 v[140:143], v[232:235], a[12:15], 0
  v_mfma_f32_16x16x32_bf16 v[140:143], v[236:239], a[28:31], v[140:143]
  ds_read_b64_tr_b16 v[226:227], v250 offset:50176
  buffer_load_dwordx4 v10, s[4:7], s35 offen offset:2048 lds
  v_mfma_f32_16x16x32_bf16 v[136:139], v[236:239], a[24:27], 0
  v_mfma_f32_16x16x32_bf16 v[136:139], v[232:235], a[8:11], v[136:139]
  ds_read_b64_tr_b16 v[228:229], v250 offset:57344
  buffer_load_dwordx4 v11, s[4:7], s35 offen offset:3072 lds
  v_mfma_f32_16x16x32_bf16 v[132:135], v[232:235], a[4:7], 0
  v_mfma_f32_16x16x32_bf16 v[132:135], v[236:239], a[20:23], v[132:135]
  ds_read_b64_tr_b16 v[230:231], v250 offset:58368
  v_mfma_f32_16x16x32_bf16 v[128:131], v[236:239], a[16:19], 0
  buffer_store_dword v76, v77, s[20:23], 0 offen sc1
  v_mfma_f32_16x16x32_bf16 v[128:131], v[232:235], a[0:3], v[128:131]
  ds_read_b64_tr_b16 v[232:233], v251 offset:49152
  s_waitcnt lgkmcnt(9)
  v_mfma_f32_16x16x32_bf16 v[144:147], v[208:211], a[0:3], 0
  s_waitcnt vmcnt(13)
  s_barrier
  v_mfma_f32_16x16x32_bf16 v[144:147], v[212:215], a[16:19], v[144:147]
  ds_read_b64_tr_b16 v[234:235], v251 offset:50176
  s_add_u32 m0, s37, 32768
  v_mfma_f32_16x16x32_bf16 v[148:151], v[212:215], a[20:23], 0
  ds_read_b128 a[32:35], v240 offset:32768
  v_mfma_f32_16x16x32_bf16 v[148:151], v[208:211], a[4:7], v[148:151]
  ds_read_b64_tr_b16 v[236:237], v251 offset:57344
  v_mfma_f32_16x16x32_bf16 v[152:155], v[208:211], a[8:11], 0
  s_add_u32 s34, s32, 1572864
  ds_read_b128 a[36:39], v240 offset:34816
  v_mfma_f32_16x16x32_bf16 v[152:155], v[212:215], a[24:27], v[152:155]
  ds_read_b64_tr_b16 v[238:239], v251 offset:58368
  v_mfma_f32_16x16x32_bf16 v[156:159], v[212:215], a[28:31], 0
  v_mfma_f32_16x16x32_bf16 v[156:159], v[208:211], a[12:15], v[156:159]
  ds_read_b64_tr_b16 v[208:209], v244 offset:0
  ds_read_b128 a[40:43], v240 offset:36864
  s_waitcnt lgkmcnt(12)
K_hA0_0:
  s_cbranch_execz K_hA0_1
  v_mfma_f32_16x16x32_bf16 v[172:175], v[216:219], a[12:15], 0
  buffer_load_dwordx4 v4, s[8:11], s34 offen offset:0 lds
  v_mfma_f32_16x16x32_bf16 v[172:175], v[220:223], a[28:31], v[172:175]
  ds_read_b64_tr_b16 v[210:211], v244 offset:1024
  v_mfma_f32_16x16x32_bf16 v[168:171], v[220:223], a[24:27], 0
  ds_read_b128 a[44:47], v240 offset:38912
  v_mfma_f32_16x16x32_bf16 v[168:171], v[216:219], a[8:11], v[168:171]
  ds_read_b64_tr_b16 v[212:213], v244 offset:8192
  buffer_load_dwordx4 v5, s[8:11], s34 offen offset:1024 lds
  v_mfma_f32_16x16x32_bf16 v[164:167], v[216:219], a[4:7], 0
  v_mfma_f32_16x16x32_bf16 v[164:167], v[220:223], a[20:23], v[164:167]
  ds_read_b64_tr_b16 v[214:215], v244 offset:9216
  ds_read_b128 a[48:51], v241 offset:32768
  v_mfma_f32_16x16x32_bf16 v[160:163], v[220:223], a[16:19], 0
  v_mfma_f32_16x16x32_bf16 v[160:163], v[216:219], a[0:3], v[160:163]
  ds_read_b64_tr_b16 v[216:217], v245 offset:0
  buffer_load_dwordx4 v6, s[8:11], s34 offen offset:2048 lds
  s_waitcnt lgkmcnt(14)
  v_mfma_f32_16x16x32_bf16 v[176:179], v[224:227], a[0:3], 0
  ds_read_b128 a[52:55], v241 offset:34816
  v_mfma_f32_16x16x32_bf16 v[176:179], v[228:231], a[16:19], v[176:179]
  ds_read_b64_tr_b16 v[218:219], v245 offset:1024
  v_mfma_f32_16x16x32_bf16 v[180:183], v[228:231], a[20:23], 0
  buffer_load_dwordx4 v7, s[8:11], s34 offen offset:3072 lds
  v_mfma_f32_16x16x32_bf16 v[180:183], v[224:227], a[4:7], v[180:183]
  ds_read_b64_tr_b16 v[220:221], v245 offset:8192
  ds_read_b128 a[56:59], v241 offset:36864
  v_mfma_f32_16x16x32_bf16 v[184:187], v[224:227], a[8:11], 0
  v_mfma_f32_16x16x32_bf16 v[184:187], v[228:231], a[24:27], v[184:187]
  ds_read_b64_tr_b16 v[222:223], v245 offset:9216
  v_mfma_f32_16x16x32_bf16 v[188:191], v[228:231], a[28:31], 0
  s_add_u32 m0, s33, 0
  ds_read_b128 a[60:63], v241 offset:38912
  v_mfma_f32_16x16x32_bf16 v[188:191], v[224:227], a[12:15], v[188:191]
  ds_read_b64_tr_b16 v[224:225], v246 offset:0
  s_waitcnt lgkmcnt(15)
  v_mfma_f32_16x16x32_bf16 v[204:207], v[232:235], a[12:15], 0
  v_mfma_f32_16x16x32_bf16 v[204:207], v[236:239], a[28:31], v[204:207]
  ds_read_b64_tr_b16 v[226:227], v246 offset:1024
  s_add_u32 s35, s30, 384
  v_mfma_f32_16x16x32_bf16 v[200:203], v[236:239], a[24:27], 0
  v_mfma_f32_16x16x32_bf16 v[200:203], v[232:235], a[8:11], v[200:203]
  ds_read_b64_tr_b16 v[228:229], v246 offset:8192
  v_mfma_f32_16x16x32_bf16 v[196:199], v[232:235], a[4:7], 0
  v_mfma_f32_16x16x32_bf16 v[196:199], v[236:239], a[20:23], v[196:199]
  ds_read_b64_tr_b16 v[230:231], v246 offset:9216
  buffer_load_dwordx4 v8, s[4:7], s35 offen offset:0 lds
  v_mfma_f32_16x16x32_bf16 v[192:195], v[236:239], a[16:19], 0
  v_mfma_f32_16x16x32_bf16 v[192:195], v[232:235], a[0:3], v[192:195]
  ds_read_b64_tr_b16 v[232:233], v247 offset:0
  s_waitcnt lgkmcnt(5)
  v_mfma_f32_16x16x32_bf16 v[80:83], v[208:211], a[32:35], v[80:83]
  buffer_load_dwordx4 v9, s[4:7], s35 offen offset:1024 lds
  v_mfma_f32_16x16x32_bf16 v[80:83], v[212:215], a[48:51], v[80:83]
  ds_read_b64_tr_b16 v[234:235], v247 offset:1024
  v_mfma_f32_16x16x32_bf16 v[84:87], v[212:215], a[52:55], v[84:87]
  buffer_load_dwordx4 v[60:63], v252, s[60:63], 0 offen
  v_mfma_f32_16x16x32_bf16 v[84:87], v[208:211], a[36:39], v[84:87]
  ds_read_b64_tr_b16 v[236:237], v247 offset:8192
  v_subrev_u32 v252, 3456, v35
  v_mfma_f32_16x16x32_bf16 v[88:91], v[208:211], a[40:43], v[88:91]
  buffer_load_dwordx4 v10, s[4:7], s35 offen offset:2048 lds
  buffer_load_dword v16, v252, s[52:55], 0 offen
  v_mfma_f32_16x16x32_bf16 v[88:91], v[212:215], a[56:59], v[88:91]
  ds_read_b64_tr_b16 v[238:239], v247 offset:9216
  v_subrev_u32 v252, 2304, v35
  v_mfma_f32_16x16x32_bf16 v[92:95], v[212:215], a[60:63], v[92:95]
  v_mfma_f32_16x16x32_bf16 v[92:95], v[208:211], a[44:47], v[92:95]
  ds_read_b64_tr_b16 v[208:209], v248 offset:0
  buffer_load_dwordx4 v11, s[4:7], s35 offen offset:3072 lds
  v_mfma_f32_16x16x32_bf16 v[108:111], v[216:219], a[44:47], v[108:111]
  buffer_load_dword v17, v252, s[52:55], 0 offen
  v_subrev_u32 v252, 1152, v35
  v_mfma_f32_16x16x32_bf16 v[108:111], v[220:223], a[60:63], v[108:111]
  ds_read_b64_tr_b16 v[210:211], v248 offset:1024
  buffer_load_dword v18, v252, s[52:55], 0 offen
  v_mfma_f32_16x16x32_bf16 v[104:107], v[220:223], a[56:59], v[104:107]
  v_mfma_f32_16x16x32_bf16 v[104:107], v[216:219], a[40:43], v[104:107]
  ds_read_b64_tr_b16 v[212:213], v248 offset:8192
  buffer_load_dword v19, v35, s[52:55], 0 offen offset:0
  s_add_u32 m0, s33, 4096
  v_mfma_f32_16x16x32_bf16 v[100:103], v[216:219], a[36:39], v[100:103]
  buffer_load_dword v43, v35, s[56:59], 0 offen offset:0
  v_mfma_f32_16x16x32_bf16 v[100:103], v[220:223], a[52:55], v[100:103]
  ds_read_b64_tr_b16 v[214:215], v248 offset:9216
  buffer_load_dword v20, v35, s[52:55], 0 offen offset:1152
  v_mfma_f32_16x16x32_bf16 v[96:99], v[220:223], a[48:51], v[96:99]
  s_add_u32 s35, s30, 33152
  buffer_load_dword v51, v35, s[56:59], 0 offen offset:1152
  v_mfma_f32_16x16x32_bf16 v[96:99], v[216:219], a[32:35], v[96:99]
  ds_read_b64_tr_b16 v[216:217], v249 offset:0
  s_waitcnt lgkmcnt(9)
  v_mfma_f32_16x16x32_bf16 v[112:115], v[224:227], a[32:35], v[112:115]
  buffer_load_dword v21, v35, s[52:55], 0 offen offset:2304
  v_mfma_f32_16x16x32_bf16 v[112:115], v[228:231], a[48:51], v[112:115]
  ds_read_b64_tr_b16 v[218:219], v249 offset:1024
  buffer_load_dword v42, v35, s[56:59], 0 offen offset:2304
  v_mfma_f32_16x16x32_bf16 v[116:119], v[228:231], a[52:55], v[116:119]
  buffer_load_dwordx4 v8, s[4:7], s35 offen offset:0 lds
  v_add_u32 v35, 3456, v35
  v_mfma_f32_16x16x32_bf16 v[116:119], v[224:227], a[36:39], v[116:119]
  ds_read_b64_tr_b16 v[220:221], v249 offset:8192
  v_mfma_f32_16x16x32_bf16 v[120:123], v[224:227], a[40:43], v[120:123]
  buffer_load_dword v22, v35, s[52:55], 0 offen offset:0
  v_mfma_f32_16x16x32_bf16 v[120:123], v[228:231], a[56:59], v[120:123]
  ds_read_b64_tr_b16 v[222:223], v249 offset:9216
  buffer_load_dword v50, v35, s[56:59], 0 offen offset:0
  v_mfma_f32_16x16x32_bf16 v[124:127], v[228:231], a[60:63], v[124:127]
  buffer_load_dwordx4 v9, s[4:7], s35 offen offset:1024 lds
  buffer_load_dword v23, v35, s[52:55], 0 offen offset:1152
  v_mfma_f32_16x16x32_bf16 v[124:127], v[224:227], a[44:47], v[124:127]
  ds_read_b64_tr_b16 v[224:225], v250 offset:0
  s_waitcnt lgkmcnt(9)
  v_mfma_f32_16x16x32_bf16 v[140:143], v[232:235], a[44:47], v[140:143]
  buffer_load_dword v41, v35, s[56:59], 0 offen offset:1152
  v_mfma_f32_16x16x32_bf16 v[140:143], v[236:239], a[60:63], v[140:143]
  ds_read_b64_tr_b16 v[226:227], v250 offset:1024
  buffer_load_dwordx4 v10, s[4:7], s35 offen offset:2048 lds
  v_mfma_f32_16x16x32_bf16 v[136:139], v[236:239], a[56:59], v[136:139]
  buffer_load_dword v24, v35, s[52:55], 0 offen offset:2304
  buffer_load_dword v49, v35, s[56:59], 0 offen offset:2304
  v_mfma_f32_16x16x32_bf16 v[136:139], v[232:235], a[40:43], v[136:139]
  ds_read_b64_tr_b16 v[228:229], v250 offset:8192
  v_add_u32 v35, 3456, v35
  v_mfma_f32_16x16x32_bf16 v[132:135], v[232:235], a[36:39], v[132:135]
  v_mfma_f32_16x16x32_bf16 v[132:135], v[236:239], a[52:55], v[132:135]
  ds_read_b64_tr_b16 v[230:231], v250 offset:9216
  buffer_load_dwordx4 v11, s[4:7], s35 offen offset:3072 lds
  v_mfma_f32_16x16x32_bf16 v[128:131], v[236:239], a[48:51], v[128:131]
  buffer_load_dword v25, v35, s[52:55], 0 offen offset:0
  buffer_load_dword v40, v35, s[56:59], 0 offen offset:0
K_hA1_0:
  s_cbranch_execz K_hA1_1
  v_mfma_f32_16x16x32_bf16 v[128:131], v[232:235], a[32:35], v[128:131]
  ds_read_b64_tr_b16 v[232:233], v251 offset:0
  buffer_load_dword v26, v35, s[52:55], 0 offen offset:1152
  s_waitcnt lgkmcnt(9)
  v_mfma_f32_16x16x32_bf16 v[144:147], v[208:211], a[32:35], v[144:147]
  s_waitcnt vmcnt(32)
  s_barrier
  v_mfma_f32_16x16x32_bf16 v[144:147], v[212:215], a[48:51], v[144:147]
  ds_read_b64_tr_b16 v[234:235], v251 offset:1024
  buffer_load_dword v48, v35, s[56:59], 0 offen offset:1152
  s_add_u32 m0, s37, 49152
  v_mfma_f32_16x16x32_bf16 v[148:151], v[212:215], a[52:55], v[148:151]
  ds_read_b128 a[64:67], v242 offset:0
  buffer_load_dword v27, v35, s[52:55], 0 offen offset:2304
  v_mfma_f32_16x16x32_bf16 v[148:151], v[208:211], a[36:39], v[148:151]
  ds_read_b64_tr_b16 v[236:237], v251 offset:8192
  buffer_load_dword v39, v35, s[56:59], 0 offen offset:2304
  v_mfma_f32_16x16x32_bf16 v[152:155], v[208:211], a[40:43], v[152:155]
  s_add_u32 s34, s32, 2097152
  ds_read_b128 a[68:71], v242 offset:2048
  v_mfma_f32_16x16x32_bf16 v[152:155], v[212:215], a[56:59], v[152:155]
  ds_read_b64_tr_b16 v[238:239], v251 offset:9216
  v_add_u32 v35, 3456, v35
  v_mfma_f32_16x16x32_bf16 v[156:159], v[212:215], a[60:63], v[156:159]
  buffer_load_dword v28, v35, s[52:55], 0 offen offset:0
  v_mfma_f32_16x16x32_bf16 v[156:159], v[208:211], a[44:47], v[156:159]
  ds_read_b64_tr_b16 v[208:209], v244 offset:16384
  ds_read_b128 a[72:75], v242 offset:4096
  s_waitcnt lgkmcnt(12)
  v_mfma_f32_16x16x32_bf16 v[172:175], v[216:219], a[44:47], v[172:175]
  buffer_load_dwordx4 v4, s[8:11], s34 offen offset:0 lds
  buffer_load_dword v47, v35, s[56:59], 0 offen offset:0
  v_mfma_f32_16x16x32_bf16 v[172:175], v[220:223], a[60:63], v[172:175]
  ds_read_b64_tr_b16 v[210:211], v244 offset:17408
  buffer_load_dword v29, v35, s[52:55], 0 offen offset:1152
  v_mfma_f32_16x16x32_bf16 v[168:171], v[220:223], a[56:59], v[168:171]
  ds_read_b128 a[76:79], v242 offset:6144
  buffer_load_dword v38, v35, s[56:59], 0 offen offset:1152
  v_mfma_f32_16x16x32_bf16 v[168:171], v[216:219], a[40:43], v[168:171]
  ds_read_b64_tr_b16 v[212:213], v244 offset:24576
  buffer_load_dwordx4 v5, s[8:11], s34 offen offset:1024 lds
  v_mfma_f32_16x16x32_bf16 v[164:167], v[216:219], a[36:39], v[164:167]
  buffer_load_dword v30, v35, s[52:55], 0 offen offset:2304
  buffer_load_dword v46, v35, s[56:59], 0 offen offset:2304
  v_mfma_f32_16x16x32_bf16 v[164:167], v[220:223], a[52:55], v[164:167]
  ds_read_b64_tr_b16 v[214:215], v244 offset:25600
  ds_read_b128 a[80:83], v243 offset:0
  v_mfma_f32_16x16x32_bf16 v[160:163], v[220:223], a[48:51], v[160:163]
  v_add_u32 v35, 3456, v35
  v_mfma_f32_16x16x32_bf16 v[160:163], v[216:219], a[32:35], v[160:163]
  ds_read_b64_tr_b16 v[216:217], v245 offset:16384
  buffer_load_dwordx4 v6, s[8:11], s34 offen offset:2048 lds
  s_waitcnt lgkmcnt(14)
  v_mfma_f32_16x16x32_bf16 v[176:179], v[224:227], a[32:35], v[176:179]
  ds_read_b128 a[84:87], v243 offset:2048
  buffer_load_dword v31, v35, s[52:55], 0 offen offset:0
  v_mfma_f32_16x16x32_bf16 v[176:179], v[228:231], a[48:51], v[176:179]
  ds_read_b64_tr_b16 v[218:219], v245 offset:17408
  buffer_load_dword v37, v35, s[56:59], 0 offen offset:0
  v_mfma_f32_16x16x32_bf16 v[180:183], v[228:231], a[52:55], v[180:183]
  buffer_load_dwordx4 v7, s[8:11], s34 offen offset:3072 lds
  buffer_load_dword v32, v35, s[52:55], 0 offen offset:1152
  v_mfma_f32_16x16x32_bf16 v[180:183], v[224:227], a[36:39], v[180:183]
  ds_read_b64_tr_b16 v[220:221], v245 offset:24576
  ds_read_b128 a[88:91], v243 offset:4096
  v_mfma_f32_16x16x32_bf16 v[184:187], v[224:227], a[40:43], v[184:187]
  buffer_load_dword v45, v35, s[56:59], 0 offen offset:1152
  buffer_load_dword v33, v35, s[52:55], 0 offen offset:2304
  v_mfma_f32_16x16x32_bf16 v[184:187], v[228:231], a[56:59], v[184:187]
  ds_read_b64_tr_b16 v[222:223], v245 offset:25600
  buffer_load_dword v36, v35, s[56:59], 0 offen offset:2304
  v_mfma_f32_16x16x32_bf16 v[188:191], v[228:231], a[60:63], v[188:191]
  s_add_u32 m0, s33, 32768
  ds_read_b128 a[92:95], v243 offset:6144
  v_mfma_f32_16x16x32_bf16 v[188:191], v[224:227], a[44:47], v[188:191]
  ds_read_b64_tr_b16 v[224:225], v246 offset:16384
  s_waitcnt lgkmcnt(15)
  v_add_u32 v35, 3456, v35
  v_mfma_f32_16x16x32_bf16 v[204:207], v[232:235], a[44:47], v[204:207]
  buffer_load_dword v34, v35, s[52:55], 0 offen offset:0
  v_mfma_f32_16x16x32_bf16 v[204:207], v[236:239], a[60:63], v[204:207]
  ds_read_b64_tr_b16 v[226:227], v246 offset:17408
  buffer_load_dword v44, v35, s[56:59], 0 offen offset:0
  s_add_u32 s35, s30, 512
  v_mfma_f32_16x16x32_bf16 v[200:203], v[236:239], a[56:59], v[200:203]
  v_mfma_f32_16x16x32_bf16 v[200:203], v[232:235], a[40:43], v[200:203]
  ds_read_b64_tr_b16 v[228:229], v246 offset:24576
  s_mov_b32 s56, s92
  v_mfma_f32_16x16x32_bf16 v[196:199], v[232:235], a[36:39], v[196:199]
  s_and_b32 s57, s93, 0xffff
  v_mfma_f32_16x16x32_bf16 v[196:199], v[236:239], a[52:55], v[196:199]
  ds_read_b64_tr_b16 v[230:231], v246 offset:25600
  buffer_load_dwordx4 v8, s[4:7], s35 offen offset:0 lds
  s_mov_b32 s58, 256
  v_mfma_f32_16x16x32_bf16 v[192:195], v[236:239], a[48:51], v[192:195]
  v_mfma_f32_16x16x32_bf16 v[192:195], v[232:235], a[32:35], v[192:195]
  ds_read_b64_tr_b16 v[232:233], v247 offset:16384
  s_waitcnt lgkmcnt(5)
  v_mfma_f32_16x16x32_bf16 v[80:83], v[208:211], a[64:67], v[80:83]
  buffer_load_dwordx4 v9, s[4:7], s35 offen offset:1024 lds
  v_mfma_f32_16x16x32_bf16 v[80:83], v[212:215], a[80:83], v[80:83]
  ds_read_b64_tr_b16 v[234:235], v247 offset:17408
  v_mfma_f32_16x16x32_bf16 v[84:87], v[212:215], a[84:87], v[84:87]
  v_mfma_f32_16x16x32_bf16 v[84:87], v[208:211], a[68:71], v[84:87]
  ds_read_b64_tr_b16 v[236:237], v247 offset:24576
  v_mfma_f32_16x16x32_bf16 v[88:91], v[208:211], a[72:75], v[88:91]
  buffer_load_dwordx4 v10, s[4:7], s35 offen offset:2048 lds
  v_mfma_f32_16x16x32_bf16 v[88:91], v[212:215], a[88:91], v[88:91]
  ds_read_b64_tr_b16 v[238:239], v247 offset:25600
  v_mfma_f32_16x16x32_bf16 v[92:95], v[212:215], a[92:95], v[92:95]
  v_mfma_f32_16x16x32_bf16 v[92:95], v[208:211], a[76:79], v[92:95]
  ds_read_b64_tr_b16 v[208:209], v248 offset:16384
  buffer_load_dwordx4 v11, s[4:7], s35 offen offset:3072 lds
  v_mfma_f32_16x16x32_bf16 v[108:111], v[216:219], a[76:79], v[108:111]
  v_mfma_f32_16x16x32_bf16 v[108:111], v[220:223], a[92:95], v[108:111]
  ds_read_b64_tr_b16 v[210:211], v248 offset:17408
  v_mfma_f32_16x16x32_bf16 v[104:107], v[220:223], a[88:91], v[104:107]
  v_mfma_f32_16x16x32_bf16 v[104:107], v[216:219], a[72:75], v[104:107]
  ds_read_b64_tr_b16 v[212:213], v248 offset:24576
  s_add_u32 m0, s33, 36864
  v_mfma_f32_16x16x32_bf16 v[100:103], v[216:219], a[68:71], v[100:103]
  v_mfma_f32_16x16x32_bf16 v[100:103], v[220:223], a[84:87], v[100:103]
  ds_read_b64_tr_b16 v[214:215], v248 offset:25600
  v_mfma_f32_16x16x32_bf16 v[96:99], v[220:223], a[80:83], v[96:99]
  s_add_u32 s35, s30, 33280
  v_mfma_f32_16x16x32_bf16 v[96:99], v[216:219], a[64:67], v[96:99]
  ds_read_b64_tr_b16 v[216:217], v249 offset:16384
  s_waitcnt lgkmcnt(9)
  v_mfma_f32_16x16x32_bf16 v[112:115], v[224:227], a[64:67], v[112:115]
  v_mfma_f32_16x16x32_bf16 v[112:115], v[228:231], a[80:83], v[112:115]
  ds_read_b64_tr_b16 v[218:219], v249 offset:17408
  v_mfma_f32_16x16x32_bf16 v[116:119], v[228:231], a[84:87], v[116:119]
K_hA2_0:
  s_cbranch_execz K_hA2_1
  buffer_load_dwordx4 v8, s[4:7], s35 offen offset:0 lds
  v_mfma_f32_16x16x32_bf16 v[116:119], v[224:227], a[68:71], v[116:119]
  ds_read_b64_tr_b16 v[220:221], v249 offset:24576
  v_mfma_f32_16x16x32_bf16 v[120:123], v[224:227], a[72:75], v[120:123]
  v_mfma_f32_16x16x32_bf16 v[120:123], v[228:231], a[88:91], v[120:123]
  ds_read_b64_tr_b16 v[222:223], v249 offset:25600
  v_mfma_f32_16x16x32_bf16 v[124:127], v[228:231], a[92:95], v[124:127]
  buffer_load_dwordx4 v9, s[4:7], s35 offen offset:1024 lds
  v_mfma_f32_16x16x32_bf16 v[124:127], v[224:227], a[76:79], v[124:127]
  ds_read_b64_tr_b16 v[224:225], v250 offset:16384
  s_waitcnt lgkmcnt(9)
  v_mfma_f32_16x16x32_bf16 v[140:143], v[232:235], a[76:79], v[140:143]
  v_mfma_f32_16x16x32_bf16 v[140:143], v[236:239], a[92:95], v[140:143]
  ds_read_b64_tr_b16 v[226:227], v250 offset:17408
  buffer_load_dwordx4 v10, s[4:7], s35 offen offset:2048 lds
  v_mfma_f32_16x16x32_bf16 v[136:139], v[236:239], a[88:91], v[136:139]
  v_mfma_f32_16x16x32_bf16 v[136:139], v[232:235], a[72:75], v[136:139]
  ds_read_b64_tr_b16 v[228:229], v250 offset:24576
  v_mfma_f32_16x16x32_bf16 v[132:135], v[232:235], a[68:71], v[132:135]
  v_mfma_f32_16x16x32_bf16 v[132:135], v[236:239], a[84:87], v[132:135]
  ds_read_b64_tr_b16 v[230:231], v250 offset:25600
  buffer_load_dwordx4 v11, s[4:7], s35 offen offset:3072 lds
  v_mfma_f32_16x16x32_bf16 v[128:131], v[236:239], a[80:83], v[128:131]
  v_mfma_f32_16x16x32_bf16 v[128:131], v[232:235], a[64:67], v[128:131]
  ds_read_b64_tr_b16 v[232:233], v251 offset:16384
  s_waitcnt lgkmcnt(9)
  v_mfma_f32_16x16x32_bf16 v[144:147], v[208:211], a[64:67], v[144:147]
  s_waitcnt vmcnt(32)
  s_barrier
  v_mfma_f32_16x16x32_bf16 v[144:147], v[212:215], a[80:83], v[144:147]
  ds_read_b64_tr_b16 v[234:235], v251 offset:17408
  s_add_u32 m0, s37, 0
  v_mfma_f32_16x16x32_bf16 v[148:151], v[212:215], a[84:87], v[148:151]
  ds_read_b128 a[96:99], v240 offset:0
  s_waitcnt vmcnt(8)
  v_lshlrev_b32 v52, 16, v60
  v_mfma_f32_16x16x32_bf16 v[148:151], v[208:211], a[68:71], v[148:151]
  ds_read_b64_tr_b16 v[236:237], v251 offset:24576
  v_and_b32 v53, 0xffff0000, v60
  v_mfma_f32_16x16x32_bf16 v[152:155], v[208:211], a[72:75], v[152:155]
  ds_read_b128 a[100:103], v240 offset:2048
  s_add_u32 s34, s32, 2621440
  v_lshlrev_b32 v54, 16, v61
  v_mfma_f32_16x16x32_bf16 v[152:155], v[212:215], a[88:91], v[152:155]
  ds_read_b64_tr_b16 v[238:239], v251 offset:25600
  v_and_b32 v55, 0xffff0000, v61
  v_mfma_f32_16x16x32_bf16 v[156:159], v[212:215], a[92:95], v[156:159]
  v_lshlrev_b32 v56, 16, v62
  v_mfma_f32_16x16x32_bf16 v[156:159], v[208:211], a[76:79], v[156:159]
  ds_read_b64_tr_b16 v[208:209], v244 offset:32768
  ds_read_b128 a[104:107], v240 offset:4096
  s_waitcnt lgkmcnt(12)
  v_mfma_f32_16x16x32_bf16 v[172:175], v[216:219], a[76:79], v[172:175]
  buffer_load_dwordx4 v4, s[8:11], s34 offen offset:0 lds
  v_and_b32 v57, 0xffff0000, v62
  v_mfma_f32_16x16x32_bf16 v[172:175], v[220:223], a[92:95], v[172:175]
  ds_read_b64_tr_b16 v[210:211], v244 offset:33792
  v_lshlrev_b32 v58, 16, v63
  v_mfma_f32_16x16x32_bf16 v[168:171], v[220:223], a[88:91], v[168:171]
  ds_read_b128 a[108:111], v240 offset:6144
  v_and_b32 v59, 0xffff0000, v63
  v_mfma_f32_16x16x32_bf16 v[168:171], v[216:219], a[72:75], v[168:171]
  ds_read_b64_tr_b16 v[212:213], v244 offset:40960
  buffer_load_dwordx4 v5, s[8:11], s34 offen offset:1024 lds
  v_mfma_f32_16x16x32_bf16 v[164:167], v[216:219], a[68:71], v[164:167]
  v_lshlrev_b32 v64, 16, v16
  v_lshlrev_b32 v65, 16, v17
  v_mfma_f32_16x16x32_bf16 v[164:167], v[220:223], a[84:87], v[164:167]
  ds_read_b64_tr_b16 v[214:215], v244 offset:41984
  ds_read_b128 a[112:115], v241 offset:0
  v_mfma_f32_16x16x32_bf16 v[160:163], v[220:223], a[80:83], v[160:163]
  v_lshlrev_b32 v66, 16, v18
  v_and_b32 v69, 0xffff0000, v16
  v_mfma_f32_16x16x32_bf16 v[160:163], v[216:219], a[64:67], v[160:163]
  ds_read_b64_tr_b16 v[216:217], v245 offset:32768
  buffer_load_dwordx4 v6, s[8:11], s34 offen offset:2048 lds
  s_waitcnt lgkmcnt(14)
  v_mfma_f32_16x16x32_bf16 v[176:179], v[224:227], a[64:67], v[176:179]
  ds_read_b128 a[116:119], v241 offset:2048
  v_and_b32 v70, 0xffff0000, v17
  v_mfma_f32_16x16x32_bf16 v[176:179], v[228:231], a[80:83], v[176:179]
  ds_read_b64_tr_b16 v[218:219], v245 offset:33792
  v_and_b32 v71, 0xffff0000, v18
  v_mfma_f32_16x16x32_bf16 v[180:183], v[228:231], a[84:87], v[180:183]
  buffer_load_dwordx4 v7, s[8:11], s34 offen offset:3072 lds
  v_lshlrev_b32 v67, 16, v19
  v_mfma_f32_16x16x32_bf16 v[180:183], v[224:227], a[68:71], v[180:183]
  ds_read_b64_tr_b16 v[220:221], v245 offset:40960
  ds_read_b128 a[120:123], v241 offset:4096
  v_mfma_f32_16x16x32_bf16 v[184:187], v[224:227], a[72:75], v[184:187]
  v_lshlrev_b32 v68, 16, v20
  v_and_b32 v72, 0xffff0000, v19
  v_mfma_f32_16x16x32_bf16 v[184:187], v[228:231], a[88:91], v[184:187]
  ds_read_b64_tr_b16 v[222:223], v245 offset:41984
  v_and_b32 v73, 0xffff0000, v20
  v_mfma_f32_16x16x32_bf16 v[188:191], v[228:231], a[92:95], v[188:191]
  ds_read_b128 a[124:127], v241 offset:6144
  s_add_u32 m0, s33, 65536
  v_mul_f32 v74, v64, v55
  v_mfma_f32_16x16x32_bf16 v[188:191], v[224:227], a[76:79], v[188:191]
  ds_read_b64_tr_b16 v[224:225], v246 offset:32768
  s_waitcnt lgkmcnt(15)
  v_mul_f32 v75, v65, v55
  v_mfma_f32_16x16x32_bf16 v[204:207], v[232:235], a[76:79], v[204:207]
  v_mul_f32 v76, v69, v59
  v_mul_f32 v77, v70, v59
  v_mfma_f32_16x16x32_bf16 v[204:207], v[236:239], a[92:95], v[204:207]
  ds_read_b64_tr_b16 v[226:227], v246 offset:33792
  s_add_u32 s35, s30, 640
  v_fmac_f32 v74, v65, v54
  v_mfma_f32_16x16x32_bf16 v[200:203], v[236:239], a[88:91], v[200:203]
  v_fmac_f32 v75, v66, v54
  v_fmac_f32 v76, v70, v58
  v_mfma_f32_16x16x32_bf16 v[200:203], v[232:235], a[72:75], v[200:203]
  ds_read_b64_tr_b16 v[228:229], v246 offset:40960
  v_fmac_f32 v77, v71, v58
  v_mfma_f32_16x16x32_bf16 v[196:199], v[232:235], a[68:71], v[196:199]
  v_fmac_f32 v74, v66, v53
  v_fmac_f32 v75, v67, v53
  v_mfma_f32_16x16x32_bf16 v[196:199], v[236:239], a[84:87], v[196:199]
  ds_read_b64_tr_b16 v[230:231], v246 offset:41984
  buffer_load_dwordx4 v8, s[4:7], s35 offen offset:0 lds
  v_mfma_f32_16x16x32_bf16 v[192:195], v[236:239], a[80:83], v[192:195]
  v_fmac_f32 v76, v71, v57
  v_fmac_f32 v77, v72, v57
  v_mfma_f32_16x16x32_bf16 v[192:195], v[232:235], a[64:67], v[192:195]
  ds_read_b64_tr_b16 v[232:233], v247 offset:32768
  s_waitcnt lgkmcnt(5)
  v_fmac_f32 v74, v67, v52
  v_mfma_f32_16x16x32_bf16 v[80:83], v[208:211], a[96:99], v[80:83]
  buffer_load_dwordx4 v9, s[4:7], s35 offen offset:1024 lds
  v_fmac_f32 v75, v68, v52
  v_mfma_f32_16x16x32_bf16 v[80:83], v[212:215], a[112:115], v[80:83]
  ds_read_b64_tr_b16 v[234:235], v247 offset:33792
  v_fmac_f32 v76, v72, v56
  v_mfma_f32_16x16x32_bf16 v[84:87], v[212:215], a[116:119], v[84:87]
  v_fmac_f32 v77, v73, v56
  v_lshlrev_b32 v60, 16, v43
  v_mfma_f32_16x16x32_bf16 v[84:87], v[208:211], a[100:103], v[84:87]
  ds_read_b64_tr_b16 v[236:237], v247 offset:40960
  v_lshlrev_b32 v61, 16, v51
  v_mfma_f32_16x16x32_bf16 v[88:91], v[208:211], a[104:107], v[88:91]
  buffer_load_dwordx4 v10, s[4:7], s35 offen offset:2048 lds
  v_and_b32 v62, 0xffff0000, v43
  v_mfma_f32_16x16x32_bf16 v[88:91], v[212:215], a[120:123], v[88:91]
  ds_read_b64_tr_b16 v[238:239], v247 offset:41984
K_hA3_0:
  s_cbranch_execz K_hA3_1
  v_and_b32 v63, 0xffff0000, v51
  v_mfma_f32_16x16x32_bf16 v[92:95], v[212:215], a[124:127], v[92:95]
  v_mul_f32 v74, v74, v60
  v_mul_f32 v75, v75, v61
  v_mfma_f32_16x16x32_bf16 v[92:95], v[208:211], a[108:111], v[92:95]
  ds_read_b64_tr_b16 v[208:209], v248 offset:32768
  buffer_load_dwordx4 v11, s[4:7], s35 offen offset:3072 lds
  v_mfma_f32_16x16x32_bf16 v[108:111], v[216:219], a[108:111], v[108:111]
  v_mul_f32 v76, v76, v62
  v_mul_f32 v77, v77, v63
  v_mfma_f32_16x16x32_bf16 v[108:111], v[220:223], a[124:127], v[108:111]
  ds_read_b64_tr_b16 v[210:211], v248 offset:33792
  v_cvt_pk_bf16_f32 v43, v75, v74
  v_mfma_f32_16x16x32_bf16 v[104:107], v[220:223], a[120:123], v[104:107]
  v_cvt_pk_bf16_f32 v51, v77, v76
  v_lshlrev_b32 v64, 16, v21
  v_mfma_f32_16x16x32_bf16 v[104:107], v[216:219], a[104:107], v[104:107]
  ds_read_b64_tr_b16 v[212:213], v248 offset:40960
  s_add_u32 m0, s33, 69632
  v_lshlrev_b32 v65, 16, v22
  v_mfma_f32_16x16x32_bf16 v[100:103], v[216:219], a[100:103], v[100:103]
  v_and_b32 v69, 0xffff0000, v21
  v_and_b32 v70, 0xffff0000, v22
  v_mfma_f32_16x16x32_bf16 v[100:103], v[220:223], a[116:119], v[100:103]
  ds_read_b64_tr_b16 v[214:215], v248 offset:41984
  v_mul_f32 v74, v66, v55
  v_mfma_f32_16x16x32_bf16 v[96:99], v[220:223], a[112:115], v[96:99]
  s_add_u32 s35, s30, 33408
  v_mul_f32 v75, v67, v55
  v_mfma_f32_16x16x32_bf16 v[96:99], v[216:219], a[96:99], v[96:99]
  ds_read_b64_tr_b16 v[216:217], v249 offset:32768
  s_waitcnt lgkmcnt(9)
  v_mul_f32 v76, v71, v59
  v_mfma_f32_16x16x32_bf16 v[112:115], v[224:227], a[96:99], v[112:115]
  v_mul_f32 v77, v72, v59
  v_mfma_f32_16x16x32_bf16 v[112:115], v[228:231], a[112:115], v[112:115]
  ds_read_b64_tr_b16 v[218:219], v249 offset:33792
  v_fmac_f32 v74, v67, v54
  v_mfma_f32_16x16x32_bf16 v[116:119], v[228:231], a[116:119], v[116:119]
  buffer_load_dwordx4 v8, s[4:7], s35 offen offset:0 lds
  v_fmac_f32 v75, v68, v54
  v_mfma_f32_16x16x32_bf16 v[116:119], v[224:227], a[100:103], v[116:119]
  ds_read_b64_tr_b16 v[220:221], v249 offset:40960
  v_fmac_f32 v76, v72, v58
  v_mfma_f32_16x16x32_bf16 v[120:123], v[224:227], a[104:107], v[120:123]
  v_fmac_f32 v77, v73, v58
  v_fmac_f32 v74, v68, v53
  v_mfma_f32_16x16x32_bf16 v[120:123], v[228:231], a[120:123], v[120:123]
  ds_read_b64_tr_b16 v[222:223], v249 offset:41984
  v_fmac_f32 v75, v64, v53
  v_mfma_f32_16x16x32_bf16 v[124:127], v[228:231], a[124:127], v[124:127]
  buffer_load_dwordx4 v9, s[4:7], s35 offen offset:1024 lds
  v_fmac_f32 v76, v73, v57
  v_mfma_f32_16x16x32_bf16 v[124:127], v[224:227], a[108:111], v[124:127]
  ds_read_b64_tr_b16 v[224:225], v250 offset:32768
  s_waitcnt lgkmcnt(9)
  v_fmac_f32 v77, v69, v57
  v_mfma_f32_16x16x32_bf16 v[140:143], v[232:235], a[108:111], v[140:143]
  v_fmac_f32 v74, v64, v52
  v_mfma_f32_16x16x32_bf16 v[140:143], v[236:239], a[124:127], v[140:143]
  ds_read_b64_tr_b16 v[226:227], v250 offset:33792
  buffer_load_dwordx4 v10, s[4:7], s35 offen offset:2048 lds
  v_mfma_f32_16x16x32_bf16 v[136:139], v[236:239], a[120:123], v[136:139]
  v_fmac_f32 v75, v65, v52
  v_fmac_f32 v76, v69, v56
  v_mfma_f32_16x16x32_bf16 v[136:139], v[232:235], a[104:107], v[136:139]
  ds_read_b64_tr_b16 v[228:229], v250 offset:40960
  v_fmac_f32 v77, v70, v56
  v_mfma_f32_16x16x32_bf16 v[132:135], v[232:235], a[100:103], v[132:135]
  v_lshlrev_b32 v60, 16, v42
  v_lshlrev_b32 v61, 16, v50
  v_mfma_f32_16x16x32_bf16 v[132:135], v[236:239], a[116:119], v[132:135]
  ds_read_b64_tr_b16 v[230:231], v250 offset:41984
  buffer_load_dwordx4 v11, s[4:7], s35 offen offset:3072 lds
  v_mfma_f32_16x16x32_bf16 v[128:131], v[236:239], a[112:115], v[128:131]
  v_and_b32 v62, 0xffff0000, v42
  v_and_b32 v63, 0xffff0000, v50
  v_mfma_f32_16x16x32_bf16 v[128:131], v[232:235], a[96:99], v[128:131]
  ds_read_b64_tr_b16 v[232:233], v251 offset:32768
  s_waitcnt lgkmcnt(9)
  v_mul_f32 v74, v74, v60
  v_mfma_f32_16x16x32_bf16 v[144:147], v[208:211], a[96:99], v[144:147]
  s_waitcnt vmcnt(12)
  s_barrier
  v_mfma_f32_16x16x32_bf16 v[144:147], v[212:215], a[112:115], v[144:147]
  ds_read_b64_tr_b16 v[234:235], v251 offset:33792
  s_add_u32 m0, s37, 16384
  v_mul_f32 v75, v75, v61
  v_mfma_f32_16x16x32_bf16 v[148:151], v[212:215], a[116:119], v[148:151]
  ds_read_b128 a[128:131], v240 offset:32768
  v_mul_f32 v76, v76, v62
  v_mfma_f32_16x16x32_bf16 v[148:151], v[208:211], a[100:103], v[148:151]
  ds_read_b64_tr_b16 v[236:237], v251 offset:40960
  v_mul_f32 v77, v77, v63
  v_mfma_f32_16x16x32_bf16 v[152:155], v[208:211], a[104:107], v[152:155]
  ds_read_b128 a[132:135], v240 offset:34816
  s_add_u32 s34, s32, 3145728
  v_cvt_pk_bf16_f32 v42, v75, v74
  v_mfma_f32_16x16x32_bf16 v[152:155], v[212:215], a[120:123], v[152:155]
  ds_read_b64_tr_b16 v[238:239], v251 offset:41984
  v_cvt_pk_bf16_f32 v50, v77, v76
  v_mfma_f32_16x16x32_bf16 v[156:159], v[212:215], a[124:127], v[156:159]
  v_lshlrev_b32 v66, 16, v23
  v_lshlrev_b32 v67, 16, v24
  v_mfma_f32_16x16x32_bf16 v[156:159], v[208:211], a[108:111], v[156:159]
  ds_read_b64_tr_b16 v[208:209], v244 offset:49152
  ds_read_b128 a[136:139], v240 offset:36864
  s_waitcnt lgkmcnt(12)
  v_mfma_f32_16x16x32_bf16 v[172:175], v[216:219], a[108:111], v[172:175]
  buffer_load_dwordx4 v4, s[8:11], s34 offen offset:0 lds
  v_and_b32 v71, 0xffff0000, v23
  v_mfma_f32_16x16x32_bf16 v[172:175], v[220:223], a[124:127], v[172:175]
  ds_read_b64_tr_b16 v[210:211], v244 offset:50176
  v_and_b32 v72, 0xffff0000, v24
  v_mfma_f32_16x16x32_bf16 v[168:171], v[220:223], a[120:123], v[168:171]
  ds_read_b128 a[140:143], v240 offset:38912
  v_mul_f32 v74, v68, v55
  v_mfma_f32_16x16x32_bf16 v[168:171], v[216:219], a[104:107], v[168:171]
  ds_read_b64_tr_b16 v[212:213], v244 offset:57344
  buffer_load_dwordx4 v5, s[8:11], s34 offen offset:1024 lds
  v_mfma_f32_16x16x32_bf16 v[164:167], v[216:219], a[100:103], v[164:167]
  v_mul_f32 v75, v64, v55
  v_mul_f32 v76, v73, v59
  v_mfma_f32_16x16x32_bf16 v[164:167], v[220:223], a[116:119], v[164:167]
  ds_read_b64_tr_b16 v[214:215], v244 offset:58368
  ds_read_b128 a[144:147], v241 offset:32768
  v_mfma_f32_16x16x32_bf16 v[160:163], v[220:223], a[112:115], v[160:163]
  v_mul_f32 v77, v69, v59
  v_fmac_f32 v74, v64, v54
  v_mfma_f32_16x16x32_bf16 v[160:163], v[216:219], a[96:99], v[160:163]
  ds_read_b64_tr_b16 v[216:217], v245 offset:49152
  buffer_load_dwordx4 v6, s[8:11], s34 offen offset:2048 lds
  s_waitcnt lgkmcnt(14)
  v_mfma_f32_16x16x32_bf16 v[176:179], v[224:227], a[96:99], v[176:179]
  ds_read_b128 a[148:151], v241 offset:34816
  v_fmac_f32 v75, v65, v54
  v_mfma_f32_16x16x32_bf16 v[176:179], v[228:231], a[112:115], v[176:179]
  ds_read_b64_tr_b16 v[218:219], v245 offset:50176
  v_fmac_f32 v76, v69, v58
  v_mfma_f32_16x16x32_bf16 v[180:183], v[228:231], a[116:119], v[180:183]
  buffer_load_dwordx4 v7, s[8:11], s34 offen offset:3072 lds
  v_fmac_f32 v77, v70, v58
  v_mfma_f32_16x16x32_bf16 v[180:183], v[224:227], a[100:103], v[180:183]
  ds_read_b64_tr_b16 v[220:221], v245 offset:57344
  ds_read_b128 a[152:155], v241 offset:36864
  v_mfma_f32_16x16x32_bf16 v[184:187], v[224:227], a[104:107], v[184:187]
  v_fmac_f32 v74, v65, v53
  v_fmac_f32 v75, v66, v53
  v_mfma_f32_16x16x32_bf16 v[184:187], v[228:231], a[120:123], v[184:187]
  ds_read_b64_tr_b16 v[222:223], v245 offset:58368
  v_fmac_f32 v76, v70, v57
K_hA0_1:
  s_cbranch_execz K_hA0_2
  v_mfma_f32_16x16x32_bf16 v[188:191], v[228:231], a[124:127], v[188:191]
  ds_read_b128 a[156:159], v241 offset:38912
  s_add_u32 m0, s33, 0
  v_fmac_f32 v77, v71, v57
  v_mfma_f32_16x16x32_bf16 v[188:191], v[224:227], a[108:111], v[188:191]
  ds_read_b64_tr_b16 v[224:225], v246 offset:49152
  s_waitcnt lgkmcnt(15)
  v_fmac_f32 v74, v66, v52
  v_mfma_f32_16x16x32_bf16 v[204:207], v[232:235], a[108:111], v[204:207]
  v_fmac_f32 v75, v67, v52
  v_fmac_f32 v76, v71, v56
  v_mfma_f32_16x16x32_bf16 v[204:207], v[236:239], a[124:127], v[204:207]
  ds_read_b64_tr_b16 v[226:227], v246 offset:50176
  s_add_u32 s35, s30, 768
  v_fmac_f32 v77, v72, v56
  v_mfma_f32_16x16x32_bf16 v[200:203], v[236:239], a[120:123], v[200:203]
  v_lshlrev_b32 v60, 16, v41
  v_lshlrev_b32 v61, 16, v49
  v_mfma_f32_16x16x32_bf16 v[200:203], v[232:235], a[104:107], v[200:203]
  ds_read_b64_tr_b16 v[228:229], v246 offset:57344
  v_and_b32 v62, 0xffff0000, v41
  v_mfma_f32_16x16x32_bf16 v[196:199], v[232:235], a[100:103], v[196:199]
  v_and_b32 v63, 0xffff0000, v49
  v_mul_f32 v74, v74, v60
  v_mfma_f32_16x16x32_bf16 v[196:199], v[236:239], a[116:119], v[196:199]
  ds_read_b64_tr_b16 v[230:231], v246 offset:58368
  buffer_load_dwordx4 v8, s[4:7], s35 offen offset:0 lds
  v_mfma_f32_16x16x32_bf16 v[192:195], v[236:239], a[112:115], v[192:195]
  v_mul_f32 v75, v75, v61
  v_mul_f32 v76, v76, v62
  v_mfma_f32_16x16x32_bf16 v[192:195], v[232:235], a[96:99], v[192:195]
  ds_read_b64_tr_b16 v[232:233], v247 offset:49152
  s_waitcnt lgkmcnt(5)
  v_mul_f32 v77, v77, v63
  v_mfma_f32_16x16x32_bf16 v[80:83], v[208:211], a[128:131], v[80:83]
  buffer_load_dwordx4 v9, s[4:7], s35 offen offset:1024 lds
  v_cvt_pk_bf16_f32 v41, v75, v74
  v_mfma_f32_16x16x32_bf16 v[80:83], v[212:215], a[144:147], v[80:83]
  ds_read_b64_tr_b16 v[234:235], v247 offset:50176
  v_cvt_pk_bf16_f32 v49, v77, v76
  v_mfma_f32_16x16x32_bf16 v[84:87], v[212:215], a[148:151], v[84:87]
  v_lshlrev_b32 v68, 16, v25
  v_lshlrev_b32 v64, 16, v26
  v_mfma_f32_16x16x32_bf16 v[84:87], v[208:211], a[132:135], v[84:87]
  ds_read_b64_tr_b16 v[236:237], v247 offset:57344
  v_and_b32 v73, 0xffff0000, v25
  v_mfma_f32_16x16x32_bf16 v[88:91], v[208:211], a[136:139], v[88:91]
  buffer_load_dwordx4 v10, s[4:7], s35 offen offset:2048 lds
  v_and_b32 v69, 0xffff0000, v26
  v_mfma_f32_16x16x32_bf16 v[88:91], v[212:215], a[152:155], v[88:91]
  ds_read_b64_tr_b16 v[238:239], v247 offset:58368
  v_mul_f32 v74, v65, v55
  v_mfma_f32_16x16x32_bf16 v[92:95], v[212:215], a[156:159], v[92:95]
  v_mul_f32 v75, v66, v55
  v_mul_f32 v76, v70, v59
  v_mfma_f32_16x16x32_bf16 v[92:95], v[208:211], a[140:143], v[92:95]
  ds_read_b64_tr_b16 v[208:209], v248 offset:49152
  buffer_load_dwordx4 v11, s[4:7], s35 offen offset:3072 lds
  v_mfma_f32_16x16x32_bf16 v[108:111], v[216:219], a[140:143], v[108:111]
  v_mul_f32 v77, v71, v59
  v_fmac_f32 v74, v66, v54
  v_mfma_f32_16x16x32_bf16 v[108:111], v[220:223], a[156:159], v[108:111]
  ds_read_b64_tr_b16 v[210:211], v248 offset:50176
  v_fmac_f32 v75, v67, v54
  v_mfma_f32_16x16x32_bf16 v[104:107], v[220:223], a[152:155], v[104:107]
  v_fmac_f32 v76, v71, v58
  v_fmac_f32 v77, v72, v58
  v_mfma_f32_16x16x32_bf16 v[104:107], v[216:219], a[136:139], v[104:107]
  ds_read_b64_tr_b16 v[212:213], v248 offset:57344
  s_add_u32 m0, s33, 4096
  v_fmac_f32 v74, v67, v53
  v_mfma_f32_16x16x32_bf16 v[100:103], v[216:219], a[132:135], v[100:103]
  v_fmac_f32 v75, v68, v53
  v_fmac_f32 v76, v72, v57
  v_mfma_f32_16x16x32_bf16 v[100:103], v[220:223], a[148:151], v[100:103]
  ds_read_b64_tr_b16 v[214:215], v248 offset:58368
  v_fmac_f32 v77, v73, v57
  v_mfma_f32_16x16x32_bf16 v[96:99], v[220:223], a[144:147], v[96:99]
  s_add_u32 s35, s30, 33536
  v_fmac_f32 v74, v68, v52
  v_fmac_f32 v75, v64, v52
  v_mfma_f32_16x16x32_bf16 v[96:99], v[216:219], a[128:131], v[96:99]
  ds_read_b64_tr_b16 v[216:217], v249 offset:49152
  s_waitcnt lgkmcnt(9)
  v_fmac_f32 v76, v73, v56
  v_mfma_f32_16x16x32_bf16 v[112:115], v[224:227], a[128:131], v[112:115]
  v_fmac_f32 v77, v69, v56
  v_mfma_f32_16x16x32_bf16 v[112:115], v[228:231], a[144:147], v[112:115]
  ds_read_b64_tr_b16 v[218:219], v249 offset:50176
  v_lshlrev_b32 v60, 16, v40
  v_mfma_f32_16x16x32_bf16 v[116:119], v[228:231], a[148:151], v[116:119]
  buffer_load_dwordx4 v8, s[4:7], s35 offen offset:0 lds
  v_lshlrev_b32 v61, 16, v48
  v_mfma_f32_16x16x32_bf16 v[116:119], v[224:227], a[132:135], v[116:119]
  ds_read_b64_tr_b16 v[220:221], v249 offset:57344
  v_and_b32 v62, 0xffff0000, v40
  v_mfma_f32_16x16x32_bf16 v[120:123], v[224:227], a[136:139], v[120:123]
  v_and_b32 v63, 0xffff0000, v48
  v_mul_f32 v74, v74, v60
  v_mfma_f32_16x16x32_bf16 v[120:123], v[228:231], a[152:155], v[120:123]
  ds_read_b64_tr_b16 v[222:223], v249 offset:58368
  v_mul_f32 v75, v75, v61
  v_mfma_f32_16x16x32_bf16 v[124:127], v[228:231], a[156:159], v[124:127]
  buffer_load_dwordx4 v9, s[4:7], s35 offen offset:1024 lds
  v_mul_f32 v76, v76, v62
  v_mfma_f32_16x16x32_bf16 v[124:127], v[224:227], a[140:143], v[124:127]
  ds_read_b64_tr_b16 v[224:225], v250 offset:49152
  s_waitcnt lgkmcnt(9)
  v_mul_f32 v77, v77, v63
  v_mfma_f32_16x16x32_bf16 v[140:143], v[232:235], a[140:143], v[140:143]
  v_cvt_pk_bf16_f32 v40, v75, v74
  v_mfma_f32_16x16x32_bf16 v[140:143], v[236:239], a[156:159], v[140:143]
  ds_read_b64_tr_b16 v[226:227], v250 offset:50176
  buffer_load_dwordx4 v10, s[4:7], s35 offen offset:2048 lds
  v_mfma_f32_16x16x32_bf16 v[136:139], v[236:239], a[152:155], v[136:139]
  v_cvt_pk_bf16_f32 v48, v77, v76
  v_lshlrev_b32 v65, 16, v27
  v_mfma_f32_16x16x32_bf16 v[136:139], v[232:235], a[136:139], v[136:139]
  ds_read_b64_tr_b16 v[228:229], v250 offset:57344
  v_lshlrev_b32 v66, 16, v28
  v_mfma_f32_16x16x32_bf16 v[132:135], v[232:235], a[132:135], v[132:135]
  v_and_b32 v70, 0xffff0000, v27
  v_and_b32 v71, 0xffff0000, v28
  v_mfma_f32_16x16x32_bf16 v[132:135], v[236:239], a[148:151], v[132:135]
  ds_read_b64_tr_b16 v[230:231], v250 offset:58368
  buffer_load_dwordx4 v11, s[4:7], s35 offen offset:3072 lds
  v_mfma_f32_16x16x32_bf16 v[128:131], v[236:239], a[144:147], v[128:131]
  v_mul_f32 v74, v67, v55
  v_mul_f32 v75, v68, v55
  v_mfma_f32_16x16x32_bf16 v[128:131], v[232:235], a[128:131], v[128:131]
  ds_read_b64_tr_b16 v[232:233], v251 offset:49152
  s_waitcnt lgkmcnt(9)
  v_mul_f32 v76, v72, v59
  v_mfma_f32_16x16x32_bf16 v[144:147], v[208:211], a[128:131], v[144:147]
  s_waitcnt vmcnt(12)
  s_barrier
  v_mfma_f32_16x16x32_bf16 v[144:147], v[212:215], a[144:147], v[144:147]
  ds_read_b64_tr_b16 v[234:235], v251 offset:50176
  v_mul_f32 v77, v73, v59
  v_mfma_f32_16x16x32_bf16 v[148:151], v[212:215], a[148:151], v[148:151]
  s_and_b32 s27, s2, 7
  s_lshl_b32 s27, s27, 5
  s_cmp_eq_u32 s24, 0
  s_cselect_b32 s27, s27, 0x7f000000
  buffer_atomic_add v78, v79, s[56:59], s27 offen sc1
  v_mfma_f32_16x16x32_bf16 v[148:151], v[208:211], a[132:135], v[148:151]
  ds_read_b64_tr_b16 v[236:237], v251 offset:57344
  ds_read_b128 a[160:163], v242 offset:0
  v_mfma_f32_16x16x32_bf16 v[152:155], v[208:211], a[136:139], v[152:155]
  ds_read_b128 a[164:167], v242 offset:2048
  s_add_u32 m0, s37, 32768
  v_fmac_f32 v74, v68, v54
  v_mfma_f32_16x16x32_bf16 v[152:155], v[212:215], a[152:155], v[152:155]
  ds_read_b64_tr_b16 v[238:239], v251 offset:58368
K_hA1_1:
  s_cbranch_execz K_hA1_2
  v_fmac_f32 v75, v64, v54
  v_mfma_f32_16x16x32_bf16 v[156:159], v[212:215], a[156:159], v[156:159]
  v_fmac_f32 v76, v73, v58
  v_fmac_f32 v77, v69, v58
  v_mfma_f32_16x16x32_bf16 v[156:159], v[208:211], a[140:143], v[156:159]
  ds_read_b64_tr_b16 v[208:209], v244 offset:0
  s_add_u32 s34, s32, 3670016
  s_waitcnt lgkmcnt(11)
  v_mfma_f32_16x16x32_bf16 v[172:175], v[216:219], a[140:143], v[172:175]
  ds_read_b128 a[168:171], v242 offset:4096
  v_fmac_f32 v74, v64, v53
  v_mfma_f32_16x16x32_bf16 v[172:175], v[220:223], a[156:159], v[172:175]
  ds_read_b64_tr_b16 v[210:211], v244 offset:1024
  v_fmac_f32 v75, v65, v53
  v_mfma_f32_16x16x32_bf16 v[168:171], v[220:223], a[152:155], v[168:171]
  buffer_load_dwordx4 v4, s[8:11], s34 offen offset:0 lds
  ds_read_b128 a[172:175], v242 offset:6144
  v_mfma_f32_16x16x32_bf16 v[168:171], v[216:219], a[136:139], v[168:171]
  ds_read_b64_tr_b16 v[212:213], v244 offset:8192
  v_fmac_f32 v76, v69, v57
  v_mfma_f32_16x16x32_bf16 v[164:167], v[216:219], a[132:135], v[164:167]
  v_fmac_f32 v77, v70, v57
  v_fmac_f32 v74, v65, v52
  v_mfma_f32_16x16x32_bf16 v[164:167], v[220:223], a[148:151], v[164:167]
  ds_read_b64_tr_b16 v[214:215], v244 offset:9216
  buffer_load_dwordx4 v5, s[8:11], s34 offen offset:1024 lds
  v_mfma_f32_16x16x32_bf16 v[160:163], v[220:223], a[144:147], v[160:163]
  ds_read_b128 a[176:179], v243 offset:0
  v_fmac_f32 v75, v66, v52
  v_mfma_f32_16x16x32_bf16 v[160:163], v[216:219], a[128:131], v[160:163]
  ds_read_b64_tr_b16 v[216:217], v245 offset:0
  s_waitcnt lgkmcnt(14)
  v_fmac_f32 v76, v70, v56
  v_mfma_f32_16x16x32_bf16 v[176:179], v[224:227], a[128:131], v[176:179]
  buffer_load_dwordx4 v6, s[8:11], s34 offen offset:2048 lds
  ds_read_b128 a[180:183], v243 offset:2048
  v_mfma_f32_16x16x32_bf16 v[176:179], v[228:231], a[144:147], v[176:179]
  ds_read_b64_tr_b16 v[218:219], v245 offset:1024
  v_fmac_f32 v77, v71, v56
  v_lshlrev_b32 v60, 16, v39
  v_mfma_f32_16x16x32_bf16 v[180:183], v[228:231], a[148:151], v[180:183]
  v_lshlrev_b32 v61, 16, v47
  v_and_b32 v62, 0xffff0000, v39
  v_mfma_f32_16x16x32_bf16 v[180:183], v[224:227], a[132:135], v[180:183]
  ds_read_b64_tr_b16 v[220:221], v245 offset:8192
  buffer_load_dwordx4 v7, s[8:11], s34 offen offset:3072 lds
  v_mfma_f32_16x16x32_bf16 v[184:187], v[224:227], a[136:139], v[184:187]
  ds_read_b128 a[184:187], v243 offset:4096
  v_and_b32 v63, 0xffff0000, v47
  v_mfma_f32_16x16x32_bf16 v[184:187], v[228:231], a[152:155], v[184:187]
  ds_read_b64_tr_b16 v[222:223], v245 offset:9216
  v_mul_f32 v74, v74, v60
  v_mfma_f32_16x16x32_bf16 v[188:191], v[228:231], a[156:159], v[188:191]
  ds_read_b128 a[188:191], v243 offset:6144
  s_add_u32 m0, s33, 32768
  v_mul_f32 v75, v75, v61
  v_mfma_f32_16x16x32_bf16 v[188:191], v[224:227], a[140:143], v[188:191]
  ds_read_b64_tr_b16 v[224:225], v246 offset:0
  s_waitcnt lgkmcnt(15)
  v_mul_f32 v76, v76, v62
  v_mfma_f32_16x16x32_bf16 v[204:207], v[232:235], a[140:143], v[204:207]
  v_mul_f32 v77, v77, v63
  v_cvt_pk_bf16_f32 v39, v75, v74
  v_mfma_f32_16x16x32_bf16 v[204:207], v[236:239], a[156:159], v[204:207]
  ds_read_b64_tr_b16 v[226:227], v246 offset:1024
  s_add_u32 s35, s30, 896
  v_cvt_pk_bf16_f32 v47, v77, v76
  v_mfma_f32_16x16x32_bf16 v[200:203], v[236:239], a[152:155], v[200:203]
  v_lshlrev_b32 v67, 16, v29
  v_lshlrev_b32 v68, 16, v30
  v_mfma_f32_16x16x32_bf16 v[200:203], v[232:235], a[136:139], v[200:203]
  ds_read_b64_tr_b16 v[228:229], v246 offset:8192
  v_and_b32 v72, 0xffff0000, v29
  v_mfma_f32_16x16x32_bf16 v[196:199], v[232:235], a[132:135], v[196:199]
  v_and_b32 v73, 0xffff0000, v30
  v_mul_f32 v74, v64, v55
  v_mfma_f32_16x16x32_bf16 v[196:199], v[236:239], a[148:151], v[196:199]
  ds_read_b64_tr_b16 v[230:231], v246 offset:9216
  buffer_load_dwordx4 v8, s[4:7], s35 offen offset:0 lds
  v_mfma_f32_16x16x32_bf16 v[192:195], v[236:239], a[144:147], v[192:195]
  v_mul_f32 v75, v65, v55
  v_mul_f32 v76, v69, v59
  v_mfma_f32_16x16x32_bf16 v[192:195], v[232:235], a[128:131], v[192:195]
  ds_read_b64_tr_b16 v[232:233], v247 offset:0
  s_waitcnt lgkmcnt(5)
  v_mul_f32 v77, v70, v59
  v_mfma_f32_16x16x32_bf16 v[80:83], v[208:211], a[160:163], v[80:83]
  buffer_load_dwordx4 v9, s[4:7], s35 offen offset:1024 lds
  v_fmac_f32 v74, v65, v54
  v_mfma_f32_16x16x32_bf16 v[80:83], v[212:215], a[176:179], v[80:83]
  ds_read_b64_tr_b16 v[234:235], v247 offset:1024
  v_fmac_f32 v75, v66, v54
  v_mfma_f32_16x16x32_bf16 v[84:87], v[212:215], a[180:183], v[84:87]
  v_fmac_f32 v76, v70, v58
  v_fmac_f32 v77, v71, v58
  v_mfma_f32_16x16x32_bf16 v[84:87], v[208:211], a[164:167], v[84:87]
  ds_read_b64_tr_b16 v[236:237], v247 offset:8192
  v_fmac_f32 v74, v66, v53
  v_mfma_f32_16x16x32_bf16 v[88:91], v[208:211], a[168:171], v[88:91]
  buffer_load_dwordx4 v10, s[4:7], s35 offen offset:2048 lds
  v_fmac_f32 v75, v67, v53
  v_mfma_f32_16x16x32_bf16 v[88:91], v[212:215], a[184:187], v[88:91]
  ds_read_b64_tr_b16 v[238:239], v247 offset:9216
  v_fmac_f32 v76, v71, v57
  v_mfma_f32_16x16x32_bf16 v[92:95], v[212:215], a[188:191], v[92:95]
  v_fmac_f32 v77, v72, v57
  v_fmac_f32 v74, v67, v52
  v_mfma_f32_16x16x32_bf16 v[92:95], v[208:211], a[172:175], v[92:95]
  ds_read_b64_tr_b16 v[208:209], v248 offset:0
  buffer_load_dwordx4 v11, s[4:7], s35 offen offset:3072 lds
  v_mfma_f32_16x16x32_bf16 v[108:111], v[216:219], a[172:175], v[108:111]
  v_fmac_f32 v75, v68, v52
  v_fmac_f32 v76, v72, v56
  v_mfma_f32_16x16x32_bf16 v[108:111], v[220:223], a[188:191], v[108:111]
  ds_read_b64_tr_b16 v[210:211], v248 offset:1024
  v_fmac_f32 v77, v73, v56
  v_mfma_f32_16x16x32_bf16 v[104:107], v[220:223], a[184:187], v[104:107]
  v_lshlrev_b32 v60, 16, v38
  v_lshlrev_b32 v61, 16, v46
  v_mfma_f32_16x16x32_bf16 v[104:107], v[216:219], a[168:171], v[104:107]
  ds_read_b64_tr_b16 v[212:213], v248 offset:8192
  s_add_u32 m0, s33, 36864
  v_and_b32 v62, 0xffff0000, v38
  v_mfma_f32_16x16x32_bf16 v[100:103], v[216:219], a[164:167], v[100:103]
  s_add_u32 s35, s30, 33664
  v_and_b32 v63, 0xffff0000, v46
  v_mul_f32 v74, v74, v60
  v_mfma_f32_16x16x32_bf16 v[100:103], v[220:223], a[180:183], v[100:103]
  ds_read_b64_tr_b16 v[214:215], v248 offset:9216
  v_mul_f32 v75, v75, v61
  v_mfma_f32_16x16x32_bf16 v[96:99], v[220:223], a[176:179], v[96:99]
  buffer_load_dwordx4 v8, s[4:7], s35 offen offset:0 lds
  v_mul_f32 v76, v76, v62
  v_mfma_f32_16x16x32_bf16 v[96:99], v[216:219], a[160:163], v[96:99]
  ds_read_b64_tr_b16 v[216:217], v249 offset:0
  s_waitcnt lgkmcnt(9)
  v_mul_f32 v77, v77, v63
  v_mfma_f32_16x16x32_bf16 v[112:115], v[224:227], a[160:163], v[112:115]
  buffer_load_dwordx4 v9, s[4:7], s35 offen offset:1024 lds
  v_cvt_pk_bf16_f32 v38, v75, v74
  v_mfma_f32_16x16x32_bf16 v[112:115], v[228:231], a[176:179], v[112:115]
  ds_read_b64_tr_b16 v[218:219], v249 offset:1024
  v_cvt_pk_bf16_f32 v46, v77, v76
  v_mfma_f32_16x16x32_bf16 v[116:119], v[228:231], a[180:183], v[116:119]
  buffer_load_dwordx4 v10, s[4:7], s35 offen offset:2048 lds
  v_lshlrev_b32 v64, 16, v31
  v_mfma_f32_16x16x32_bf16 v[116:119], v[224:227], a[164:167], v[116:119]
  ds_read_b64_tr_b16 v[220:221], v249 offset:8192
  v_lshlrev_b32 v65, 16, v32
  v_mfma_f32_16x16x32_bf16 v[120:123], v[224:227], a[168:171], v[120:123]
  buffer_load_dwordx4 v11, s[4:7], s35 offen offset:3072 lds
  v_and_b32 v69, 0xffff0000, v31
K_hA2_1:
  s_cbranch_execz K_hA2_2
  v_mfma_f32_16x16x32_bf16 v[120:123], v[228:231], a[184:187], v[120:123]
  ds_read_b64_tr_b16 v[222:223], v249 offset:9216
  v_and_b32 v70, 0xffff0000, v32
  v_mfma_f32_16x16x32_bf16 v[124:127], v[228:231], a[188:191], v[124:127]
  s_lshl_b32 s64, s26, 2
  v_mul_f32 v74, v66, v55
  v_mul_f32 v75, v67, v55
  v_mfma_f32_16x16x32_bf16 v[124:127], v[224:227], a[172:175], v[124:127]
  ds_read_b64_tr_b16 v[224:225], v250 offset:0
  s_add_u32 s64, s64, s24
  s_waitcnt lgkmcnt(9)
  v_mfma_f32_16x16x32_bf16 v[140:143], v[232:235], a[172:175], v[140:143]
  v_mul_f32 v76, v71, v59
  v_mul_f32 v77, v72, v59
  v_mfma_f32_16x16x32_bf16 v[140:143], v[236:239], a[188:191], v[140:143]
  ds_read_b64_tr_b16 v[226:227], v250 offset:1024
  s_mul_i32 s65, s64, 131072
  v_fmac_f32 v74, v67, v54
  v_mfma_f32_16x16x32_bf16 v[136:139], v[236:239], a[184:187], v[136:139]
  v_fmac_f32 v75, v68, v54
  v_fmac_f32 v76, v72, v58
  v_mfma_f32_16x16x32_bf16 v[136:139], v[232:235], a[168:171], v[136:139]
  ds_read_b64_tr_b16 v[228:229], v250 offset:8192
  s_lshl_b32 s64, s25, 8
  v_fmac_f32 v77, v73, v58
  v_mfma_f32_16x16x32_bf16 v[132:135], v[232:235], a[164:167], v[132:135]
  v_fmac_f32 v74, v68, v53
  v_fmac_f32 v75, v64, v53
  v_mfma_f32_16x16x32_bf16 v[132:135], v[236:239], a[180:183], v[132:135]
  ds_read_b64_tr_b16 v[230:231], v250 offset:9216
  s_add_u32 s65, s65, s64
  v_fmac_f32 v76, v73, v57
  v_mfma_f32_16x16x32_bf16 v[128:131], v[236:239], a[176:179], v[128:131]
  v_fmac_f32 v77, v69, v57
  v_fmac_f32 v74, v64, v52
  v_mfma_f32_16x16x32_bf16 v[128:131], v[232:235], a[160:163], v[128:131]
  ds_read_b64_tr_b16 v[232:233], v251 offset:0
  buffer_load_dword v255, v3, s[16:19], s65 offen
  s_waitcnt lgkmcnt(9)
  v_mfma_f32_16x16x32_bf16 v[144:147], v[208:211], a[160:163], v[144:147]
  s_waitcnt vmcnt(14)
  s_barrier
  v_mfma_f32_16x16x32_bf16 v[144:147], v[212:215], a[176:179], v[144:147]
  ds_read_b64_tr_b16 v[234:235], v251 offset:1024
  s_add_u32 m0, s37, 49152
  v_fmac_f32 v75, v65, v52
  v_mfma_f32_16x16x32_bf16 v[148:151], v[212:215], a[180:183], v[148:151]
  ds_read_b128 a[192:195], v240 offset:0
  v_fmac_f32 v76, v69, v56
  v_mfma_f32_16x16x32_bf16 v[148:151], v[208:211], a[164:167], v[148:151]
  ds_read_b64_tr_b16 v[236:237], v251 offset:8192
  s_add_u32 s34, s32, 0
  v_fmac_f32 v77, v70, v56
  v_mfma_f32_16x16x32_bf16 v[152:155], v[208:211], a[168:171], v[152:155]
  ds_read_b128 a[196:199], v240 offset:2048
  v_lshlrev_b32 v60, 16, v37
  v_mfma_f32_16x16x32_bf16 v[152:155], v[212:215], a[184:187], v[152:155]
  ds_read_b64_tr_b16 v[238:239], v251 offset:9216
  buffer_load_dwordx4 v4, s[16:19], s34 offen offset:0 lds
  v_mfma_f32_16x16x32_bf16 v[156:159], v[212:215], a[188:191], v[156:159]
  v_lshlrev_b32 v61, 16, v45
  v_and_b32 v62, 0xffff0000, v37
  v_mfma_f32_16x16x32_bf16 v[156:159], v[208:211], a[172:175], v[156:159]
  ds_read_b64_tr_b16 v[208:209], v244 offset:16384
  ds_read_b128 a[200:203], v240 offset:4096
  s_waitcnt lgkmcnt(12)
  v_mfma_f32_16x16x32_bf16 v[172:175], v[216:219], a[172:175], v[172:175]
  buffer_load_dwordx4 v5, s[16:19], s34 offen offset:1024 lds
  v_and_b32 v63, 0xffff0000, v45
  v_mfma_f32_16x16x32_bf16 v[172:175], v[220:223], a[188:191], v[172:175]
  ds_read_b64_tr_b16 v[210:211], v244 offset:17408
  v_mul_f32 v74, v74, v60
  v_mfma_f32_16x16x32_bf16 v[168:171], v[220:223], a[184:187], v[168:171]
  buffer_load_dwordx4 v6, s[16:19], s34 offen offset:2048 lds
  ds_read_b128 a[204:207], v240 offset:6144
  v_mfma_f32_16x16x32_bf16 v[168:171], v[216:219], a[168:171], v[168:171]
  ds_read_b64_tr_b16 v[212:213], v244 offset:24576
  v_mul_f32 v75, v75, v61
  v_mfma_f32_16x16x32_bf16 v[164:167], v[216:219], a[164:167], v[164:167]
  v_mul_f32 v76, v76, v62
  v_mul_f32 v77, v77, v63
  v_mfma_f32_16x16x32_bf16 v[164:167], v[220:223], a[180:183], v[164:167]
  ds_read_b64_tr_b16 v[214:215], v244 offset:25600
  buffer_load_dwordx4 v7, s[16:19], s34 offen offset:3072 lds
  v_mfma_f32_16x16x32_bf16 v[160:163], v[220:223], a[176:179], v[160:163]
  ds_read_b128 a[208:211], v241 offset:0
  v_cvt_pk_bf16_f32 v37, v75, v74
  v_cvt_pk_bf16_f32 v45, v77, v76
  v_mfma_f32_16x16x32_bf16 v[160:163], v[216:219], a[160:163], v[160:163]
  ds_read_b64_tr_b16 v[216:217], v245 offset:16384
  s_lshl_b32 s64, s2, 2
  s_waitcnt lgkmcnt(14)
  v_mfma_f32_16x16x32_bf16 v[176:179], v[224:227], a[160:163], v[176:179]
  ds_read_b128 a[212:215], v241 offset:2048
  v_lshlrev_b32 v66, 16, v33
  v_mfma_f32_16x16x32_bf16 v[176:179], v[228:231], a[176:179], v[176:179]
  ds_read_b64_tr_b16 v[218:219], v245 offset:17408
  v_lshlrev_b32 v67, 16, v34
  v_mfma_f32_16x16x32_bf16 v[180:183], v[228:231], a[180:183], v[180:183]
  s_add_u32 s64, s64, s24
  v_and_b32 v71, 0xffff0000, v33
  v_and_b32 v72, 0xffff0000, v34
  v_mul_f32 v74, v68, v55
  v_mfma_f32_16x16x32_bf16 v[180:183], v[224:227], a[164:167], v[180:183]
  ds_read_b64_tr_b16 v[220:221], v245 offset:24576
  ds_read_b128 a[216:219], v241 offset:4096
  v_mfma_f32_16x16x32_bf16 v[184:187], v[224:227], a[168:171], v[184:187]
  s_mul_i32 s65, s64, 2304
  v_mul_f32 v75, v64, v55
  v_mul_f32 v76, v73, v59
  v_mfma_f32_16x16x32_bf16 v[184:187], v[228:231], a[184:187], v[184:187]
  ds_read_b64_tr_b16 v[222:223], v245 offset:25600
  v_mul_f32 v77, v69, v59
  v_mfma_f32_16x16x32_bf16 v[188:191], v[228:231], a[188:191], v[188:191]
  ds_read_b128 a[220:223], v241 offset:6144
  v_fmac_f32 v74, v64, v54
  v_mfma_f32_16x16x32_bf16 v[188:191], v[224:227], a[172:175], v[188:191]
  ds_read_b64_tr_b16 v[224:225], v246 offset:16384
  s_waitcnt lgkmcnt(15)
  v_min_u32 v8, 17, v0
  v_mfma_f32_16x16x32_bf16 v[204:207], v[232:235], a[172:175], v[204:207]
  v_fmac_f32 v75, v65, v54
  v_fmac_f32 v76, v69, v58
  v_mfma_f32_16x16x32_bf16 v[204:207], v[236:239], a[188:191], v[204:207]
  ds_read_b64_tr_b16 v[226:227], v246 offset:17408
  v_lshlrev_b32 v8, 7, v8
  v_mfma_f32_16x16x32_bf16 v[200:203], v[236:239], a[184:187], v[200:203]
  v_fmac_f32 v77, v70, v58
  v_fmac_f32 v74, v65, v53
  v_mfma_f32_16x16x32_bf16 v[200:203], v[232:235], a[168:171], v[200:203]
  ds_read_b64_tr_b16 v[228:229], v246 offset:24576
  v_fmac_f32 v75, v66, v53
  v_mfma_f32_16x16x32_bf16 v[196:199], v[232:235], a[164:167], v[196:199]
  buffer_load_dword v255, v8, s[12:15], s65 offen
  v_fmac_f32 v76, v70, v57
  v_mfma_f32_16x16x32_bf16 v[196:199], v[236:239], a[180:183], v[196:199]
  ds_read_b64_tr_b16 v[230:231], v246 offset:25600
  v_fmac_f32 v77, v71, v57
  v_mfma_f32_16x16x32_bf16 v[192:195], v[236:239], a[176:179], v[192:195]
  s_mov_b32 s52, s80
  v_fmac_f32 v74, v66, v52
  v_fmac_f32 v75, v67, v52
  v_mfma_f32_16x16x32_bf16 v[192:195], v[232:235], a[160:163], v[192:195]
  ds_read_b64_tr_b16 v[232:233], v247 offset:16384
  s_waitcnt lgkmcnt(5)
  v_fmac_f32 v76, v71, v56
  v_mfma_f32_16x16x32_bf16 v[80:83], v[208:211], a[192:195], v[80:83]
  v_fmac_f32 v77, v72, v56
  v_lshlrev_b32 v60, 16, v36
  v_mfma_f32_16x16x32_bf16 v[80:83], v[212:215], a[208:211], v[80:83]
  ds_read_b64_tr_b16 v[234:235], v247 offset:17408
  s_and_b32 s53, s81, 0xffff
  v_lshlrev_b32 v61, 16, v44
  v_mfma_f32_16x16x32_bf16 v[84:87], v[212:215], a[212:215], v[84:87]
  v_and_b32 v62, 0xffff0000, v36
  v_and_b32 v63, 0xffff0000, v44
  v_mfma_f32_16x16x32_bf16 v[84:87], v[208:211], a[196:199], v[84:87]
K_hA3_1:
  s_cbranch_execz K_hA3_2
  ds_read_b64_tr_b16 v[236:237], v247 offset:24576
  s_mov_b32 s54, 4718592
  v_mul_f32 v74, v74, v60
  v_mfma_f32_16x16x32_bf16 v[88:91], v[208:211], a[200:203], v[88:91]
  v_mul_f32 v75, v75, v61
  v_mul_f32 v76, v76, v62
  v_mul_f32 v77, v77, v63
  v_cvt_pk_bf16_f32 v36, v75, v74
  v_cvt_pk_bf16_f32 v44, v77, v76
  v_mfma_f32_16x16x32_bf16 v[88:91], v[212:215], a[216:219], v[88:91]
  ds_write_b128 v253, v[40:43] offset:16
  ds_read_b64_tr_b16 v[238:239], v247 offset:25600
  s_lshl_b32 s64, s26, 2
  v_mfma_f32_16x16x32_bf16 v[92:95], v[212:215], a[220:223], v[92:95]
  ds_write_b128 v253, v[48:51] offset:160
  v_mfma_f32_16x16x32_bf16 v[92:95], v[208:211], a[204:207], v[92:95]
  ds_write_b128 v253, v[36:39] offset:0
  ds_read_b64_tr_b16 v[208:209], v248 offset:16384
  v_mfma_f32_16x16x32_bf16 v[108:111], v[216:219], a[204:207], v[108:111]
  s_add_u32 s64, s64, s24
  v_mfma_f32_16x16x32_bf16 v[108:111], v[220:223], a[220:223], v[108:111]
  ds_write_b128 v253, v[44:47] offset:144
  ds_read_b64_tr_b16 v[210:211], v248 offset:17408
  v_mfma_f32_16x16x32_bf16 v[104:107], v[220:223], a[216:219], v[104:107]
  s_mul_i32 s65, s64, 147456
  v_lshrrev_b32 v16, 3, v0
  v_mfma_f32_16x16x32_bf16 v[104:107], v[216:219], a[200:203], v[104:107]
  ds_read_b64_tr_b16 v[212:213], v248 offset:24576
  v_mfma_f32_16x16x32_bf16 v[100:103], v[216:219], a[196:199], v[100:103]
  v_and_b32 v18, 7, v0
  v_mfma_f32_16x16x32_bf16 v[100:103], v[220:223], a[212:215], v[100:103]
  ds_read_b64_tr_b16 v[214:215], v248 offset:25600
  s_lshl_b32 s64, s25, 8
  v_lshlrev_b32 v18, 4, v18
  v_mfma_f32_16x16x32_bf16 v[96:99], v[220:223], a[208:211], v[96:99]
  v_mfma_f32_16x16x32_bf16 v[96:99], v[216:219], a[192:195], v[96:99]
  ds_read_b64_tr_b16 v[216:217], v249 offset:16384
  s_add_u32 s65, s65, s64
  s_waitcnt lgkmcnt(13)
  v_mfma_f32_16x16x32_bf16 v[112:115], v[224:227], a[192:195], v[112:115]
  v_mul_u32_u24 v17, 4224, v16
  v_add_u32 v17, v17, v18
  v_mfma_f32_16x16x32_bf16 v[112:115], v[228:231], a[208:211], v[112:115]
  ds_read_b64_tr_b16 v[218:219], v249 offset:17408
  v_mfma_f32_16x16x32_bf16 v[116:119], v[228:231], a[212:215], v[116:119]
  v_min_u32 v8, 35, v0
  v_mul_u32_u24 v16, 144, v16
  v_mfma_f32_16x16x32_bf16 v[116:119], v[224:227], a[196:199], v[116:119]
  ds_read_b64_tr_b16 v[220:221], v249 offset:24576
  s_mul_i32 s44, s24, 2592
  s_add_u32 s44, s44, 131072
  v_mfma_f32_16x16x32_bf16 v[120:123], v[224:227], a[200:203], v[120:123]
  v_and_b32 v9, 1, v8
  v_mfma_f32_16x16x32_bf16 v[120:123], v[228:231], a[216:219], v[120:123]
  ds_read_b64_tr_b16 v[222:223], v249 offset:25600
  v_add3_u32 v16, v16, v18, s44
  v_mfma_f32_16x16x32_bf16 v[124:127], v[228:231], a[220:223], v[124:127]
  s_and_b32 s44, s2, 7
  s_lshl_b32 s44, s44, 2
  v_mfma_f32_16x16x32_bf16 v[124:127], v[224:227], a[204:207], v[124:127]
  ds_read_b64_tr_b16 v[224:225], v250 offset:16384
  s_waitcnt lgkmcnt(12)
  v_mul_u32_u24 v9, 3968, v9
  v_mfma_f32_16x16x32_bf16 v[140:143], v[232:235], a[204:207], v[140:143]
  s_add_u32 s44, s44, s24
  s_mul_i32 s44, s44, 76032
  v_mfma_f32_16x16x32_bf16 v[140:143], v[236:239], a[220:223], v[140:143]
  ds_read_b64_tr_b16 v[226:227], v250 offset:17408
  v_lshlrev_b32 v8, 12, v8
  v_mfma_f32_16x16x32_bf16 v[136:139], v[236:239], a[216:219], v[136:139]
  s_lshr_b32 s45, s2, 3
  s_lshl_b32 s45, s45, 7
  v_mfma_f32_16x16x32_bf16 v[136:139], v[232:235], a[200:203], v[136:139]
  ds_read_b64_tr_b16 v[228:229], v250 offset:24576
  s_sub_u32 s44, s44, s45
  s_add_u32 s44, s44, 56627072
  v_mfma_f32_16x16x32_bf16 v[132:135], v[232:235], a[196:199], v[132:135]
  v_sub_u32 v8, v8, v9
  v_cmp_gt_u32 vcc, 16, v0
  v_mov_b32 v18, 0x7f000000
  s_nop 0
  v_cndmask_b32 v18, v18, v17, vcc
  v_mfma_f32_16x16x32_bf16 v[132:135], v[236:239], a[212:215], v[132:135]
  ds_read_b64_tr_b16 v[230:231], v250 offset:25600
  v_mfma_f32_16x16x32_bf16 v[128:131], v[236:239], a[208:211], v[128:131]
  buffer_load_dword v255, v8, s[52:55], s65 offen
  v_mfma_f32_16x16x32_bf16 v[128:131], v[232:235], a[192:195], v[128:131]
  ds_read_b64_tr_b16 v[232:233], v251 offset:16384
  s_waitcnt lgkmcnt(9)
  v_mfma_f32_16x16x32_bf16 v[144:147], v[208:211], a[192:195], v[144:147]
  s_waitcnt vmcnt(7)
  s_barrier
  v_mfma_f32_16x16x32_bf16 v[144:147], v[212:215], a[208:211], v[144:147]
  ds_read_b64_tr_b16 v[234:235], v251 offset:17408
  s_add_u32 m0, s37, 0
  v_mfma_f32_16x16x32_bf16 v[148:151], v[212:215], a[212:215], v[148:151]
  ds_read_b128 a[224:227], v240 offset:32768
  ds_read_b128 v[20:23], v16 offset:0
  v_mfma_f32_16x16x32_bf16 v[148:151], v[208:211], a[196:199], v[148:151]
  ds_read_b64_tr_b16 v[236:237], v251 offset:24576
  v_mfma_f32_16x16x32_bf16 v[152:155], v[208:211], a[200:203], v[152:155]
  ds_read_b128 a[228:231], v240 offset:34816
  v_mfma_f32_16x16x32_bf16 v[152:155], v[212:215], a[216:219], v[152:155]
  ds_read_b64_tr_b16 v[238:239], v251 offset:25600
  ds_read_b128 v[24:27], v16 offset:1152
  s_add_u32 s34, s32, 524288
  v_mfma_f32_16x16x32_bf16 v[156:159], v[212:215], a[220:223], v[156:159]
  v_mfma_f32_16x16x32_bf16 v[156:159], v[208:211], a[204:207], v[156:159]
  ds_read_b64_tr_b16 v[208:209], v244 offset:32768
  ds_read_b128 a[232:235], v240 offset:36864
  s_waitcnt lgkmcnt(14)
  v_mfma_f32_16x16x32_bf16 v[172:175], v[216:219], a[204:207], v[172:175]
  ds_read_b128 v[28:31], v16 offset:2304
  v_mfma_f32_16x16x32_bf16 v[172:175], v[220:223], a[220:223], v[172:175]
  ds_read_b64_tr_b16 v[210:211], v244 offset:33792
  buffer_load_dwordx4 v4, s[16:19], s34 offen offset:0 lds
  v_mfma_f32_16x16x32_bf16 v[168:171], v[220:223], a[216:219], v[168:171]
  ds_read_b128 a[236:239], v240 offset:38912
  v_mfma_f32_16x16x32_bf16 v[168:171], v[216:219], a[200:203], v[168:171]
  ds_read_b64_tr_b16 v[212:213], v244 offset:40960
  v_mfma_f32_16x16x32_bf16 v[164:167], v[216:219], a[196:199], v[164:167]
  v_mfma_f32_16x16x32_bf16 v[164:167], v[220:223], a[212:215], v[164:167]
  ds_read_b64_tr_b16 v[214:215], v244 offset:41984
  buffer_load_dwordx4 v5, s[16:19], s34 offen offset:1024 lds
  v_mfma_f32_16x16x32_bf16 v[160:163], v[220:223], a[208:211], v[160:163]
  ds_read_b128 a[240:243], v241 offset:32768
  v_mfma_f32_16x16x32_bf16 v[160:163], v[216:219], a[192:195], v[160:163]
  ds_read_b64_tr_b16 v[216:217], v245 offset:32768
  s_waitcnt lgkmcnt(15)
  v_mfma_f32_16x16x32_bf16 v[176:179], v[224:227], a[192:195], v[176:179]
  ds_read_b128 a[244:247], v241 offset:34816
  v_mfma_f32_16x16x32_bf16 v[176:179], v[228:231], a[208:211], v[176:179]
  ds_read_b64_tr_b16 v[218:219], v245 offset:33792
  buffer_load_dwordx4 v6, s[16:19], s34 offen offset:2048 lds
  v_mfma_f32_16x16x32_bf16 v[180:183], v[228:231], a[212:215], v[180:183]
  v_mfma_f32_16x16x32_bf16 v[180:183], v[224:227], a[196:199], v[180:183]
  ds_read_b64_tr_b16 v[220:221], v245 offset:40960
  ds_read_b128 a[248:251], v241 offset:36864
  v_mfma_f32_16x16x32_bf16 v[184:187], v[224:227], a[200:203], v[184:187]
  s_waitcnt lgkmcnt(15)
  buffer_store_dwordx4 v[20:23], v17, s[20:23], s44 offen sc1
  v_mfma_f32_16x16x32_bf16 v[184:187], v[228:231], a[216:219], v[184:187]
  ds_read_b64_tr_b16 v[222:223], v245 offset:41984
  buffer_load_dwordx4 v7, s[16:19], s34 offen offset:3072 lds
  v_mfma_f32_16x16x32_bf16 v[188:191], v[228:231], a[220:223], v[188:191]
K_hA0_2:
  s_cbranch_execz K_hA0_3
  ds_read_b128 a[252:255], v241 offset:38912
  v_mfma_f32_16x16x32_bf16 v[188:191], v[224:227], a[204:207], v[188:191]
  ds_read_b64_tr_b16 v[224:225], v246 offset:32768
  s_waitcnt lgkmcnt(15)
  v_mfma_f32_16x16x32_bf16 v[204:207], v[232:235], a[204:207], v[204:207]
  v_mfma_f32_16x16x32_bf16 v[204:207], v[236:239], a[220:223], v[204:207]
  ds_read_b64_tr_b16 v[226:227], v246 offset:33792
  v_mfma_f32_16x16x32_bf16 v[200:203], v[236:239], a[216:219], v[200:203]
  v_mfma_f32_16x16x32_bf16 v[200:203], v[232:235], a[200:203], v[200:203]
  ds_read_b64_tr_b16 v[228:229], v246 offset:40960
  v_mfma_f32_16x16x32_bf16 v[196:199], v[232:235], a[196:199], v[196:199]
  s_add_u32 s44, s44, 33792
  v_mfma_f32_16x16x32_bf16 v[196:199], v[236:239], a[212:215], v[196:199]
  ds_read_b64_tr_b16 v[230:231], v246 offset:41984
  v_mfma_f32_16x16x32_bf16 v[192:195], v[236:239], a[208:211], v[192:195]
  v_mfma_f32_16x16x32_bf16 v[192:195], v[232:235], a[192:195], v[192:195]
  ds_read_b64_tr_b16 v[232:233], v247 offset:32768
  s_waitcnt lgkmcnt(5)
  v_mfma_f32_16x16x32_bf16 v[80:83], v[208:211], a[224:227], v[80:83]
  v_mfma_f32_16x16x32_bf16 v[80:83], v[212:215], a[240:243], v[80:83]
  ds_read_b64_tr_b16 v[234:235], v247 offset:33792
  v_mfma_f32_16x16x32_bf16 v[84:87], v[212:215], a[244:247], v[84:87]
  v_mfma_f32_16x16x32_bf16 v[84:87], v[208:211], a[228:231], v[84:87]
  ds_read_b64_tr_b16 v[236:237], v247 offset:40960
  v_mfma_f32_16x16x32_bf16 v[88:91], v[208:211], a[232:235], v[88:91]
  buffer_store_dwordx4 v[24:27], v17, s[20:23], s44 offen sc1
  v_mfma_f32_16x16x32_bf16 v[88:91], v[212:215], a[248:251], v[88:91]
  ds_read_b64_tr_b16 v[238:239], v247 offset:41984
  v_mfma_f32_16x16x32_bf16 v[92:95], v[212:215], a[252:255], v[92:95]
  v_mfma_f32_16x16x32_bf16 v[92:95], v[208:211], a[236:239], v[92:95]
  ds_read_b64_tr_b16 v[208:209], v248 offset:32768
  v_mfma_f32_16x16x32_bf16 v[108:111], v[216:219], a[236:239], v[108:111]
  v_mfma_f32_16x16x32_bf16 v[108:111], v[220:223], a[252:255], v[108:111]
  ds_read_b64_tr_b16 v[210:211], v248 offset:33792
  v_mfma_f32_16x16x32_bf16 v[104:107], v[220:223], a[248:251], v[104:107]
  v_mfma_f32_16x16x32_bf16 v[104:107], v[216:219], a[232:235], v[104:107]
  ds_read_b64_tr_b16 v[212:213], v248 offset:40960
  v_mfma_f32_16x16x32_bf16 v[100:103], v[216:219], a[228:231], v[100:103]
  s_add_u32 s44, s44, 33792
  v_mfma_f32_16x16x32_bf16 v[100:103], v[220:223], a[244:247], v[100:103]
  ds_read_b64_tr_b16 v[214:215], v248 offset:41984
  v_mfma_f32_16x16x32_bf16 v[96:99], v[220:223], a[240:243], v[96:99]
  v_mfma_f32_16x16x32_bf16 v[96:99], v[216:219], a[224:227], v[96:99]
  ds_read_b64_tr_b16 v[216:217], v249 offset:32768
  s_waitcnt lgkmcnt(9)
  v_mfma_f32_16x16x32_bf16 v[112:115], v[224:227], a[224:227], v[112:115]
  v_mfma_f32_16x16x32_bf16 v[112:115], v[228:231], a[240:243], v[112:115]
  ds_read_b64_tr_b16 v[218:219], v249 offset:33792
  v_mfma_f32_16x16x32_bf16 v[116:119], v[228:231], a[244:247], v[116:119]
  v_mfma_f32_16x16x32_bf16 v[116:119], v[224:227], a[228:231], v[116:119]
  ds_read_b64_tr_b16 v[220:221], v249 offset:40960
  v_mfma_f32_16x16x32_bf16 v[120:123], v[224:227], a[232:235], v[120:123]
  buffer_store_dwordx4 v[28:31], v18, s[20:23], s44 offen sc1
  v_mfma_f32_16x16x32_bf16 v[120:123], v[228:231], a[248:251], v[120:123]
  ds_read_b64_tr_b16 v[222:223], v249 offset:41984
  v_mfma_f32_16x16x32_bf16 v[124:127], v[228:231], a[252:255], v[124:127]
  v_mfma_f32_16x16x32_bf16 v[124:127], v[224:227], a[236:239], v[124:127]
  ds_read_b64_tr_b16 v[224:225], v250 offset:32768
  s_waitcnt lgkmcnt(9)
  v_mfma_f32_16x16x32_bf16 v[140:143], v[232:235], a[236:239], v[140:143]
  v_mfma_f32_16x16x32_bf16 v[140:143], v[236:239], a[252:255], v[140:143]
  ds_read_b64_tr_b16 v[226:227], v250 offset:33792
  v_mfma_f32_16x16x32_bf16 v[136:139], v[236:239], a[248:251], v[136:139]
  v_mfma_f32_16x16x32_bf16 v[136:139], v[232:235], a[232:235], v[136:139]
  ds_read_b64_tr_b16 v[228:229], v250 offset:40960
  v_mfma_f32_16x16x32_bf16 v[132:135], v[232:235], a[228:231], v[132:135]
  v_mfma_f32_16x16x32_bf16 v[132:135], v[236:239], a[244:247], v[132:135]
  ds_read_b64_tr_b16 v[230:231], v250 offset:41984
  v_mfma_f32_16x16x32_bf16 v[128:131], v[236:239], a[240:243], v[128:131]
  v_mfma_f32_16x16x32_bf16 v[128:131], v[232:235], a[224:227], v[128:131]
  ds_read_b64_tr_b16 v[232:233], v251 offset:32768
  s_waitcnt lgkmcnt(9)
  v_mfma_f32_16x16x32_bf16 v[144:147], v[208:211], a[224:227], v[144:147]
  s_waitcnt vmcnt(9)
  s_barrier
  v_mfma_f32_16x16x32_bf16 v[144:147], v[212:215], a[240:243], v[144:147]
  ds_read_b64_tr_b16 v[234:235], v251 offset:33792
  s_add_u32 m0, s37, 16384
  v_cvt_pk_bf16_f32 v16, v80, v81
  v_mfma_f32_16x16x32_bf16 v[148:151], v[212:215], a[244:247], v[148:151]
  v_cvt_pk_bf16_f32 v17, v82, v83
  v_cvt_pk_bf16_f32 v18, v96, v97
  v_mfma_f32_16x16x32_bf16 v[148:151], v[208:211], a[228:231], v[148:151]
  ds_read_b64_tr_b16 v[236:237], v251 offset:40960
  v_cvt_pk_bf16_f32 v19, v98, v99
  v_mfma_f32_16x16x32_bf16 v[152:155], v[208:211], a[232:235], v[152:155]
  s_add_u32 s34, s32, 1048576
  v_cvt_pk_bf16_f32 v32, v84, v85
  v_cvt_pk_bf16_f32 v33, v86, v87
  v_mfma_f32_16x16x32_bf16 v[152:155], v[212:215], a[248:251], v[152:155]
  ds_read_b64_tr_b16 v[238:239], v251 offset:41984
  v_cvt_pk_bf16_f32 v34, v100, v101
  v_mfma_f32_16x16x32_bf16 v[156:159], v[212:215], a[252:255], v[156:159]
  v_cvt_pk_bf16_f32 v35, v102, v103
  v_cvt_pk_bf16_f32 v48, v88, v89
  v_mfma_f32_16x16x32_bf16 v[156:159], v[208:211], a[236:239], v[156:159]
  ds_read_b64_tr_b16 v[208:209], v244 offset:49152
  buffer_load_dwordx4 v4, s[16:19], s34 offen offset:0 lds
  s_waitcnt lgkmcnt(9)
  v_mfma_f32_16x16x32_bf16 v[172:175], v[216:219], a[236:239], v[172:175]
  v_cvt_pk_bf16_f32 v49, v90, v91
  v_cvt_pk_bf16_f32 v50, v104, v105
  v_mfma_f32_16x16x32_bf16 v[172:175], v[220:223], a[252:255], v[172:175]
  ds_read_b64_tr_b16 v[210:211], v244 offset:50176
  v_cvt_pk_bf16_f32 v51, v106, v107
  v_mfma_f32_16x16x32_bf16 v[168:171], v[220:223], a[248:251], v[168:171]
  v_cvt_pk_bf16_f32 v64, v92, v93
  v_cvt_pk_bf16_f32 v65, v94, v95
  v_mfma_f32_16x16x32_bf16 v[168:171], v[216:219], a[232:235], v[168:171]
  ds_read_b64_tr_b16 v[212:213], v244 offset:57344
  buffer_load_dwordx4 v5, s[16:19], s34 offen offset:1024 lds
  v_mfma_f32_16x16x32_bf16 v[164:167], v[216:219], a[228:231], v[164:167]
  v_cvt_pk_bf16_f32 v66, v108, v109
  v_cvt_pk_bf16_f32 v67, v110, v111
  v_mfma_f32_16x16x32_bf16 v[164:167], v[220:223], a[244:247], v[164:167]
  ds_read_b64_tr_b16 v[214:215], v244 offset:58368
  v_cvt_pk_bf16_f32 v20, v112, v113
  v_mfma_f32_16x16x32_bf16 v[160:163], v[220:223], a[240:243], v[160:163]
  buffer_load_dwordx4 v6, s[16:19], s34 offen offset:2048 lds
  v_cvt_pk_bf16_f32 v21, v114, v115
  v_mfma_f32_16x16x32_bf16 v[160:163], v[216:219], a[224:227], v[160:163]
  ds_read_b64_tr_b16 v[216:217], v245 offset:49152
  s_waitcnt lgkmcnt(9)
  v_cvt_pk_bf16_f32 v22, v128, v129
  v_mfma_f32_16x16x32_bf16 v[176:179], v[224:227], a[224:227], v[176:179]
  v_cvt_pk_bf16_f32 v23, v130, v131
  v_cvt_pk_bf16_f32 v36, v116, v117
  v_mfma_f32_16x16x32_bf16 v[176:179], v[228:231], a[240:243], v[176:179]
  ds_read_b64_tr_b16 v[218:219], v245 offset:50176
  buffer_load_dwordx4 v7, s[16:19], s34 offen offset:3072 lds
  v_mfma_f32_16x16x32_bf16 v[180:183], v[228:231], a[244:247], v[180:183]
  v_cvt_pk_bf16_f32 v37, v118, v119
K_hA1_2:
  s_cbranch_execz K_hA1_3
  v_cvt_pk_bf16_f32 v38, v132, v133
  v_mfma_f32_16x16x32_bf16 v[180:183], v[224:227], a[228:231], v[180:183]
  ds_read_b64_tr_b16 v[220:221], v245 offset:57344
  v_cvt_pk_bf16_f32 v39, v134, v135
  v_mfma_f32_16x16x32_bf16 v[184:187], v[224:227], a[232:235], v[184:187]
  v_cvt_pk_bf16_f32 v52, v120, v121
  v_cvt_pk_bf16_f32 v53, v122, v123
  v_mfma_f32_16x16x32_bf16 v[184:187], v[228:231], a[248:251], v[184:187]
  ds_read_b64_tr_b16 v[222:223], v245 offset:58368
  s_add_u32 m0, s33, 65536
  v_cvt_pk_bf16_f32 v54, v136, v137
  v_mfma_f32_16x16x32_bf16 v[188:191], v[228:231], a[252:255], v[188:191]
  v_cvt_pk_bf16_f32 v55, v138, v139
  v_cvt_pk_bf16_f32 v68, v124, v125
  v_mfma_f32_16x16x32_bf16 v[188:191], v[224:227], a[236:239], v[188:191]
  ds_read_b64_tr_b16 v[224:225], v246 offset:49152
  s_waitcnt lgkmcnt(9)
  v_cvt_pk_bf16_f32 v69, v126, v127
  v_mfma_f32_16x16x32_bf16 v[204:207], v[232:235], a[236:239], v[204:207]
  v_cvt_pk_bf16_f32 v70, v140, v141
  v_cvt_pk_bf16_f32 v71, v142, v143
  v_mfma_f32_16x16x32_bf16 v[204:207], v[236:239], a[252:255], v[204:207]
  ds_read_b64_tr_b16 v[226:227], v246 offset:50176
  s_add_u32 s35, s48, 0
  v_cvt_pk_bf16_f32 v24, v144, v145
  v_mfma_f32_16x16x32_bf16 v[200:203], v[236:239], a[248:251], v[200:203]
  v_cvt_pk_bf16_f32 v25, v146, v147
  v_cvt_pk_bf16_f32 v26, v160, v161
  v_mfma_f32_16x16x32_bf16 v[200:203], v[232:235], a[232:235], v[200:203]
  ds_read_b64_tr_b16 v[228:229], v246 offset:57344
  v_cvt_pk_bf16_f32 v27, v162, v163
  v_mfma_f32_16x16x32_bf16 v[196:199], v[232:235], a[228:231], v[196:199]
  v_cvt_pk_bf16_f32 v40, v148, v149
  v_cvt_pk_bf16_f32 v41, v150, v151
  v_mfma_f32_16x16x32_bf16 v[196:199], v[236:239], a[244:247], v[196:199]
  ds_read_b64_tr_b16 v[230:231], v246 offset:58368
  buffer_load_dwordx4 v12, s[12:15], s35 offen offset:0 lds
  v_mfma_f32_16x16x32_bf16 v[192:195], v[236:239], a[240:243], v[192:195]
  v_cvt_pk_bf16_f32 v42, v164, v165
  v_cvt_pk_bf16_f32 v43, v166, v167
  v_mfma_f32_16x16x32_bf16 v[192:195], v[232:235], a[224:227], v[192:195]
  ds_read_b64_tr_b16 v[232:233], v247 offset:49152
  s_waitcnt lgkmcnt(9)
  v_cvt_pk_bf16_f32 v56, v152, v153
  v_mfma_f32_16x16x32_bf16 v[80:83], a[0:3], v[208:211], 0
  v_cvt_pk_bf16_f32 v57, v154, v155
  v_cvt_pk_bf16_f32 v58, v168, v169
  v_mfma_f32_16x16x32_bf16 v[80:83], a[16:19], v[212:215], v[80:83]
  ds_read_b64_tr_b16 v[234:235], v247 offset:50176
  buffer_load_dwordx4 v13, s[12:15], s35 offen offset:1024 lds
  v_mfma_f32_16x16x32_bf16 v[84:87], a[20:23], v[212:215], 0
  v_cvt_pk_bf16_f32 v59, v170, v171
  v_cvt_pk_bf16_f32 v72, v156, v157
  v_mfma_f32_16x16x32_bf16 v[84:87], a[4:7], v[208:211], v[84:87]
  ds_read_b64_tr_b16 v[236:237], v247 offset:57344
  v_cvt_pk_bf16_f32 v73, v158, v159
  v_mfma_f32_16x16x32_bf16 v[88:91], a[8:11], v[208:211], 0
  v_cvt_pk_bf16_f32 v74, v172, v173
  v_cvt_pk_bf16_f32 v75, v174, v175
  v_mfma_f32_16x16x32_bf16 v[88:91], a[24:27], v[212:215], v[88:91]
  ds_read_b64_tr_b16 v[238:239], v247 offset:58368
  buffer_load_dwordx4 v14, s[12:15], s35 offen offset:2048 lds
  v_mfma_f32_16x16x32_bf16 v[92:95], a[28:31], v[212:215], 0
  v_cvt_pk_bf16_f32 v28, v176, v177
  v_cvt_pk_bf16_f32 v29, v178, v179
  v_mfma_f32_16x16x32_bf16 v[92:95], a[12:15], v[208:211], v[92:95]
  ds_read_b64_tr_b16 v[208:209], v248 offset:49152
  s_waitcnt lgkmcnt(9)
  v_cvt_pk_bf16_f32 v30, v192, v193
  v_mfma_f32_16x16x32_bf16 v[108:111], a[12:15], v[216:219], 0
  v_cvt_pk_bf16_f32 v31, v194, v195
  v_cvt_pk_bf16_f32 v44, v180, v181
  v_mfma_f32_16x16x32_bf16 v[108:111], a[28:31], v[220:223], v[108:111]
  ds_read_b64_tr_b16 v[210:211], v248 offset:50176
  buffer_load_dwordx4 v15, s[12:15], s35 offen offset:3072 lds
  v_mfma_f32_16x16x32_bf16 v[104:107], a[24:27], v[220:223], 0
  v_cvt_pk_bf16_f32 v45, v182, v183
  v_cvt_pk_bf16_f32 v46, v196, v197
  v_mfma_f32_16x16x32_bf16 v[104:107], a[8:11], v[216:219], v[104:107]
  ds_read_b64_tr_b16 v[212:213], v248 offset:57344
  v_cvt_pk_bf16_f32 v47, v198, v199
  v_mfma_f32_16x16x32_bf16 v[100:103], a[4:7], v[216:219], 0
  v_cvt_pk_bf16_f32 v60, v184, v185
  v_cvt_pk_bf16_f32 v61, v186, v187
  v_mfma_f32_16x16x32_bf16 v[100:103], a[20:23], v[220:223], v[100:103]
  ds_read_b64_tr_b16 v[214:215], v248 offset:58368
  v_cvt_pk_bf16_f32 v62, v200, v201
  v_mfma_f32_16x16x32_bf16 v[96:99], a[16:19], v[220:223], 0
  v_cvt_pk_bf16_f32 v63, v202, v203
  v_cvt_pk_bf16_f32 v76, v188, v189
  v_mfma_f32_16x16x32_bf16 v[96:99], a[0:3], v[216:219], v[96:99]
  ds_read_b64_tr_b16 v[216:217], v249 offset:49152
  s_waitcnt lgkmcnt(9)
  v_cvt_pk_bf16_f32 v77, v190, v191
  v_mfma_f32_16x16x32_bf16 v[112:115], a[0:3], v[224:227], 0
  v_cvt_pk_bf16_f32 v78, v204, v205
  v_cvt_pk_bf16_f32 v79, v206, v207
  v_mfma_f32_16x16x32_bf16 v[112:115], a[16:19], v[228:231], v[112:115]
  ds_read_b64_tr_b16 v[218:219], v249 offset:50176
  v_mfma_f32_16x16x32_bf16 v[116:119], a[20:23], v[228:231], 0
  v_mfma_f32_16x16x32_bf16 v[116:119], a[4:7], v[224:227], v[116:119]
  ds_read_b64_tr_b16 v[220:221], v249 offset:57344
  s_add_u32 m0, s33, 69632
  v_mfma_f32_16x16x32_bf16 v[120:123], a[8:11], v[224:227], 0
  v_mov_b32 v252, 1
  v_mfma_f32_16x16x32_bf16 v[120:123], a[24:27], v[228:231], v[120:123]
  ds_read_b64_tr_b16 v[222:223], v249 offset:58368
  s_add_u32 s35, s49, 0
  v_mfma_f32_16x16x32_bf16 v[124:127], a[28:31], v[228:231], 0
  v_bfe_u32 v253, v0, 3, 2
  v_mfma_f32_16x16x32_bf16 v[124:127], a[12:15], v[224:227], v[124:127]
  ds_read_b64_tr_b16 v[224:225], v250 offset:49152
  buffer_load_dwordx4 v12, s[12:15], s35 offen offset:0 lds
  s_waitcnt lgkmcnt(9)
  v_mfma_f32_16x16x32_bf16 v[140:143], a[12:15], v[232:235], 0
  v_mfma_f32_16x16x32_bf16 v[140:143], a[28:31], v[236:239], v[140:143]
  ds_read_b64_tr_b16 v[226:227], v250 offset:50176
  v_lshlrev_b32 v253, 7, v253
  v_mfma_f32_16x16x32_bf16 v[136:139], a[24:27], v[236:239], 0
  buffer_load_dwordx4 v13, s[12:15], s35 offen offset:1024 lds
  v_mfma_f32_16x16x32_bf16 v[136:139], a[8:11], v[232:235], v[136:139]
  ds_read_b64_tr_b16 v[228:229], v250 offset:57344
  v_and_b32 v3, 7, v0
  v_mfma_f32_16x16x32_bf16 v[132:135], a[4:7], v[232:235], 0
  buffer_load_dwordx4 v14, s[12:15], s35 offen offset:2048 lds
  v_mfma_f32_16x16x32_bf16 v[132:135], a[20:23], v[236:239], v[132:135]
  ds_read_b64_tr_b16 v[230:231], v250 offset:58368
  v_mfma_f32_16x16x32_bf16 v[128:131], a[16:19], v[236:239], 0
  buffer_load_dwordx4 v15, s[12:15], s35 offen offset:3072 lds
  v_lshl_add_u32 v253, v3, 2, v253
  v_mfma_f32_16x16x32_bf16 v[128:131], a[0:3], v[232:235], v[128:131]
  ds_read_b64_tr_b16 v[232:233], v251 offset:49152
K_hA2_2:
  s_cbranch_execz K_hA2_3
  s_waitcnt lgkmcnt(9)
  v_mfma_f32_16x16x32_bf16 v[144:147], a[0:3], v[208:211], 0
  s_waitcnt vmcnt(14)
  s_barrier
  v_mfma_f32_16x16x32_bf16 v[144:147], a[16:19], v[212:215], v[144:147]
  ds_read_b64_tr_b16 v[234:235], v251 offset:50176
  s_add_u32 m0, s37, 32768
  s_add_u32 s29, s50, 0
  v_mfma_f32_16x16x32_bf16 v[148:151], a[20:23], v[212:215], 0
  v_mfma_f32_16x16x32_bf16 v[148:151], a[4:7], v[208:211], v[148:151]
  ds_read_b64_tr_b16 v[236:237], v251 offset:57344
  v_mfma_f32_16x16x32_bf16 v[152:155], a[8:11], v[208:211], 0
  v_mfma_f32_16x16x32_bf16 v[152:155], a[24:27], v[212:215], v[152:155]
  ds_read_b64_tr_b16 v[238:239], v251 offset:58368
  s_add_u32 s34, s32, 1572864
  v_mfma_f32_16x16x32_bf16 v[156:159], a[28:31], v[212:215], 0
  v_mfma_f32_16x16x32_bf16 v[156:159], a[12:15], v[208:211], v[156:159]
  ds_read_b64_tr_b16 v[208:209], v244 offset:0
  s_waitcnt lgkmcnt(9)
  v_mfma_f32_16x16x32_bf16 v[172:175], a[12:15], v[216:219], 0
  v_mfma_f32_16x16x32_bf16 v[172:175], a[28:31], v[220:223], v[172:175]
  ds_read_b64_tr_b16 v[210:211], v244 offset:1024
  buffer_load_dwordx4 v4, s[16:19], s34 offen offset:0 lds
  v_mfma_f32_16x16x32_bf16 v[168:171], a[24:27], v[220:223], 0
  v_mfma_f32_16x16x32_bf16 v[168:171], a[8:11], v[216:219], v[168:171]
  ds_read_b64_tr_b16 v[212:213], v244 offset:8192
  v_mfma_f32_16x16x32_bf16 v[164:167], a[4:7], v[216:219], 0
  v_mfma_f32_16x16x32_bf16 v[164:167], a[20:23], v[220:223], v[164:167]
  ds_read_b64_tr_b16 v[214:215], v244 offset:9216
  buffer_load_dwordx4 v5, s[16:19], s34 offen offset:1024 lds
  v_mfma_f32_16x16x32_bf16 v[160:163], a[16:19], v[220:223], 0
  v_mfma_f32_16x16x32_bf16 v[160:163], a[0:3], v[216:219], v[160:163]
  ds_read_b64_tr_b16 v[216:217], v245 offset:0
  s_waitcnt lgkmcnt(9)
  v_mfma_f32_16x16x32_bf16 v[176:179], a[0:3], v[224:227], 0
  v_mfma_f32_16x16x32_bf16 v[176:179], a[16:19], v[228:231], v[176:179]
  ds_read_b64_tr_b16 v[218:219], v245 offset:1024
  buffer_load_dwordx4 v6, s[16:19], s34 offen offset:2048 lds
  v_mfma_f32_16x16x32_bf16 v[180:183], a[20:23], v[228:231], 0
  v_mfma_f32_16x16x32_bf16 v[180:183], a[4:7], v[224:227], v[180:183]
  ds_read_b64_tr_b16 v[220:221], v245 offset:8192
  v_mfma_f32_16x16x32_bf16 v[184:187], a[8:11], v[224:227], 0
  buffer_store_dwordx4 v[16:19], v1, s[20:23], s29 offen offset:0 sc1
  v_mfma_f32_16x16x32_bf16 v[184:187], a[24:27], v[228:231], v[184:187]
  ds_read_b64_tr_b16 v[222:223], v245 offset:9216
  buffer_load_dwordx4 v7, s[16:19], s34 offen offset:3072 lds
  v_mfma_f32_16x16x32_bf16 v[188:191], a[28:31], v[228:231], 0
  v_mfma_f32_16x16x32_bf16 v[188:191], a[12:15], v[224:227], v[188:191]
  ds_read_b64_tr_b16 v[224:225], v246 offset:0
  s_waitcnt lgkmcnt(9)
  v_mfma_f32_16x16x32_bf16 v[204:207], a[12:15], v[232:235], 0
  v_mfma_f32_16x16x32_bf16 v[204:207], a[28:31], v[236:239], v[204:207]
  ds_read_b64_tr_b16 v[226:227], v246 offset:1024
  v_mfma_f32_16x16x32_bf16 v[200:203], a[24:27], v[236:239], 0
  v_mfma_f32_16x16x32_bf16 v[200:203], a[8:11], v[232:235], v[200:203]
  ds_read_b64_tr_b16 v[228:229], v246 offset:8192
  v_mfma_f32_16x16x32_bf16 v[196:199], a[4:7], v[232:235], 0
  v_mfma_f32_16x16x32_bf16 v[196:199], a[20:23], v[236:239], v[196:199]
  ds_read_b64_tr_b16 v[230:231], v246 offset:9216
  v_mfma_f32_16x16x32_bf16 v[192:195], a[16:19], v[236:239], 0
  v_mfma_f32_16x16x32_bf16 v[192:195], a[0:3], v[232:235], v[192:195]
  ds_read_b64_tr_b16 v[232:233], v247 offset:0
  s_waitcnt lgkmcnt(9)
  v_mfma_f32_16x16x32_bf16 v[80:83], a[32:35], v[208:211], v[80:83]
  v_mfma_f32_16x16x32_bf16 v[80:83], a[48:51], v[212:215], v[80:83]
  ds_read_b64_tr_b16 v[234:235], v247 offset:1024
  v_mfma_f32_16x16x32_bf16 v[84:87], a[52:55], v[212:215], v[84:87]
  v_mfma_f32_16x16x32_bf16 v[84:87], a[36:39], v[208:211], v[84:87]
  ds_read_b64_tr_b16 v[236:237], v247 offset:8192
  v_mfma_f32_16x16x32_bf16 v[88:91], a[40:43], v[208:211], v[88:91]
  v_mfma_f32_16x16x32_bf16 v[88:91], a[56:59], v[212:215], v[88:91]
  ds_read_b64_tr_b16 v[238:239], v247 offset:9216
  s_add_u32 m0, s33, 0
  v_mfma_f32_16x16x32_bf16 v[92:95], a[60:63], v[212:215], v[92:95]
  v_mfma_f32_16x16x32_bf16 v[92:95], a[44:47], v[208:211], v[92:95]
  ds_read_b64_tr_b16 v[208:209], v248 offset:0
  s_waitcnt lgkmcnt(9)
  v_mfma_f32_16x16x32_bf16 v[108:111], a[44:47], v[216:219], v[108:111]
  v_mfma_f32_16x16x32_bf16 v[108:111], a[60:63], v[220:223], v[108:111]
  buffer_store_dwordx4 v[20:23], v1, s[20:23], s29 offen offset:1024 sc1
  ds_read_b64_tr_b16 v[210:211], v248 offset:1024
  s_add_u32 s35, s48, 128
  v_mfma_f32_16x16x32_bf16 v[104:107], a[56:59], v[220:223], v[104:107]
  v_mfma_f32_16x16x32_bf16 v[104:107], a[40:43], v[216:219], v[104:107]
  ds_read_b64_tr_b16 v[212:213], v248 offset:8192
  v_mfma_f32_16x16x32_bf16 v[100:103], a[36:39], v[216:219], v[100:103]
  v_mfma_f32_16x16x32_bf16 v[100:103], a[52:55], v[220:223], v[100:103]
  ds_read_b64_tr_b16 v[214:215], v248 offset:9216
  buffer_load_dwordx4 v12, s[12:15], s35 offen offset:0 lds
  v_mfma_f32_16x16x32_bf16 v[96:99], a[48:51], v[220:223], v[96:99]
  v_mfma_f32_16x16x32_bf16 v[96:99], a[32:35], v[216:219], v[96:99]
  ds_read_b64_tr_b16 v[216:217], v249 offset:0
  s_waitcnt lgkmcnt(9)
  v_mfma_f32_16x16x32_bf16 v[112:115], a[32:35], v[224:227], v[112:115]
  v_mfma_f32_16x16x32_bf16 v[112:115], a[48:51], v[228:231], v[112:115]
  ds_read_b64_tr_b16 v[218:219], v249 offset:1024
  buffer_load_dwordx4 v13, s[12:15], s35 offen offset:1024 lds
  v_mfma_f32_16x16x32_bf16 v[116:119], a[52:55], v[228:231], v[116:119]
  v_mfma_f32_16x16x32_bf16 v[116:119], a[36:39], v[224:227], v[116:119]
  ds_read_b64_tr_b16 v[220:221], v249 offset:8192
  v_mfma_f32_16x16x32_bf16 v[120:123], a[40:43], v[224:227], v[120:123]
  v_mfma_f32_16x16x32_bf16 v[120:123], a[56:59], v[228:231], v[120:123]
  ds_read_b64_tr_b16 v[222:223], v249 offset:9216
  buffer_load_dwordx4 v14, s[12:15], s35 offen offset:2048 lds
  v_mfma_f32_16x16x32_bf16 v[124:127], a[60:63], v[228:231], v[124:127]
  v_mfma_f32_16x16x32_bf16 v[124:127], a[44:47], v[224:227], v[124:127]
  ds_read_b64_tr_b16 v[224:225], v250 offset:0
  s_waitcnt lgkmcnt(9)
  v_mfma_f32_16x16x32_bf16 v[140:143], a[44:47], v[232:235], v[140:143]
  v_mfma_f32_16x16x32_bf16 v[140:143], a[60:63], v[236:239], v[140:143]
  ds_read_b64_tr_b16 v[226:227], v250 offset:1024
  buffer_load_dwordx4 v15, s[12:15], s35 offen offset:3072 lds
  v_mfma_f32_16x16x32_bf16 v[136:139], a[56:59], v[236:239], v[136:139]
  v_mfma_f32_16x16x32_bf16 v[136:139], a[40:43], v[232:235], v[136:139]
  ds_read_b64_tr_b16 v[228:229], v250 offset:8192
  v_mfma_f32_16x16x32_bf16 v[132:135], a[36:39], v[232:235], v[132:135]
  v_mfma_f32_16x16x32_bf16 v[132:135], a[52:55], v[236:239], v[132:135]
  ds_read_b64_tr_b16 v[230:231], v250 offset:9216
  v_mfma_f32_16x16x32_bf16 v[128:131], a[48:51], v[236:239], v[128:131]
  buffer_store_dwordx4 v[24:27], v1, s[20:23], s29 offen offset:2048 sc1
  v_mfma_f32_16x16x32_bf16 v[128:131], a[32:35], v[232:235], v[128:131]
  ds_read_b64_tr_b16 v[232:233], v251 offset:0
  s_waitcnt lgkmcnt(9)
  v_mfma_f32_16x16x32_bf16 v[144:147], a[32:35], v[208:211], v[144:147]
  s_waitcnt vmcnt(19)
  s_barrier
  v_mfma_f32_16x16x32_bf16 v[144:147], a[48:51], v[212:215], v[144:147]
  ds_read_b64_tr_b16 v[234:235], v251 offset:1024
  s_add_u32 m0, s37, 49152
  v_mfma_f32_16x16x32_bf16 v[148:151], a[52:55], v[212:215], v[148:151]
  v_mfma_f32_16x16x32_bf16 v[148:151], a[36:39], v[208:211], v[148:151]
  ds_read_b64_tr_b16 v[236:237], v251 offset:8192
  v_mfma_f32_16x16x32_bf16 v[152:155], a[40:43], v[208:211], v[152:155]
  s_add_u32 s34, s32, 2097152
  v_mfma_f32_16x16x32_bf16 v[152:155], a[56:59], v[212:215], v[152:155]
K_hA3_2:
  s_cbranch_execz K_hA3_3
  ds_read_b64_tr_b16 v[238:239], v251 offset:9216
  v_mfma_f32_16x16x32_bf16 v[156:159], a[60:63], v[212:215], v[156:159]
  v_mfma_f32_16x16x32_bf16 v[156:159], a[44:47], v[208:211], v[156:159]
  ds_read_b64_tr_b16 v[208:209], v244 offset:16384
  s_waitcnt lgkmcnt(9)
  v_mfma_f32_16x16x32_bf16 v[172:175], a[44:47], v[216:219], v[172:175]
  buffer_load_dwordx4 v4, s[16:19], s34 offen offset:0 lds
  v_mfma_f32_16x16x32_bf16 v[172:175], a[60:63], v[220:223], v[172:175]
  ds_read_b64_tr_b16 v[210:211], v244 offset:17408
  v_mfma_f32_16x16x32_bf16 v[168:171], a[56:59], v[220:223], v[168:171]
  v_mfma_f32_16x16x32_bf16 v[168:171], a[40:43], v[216:219], v[168:171]
  ds_read_b64_tr_b16 v[212:213], v244 offset:24576
  v_mfma_f32_16x16x32_bf16 v[164:167], a[36:39], v[216:219], v[164:167]
  buffer_load_dwordx4 v5, s[16:19], s34 offen offset:1024 lds
  v_mfma_f32_16x16x32_bf16 v[164:167], a[52:55], v[220:223], v[164:167]
  ds_read_b64_tr_b16 v[214:215], v244 offset:25600
  v_mfma_f32_16x16x32_bf16 v[160:163], a[48:51], v[220:223], v[160:163]
  v_mfma_f32_16x16x32_bf16 v[160:163], a[32:35], v[216:219], v[160:163]
  ds_read_b64_tr_b16 v[216:217], v245 offset:16384
  buffer_load_dwordx4 v6, s[16:19], s34 offen offset:2048 lds
  s_waitcnt lgkmcnt(9)
  v_mfma_f32_16x16x32_bf16 v[176:179], a[32:35], v[224:227], v[176:179]
  v_mfma_f32_16x16x32_bf16 v[176:179], a[48:51], v[228:231], v[176:179]
  ds_read_b64_tr_b16 v[218:219], v245 offset:17408
  v_mfma_f32_16x16x32_bf16 v[180:183], a[52:55], v[228:231], v[180:183]
  v_mfma_f32_16x16x32_bf16 v[180:183], a[36:39], v[224:227], v[180:183]
  buffer_store_dwordx4 v[28:31], v1, s[20:23], s29 offen offset:3072 sc1
  ds_read_b64_tr_b16 v[220:221], v245 offset:24576
  buffer_load_dwordx4 v7, s[16:19], s34 offen offset:3072 lds
  v_mfma_f32_16x16x32_bf16 v[184:187], a[40:43], v[224:227], v[184:187]
  v_mfma_f32_16x16x32_bf16 v[184:187], a[56:59], v[228:231], v[184:187]
  ds_read_b64_tr_b16 v[222:223], v245 offset:25600
  v_mfma_f32_16x16x32_bf16 v[188:191], a[60:63], v[228:231], v[188:191]
  v_mfma_f32_16x16x32_bf16 v[188:191], a[44:47], v[224:227], v[188:191]
  ds_read_b64_tr_b16 v[224:225], v246 offset:16384
  s_add_u32 m0, s33, 4096
  s_waitcnt lgkmcnt(9)
  v_mfma_f32_16x16x32_bf16 v[204:207], a[44:47], v[232:235], v[204:207]
  v_mfma_f32_16x16x32_bf16 v[204:207], a[60:63], v[236:239], v[204:207]
  ds_read_b64_tr_b16 v[226:227], v246 offset:17408
  v_mfma_f32_16x16x32_bf16 v[200:203], a[56:59], v[236:239], v[200:203]
  v_mfma_f32_16x16x32_bf16 v[200:203], a[40:43], v[232:235], v[200:203]
  ds_read_b64_tr_b16 v[228:229], v246 offset:24576
  s_add_u32 s35, s49, 128
  v_mfma_f32_16x16x32_bf16 v[196:199], a[36:39], v[232:235], v[196:199]
  v_mfma_f32_16x16x32_bf16 v[196:199], a[52:55], v[236:239], v[196:199]
  ds_read_b64_tr_b16 v[230:231], v246 offset:25600
  v_mfma_f32_16x16x32_bf16 v[192:195], a[48:51], v[236:239], v[192:195]
  v_mfma_f32_16x16x32_bf16 v[192:195], a[32:35], v[232:235], v[192:195]
  ds_read_b64_tr_b16 v[232:233], v247 offset:16384
  buffer_load_dwordx4 v12, s[12:15], s35 offen offset:0 lds
  s_waitcnt lgkmcnt(9)
  v_mfma_f32_16x16x32_bf16 v[80:83], a[64:67], v[208:211], v[80:83]
  v_mfma_f32_16x16x32_bf16 v[80:83], a[80:83], v[212:215], v[80:83]
  ds_read_b64_tr_b16 v[234:235], v247 offset:17408
  v_mfma_f32_16x16x32_bf16 v[84:87], a[84:87], v[212:215], v[84:87]
  v_mfma_f32_16x16x32_bf16 v[84:87], a[68:71], v[208:211], v[84:87]
  ds_read_b64_tr_b16 v[236:237], v247 offset:24576
  buffer_load_dwordx4 v13, s[12:15], s35 offen offset:1024 lds
  v_mfma_f32_16x16x32_bf16 v[88:91], a[72:75], v[208:211], v[88:91]
  v_mfma_f32_16x16x32_bf16 v[88:91], a[88:91], v[212:215], v[88:91]
  ds_read_b64_tr_b16 v[238:239], v247 offset:25600
  v_mfma_f32_16x16x32_bf16 v[92:95], a[92:95], v[212:215], v[92:95]
  v_mfma_f32_16x16x32_bf16 v[92:95], a[76:79], v[208:211], v[92:95]
  ds_read_b64_tr_b16 v[208:209], v248 offset:16384
  buffer_load_dwordx4 v14, s[12:15], s35 offen offset:2048 lds
  s_waitcnt lgkmcnt(9)
  v_mfma_f32_16x16x32_bf16 v[108:111], a[76:79], v[216:219], v[108:111]
  s_add_u32 s29, s50, 4096
  v_mfma_f32_16x16x32_bf16 v[108:111], a[92:95], v[220:223], v[108:111]
  ds_read_b64_tr_b16 v[210:211], v248 offset:17408
  v_mfma_f32_16x16x32_bf16 v[104:107], a[88:91], v[220:223], v[104:107]
  v_mfma_f32_16x16x32_bf16 v[104:107], a[72:75], v[216:219], v[104:107]
  ds_read_b64_tr_b16 v[212:213], v248 offset:24576
  buffer_load_dwordx4 v15, s[12:15], s35 offen offset:3072 lds
  v_mfma_f32_16x16x32_bf16 v[100:103], a[68:71], v[216:219], v[100:103]
  v_mfma_f32_16x16x32_bf16 v[100:103], a[84:87], v[220:223], v[100:103]
  ds_read_b64_tr_b16 v[214:215], v248 offset:25600
  v_mfma_f32_16x16x32_bf16 v[96:99], a[80:83], v[220:223], v[96:99]
  v_mfma_f32_16x16x32_bf16 v[96:99], a[64:67], v[216:219], v[96:99]
  ds_read_b64_tr_b16 v[216:217], v249 offset:16384
  s_waitcnt lgkmcnt(9)
  v_mfma_f32_16x16x32_bf16 v[112:115], a[64:67], v[224:227], v[112:115]
  v_mfma_f32_16x16x32_bf16 v[112:115], a[80:83], v[228:231], v[112:115]
  ds_read_b64_tr_b16 v[218:219], v249 offset:17408
  v_mfma_f32_16x16x32_bf16 v[116:119], a[84:87], v[228:231], v[116:119]
  v_mfma_f32_16x16x32_bf16 v[116:119], a[68:71], v[224:227], v[116:119]
  ds_read_b64_tr_b16 v[220:221], v249 offset:24576
  v_mfma_f32_16x16x32_bf16 v[120:123], a[72:75], v[224:227], v[120:123]
  v_mfma_f32_16x16x32_bf16 v[120:123], a[88:91], v[228:231], v[120:123]
  ds_read_b64_tr_b16 v[222:223], v249 offset:25600
  v_mfma_f32_16x16x32_bf16 v[124:127], a[92:95], v[228:231], v[124:127]
  v_mfma_f32_16x16x32_bf16 v[124:127], a[76:79], v[224:227], v[124:127]
  ds_read_b64_tr_b16 v[224:225], v250 offset:16384
  s_waitcnt lgkmcnt(9)
  v_mfma_f32_16x16x32_bf16 v[140:143], a[76:79], v[232:235], v[140:143]
  v_mfma_f32_16x16x32_bf16 v[140:143], a[92:95], v[236:239], v[140:143]
  ds_read_b64_tr_b16 v[226:227], v250 offset:17408
  v_mfma_f32_16x16x32_bf16 v[136:139], a[88:91], v[236:239], v[136:139]
  v_mfma_f32_16x16x32_bf16 v[136:139], a[72:75], v[232:235], v[136:139]
  ds_read_b64_tr_b16 v[228:229], v250 offset:24576
  v_mfma_f32_16x16x32_bf16 v[132:135], a[68:71], v[232:235], v[132:135]
  buffer_store_dwordx4 v[32:35], v1, s[20:23], s29 offen offset:0 sc1
  v_mfma_f32_16x16x32_bf16 v[132:135], a[84:87], v[236:239], v[132:135]
  ds_read_b64_tr_b16 v[230:231], v250 offset:25600
  v_mfma_f32_16x16x32_bf16 v[128:131], a[80:83], v[236:239], v[128:131]
  v_mfma_f32_16x16x32_bf16 v[128:131], a[64:67], v[232:235], v[128:131]
  ds_read_b64_tr_b16 v[232:233], v251 offset:16384
  s_waitcnt lgkmcnt(9)
  v_mfma_f32_16x16x32_bf16 v[144:147], a[64:67], v[208:211], v[144:147]
  s_waitcnt vmcnt(16)
  s_barrier
  v_mfma_f32_16x16x32_bf16 v[144:147], a[80:83], v[212:215], v[144:147]
  ds_read_b64_tr_b16 v[234:235], v251 offset:17408
  s_add_u32 m0, s37, 0
  v_mfma_f32_16x16x32_bf16 v[148:151], a[84:87], v[212:215], v[148:151]
  v_mfma_f32_16x16x32_bf16 v[148:151], a[68:71], v[208:211], v[148:151]
  ds_read_b64_tr_b16 v[236:237], v251 offset:24576
  v_mfma_f32_16x16x32_bf16 v[152:155], a[72:75], v[208:211], v[152:155]
  s_add_u32 s34, s32, 2621440
  v_mfma_f32_16x16x32_bf16 v[152:155], a[88:91], v[212:215], v[152:155]
  ds_read_b64_tr_b16 v[238:239], v251 offset:25600
  v_mfma_f32_16x16x32_bf16 v[156:159], a[92:95], v[212:215], v[156:159]
  ds_read_b128 a[0:3], v242 offset:0
  v_mfma_f32_16x16x32_bf16 v[156:159], a[76:79], v[208:211], v[156:159]
  ds_read_b64_tr_b16 v[208:209], v244 offset:32768
  buffer_load_dwordx4 v4, s[16:19], s34 offen offset:0 lds
  s_waitcnt lgkmcnt(10)
  v_mfma_f32_16x16x32_bf16 v[172:175], a[76:79], v[216:219], v[172:175]
  ds_read_b128 a[4:7], v242 offset:2048
  v_mfma_f32_16x16x32_bf16 v[172:175], a[92:95], v[220:223], v[172:175]
  ds_read_b64_tr_b16 v[210:211], v244 offset:33792
  ds_read_b128 a[8:11], v242 offset:4096
  v_mfma_f32_16x16x32_bf16 v[168:171], a[88:91], v[220:223], v[168:171]
K_hA0_3:
  s_cbranch_execz K_hA0_4
  v_mfma_f32_16x16x32_bf16 v[168:171], a[72:75], v[216:219], v[168:171]
  ds_read_b64_tr_b16 v[212:213], v244 offset:40960
  buffer_load_dwordx4 v5, s[16:19], s34 offen offset:1024 lds
  v_mfma_f32_16x16x32_bf16 v[164:167], a[68:71], v[216:219], v[164:167]
  ds_read_b128 a[12:15], v242 offset:6144
  v_mfma_f32_16x16x32_bf16 v[164:167], a[84:87], v[220:223], v[164:167]
  ds_read_b64_tr_b16 v[214:215], v244 offset:41984
  v_mfma_f32_16x16x32_bf16 v[160:163], a[80:83], v[220:223], v[160:163]
  buffer_load_dwordx4 v6, s[16:19], s34 offen offset:2048 lds
  v_mfma_f32_16x16x32_bf16 v[160:163], a[64:67], v[216:219], v[160:163]
  ds_read_b64_tr_b16 v[216:217], v245 offset:32768
  ds_read_b128 a[16:19], v243 offset:0
  s_waitcnt lgkmcnt(14)
  v_mfma_f32_16x16x32_bf16 v[176:179], a[64:67], v[224:227], v[176:179]
  v_mfma_f32_16x16x32_bf16 v[176:179], a[80:83], v[228:231], v[176:179]
  buffer_store_dwordx4 v[36:39], v1, s[20:23], s29 offen offset:1024 sc1
  ds_read_b64_tr_b16 v[218:219], v245 offset:33792
  buffer_load_dwordx4 v7, s[16:19], s34 offen offset:3072 lds
  v_mfma_f32_16x16x32_bf16 v[180:183], a[84:87], v[228:231], v[180:183]
  ds_read_b128 a[20:23], v243 offset:2048
  v_mfma_f32_16x16x32_bf16 v[180:183], a[68:71], v[224:227], v[180:183]
  ds_read_b64_tr_b16 v[220:221], v245 offset:40960
  v_mfma_f32_16x16x32_bf16 v[184:187], a[72:75], v[224:227], v[184:187]
  v_mfma_f32_16x16x32_bf16 v[184:187], a[88:91], v[228:231], v[184:187]
  ds_read_b64_tr_b16 v[222:223], v245 offset:41984
  ds_read_b128 a[24:27], v243 offset:4096
  s_add_u32 m0, s33, 32768
  v_mfma_f32_16x16x32_bf16 v[188:191], a[92:95], v[228:231], v[188:191]
  v_mfma_f32_16x16x32_bf16 v[188:191], a[76:79], v[224:227], v[188:191]
  ds_read_b64_tr_b16 v[224:225], v246 offset:32768
  s_waitcnt lgkmcnt(15)
  v_mfma_f32_16x16x32_bf16 v[204:207], a[76:79], v[232:235], v[204:207]
  ds_read_b128 a[28:31], v243 offset:6144
  v_mfma_f32_16x16x32_bf16 v[204:207], a[92:95], v[236:239], v[204:207]
  ds_read_b64_tr_b16 v[226:227], v246 offset:33792
  s_add_u32 s35, s48, 256
  v_mfma_f32_16x16x32_bf16 v[200:203], a[88:91], v[236:239], v[200:203]
  v_mfma_f32_16x16x32_bf16 v[200:203], a[72:75], v[232:235], v[200:203]
  ds_read_b64_tr_b16 v[228:229], v246 offset:40960
  v_mfma_f32_16x16x32_bf16 v[196:199], a[68:71], v[232:235], v[196:199]
  v_mfma_f32_16x16x32_bf16 v[196:199], a[84:87], v[236:239], v[196:199]
  ds_read_b64_tr_b16 v[230:231], v246 offset:41984
  buffer_load_dwordx4 v12, s[12:15], s35 offen offset:0 lds
  v_mfma_f32_16x16x32_bf16 v[192:195], a[80:83], v[236:239], v[192:195]
  v_mfma_f32_16x16x32_bf16 v[192:195], a[64:67], v[232:235], v[192:195]
  ds_read_b64_tr_b16 v[232:233], v247 offset:32768
  s_waitcnt lgkmcnt(13)
  v_mfma_f32_16x16x32_bf16 v[80:83], a[96:99], v[208:211], v[80:83]
  v_mfma_f32_16x16x32_bf16 v[80:83], a[112:115], v[212:215], v[80:83]
  ds_read_b64_tr_b16 v[234:235], v247 offset:33792
  buffer_load_dwordx4 v13, s[12:15], s35 offen offset:1024 lds
  v_mfma_f32_16x16x32_bf16 v[84:87], a[116:119], v[212:215], v[84:87]
  v_mfma_f32_16x16x32_bf16 v[84:87], a[100:103], v[208:211], v[84:87]
  ds_read_b64_tr_b16 v[236:237], v247 offset:40960
  v_mfma_f32_16x16x32_bf16 v[88:91], a[104:107], v[208:211], v[88:91]
  v_mfma_f32_16x16x32_bf16 v[88:91], a[120:123], v[212:215], v[88:91]
  ds_read_b64_tr_b16 v[238:239], v247 offset:41984
  buffer_load_dwordx4 v14, s[12:15], s35 offen offset:2048 lds
  v_mfma_f32_16x16x32_bf16 v[92:95], a[124:127], v[212:215], v[92:95]
  buffer_store_dwordx4 v[40:43], v1, s[20:23], s29 offen offset:2048 sc1
  v_mfma_f32_16x16x32_bf16 v[92:95], a[108:111], v[208:211], v[92:95]
  ds_read_b64_tr_b16 v[208:209], v248 offset:32768
  s_waitcnt lgkmcnt(11)
  v_mfma_f32_16x16x32_bf16 v[108:111], a[108:111], v[216:219], v[108:111]
  v_mfma_f32_16x16x32_bf16 v[108:111], a[124:127], v[220:223], v[108:111]
  ds_read_b64_tr_b16 v[210:211], v248 offset:33792
  buffer_load_dwordx4 v15, s[12:15], s35 offen offset:3072 lds
  v_mfma_f32_16x16x32_bf16 v[104:107], a[120:123], v[220:223], v[104:107]
  v_mfma_f32_16x16x32_bf16 v[104:107], a[104:107], v[216:219], v[104:107]
  ds_read_b64_tr_b16 v[212:213], v248 offset:40960
  s_waitcnt lgkmcnt(10)
  v_mfma_f32_16x16x32_bf16 v[100:103], a[100:103], v[216:219], v[100:103]
  v_mfma_f32_16x16x32_bf16 v[100:103], a[116:119], v[220:223], v[100:103]
  ds_read_b64_tr_b16 v[214:215], v248 offset:41984
  v_mfma_f32_16x16x32_bf16 v[96:99], a[112:115], v[220:223], v[96:99]
  v_mfma_f32_16x16x32_bf16 v[96:99], a[96:99], v[216:219], v[96:99]
  ds_read_b64_tr_b16 v[216:217], v249 offset:32768
  s_waitcnt lgkmcnt(9)
  v_mfma_f32_16x16x32_bf16 v[112:115], a[96:99], v[224:227], v[112:115]
  v_mfma_f32_16x16x32_bf16 v[112:115], a[112:115], v[228:231], v[112:115]
  ds_read_b64_tr_b16 v[218:219], v249 offset:33792
  v_mfma_f32_16x16x32_bf16 v[116:119], a[116:119], v[228:231], v[116:119]
  v_mfma_f32_16x16x32_bf16 v[116:119], a[100:103], v[224:227], v[116:119]
  ds_read_b64_tr_b16 v[220:221], v249 offset:40960
  v_mfma_f32_16x16x32_bf16 v[120:123], a[104:107], v[224:227], v[120:123]
  v_mfma_f32_16x16x32_bf16 v[120:123], a[120:123], v[228:231], v[120:123]
  ds_read_b64_tr_b16 v[222:223], v249 offset:41984
  v_mfma_f32_16x16x32_bf16 v[124:127], a[124:127], v[228:231], v[124:127]
  v_mfma_f32_16x16x32_bf16 v[124:127], a[108:111], v[224:227], v[124:127]
  ds_read_b64_tr_b16 v[224:225], v250 offset:32768
  s_waitcnt lgkmcnt(9)
  v_mfma_f32_16x16x32_bf16 v[140:143], a[108:111], v[232:235], v[140:143]
  v_mfma_f32_16x16x32_bf16 v[140:143], a[124:127], v[236:239], v[140:143]
  ds_read_b64_tr_b16 v[226:227], v250 offset:33792
  v_mfma_f32_16x16x32_bf16 v[136:139], a[120:123], v[236:239], v[136:139]
  s_add_u32 m0, s33, 36864
  v_mfma_f32_16x16x32_bf16 v[136:139], a[104:107], v[232:235], v[136:139]
  buffer_store_dwordx4 v[44:47], v1, s[20:23], s29 offen offset:3072 sc1
  ds_read_b64_tr_b16 v[228:229], v250 offset:40960
  s_add_u32 s35, s49, 256
  v_mfma_f32_16x16x32_bf16 v[132:135], a[100:103], v[232:235], v[132:135]
  buffer_load_dwordx4 v12, s[12:15], s35 offen offset:0 lds
  v_mfma_f32_16x16x32_bf16 v[132:135], a[116:119], v[236:239], v[132:135]
  ds_read_b64_tr_b16 v[230:231], v250 offset:41984
  buffer_load_dwordx4 v13, s[12:15], s35 offen offset:1024 lds
  v_mfma_f32_16x16x32_bf16 v[128:131], a[112:115], v[236:239], v[128:131]
  buffer_load_dwordx4 v14, s[12:15], s35 offen offset:2048 lds
  v_mfma_f32_16x16x32_bf16 v[128:131], a[96:99], v[232:235], v[128:131]
  ds_read_b64_tr_b16 v[232:233], v251 offset:32768
  buffer_load_dwordx4 v15, s[12:15], s35 offen offset:3072 lds
  s_waitcnt lgkmcnt(9)
  v_mfma_f32_16x16x32_bf16 v[144:147], a[96:99], v[208:211], v[144:147]
  s_waitcnt vmcnt(20)
  s_barrier
  v_mfma_f32_16x16x32_bf16 v[144:147], a[112:115], v[212:215], v[144:147]
  ds_read_b64_tr_b16 v[234:235], v251 offset:33792
  s_add_u32 m0, s37, 16384
  v_mfma_f32_16x16x32_bf16 v[148:151], a[116:119], v[212:215], v[148:151]
  v_mfma_f32_16x16x32_bf16 v[148:151], a[100:103], v[208:211], v[148:151]
  ds_read_b64_tr_b16 v[236:237], v251 offset:40960
  v_mfma_f32_16x16x32_bf16 v[152:155], a[104:107], v[208:211], v[152:155]
  v_mfma_f32_16x16x32_bf16 v[152:155], a[120:123], v[212:215], v[152:155]
  ds_read_b64_tr_b16 v[238:239], v251 offset:41984
  s_add_u32 s34, s32, 3145728
  v_mfma_f32_16x16x32_bf16 v[156:159], a[124:127], v[212:215], v[156:159]
  v_mfma_f32_16x16x32_bf16 v[156:159], a[108:111], v[208:211], v[156:159]
  ds_read_b64_tr_b16 v[208:209], v244 offset:49152
  s_waitcnt lgkmcnt(9)
  v_mfma_f32_16x16x32_bf16 v[172:175], a[108:111], v[216:219], v[172:175]
  v_mfma_f32_16x16x32_bf16 v[172:175], a[124:127], v[220:223], v[172:175]
  ds_read_b64_tr_b16 v[210:211], v244 offset:50176
  buffer_load_dwordx4 v4, s[16:19], s34 offen offset:0 lds
  v_mfma_f32_16x16x32_bf16 v[168:171], a[120:123], v[220:223], v[168:171]
K_hA1_3:
  s_cbranch_execz K_hA1_4
  v_mfma_f32_16x16x32_bf16 v[168:171], a[104:107], v[216:219], v[168:171]
  ds_read_b64_tr_b16 v[212:213], v244 offset:57344
  v_mfma_f32_16x16x32_bf16 v[164:167], a[100:103], v[216:219], v[164:167]
  v_mfma_f32_16x16x32_bf16 v[164:167], a[116:119], v[220:223], v[164:167]
  ds_read_b64_tr_b16 v[214:215], v244 offset:58368
  buffer_load_dwordx4 v5, s[16:19], s34 offen offset:1024 lds
  v_mfma_f32_16x16x32_bf16 v[160:163], a[112:115], v[220:223], v[160:163]
  v_mfma_f32_16x16x32_bf16 v[160:163], a[96:99], v[216:219], v[160:163]
  ds_read_b64_tr_b16 v[216:217], v245 offset:49152
  s_waitcnt lgkmcnt(9)
  v_mfma_f32_16x16x32_bf16 v[176:179], a[96:99], v[224:227], v[176:179]
  s_add_u32 s29, s50, 8192
  v_mfma_f32_16x16x32_bf16 v[176:179], a[112:115], v[228:231], v[176:179]
  ds_read_b64_tr_b16 v[218:219], v245 offset:50176
  buffer_load_dwordx4 v6, s[16:19], s34 offen offset:2048 lds
  v_mfma_f32_16x16x32_bf16 v[180:183], a[116:119], v[228:231], v[180:183]
  v_mfma_f32_16x16x32_bf16 v[180:183], a[100:103], v[224:227], v[180:183]
  ds_read_b64_tr_b16 v[220:221], v245 offset:57344
  v_mfma_f32_16x16x32_bf16 v[184:187], a[104:107], v[224:227], v[184:187]
  v_mfma_f32_16x16x32_bf16 v[184:187], a[120:123], v[228:231], v[184:187]
  ds_read_b64_tr_b16 v[222:223], v245 offset:58368
  buffer_load_dwordx4 v7, s[16:19], s34 offen offset:3072 lds
  v_mfma_f32_16x16x32_bf16 v[188:191], a[124:127], v[228:231], v[188:191]
  v_mfma_f32_16x16x32_bf16 v[188:191], a[108:111], v[224:227], v[188:191]
  ds_read_b64_tr_b16 v[224:225], v246 offset:49152
  s_waitcnt lgkmcnt(9)
  v_mfma_f32_16x16x32_bf16 v[204:207], a[108:111], v[232:235], v[204:207]
  v_mfma_f32_16x16x32_bf16 v[204:207], a[124:127], v[236:239], v[204:207]
  ds_read_b64_tr_b16 v[226:227], v246 offset:50176
  v_mfma_f32_16x16x32_bf16 v[200:203], a[120:123], v[236:239], v[200:203]
  v_mfma_f32_16x16x32_bf16 v[200:203], a[104:107], v[232:235], v[200:203]
  ds_read_b64_tr_b16 v[228:229], v246 offset:57344
  v_mfma_f32_16x16x32_bf16 v[196:199], a[100:103], v[232:235], v[196:199]
  v_mfma_f32_16x16x32_bf16 v[196:199], a[116:119], v[236:239], v[196:199]
  ds_read_b64_tr_b16 v[230:231], v246 offset:58368
  v_mfma_f32_16x16x32_bf16 v[192:195], a[112:115], v[236:239], v[192:195]
  v_mfma_f32_16x16x32_bf16 v[192:195], a[96:99], v[232:235], v[192:195]
  ds_read_b64_tr_b16 v[232:233], v247 offset:49152
  s_waitcnt lgkmcnt(9)
  v_mfma_f32_16x16x32_bf16 v[80:83], a[128:131], v[208:211], v[80:83]
  v_mfma_f32_16x16x32_bf16 v[80:83], a[144:147], v[212:215], v[80:83]
  ds_read_b64_tr_b16 v[234:235], v247 offset:50176
  v_mfma_f32_16x16x32_bf16 v[84:87], a[148:151], v[212:215], v[84:87]
  v_mfma_f32_16x16x32_bf16 v[84:87], a[132:135], v[208:211], v[84:87]
  ds_read_b64_tr_b16 v[236:237], v247 offset:57344
  v_mfma_f32_16x16x32_bf16 v[88:91], a[136:139], v[208:211], v[88:91]
  buffer_store_dwordx4 v[48:51], v1, s[20:23], s29 offen offset:0 sc1
  v_mfma_f32_16x16x32_bf16 v[88:91], a[152:155], v[212:215], v[88:91]
  ds_read_b64_tr_b16 v[238:239], v247 offset:58368
  v_mfma_f32_16x16x32_bf16 v[92:95], a[156:159], v[212:215], v[92:95]
  v_mfma_f32_16x16x32_bf16 v[92:95], a[140:143], v[208:211], v[92:95]
  ds_read_b64_tr_b16 v[208:209], v248 offset:49152
  s_waitcnt lgkmcnt(9)
  v_mfma_f32_16x16x32_bf16 v[108:111], a[140:143], v[216:219], v[108:111]
  s_waitcnt vmcnt(21)
  ds_read_b128 a[32:35], v240 offset:0
  v_mfma_f32_16x16x32_bf16 v[108:111], a[156:159], v[220:223], v[108:111]
  ds_read_b64_tr_b16 v[210:211], v248 offset:50176
  v_mfma_f32_16x16x32_bf16 v[104:107], a[152:155], v[220:223], v[104:107]
  ds_read_b128 a[36:39], v240 offset:2048
  v_mfma_f32_16x16x32_bf16 v[104:107], a[136:139], v[216:219], v[104:107]
  ds_read_b64_tr_b16 v[212:213], v248 offset:57344
  v_mfma_f32_16x16x32_bf16 v[100:103], a[132:135], v[216:219], v[100:103]
  s_add_u32 m0, s33, 65536
  v_mfma_f32_16x16x32_bf16 v[100:103], a[148:151], v[220:223], v[100:103]
  ds_read_b64_tr_b16 v[214:215], v248 offset:58368
  ds_read_b128 a[40:43], v240 offset:4096
  v_mfma_f32_16x16x32_bf16 v[96:99], a[144:147], v[220:223], v[96:99]
  v_mfma_f32_16x16x32_bf16 v[96:99], a[128:131], v[216:219], v[96:99]
  ds_read_b64_tr_b16 v[216:217], v249 offset:49152
  s_add_u32 s35, s48, 384
  s_waitcnt lgkmcnt(12)
  v_mfma_f32_16x16x32_bf16 v[112:115], a[128:131], v[224:227], v[112:115]
  ds_read_b128 a[44:47], v240 offset:6144
  v_mfma_f32_16x16x32_bf16 v[112:115], a[144:147], v[228:231], v[112:115]
  ds_read_b64_tr_b16 v[218:219], v249 offset:50176
  v_mfma_f32_16x16x32_bf16 v[116:119], a[148:151], v[228:231], v[116:119]
  v_mfma_f32_16x16x32_bf16 v[116:119], a[132:135], v[224:227], v[116:119]
  ds_read_b64_tr_b16 v[220:221], v249 offset:57344
  buffer_load_dwordx4 v12, s[12:15], s35 offen offset:0 lds
  v_mfma_f32_16x16x32_bf16 v[120:123], a[136:139], v[224:227], v[120:123]
  ds_read_b128 a[48:51], v241 offset:0
  v_mfma_f32_16x16x32_bf16 v[120:123], a[152:155], v[228:231], v[120:123]
  ds_read_b64_tr_b16 v[222:223], v249 offset:58368
  v_mfma_f32_16x16x32_bf16 v[124:127], a[156:159], v[228:231], v[124:127]
  buffer_load_dwordx4 v13, s[12:15], s35 offen offset:1024 lds
  ds_read_b128 a[52:55], v241 offset:2048
  v_mfma_f32_16x16x32_bf16 v[124:127], a[140:143], v[224:227], v[124:127]
  ds_read_b64_tr_b16 v[224:225], v250 offset:49152
  s_waitcnt lgkmcnt(15)
  v_mfma_f32_16x16x32_bf16 v[140:143], a[140:143], v[232:235], v[140:143]
  v_mfma_f32_16x16x32_bf16 v[140:143], a[156:159], v[236:239], v[140:143]
  buffer_store_dwordx4 v[52:55], v1, s[20:23], s29 offen offset:1024 sc1
  ds_read_b64_tr_b16 v[226:227], v250 offset:50176
  ds_read_b128 a[56:59], v241 offset:4096
  v_mfma_f32_16x16x32_bf16 v[136:139], a[152:155], v[236:239], v[136:139]
  buffer_load_dwordx4 v14, s[12:15], s35 offen offset:2048 lds
  v_mfma_f32_16x16x32_bf16 v[136:139], a[136:139], v[232:235], v[136:139]
  ds_read_b64_tr_b16 v[228:229], v250 offset:57344
  v_mfma_f32_16x16x32_bf16 v[132:135], a[132:135], v[232:235], v[132:135]
  ds_read_b128 a[60:63], v241 offset:6144
  v_mfma_f32_16x16x32_bf16 v[132:135], a[148:151], v[236:239], v[132:135]
  ds_read_b64_tr_b16 v[230:231], v250 offset:58368
  buffer_load_dwordx4 v15, s[12:15], s35 offen offset:3072 lds
  v_mfma_f32_16x16x32_bf16 v[128:131], a[144:147], v[236:239], v[128:131]
  v_mfma_f32_16x16x32_bf16 v[128:131], a[128:131], v[232:235], v[128:131]
  ds_read_b64_tr_b16 v[232:233], v251 offset:49152
  s_waitcnt lgkmcnt(15)
  v_mfma_f32_16x16x32_bf16 v[144:147], a[128:131], v[208:211], v[144:147]
  s_waitcnt vmcnt(20)
  s_barrier
  v_mfma_f32_16x16x32_bf16 v[144:147], a[144:147], v[212:215], v[144:147]
  ds_read_b64_tr_b16 v[234:235], v251 offset:50176
  v_mfma_f32_16x16x32_bf16 v[148:151], a[148:151], v[212:215], v[148:151]
  v_and_b32 v3, 28, v253
  v_lshlrev_b32 v3, 3, v3
  buffer_load_dword v3, v3, s[56:59], 0 offen sc1
  v_mfma_f32_16x16x32_bf16 v[148:151], a[132:135], v[208:211], v[148:151]
  ds_read_b64_tr_b16 v[236:237], v251 offset:57344
  v_mfma_f32_16x16x32_bf16 v[152:155], a[136:139], v[208:211], v[152:155]
  v_mfma_f32_16x16x32_bf16 v[152:155], a[152:155], v[212:215], v[152:155]
  ds_read_b64_tr_b16 v[238:239], v251 offset:58368
  s_add_u32 m0, s37, 32768
  v_mfma_f32_16x16x32_bf16 v[156:159], a[156:159], v[212:215], v[156:159]
  v_mfma_f32_16x16x32_bf16 v[156:159], a[140:143], v[208:211], v[156:159]
  ds_read_b64_tr_b16 v[208:209], v244 offset:0
  s_waitcnt lgkmcnt(12)
  v_mfma_f32_16x16x32_bf16 v[172:175], a[140:143], v[216:219], v[172:175]
  v_mfma_f32_16x16x32_bf16 v[172:175], a[156:159], v[220:223], v[172:175]
  ds_read_b64_tr_b16 v[210:211], v244 offset:1024
  s_add_u32 s34, s32, 3670016
  v_mfma_f32_16x16x32_bf16 v[168:171], a[152:155], v[220:223], v[168:171]
  v_mfma_f32_16x16x32_bf16 v[168:171], a[136:139], v[216:219], v[168:171]
  ds_read_b64_tr_b16 v[212:213], v244 offset:8192
K_hA2_3:
  s_cbranch_execz K_hA2_4
  v_mfma_f32_16x16x32_bf16 v[164:167], a[132:135], v[216:219], v[164:167]
  v_mfma_f32_16x16x32_bf16 v[164:167], a[148:151], v[220:223], v[164:167]
  ds_read_b64_tr_b16 v[214:215], v244 offset:9216
  buffer_load_dwordx4 v4, s[16:19], s34 offen offset:0 lds
  v_mfma_f32_16x16x32_bf16 v[160:163], a[144:147], v[220:223], v[160:163]
  buffer_store_dwordx4 v[56:59], v1, s[20:23], s29 offen offset:2048 sc1
  v_mfma_f32_16x16x32_bf16 v[160:163], a[128:131], v[216:219], v[160:163]
  ds_read_b64_tr_b16 v[216:217], v245 offset:0
  s_waitcnt lgkmcnt(10)
  s_waitcnt lgkmcnt(9)
  v_mfma_f32_16x16x32_bf16 v[176:179], a[128:131], v[224:227], v[176:179]
  v_mfma_f32_16x16x32_bf16 v[176:179], a[144:147], v[228:231], v[176:179]
  ds_read_b64_tr_b16 v[218:219], v245 offset:1024
  buffer_load_dwordx4 v5, s[16:19], s34 offen offset:1024 lds
  v_mfma_f32_16x16x32_bf16 v[180:183], a[148:151], v[228:231], v[180:183]
  v_mfma_f32_16x16x32_bf16 v[180:183], a[132:135], v[224:227], v[180:183]
  ds_read_b64_tr_b16 v[220:221], v245 offset:8192
  v_mfma_f32_16x16x32_bf16 v[184:187], a[136:139], v[224:227], v[184:187]
  v_mfma_f32_16x16x32_bf16 v[184:187], a[152:155], v[228:231], v[184:187]
  ds_read_b64_tr_b16 v[222:223], v245 offset:9216
  buffer_load_dwordx4 v6, s[16:19], s34 offen offset:2048 lds
  v_mfma_f32_16x16x32_bf16 v[188:191], a[156:159], v[228:231], v[188:191]
  v_mfma_f32_16x16x32_bf16 v[188:191], a[140:143], v[224:227], v[188:191]
  ds_read_b64_tr_b16 v[224:225], v246 offset:0
  s_waitcnt lgkmcnt(9)
  v_mfma_f32_16x16x32_bf16 v[204:207], a[140:143], v[232:235], v[204:207]
  v_mfma_f32_16x16x32_bf16 v[204:207], a[156:159], v[236:239], v[204:207]
  ds_read_b64_tr_b16 v[226:227], v246 offset:1024
  buffer_load_dwordx4 v7, s[16:19], s34 offen offset:3072 lds
  v_mfma_f32_16x16x32_bf16 v[200:203], a[152:155], v[236:239], v[200:203]
  v_mfma_f32_16x16x32_bf16 v[200:203], a[136:139], v[232:235], v[200:203]
  ds_read_b64_tr_b16 v[228:229], v246 offset:8192
  v_mfma_f32_16x16x32_bf16 v[196:199], a[132:135], v[232:235], v[196:199]
  v_mfma_f32_16x16x32_bf16 v[196:199], a[148:151], v[236:239], v[196:199]
  ds_read_b64_tr_b16 v[230:231], v246 offset:9216
  v_mfma_f32_16x16x32_bf16 v[192:195], a[144:147], v[236:239], v[192:195]
  s_add_u32 m0, s33, 69632
  v_mfma_f32_16x16x32_bf16 v[192:195], a[128:131], v[232:235], v[192:195]
  ds_read_b64_tr_b16 v[232:233], v247 offset:0
  s_waitcnt lgkmcnt(9)
  v_mfma_f32_16x16x32_bf16 v[80:83], a[160:163], v[208:211], v[80:83]
  v_mfma_f32_16x16x32_bf16 v[80:83], a[176:179], v[212:215], v[80:83]
  ds_read_b64_tr_b16 v[234:235], v247 offset:1024
  v_mfma_f32_16x16x32_bf16 v[84:87], a[180:183], v[212:215], v[84:87]
  s_add_u32 s35, s49, 384
  v_mfma_f32_16x16x32_bf16 v[84:87], a[164:167], v[208:211], v[84:87]
  buffer_store_dwordx4 v[60:63], v1, s[20:23], s29 offen offset:3072 sc1
  ds_read_b64_tr_b16 v[236:237], v247 offset:8192
  v_mfma_f32_16x16x32_bf16 v[88:91], a[168:171], v[208:211], v[88:91]
  v_mfma_f32_16x16x32_bf16 v[88:91], a[184:187], v[212:215], v[88:91]
  ds_read_b64_tr_b16 v[238:239], v247 offset:9216
  v_mfma_f32_16x16x32_bf16 v[92:95], a[188:191], v[212:215], v[92:95]
  buffer_load_dwordx4 v12, s[12:15], s35 offen offset:0 lds
  v_mfma_f32_16x16x32_bf16 v[92:95], a[172:175], v[208:211], v[92:95]
  ds_read_b64_tr_b16 v[208:209], v248 offset:0
  s_waitcnt lgkmcnt(9)
  v_mfma_f32_16x16x32_bf16 v[108:111], a[172:175], v[216:219], v[108:111]
  v_mfma_f32_16x16x32_bf16 v[108:111], a[188:191], v[220:223], v[108:111]
  ds_read_b64_tr_b16 v[210:211], v248 offset:1024
  v_mfma_f32_16x16x32_bf16 v[104:107], a[184:187], v[220:223], v[104:107]
  buffer_load_dwordx4 v13, s[12:15], s35 offen offset:1024 lds
  v_mfma_f32_16x16x32_bf16 v[104:107], a[168:171], v[216:219], v[104:107]
  ds_read_b64_tr_b16 v[212:213], v248 offset:8192
  v_mfma_f32_16x16x32_bf16 v[100:103], a[164:167], v[216:219], v[100:103]
  v_mfma_f32_16x16x32_bf16 v[100:103], a[180:183], v[220:223], v[100:103]
  ds_read_b64_tr_b16 v[214:215], v248 offset:9216
  v_mfma_f32_16x16x32_bf16 v[96:99], a[176:179], v[220:223], v[96:99]
  buffer_load_dwordx4 v14, s[12:15], s35 offen offset:2048 lds
  v_mfma_f32_16x16x32_bf16 v[96:99], a[160:163], v[216:219], v[96:99]
  ds_read_b64_tr_b16 v[216:217], v249 offset:0
  s_waitcnt lgkmcnt(9)
  v_mfma_f32_16x16x32_bf16 v[112:115], a[160:163], v[224:227], v[112:115]
  v_mfma_f32_16x16x32_bf16 v[112:115], a[176:179], v[228:231], v[112:115]
  ds_read_b64_tr_b16 v[218:219], v249 offset:1024
  v_mfma_f32_16x16x32_bf16 v[116:119], a[180:183], v[228:231], v[116:119]
  buffer_load_dwordx4 v15, s[12:15], s35 offen offset:3072 lds
  v_mfma_f32_16x16x32_bf16 v[116:119], a[164:167], v[224:227], v[116:119]
  ds_read_b64_tr_b16 v[220:221], v249 offset:8192
  v_mfma_f32_16x16x32_bf16 v[120:123], a[168:171], v[224:227], v[120:123]
  v_mfma_f32_16x16x32_bf16 v[120:123], a[184:187], v[228:231], v[120:123]
  ds_read_b64_tr_b16 v[222:223], v249 offset:9216
  v_mfma_f32_16x16x32_bf16 v[124:127], a[188:191], v[228:231], v[124:127]
  v_mfma_f32_16x16x32_bf16 v[124:127], a[172:175], v[224:227], v[124:127]
  ds_read_b64_tr_b16 v[224:225], v250 offset:0
  s_waitcnt lgkmcnt(9)
  v_mfma_f32_16x16x32_bf16 v[140:143], a[172:175], v[232:235], v[140:143]
  s_add_u32 s29, s50, 12288
  v_mfma_f32_16x16x32_bf16 v[140:143], a[188:191], v[236:239], v[140:143]
  ds_read_b64_tr_b16 v[226:227], v250 offset:1024
  v_mfma_f32_16x16x32_bf16 v[136:139], a[184:187], v[236:239], v[136:139]
  v_mfma_f32_16x16x32_bf16 v[136:139], a[168:171], v[232:235], v[136:139]
  ds_read_b64_tr_b16 v[228:229], v250 offset:8192
  v_mfma_f32_16x16x32_bf16 v[132:135], a[164:167], v[232:235], v[132:135]
  v_mfma_f32_16x16x32_bf16 v[132:135], a[180:183], v[236:239], v[132:135]
  ds_read_b64_tr_b16 v[230:231], v250 offset:9216
  v_mfma_f32_16x16x32_bf16 v[128:131], a[176:179], v[236:239], v[128:131]
  v_mfma_f32_16x16x32_bf16 v[128:131], a[160:163], v[232:235], v[128:131]
  ds_read_b64_tr_b16 v[232:233], v251 offset:0
  s_waitcnt lgkmcnt(9)
  v_mfma_f32_16x16x32_bf16 v[144:147], a[160:163], v[208:211], v[144:147]
  s_waitcnt vmcnt(17)
  s_barrier
  v_mfma_f32_16x16x32_bf16 v[144:147], a[176:179], v[212:215], v[144:147]
  ds_read_b64_tr_b16 v[234:235], v251 offset:1024
  s_mov_b32 s8, s80
  s_mov_b32 s16, s86
  v_mfma_f32_16x16x32_bf16 v[148:151], a[180:183], v[212:215], v[148:151]
  v_mfma_f32_16x16x32_bf16 v[148:151], a[164:167], v[208:211], v[148:151]
  ds_read_b64_tr_b16 v[236:237], v251 offset:8192
  s_and_b32 s9, s81, 0xffff
  v_mfma_f32_16x16x32_bf16 v[152:155], a[168:171], v[208:211], v[152:155]
  v_mfma_f32_16x16x32_bf16 v[152:155], a[184:187], v[212:215], v[152:155]
  ds_read_b64_tr_b16 v[238:239], v251 offset:9216
  s_mov_b32 s10, 4718592
  v_mfma_f32_16x16x32_bf16 v[156:159], a[188:191], v[212:215], v[156:159]
  v_mfma_f32_16x16x32_bf16 v[156:159], a[172:175], v[208:211], v[156:159]
  ds_read_b64_tr_b16 v[208:209], v244 offset:16384
  s_add_u32 m0, s37, 49152
  s_waitcnt lgkmcnt(9)
  v_mfma_f32_16x16x32_bf16 v[172:175], a[172:175], v[216:219], v[172:175]
  v_mfma_f32_16x16x32_bf16 v[172:175], a[188:191], v[220:223], v[172:175]
  ds_read_b64_tr_b16 v[210:211], v244 offset:17408
  s_add_u32 s34, s32, 0
  v_mfma_f32_16x16x32_bf16 v[168:171], a[184:187], v[220:223], v[168:171]
  ds_read_b128 a[64:67], v240 offset:32768
  s_and_b32 s17, s87, 0xffff
  v_mfma_f32_16x16x32_bf16 v[168:171], a[168:171], v[216:219], v[168:171]
  ds_read_b64_tr_b16 v[212:213], v244 offset:24576
  v_mfma_f32_16x16x32_bf16 v[164:167], a[164:167], v[216:219], v[164:167]
  buffer_store_dwordx4 v[64:67], v1, s[20:23], s29 offen offset:0 sc1
  buffer_load_dwordx4 v4, s[8:11], s34 offen offset:0 lds
  v_mfma_f32_16x16x32_bf16 v[164:167], a[180:183], v[220:223], v[164:167]
  ds_read_b64_tr_b16 v[214:215], v244 offset:25600
  ds_read_b128 a[68:71], v240 offset:34816
K_hA3_3:
  s_cbranch_execz K_hA3_4
  v_mfma_f32_16x16x32_bf16 v[160:163], a[176:179], v[220:223], v[160:163]
  buffer_load_dwordx4 v5, s[8:11], s34 offen offset:1024 lds
  v_mfma_f32_16x16x32_bf16 v[160:163], a[160:163], v[216:219], v[160:163]
  ds_read_b64_tr_b16 v[216:217], v245 offset:16384
  s_waitcnt lgkmcnt(11)
  v_mfma_f32_16x16x32_bf16 v[176:179], a[160:163], v[224:227], v[176:179]
  buffer_load_dwordx4 v6, s[8:11], s34 offen offset:2048 lds
  ds_read_b128 a[72:75], v240 offset:36864
  v_mfma_f32_16x16x32_bf16 v[176:179], a[176:179], v[228:231], v[176:179]
  ds_read_b64_tr_b16 v[218:219], v245 offset:17408
  v_mfma_f32_16x16x32_bf16 v[180:183], a[180:183], v[228:231], v[180:183]
  buffer_load_dwordx4 v7, s[8:11], s34 offen offset:3072 lds
  v_mfma_f32_16x16x32_bf16 v[180:183], a[164:167], v[224:227], v[180:183]
  ds_read_b64_tr_b16 v[220:221], v245 offset:24576
  ds_read_b128 a[76:79], v240 offset:38912
  v_mfma_f32_16x16x32_bf16 v[184:187], a[168:171], v[224:227], v[184:187]
  v_mfma_f32_16x16x32_bf16 v[184:187], a[184:187], v[228:231], v[184:187]
  ds_read_b64_tr_b16 v[222:223], v245 offset:25600
  s_add_u32 m0, s33, 0
  s_mov_b32 s18, 4718592
  v_mfma_f32_16x16x32_bf16 v[188:191], a[188:191], v[228:231], v[188:191]
  ds_read_b128 a[80:83], v241 offset:32768
  v_mfma_f32_16x16x32_bf16 v[188:191], a[172:175], v[224:227], v[188:191]
  ds_read_b64_tr_b16 v[224:225], v246 offset:16384
  s_waitcnt lgkmcnt(14)
  v_mfma_f32_16x16x32_bf16 v[204:207], a[172:175], v[232:235], v[204:207]
  v_mfma_f32_16x16x32_bf16 v[204:207], a[188:191], v[236:239], v[204:207]
  ds_read_b64_tr_b16 v[226:227], v246 offset:17408
  ds_read_b128 a[84:87], v241 offset:34816
  s_add_u32 s35, s48, 512
  v_mfma_f32_16x16x32_bf16 v[200:203], a[184:187], v[236:239], v[200:203]
  v_mfma_f32_16x16x32_bf16 v[200:203], a[168:171], v[232:235], v[200:203]
  ds_read_b64_tr_b16 v[228:229], v246 offset:24576
  v_mfma_f32_16x16x32_bf16 v[196:199], a[164:167], v[232:235], v[196:199]
  ds_read_b128 a[88:91], v241 offset:36864
  v_mfma_f32_16x16x32_bf16 v[196:199], a[180:183], v[236:239], v[196:199]
  ds_read_b64_tr_b16 v[230:231], v246 offset:25600
  buffer_load_dwordx4 v12, s[12:15], s35 offen offset:0 lds
  v_mfma_f32_16x16x32_bf16 v[192:195], a[176:179], v[236:239], v[192:195]
  v_mfma_f32_16x16x32_bf16 v[192:195], a[160:163], v[232:235], v[192:195]
  ds_read_b64_tr_b16 v[232:233], v247 offset:16384
  ds_read_b128 a[92:95], v241 offset:38912
  s_waitcnt lgkmcnt(15)
  v_mfma_f32_16x16x32_bf16 v[80:83], a[192:195], v[208:211], v[80:83]
  s_mov_b32 s60, s72
  v_mfma_f32_16x16x32_bf16 v[80:83], a[208:211], v[212:215], v[80:83]
  buffer_store_dwordx4 v[68:71], v1, s[20:23], s29 offen offset:1024 sc1
  ds_read_b64_tr_b16 v[234:235], v247 offset:17408
  buffer_load_dwordx4 v13, s[12:15], s35 offen offset:1024 lds
  v_mfma_f32_16x16x32_bf16 v[84:87], a[212:215], v[212:215], v[84:87]
  v_mfma_f32_16x16x32_bf16 v[84:87], a[196:199], v[208:211], v[84:87]
  ds_read_b64_tr_b16 v[236:237], v247 offset:24576
  v_mfma_f32_16x16x32_bf16 v[88:91], a[200:203], v[208:211], v[88:91]
  v_mfma_f32_16x16x32_bf16 v[88:91], a[216:219], v[212:215], v[88:91]
  ds_read_b64_tr_b16 v[238:239], v247 offset:25600
  buffer_load_dwordx4 v14, s[12:15], s35 offen offset:2048 lds
  v_mfma_f32_16x16x32_bf16 v[92:95], a[220:223], v[212:215], v[92:95]
  v_mfma_f32_16x16x32_bf16 v[92:95], a[204:207], v[208:211], v[92:95]
  ds_read_b64_tr_b16 v[208:209], v248 offset:16384
  s_waitcnt lgkmcnt(13)
  v_mfma_f32_16x16x32_bf16 v[108:111], a[204:207], v[216:219], v[108:111]
  v_mfma_f32_16x16x32_bf16 v[108:111], a[220:223], v[220:223], v[108:111]
  ds_read_b64_tr_b16 v[210:211], v248 offset:17408
  buffer_load_dwordx4 v15, s[12:15], s35 offen offset:3072 lds
  v_mfma_f32_16x16x32_bf16 v[104:107], a[216:219], v[220:223], v[104:107]
  v_mfma_f32_16x16x32_bf16 v[104:107], a[200:203], v[216:219], v[104:107]
  ds_read_b64_tr_b16 v[212:213], v248 offset:24576
  s_and_b32 s61, s73, 0xffff
  v_mfma_f32_16x16x32_bf16 v[100:103], a[196:199], v[216:219], v[100:103]
  v_mfma_f32_16x16x32_bf16 v[100:103], a[212:215], v[220:223], v[100:103]
  ds_read_b64_tr_b16 v[214:215], v248 offset:25600
  v_mfma_f32_16x16x32_bf16 v[96:99], a[208:211], v[220:223], v[96:99]
  v_mfma_f32_16x16x32_bf16 v[96:99], a[192:195], v[216:219], v[96:99]
  ds_read_b64_tr_b16 v[216:217], v249 offset:16384
  s_waitcnt lgkmcnt(10)
  v_mfma_f32_16x16x32_bf16 v[112:115], a[192:195], v[224:227], v[112:115]
  v_mfma_f32_16x16x32_bf16 v[112:115], a[208:211], v[228:231], v[112:115]
  ds_read_b64_tr_b16 v[218:219], v249 offset:17408
  v_mfma_f32_16x16x32_bf16 v[116:119], a[212:215], v[228:231], v[116:119]
  s_waitcnt lgkmcnt(9)
  v_mfma_f32_16x16x32_bf16 v[116:119], a[196:199], v[224:227], v[116:119]
  ds_read_b64_tr_b16 v[220:221], v249 offset:24576
  v_mfma_f32_16x16x32_bf16 v[120:123], a[200:203], v[224:227], v[120:123]
  v_mfma_f32_16x16x32_bf16 v[120:123], a[216:219], v[228:231], v[120:123]
  ds_read_b64_tr_b16 v[222:223], v249 offset:25600
  s_mov_b32 s62, 2359296
  v_mfma_f32_16x16x32_bf16 v[124:127], a[220:223], v[228:231], v[124:127]
  buffer_store_dwordx4 v[72:75], v1, s[20:23], s29 offen offset:2048 sc1
  v_mfma_f32_16x16x32_bf16 v[124:127], a[204:207], v[224:227], v[124:127]
  ds_read_b64_tr_b16 v[224:225], v250 offset:16384
  s_waitcnt lgkmcnt(9)
  v_mfma_f32_16x16x32_bf16 v[140:143], a[204:207], v[232:235], v[140:143]
  v_mfma_f32_16x16x32_bf16 v[140:143], a[220:223], v[236:239], v[140:143]
  ds_read_b64_tr_b16 v[226:227], v250 offset:17408
  v_mfma_f32_16x16x32_bf16 v[136:139], a[216:219], v[236:239], v[136:139]
  v_mfma_f32_16x16x32_bf16 v[136:139], a[200:203], v[232:235], v[136:139]
  ds_read_b64_tr_b16 v[228:229], v250 offset:24576
  v_mfma_f32_16x16x32_bf16 v[132:135], a[196:199], v[232:235], v[132:135]
  v_mfma_f32_16x16x32_bf16 v[132:135], a[212:215], v[236:239], v[132:135]
  ds_read_b64_tr_b16 v[230:231], v250 offset:25600
  v_mfma_f32_16x16x32_bf16 v[128:131], a[208:211], v[236:239], v[128:131]
  v_mfma_f32_16x16x32_bf16 v[128:131], a[192:195], v[232:235], v[128:131]
  ds_read_b64_tr_b16 v[232:233], v251 offset:16384
  s_waitcnt lgkmcnt(9)
  v_mfma_f32_16x16x32_bf16 v[144:147], a[192:195], v[208:211], v[144:147]
  s_waitcnt vmcnt(16)
  s_barrier
  v_mfma_f32_16x16x32_bf16 v[144:147], a[208:211], v[212:215], v[144:147]
  ds_read_b64_tr_b16 v[234:235], v251 offset:17408
  s_mov_b32 s4, s90
  v_mfma_f32_16x16x32_bf16 v[148:151], a[212:215], v[212:215], v[148:151]
  v_cmp_gt_u32 vcc, 32, v3
  s_cbranch_vccnz K_PI_spin
K_PI_ok:
  v_mfma_f32_16x16x32_bf16 v[148:151], a[196:199], v[208:211], v[148:151]
  ds_read_b64_tr_b16 v[236:237], v251 offset:24576
  s_add_u32 m0, s37, 0
  v_mfma_f32_16x16x32_bf16 v[152:155], a[200:203], v[208:211], v[152:155]
  v_mfma_f32_16x16x32_bf16 v[152:155], a[216:219], v[212:215], v[152:155]
  ds_read_b64_tr_b16 v[238:239], v251 offset:25600
  v_mfma_f32_16x16x32_bf16 v[156:159], a[220:223], v[212:215], v[156:159]
  s_add_u32 s34, s32, 524288
  v_mfma_f32_16x16x32_bf16 v[156:159], a[204:207], v[208:211], v[156:159]
  ds_read_b64_tr_b16 v[208:209], v244 offset:32768
  s_waitcnt lgkmcnt(9)
  v_mfma_f32_16x16x32_bf16 v[172:175], a[204:207], v[216:219], v[172:175]
  v_mfma_f32_16x16x32_bf16 v[172:175], a[220:223], v[220:223], v[172:175]
  ds_read_b64_tr_b16 v[210:211], v244 offset:33792
  buffer_load_dwordx4 v4, s[8:11], s34 offen offset:0 lds
  v_mfma_f32_16x16x32_bf16 v[168:171], a[216:219], v[220:223], v[168:171]
  v_mfma_f32_16x16x32_bf16 v[168:171], a[200:203], v[216:219], v[168:171]
  buffer_store_dwordx4 v[76:79], v1, s[20:23], s29 offen offset:3072 sc1
  ds_read_b64_tr_b16 v[212:213], v244 offset:40960
  s_and_b32 s5, s91, 0xffff
  v_mfma_f32_16x16x32_bf16 v[164:167], a[196:199], v[216:219], v[164:167]
  buffer_load_dwordx4 v5, s[8:11], s34 offen offset:1024 lds
  v_mfma_f32_16x16x32_bf16 v[164:167], a[212:215], v[220:223], v[164:167]
K_hA0_4:
  s_cbranch_execz K_hA0_5
  ds_read_b64_tr_b16 v[214:215], v244 offset:41984
  v_mfma_f32_16x16x32_bf16 v[160:163], a[208:211], v[220:223], v[160:163]
  v_mfma_f32_16x16x32_bf16 v[160:163], a[192:195], v[216:219], v[160:163]
  ds_read_b64_tr_b16 v[216:217], v245 offset:32768
  buffer_load_dwordx4 v6, s[8:11], s34 offen offset:2048 lds
  s_waitcnt lgkmcnt(9)
  v_mfma_f32_16x16x32_bf16 v[176:179], a[192:195], v[224:227], v[176:179]
  v_mfma_f32_16x16x32_bf16 v[176:179], a[208:211], v[228:231], v[176:179]
  ds_read_b64_tr_b16 v[218:219], v245 offset:33792
  v_mfma_f32_16x16x32_bf16 v[180:183], a[212:215], v[228:231], v[180:183]
  buffer_load_dwordx4 v7, s[8:11], s34 offen offset:3072 lds
  v_mfma_f32_16x16x32_bf16 v[180:183], a[196:199], v[224:227], v[180:183]
  ds_read_b64_tr_b16 v[220:221], v245 offset:40960
  v_mfma_f32_16x16x32_bf16 v[184:187], a[200:203], v[224:227], v[184:187]
  v_mfma_f32_16x16x32_bf16 v[184:187], a[216:219], v[228:231], v[184:187]
  ds_read_b64_tr_b16 v[222:223], v245 offset:41984
  s_add_u32 m0, s33, 4096
  v_mfma_f32_16x16x32_bf16 v[188:191], a[220:223], v[228:231], v[188:191]
  s_mov_b32 s6, 2359296
  v_mfma_f32_16x16x32_bf16 v[188:191], a[204:207], v[224:227], v[188:191]
  ds_read_b64_tr_b16 v[224:225], v246 offset:32768
  s_waitcnt lgkmcnt(9)
  v_mfma_f32_16x16x32_bf16 v[204:207], a[204:207], v[232:235], v[204:207]
  v_mfma_f32_16x16x32_bf16 v[204:207], a[220:223], v[236:239], v[204:207]
  ds_read_b64_tr_b16 v[226:227], v246 offset:33792
  s_add_u32 s35, s49, 512
  v_mfma_f32_16x16x32_bf16 v[200:203], a[216:219], v[236:239], v[200:203]
  v_mfma_f32_16x16x32_bf16 v[200:203], a[200:203], v[232:235], v[200:203]
  ds_read_b64_tr_b16 v[228:229], v246 offset:40960
  v_mfma_f32_16x16x32_bf16 v[196:199], a[196:199], v[232:235], v[196:199]
  v_mfma_f32_16x16x32_bf16 v[196:199], a[212:215], v[236:239], v[196:199]
  ds_read_b64_tr_b16 v[230:231], v246 offset:41984
  buffer_load_dwordx4 v12, s[12:15], s35 offen offset:0 lds
  v_mfma_f32_16x16x32_bf16 v[192:195], a[208:211], v[236:239], v[192:195]
  v_mfma_f32_16x16x32_bf16 v[192:195], a[192:195], v[232:235], v[192:195]
  ds_read_b64_tr_b16 v[232:233], v247 offset:32768
  s_waitcnt lgkmcnt(9)
  v_mfma_f32_16x16x32_bf16 v[80:83], a[224:227], v[208:211], v[80:83]
  v_mfma_f32_16x16x32_bf16 v[80:83], a[240:243], v[212:215], v[80:83]
  ds_read_b64_tr_b16 v[234:235], v247 offset:33792
  buffer_load_dwordx4 v13, s[12:15], s35 offen offset:1024 lds
  v_mfma_f32_16x16x32_bf16 v[84:87], a[244:247], v[212:215], v[84:87]
  v_mfma_f32_16x16x32_bf16 v[84:87], a[228:231], v[208:211], v[84:87]
  ds_read_b64_tr_b16 v[236:237], v247 offset:40960
  v_mfma_f32_16x16x32_bf16 v[88:91], a[232:235], v[208:211], v[88:91]
  v_mfma_f32_16x16x32_bf16 v[88:91], a[248:251], v[212:215], v[88:91]
  ds_read_b64_tr_b16 v[238:239], v247 offset:41984
  buffer_load_dwordx4 v14, s[12:15], s35 offen offset:2048 lds
  v_mfma_f32_16x16x32_bf16 v[92:95], a[252:255], v[212:215], v[92:95]
  v_mfma_f32_16x16x32_bf16 v[92:95], a[236:239], v[208:211], v[92:95]
  ds_read_b64_tr_b16 v[208:209], v248 offset:32768
  s_waitcnt lgkmcnt(9)
  v_mfma_f32_16x16x32_bf16 v[108:111], a[236:239], v[216:219], v[108:111]
  v_mfma_f32_16x16x32_bf16 v[108:111], a[252:255], v[220:223], v[108:111]
  ds_read_b64_tr_b16 v[210:211], v248 offset:33792
  buffer_load_dwordx4 v15, s[12:15], s35 offen offset:3072 lds
  v_mfma_f32_16x16x32_bf16 v[104:107], a[248:251], v[220:223], v[104:107]
  v_mfma_f32_16x16x32_bf16 v[104:107], a[232:235], v[216:219], v[104:107]
  ds_read_b64_tr_b16 v[212:213], v248 offset:40960
  v_mfma_f32_16x16x32_bf16 v[100:103], a[228:231], v[216:219], v[100:103]
  v_mfma_f32_16x16x32_bf16 v[100:103], a[244:247], v[220:223], v[100:103]
  ds_read_b64_tr_b16 v[214:215], v248 offset:41984
  v_cvt_pk_bf16_f32 v16, v80, v81
  v_mfma_f32_16x16x32_bf16 v[96:99], a[240:243], v[220:223], v[96:99]
  s_waitcnt vmcnt(20)
  ds_read_b128 a[96:99], v242 offset:0
  v_mfma_f32_16x16x32_bf16 v[96:99], a[224:227], v[216:219], v[96:99]
  ds_read_b64_tr_b16 v[216:217], v249 offset:32768
  s_waitcnt lgkmcnt(10)
  v_cvt_pk_bf16_f32 v17, v82, v83
  v_mfma_f32_16x16x32_bf16 v[112:115], a[224:227], v[224:227], v[112:115]
  v_cvt_pk_bf16_f32 v18, v84, v85
  v_cvt_pk_bf16_f32 v19, v86, v87
  v_mfma_f32_16x16x32_bf16 v[112:115], a[240:243], v[228:231], v[112:115]
  ds_read_b64_tr_b16 v[218:219], v249 offset:33792
  ds_read_b128 a[100:103], v242 offset:2048
  v_mfma_f32_16x16x32_bf16 v[116:119], a[244:247], v[228:231], v[116:119]
  v_cvt_pk_bf16_f32 v20, v88, v89
  v_cvt_pk_bf16_f32 v21, v90, v91
  v_mfma_f32_16x16x32_bf16 v[116:119], a[228:231], v[224:227], v[116:119]
  ds_read_b64_tr_b16 v[220:221], v249 offset:40960
  s_add_u32 m0, s33, 32768
  v_cvt_pk_bf16_f32 v22, v92, v93
  v_mfma_f32_16x16x32_bf16 v[120:123], a[232:235], v[224:227], v[120:123]
  ds_read_b128 a[104:107], v242 offset:4096
  v_cvt_pk_bf16_f32 v23, v94, v95
  v_mfma_f32_16x16x32_bf16 v[120:123], a[248:251], v[228:231], v[120:123]
  ds_read_b64_tr_b16 v[222:223], v249 offset:41984
  s_add_u32 s35, s48, 640
  v_cvt_pk_bf16_f32 v24, v96, v97
  v_mfma_f32_16x16x32_bf16 v[124:127], a[252:255], v[228:231], v[124:127]
  v_cvt_pk_bf16_f32 v25, v98, v99
  v_mfma_f32_16x16x32_bf16 v[124:127], a[236:239], v[224:227], v[124:127]
  ds_read_b64_tr_b16 v[224:225], v250 offset:32768
  buffer_load_dwordx4 v12, s[12:15], s35 offen offset:0 lds
  s_waitcnt lgkmcnt(12)
  v_mfma_f32_16x16x32_bf16 v[140:143], a[236:239], v[232:235], v[140:143]
  ds_read_b128 a[108:111], v242 offset:6144
  v_cvt_pk_bf16_f32 v26, v100, v101
  v_mfma_f32_16x16x32_bf16 v[140:143], a[252:255], v[236:239], v[140:143]
  ds_read_b64_tr_b16 v[226:227], v250 offset:33792
  v_cvt_pk_bf16_f32 v27, v102, v103
  v_mfma_f32_16x16x32_bf16 v[136:139], a[248:251], v[236:239], v[136:139]
  buffer_load_dwordx4 v13, s[12:15], s35 offen offset:1024 lds
  ds_read_b128 a[112:115], v243 offset:0
  v_mfma_f32_16x16x32_bf16 v[136:139], a[232:235], v[232:235], v[136:139]
  ds_read_b64_tr_b16 v[228:229], v250 offset:40960
  v_cvt_pk_bf16_f32 v28, v104, v105
  v_mfma_f32_16x16x32_bf16 v[132:135], a[228:231], v[232:235], v[132:135]
  buffer_load_dwordx4 v14, s[12:15], s35 offen offset:2048 lds
  v_cvt_pk_bf16_f32 v29, v106, v107
  v_mfma_f32_16x16x32_bf16 v[132:135], a[244:247], v[236:239], v[132:135]
  ds_read_b64_tr_b16 v[230:231], v250 offset:41984
  ds_read_b128 a[116:119], v243 offset:2048
  v_mfma_f32_16x16x32_bf16 v[128:131], a[240:243], v[236:239], v[128:131]
  buffer_load_dwordx4 v15, s[12:15], s35 offen offset:3072 lds
  v_cvt_pk_bf16_f32 v30, v108, v109
  v_mfma_f32_16x16x32_bf16 v[128:131], a[224:227], v[232:235], v[128:131]
  ds_read_b64_tr_b16 v[232:233], v251 offset:32768
  s_waitcnt lgkmcnt(15)
  v_cvt_pk_bf16_f32 v31, v110, v111
  v_cvt_pk_bf16_f32 v32, v112, v113
  v_cvt_pk_bf16_f32 v33, v114, v115
  v_mfma_f32_16x16x32_bf16 v[144:147], a[224:227], v[208:211], v[144:147]
  s_waitcnt vmcnt(19)
  s_barrier
  v_mfma_f32_16x16x32_bf16 v[144:147], a[240:243], v[212:215], v[144:147]
  ds_read_b64_tr_b16 v[234:235], v251 offset:33792
  ds_read_b128 a[120:123], v243 offset:4096
  s_add_u32 m0, s37, 16384
  v_mfma_f32_16x16x32_bf16 v[148:151], a[244:247], v[212:215], v[148:151]
  v_cvt_pk_bf16_f32 v34, v116, v117
  v_cvt_pk_bf16_f32 v35, v118, v119
K_hA1_4:
  s_cbranch_execz K_hA1_5
  v_mfma_f32_16x16x32_bf16 v[148:151], a[228:231], v[208:211], v[148:151]
  ds_read_b64_tr_b16 v[236:237], v251 offset:40960
  ds_read_b128 a[124:127], v243 offset:6144
  v_mfma_f32_16x16x32_bf16 v[152:155], a[232:235], v[208:211], v[152:155]
  v_cvt_pk_bf16_f32 v36, v120, v121
  v_cvt_pk_bf16_f32 v37, v122, v123
  v_mfma_f32_16x16x32_bf16 v[152:155], a[248:251], v[212:215], v[152:155]
  ds_read_b64_tr_b16 v[238:239], v251 offset:41984
  s_add_u32 s34, s32, 1048576
  v_cvt_pk_bf16_f32 v38, v124, v125
  v_mfma_f32_16x16x32_bf16 v[156:159], a[252:255], v[212:215], v[156:159]
  v_cvt_pk_bf16_f32 v39, v126, v127
  v_cvt_pk_bf16_f32 v40, v128, v129
  v_mfma_f32_16x16x32_bf16 v[156:159], a[236:239], v[208:211], v[156:159]
  ds_read_b64_tr_b16 a[192:193], v244 offset:49152
  s_waitcnt lgkmcnt(14)
  v_cvt_pk_bf16_f32 v41, v130, v131
  v_mfma_f32_16x16x32_bf16 v[172:175], a[236:239], v[216:219], v[172:175]
  v_cvt_pk_bf16_f32 v42, v132, v133
  v_cvt_pk_bf16_f32 v43, v134, v135
  v_mfma_f32_16x16x32_bf16 v[172:175], a[252:255], v[220:223], v[172:175]
  ds_read_b64_tr_b16 a[194:195], v244 offset:50176
  buffer_load_dwordx4 v4, s[8:11], s34 offen offset:0 lds
  v_mfma_f32_16x16x32_bf16 v[168:171], a[248:251], v[220:223], v[168:171]
  v_cvt_pk_bf16_f32 v44, v136, v137
  v_cvt_pk_bf16_f32 v45, v138, v139
  v_mfma_f32_16x16x32_bf16 v[168:171], a[232:235], v[216:219], v[168:171]
  ds_read_b64_tr_b16 a[196:197], v244 offset:57344
  v_cvt_pk_bf16_f32 v46, v140, v141
  v_mfma_f32_16x16x32_bf16 v[164:167], a[228:231], v[216:219], v[164:167]
  v_cvt_pk_bf16_f32 v47, v142, v143
  v_mfma_f32_16x16x32_bf16 v[164:167], a[244:247], v[220:223], v[164:167]
  ds_read_b64_tr_b16 a[198:199], v244 offset:58368
  buffer_load_dwordx4 v5, s[8:11], s34 offen offset:1024 lds
  v_mfma_f32_16x16x32_bf16 v[160:163], a[240:243], v[220:223], v[160:163]
  v_cvt_pk_bf16_f32 v48, v144, v145
  v_cvt_pk_bf16_f32 v49, v146, v147
  v_mfma_f32_16x16x32_bf16 v[160:163], a[224:227], v[216:219], v[160:163]
  ds_read_b64_tr_b16 a[200:201], v245 offset:49152
  s_waitcnt lgkmcnt(12)
  v_cvt_pk_bf16_f32 v50, v148, v149
  v_mfma_f32_16x16x32_bf16 v[176:179], a[224:227], v[224:227], v[176:179]
  v_cvt_pk_bf16_f32 v51, v150, v151
  v_mfma_f32_16x16x32_bf16 v[176:179], a[240:243], v[228:231], v[176:179]
  ds_read_b64_tr_b16 a[202:203], v245 offset:50176
  buffer_load_dwordx4 v6, s[8:11], s34 offen offset:2048 lds
  v_mfma_f32_16x16x32_bf16 v[180:183], a[244:247], v[228:231], v[180:183]
  v_cvt_pk_bf16_f32 v52, v152, v153
  v_cvt_pk_bf16_f32 v53, v154, v155
  v_mfma_f32_16x16x32_bf16 v[180:183], a[228:231], v[224:227], v[180:183]
  ds_read_b64_tr_b16 a[204:205], v245 offset:57344
  v_cvt_pk_bf16_f32 v54, v156, v157
  v_mfma_f32_16x16x32_bf16 v[184:187], a[232:235], v[224:227], v[184:187]
  v_cvt_pk_bf16_f32 v55, v158, v159
  v_mfma_f32_16x16x32_bf16 v[184:187], a[248:251], v[228:231], v[184:187]
  ds_read_b64_tr_b16 a[206:207], v245 offset:58368
  buffer_load_dwordx4 v7, s[8:11], s34 offen offset:3072 lds
  v_mfma_f32_16x16x32_bf16 v[188:191], a[252:255], v[228:231], v[188:191]
  s_waitcnt lgkmcnt(9)
  v_cvt_pk_bf16_f32 v56, v160, v161
  v_cvt_pk_bf16_f32 v57, v162, v163
  v_mfma_f32_16x16x32_bf16 v[188:191], a[236:239], v[224:227], v[188:191]
  ds_read_b64_tr_b16 a[208:209], v246 offset:49152
  s_waitcnt lgkmcnt(9)
  v_cvt_pk_bf16_f32 v58, v164, v165
  v_mfma_f32_16x16x32_bf16 v[204:207], a[236:239], v[232:235], v[204:207]
  v_cvt_pk_bf16_f32 v59, v166, v167
  v_mfma_f32_16x16x32_bf16 v[204:207], a[252:255], v[236:239], v[204:207]
  ds_read_b64_tr_b16 a[210:211], v246 offset:50176
  v_cvt_pk_bf16_f32 v60, v168, v169
  v_mfma_f32_16x16x32_bf16 v[200:203], a[248:251], v[236:239], v[200:203]
  v_cvt_pk_bf16_f32 v61, v170, v171
  v_mfma_f32_16x16x32_bf16 v[200:203], a[232:235], v[232:235], v[200:203]
  ds_read_b64_tr_b16 a[212:213], v246 offset:57344
  v_cvt_pk_bf16_f32 v62, v172, v173
  v_mfma_f32_16x16x32_bf16 v[196:199], a[228:231], v[232:235], v[196:199]
  v_cvt_pk_bf16_f32 v63, v174, v175
  v_mfma_f32_16x16x32_bf16 v[196:199], a[244:247], v[236:239], v[196:199]
  ds_read_b64_tr_b16 a[214:215], v246 offset:58368
  v_cvt_pk_bf16_f32 v64, v176, v177
  v_mfma_f32_16x16x32_bf16 v[192:195], a[240:243], v[236:239], v[192:195]
  v_cvt_pk_bf16_f32 v65, v178, v179
  v_mfma_f32_16x16x32_bf16 v[192:195], a[224:227], v[232:235], v[192:195]
  ds_read_b64_tr_b16 a[216:217], v247 offset:49152
  s_waitcnt lgkmcnt(9)
  v_cvt_pk_bf16_f32 v66, v180, v181
  v_mfma_f32_16x16x32_bf16 v[80:83], a[192:195], a[0:3], 0
  v_cvt_pk_bf16_f32 v67, v182, v183
  v_mfma_f32_16x16x32_bf16 v[80:83], a[196:199], a[16:19], v[80:83]
  ds_read_b64_tr_b16 a[218:219], v247 offset:50176
  v_cvt_pk_bf16_f32 v68, v184, v185
  v_mfma_f32_16x16x32_bf16 v[84:87], a[196:199], a[20:23], 0
  v_cvt_pk_bf16_f32 v69, v186, v187
  v_mfma_f32_16x16x32_bf16 v[84:87], a[192:195], a[4:7], v[84:87]
  ds_read_b64_tr_b16 a[220:221], v247 offset:57344
  v_cvt_pk_bf16_f32 v70, v188, v189
  v_mfma_f32_16x16x32_bf16 v[88:91], a[192:195], a[8:11], 0
  v_cvt_pk_bf16_f32 v71, v190, v191
  v_mfma_f32_16x16x32_bf16 v[88:91], a[196:199], a[24:27], v[88:91]
  ds_read_b64_tr_b16 a[222:223], v247 offset:58368
  s_add_u32 m0, s33, 36864
  v_cvt_pk_bf16_f32 v72, v192, v193
  v_mfma_f32_16x16x32_bf16 v[92:95], a[196:199], a[28:31], 0
  v_cvt_pk_bf16_f32 v73, v194, v195
  v_mfma_f32_16x16x32_bf16 v[92:95], a[192:195], a[12:15], v[92:95]
  ds_read_b64_tr_b16 a[192:193], v248 offset:49152
  s_waitcnt lgkmcnt(9)
  v_cvt_pk_bf16_f32 v74, v196, v197
  v_mfma_f32_16x16x32_bf16 v[108:111], a[200:203], a[12:15], 0
  v_cvt_pk_bf16_f32 v75, v198, v199
  v_mfma_f32_16x16x32_bf16 v[108:111], a[204:207], a[28:31], v[108:111]
  ds_read_b64_tr_b16 a[194:195], v248 offset:50176
  s_add_u32 s35, s49, 640
  v_cvt_pk_bf16_f32 v76, v200, v201
  v_mfma_f32_16x16x32_bf16 v[104:107], a[204:207], a[24:27], 0
  v_cvt_pk_bf16_f32 v77, v202, v203
  v_mfma_f32_16x16x32_bf16 v[104:107], a[200:203], a[8:11], v[104:107]
  ds_read_b64_tr_b16 a[196:197], v248 offset:57344
  v_cvt_pk_bf16_f32 v78, v204, v205
  v_mfma_f32_16x16x32_bf16 v[100:103], a[200:203], a[4:7], 0
  v_cvt_pk_bf16_f32 v79, v206, v207
  v_mfma_f32_16x16x32_bf16 v[100:103], a[204:207], a[20:23], v[100:103]
  ds_read_b64_tr_b16 a[198:199], v248 offset:58368
  buffer_load_dwordx4 v12, s[12:15], s35 offen offset:0 lds
  v_mfma_f32_16x16x32_bf16 v[96:99], a[204:207], a[16:19], 0
  v_mfma_f32_16x16x32_bf16 v[96:99], a[200:203], a[0:3], v[96:99]
  ds_read_b64_tr_b16 a[200:201], v249 offset:49152
  s_waitcnt lgkmcnt(9)
  v_mfma_f32_16x16x32_bf16 v[112:115], a[208:211], a[0:3], 0
  v_mfma_f32_16x16x32_bf16 v[112:115], a[212:215], a[16:19], v[112:115]
  ds_read_b64_tr_b16 a[202:203], v249 offset:50176
K_hA2_4:
  s_cbranch_execz K_hA2_5
  buffer_load_dwordx4 v13, s[12:15], s35 offen offset:1024 lds
  v_mfma_f32_16x16x32_bf16 v[116:119], a[212:215], a[20:23], 0
  v_mfma_f32_16x16x32_bf16 v[116:119], a[208:211], a[4:7], v[116:119]
  ds_read_b64_tr_b16 a[204:205], v249 offset:57344
  v_mfma_f32_16x16x32_bf16 v[120:123], a[208:211], a[8:11], 0
  v_mfma_f32_16x16x32_bf16 v[120:123], a[212:215], a[24:27], v[120:123]
  ds_read_b64_tr_b16 a[206:207], v249 offset:58368
  buffer_load_dwordx4 v14, s[12:15], s35 offen offset:2048 lds
  v_mfma_f32_16x16x32_bf16 v[124:127], a[212:215], a[28:31], 0
  v_mfma_f32_16x16x32_bf16 v[124:127], a[208:211], a[12:15], v[124:127]
  ds_read_b64_tr_b16 a[208:209], v250 offset:49152
  s_waitcnt lgkmcnt(9)
  v_mfma_f32_16x16x32_bf16 v[140:143], a[216:219], a[12:15], 0
  v_mfma_f32_16x16x32_bf16 v[140:143], a[220:223], a[28:31], v[140:143]
  ds_read_b64_tr_b16 a[210:211], v250 offset:50176
  buffer_load_dwordx4 v15, s[12:15], s35 offen offset:3072 lds
  v_mfma_f32_16x16x32_bf16 v[136:139], a[220:223], a[24:27], 0
  v_mfma_f32_16x16x32_bf16 v[136:139], a[216:219], a[8:11], v[136:139]
  ds_read_b64_tr_b16 a[212:213], v250 offset:57344
  v_mfma_f32_16x16x32_bf16 v[132:135], a[216:219], a[4:7], 0
  v_mfma_f32_16x16x32_bf16 v[132:135], a[220:223], a[20:23], v[132:135]
  ds_read_b64_tr_b16 a[214:215], v250 offset:58368
  v_mfma_f32_16x16x32_bf16 v[128:131], a[220:223], a[16:19], 0
  v_mfma_f32_16x16x32_bf16 v[128:131], a[216:219], a[0:3], v[128:131]
  ds_read_b64_tr_b16 a[216:217], v251 offset:49152
  s_waitcnt lgkmcnt(9)
  v_mfma_f32_16x16x32_bf16 v[144:147], a[192:195], a[0:3], 0
  s_waitcnt vmcnt(16)
  s_barrier
  v_mfma_f32_16x16x32_bf16 v[144:147], a[196:199], a[16:19], v[144:147]
  ds_read_b64_tr_b16 a[218:219], v251 offset:50176
  s_add_u32 s29, s51, 0
  v_mfma_f32_16x16x32_bf16 v[148:151], a[196:199], a[20:23], 0
  s_add_u32 s27, s39, 0
  buffer_store_dword v252, off, s[20:23], s27 sc1
  s_mov_b32 s52, s88
  v_mfma_f32_16x16x32_bf16 v[148:151], a[192:195], a[4:7], v[148:151]
  ds_read_b64_tr_b16 a[220:221], v251 offset:57344
  v_mfma_f32_16x16x32_bf16 v[152:155], a[192:195], a[8:11], 0
  s_add_u32 m0, s37, 32768
  v_mfma_f32_16x16x32_bf16 v[152:155], a[196:199], a[24:27], v[152:155]
  ds_read_b64_tr_b16 a[222:223], v251 offset:58368
  s_and_b32 s53, s89, 0xffff
  v_mfma_f32_16x16x32_bf16 v[156:159], a[196:199], a[28:31], 0
  v_mfma_f32_16x16x32_bf16 v[156:159], a[192:195], a[12:15], v[156:159]
  ds_read_b64_tr_b16 a[192:193], v244 offset:0
  s_add_u32 s34, s32, 1572864
  s_waitcnt lgkmcnt(9)
  v_mfma_f32_16x16x32_bf16 v[172:175], a[200:203], a[12:15], 0
  s_mov_b32 s54, 1152
  v_mfma_f32_16x16x32_bf16 v[172:175], a[204:207], a[28:31], v[172:175]
  ds_read_b64_tr_b16 a[194:195], v244 offset:1024
  v_mfma_f32_16x16x32_bf16 v[168:171], a[204:207], a[24:27], 0
  buffer_load_dwordx4 v4, s[8:11], s34 offen offset:0 lds
  v_mfma_f32_16x16x32_bf16 v[168:171], a[200:203], a[8:11], v[168:171]
  ds_read_b64_tr_b16 a[196:197], v244 offset:8192
  s_lshl_b32 s45, s2, 2
  v_mfma_f32_16x16x32_bf16 v[164:167], a[200:203], a[4:7], 0
  v_mfma_f32_16x16x32_bf16 v[164:167], a[204:207], a[20:23], v[164:167]
  ds_read_b64_tr_b16 a[198:199], v244 offset:9216
  buffer_load_dwordx4 v5, s[8:11], s34 offen offset:1024 lds
  v_mfma_f32_16x16x32_bf16 v[160:163], a[204:207], a[16:19], 0
  s_add_u32 s45, s45, s24
  v_mfma_f32_16x16x32_bf16 v[160:163], a[200:203], a[0:3], v[160:163]
  ds_read_b64_tr_b16 a[200:201], v245 offset:0
  s_waitcnt lgkmcnt(9)
  v_mfma_f32_16x16x32_bf16 v[176:179], a[208:211], a[0:3], 0
  buffer_load_dwordx4 v6, s[8:11], s34 offen offset:2048 lds
  v_mfma_f32_16x16x32_bf16 v[176:179], a[212:215], a[16:19], v[176:179]
  ds_read_b64_tr_b16 a[202:203], v245 offset:1024
  v_mfma_f32_16x16x32_bf16 v[180:183], a[212:215], a[20:23], 0
  s_waitcnt vmcnt(16)
  ds_read_b128 a[160:163], v240 offset:0
  s_mul_i32 s44, s45, 2304
  v_mfma_f32_16x16x32_bf16 v[180:183], a[208:211], a[4:7], v[180:183]
  buffer_store_dwordx4 v[16:19], v1, s[20:23], s29 offen offset:0 sc1
  ds_read_b64_tr_b16 a[204:205], v245 offset:8192
  buffer_load_dwordx4 v7, s[8:11], s34 offen offset:3072 lds
  v_mfma_f32_16x16x32_bf16 v[184:187], a[208:211], a[8:11], 0
  ds_read_b128 a[164:167], v240 offset:2048
  v_mfma_f32_16x16x32_bf16 v[184:187], a[212:215], a[24:27], v[184:187]
  ds_read_b64_tr_b16 a[206:207], v245 offset:9216
  v_and_b32 v228, 31, v0
  v_mfma_f32_16x16x32_bf16 v[188:191], a[212:215], a[28:31], 0
  v_mfma_f32_16x16x32_bf16 v[188:191], a[208:211], a[12:15], v[188:191]
  ds_read_b64_tr_b16 a[208:209], v246 offset:0
  s_add_u32 m0, s33, 65536
  s_waitcnt lgkmcnt(11)
  v_mfma_f32_16x16x32_bf16 v[204:207], a[216:219], a[12:15], 0
  ds_read_b128 a[168:171], v240 offset:4096
  v_lshlrev_b32 v228, 2, v228
  v_mfma_f32_16x16x32_bf16 v[204:207], a[220:223], a[28:31], v[204:207]
  ds_read_b64_tr_b16 a[210:211], v246 offset:1024
  v_mfma_f32_16x16x32_bf16 v[200:203], a[220:223], a[24:27], 0
  ds_read_b128 a[172:175], v240 offset:6144
  v_mfma_f32_16x16x32_bf16 v[200:203], a[216:219], a[8:11], v[200:203]
  ds_read_b64_tr_b16 a[212:213], v246 offset:8192
  s_add_u32 s35, s48, 768
  v_lshrrev_b32 v229, 5, v0
  v_mfma_f32_16x16x32_bf16 v[196:199], a[216:219], a[4:7], 0
  v_mfma_f32_16x16x32_bf16 v[196:199], a[220:223], a[20:23], v[196:199]
  ds_read_b64_tr_b16 a[214:215], v246 offset:9216
  ds_read_b128 a[176:179], v241 offset:0
  v_mfma_f32_16x16x32_bf16 v[192:195], a[220:223], a[16:19], 0
  v_mul_u32_u24 v229, 1152, v229
  v_mfma_f32_16x16x32_bf16 v[192:195], a[216:219], a[0:3], v[192:195]
  ds_read_b64_tr_b16 a[216:217], v247 offset:0
  buffer_load_dwordx4 v12, s[12:15], s35 offen offset:0 lds
  s_waitcnt lgkmcnt(14)
  v_mfma_f32_16x16x32_bf16 v[80:83], a[192:195], a[32:35], v[80:83]
  ds_read_b128 a[180:183], v241 offset:2048
  v_mfma_f32_16x16x32_bf16 v[80:83], a[196:199], a[48:51], v[80:83]
  ds_read_b64_tr_b16 a[218:219], v247 offset:1024
  v_mfma_f32_16x16x32_bf16 v[84:87], a[196:199], a[52:55], v[84:87]
  v_lshlrev_b32 v230, 2, v228
  v_mfma_f32_16x16x32_bf16 v[84:87], a[192:195], a[36:39], v[84:87]
  ds_read_b64_tr_b16 a[220:221], v247 offset:8192
  buffer_load_dwordx4 v13, s[12:15], s35 offen offset:1024 lds
  v_mfma_f32_16x16x32_bf16 v[88:91], a[192:195], a[40:43], v[88:91]
  ds_read_b128 a[184:187], v241 offset:4096
  v_mfma_f32_16x16x32_bf16 v[88:91], a[196:199], a[56:59], v[88:91]
  ds_read_b64_tr_b16 a[222:223], v247 offset:9216
  v_add_u32 v231, v229, v230
  v_mfma_f32_16x16x32_bf16 v[92:95], a[196:199], a[60:63], v[92:95]
  buffer_store_dwordx4 v[20:23], v1, s[20:23], s29 offen offset:1024 sc1
  ds_read_b128 a[188:191], v241 offset:6144
  v_mfma_f32_16x16x32_bf16 v[92:95], a[192:195], a[44:47], v[92:95]
  ds_read_b64_tr_b16 a[192:193], v248 offset:0
  buffer_load_dwordx4 v14, s[12:15], s35 offen offset:2048 lds
  s_waitcnt lgkmcnt(15)
  v_mfma_f32_16x16x32_bf16 v[108:111], a[200:203], a[44:47], v[108:111]
  v_add_u32 v229, v229, v228
  v_mfma_f32_16x16x32_bf16 v[108:111], a[204:207], a[60:63], v[108:111]
  ds_read_b64_tr_b16 a[194:195], v248 offset:1024
  v_mfma_f32_16x16x32_bf16 v[104:107], a[204:207], a[56:59], v[104:107]
  v_mfma_f32_16x16x32_bf16 v[104:107], a[200:203], a[40:43], v[104:107]
  ds_read_b64_tr_b16 a[196:197], v248 offset:8192
  buffer_load_dwordx4 v15, s[12:15], s35 offen offset:3072 lds
K_hA3_4:
  s_cbranch_execz K_hA3_5
  v_mfma_f32_16x16x32_bf16 v[100:103], a[200:203], a[36:39], v[100:103]
  buffer_load_dwordx4 v[208:211], v231, s[12:15], s44 offen
  v_mfma_f32_16x16x32_bf16 v[100:103], a[204:207], a[52:55], v[100:103]
  ds_read_b64_tr_b16 a[198:199], v248 offset:9216
  v_mfma_f32_16x16x32_bf16 v[96:99], a[204:207], a[48:51], v[96:99]
  buffer_load_dwordx4 v[212:215], v231, s[12:15], s44 offen offset:512
  v_mfma_f32_16x16x32_bf16 v[96:99], a[200:203], a[32:35], v[96:99]
  ds_read_b64_tr_b16 a[200:201], v249 offset:0
  s_waitcnt lgkmcnt(13)
  v_mfma_f32_16x16x32_bf16 v[112:115], a[208:211], a[32:35], v[112:115]
  v_mfma_f32_16x16x32_bf16 v[112:115], a[212:215], a[48:51], v[112:115]
  ds_read_b64_tr_b16 a[202:203], v249 offset:1024
  v_mfma_f32_16x16x32_bf16 v[116:119], a[212:215], a[52:55], v[116:119]
  buffer_load_dword v216, v229, s[12:15], s44 offen offset:1024
  v_mfma_f32_16x16x32_bf16 v[116:119], a[208:211], a[36:39], v[116:119]
  ds_read_b64_tr_b16 a[204:205], v249 offset:8192
  v_mfma_f32_16x16x32_bf16 v[120:123], a[208:211], a[40:43], v[120:123]
  v_mfma_f32_16x16x32_bf16 v[120:123], a[212:215], a[56:59], v[120:123]
  ds_read_b64_tr_b16 a[206:207], v249 offset:9216
  buffer_load_dwordx4 v[218:221], v230, s[52:55], 0 offen
  v_mfma_f32_16x16x32_bf16 v[124:127], a[212:215], a[60:63], v[124:127]
  v_mfma_f32_16x16x32_bf16 v[124:127], a[208:211], a[44:47], v[124:127]
  ds_read_b64_tr_b16 a[208:209], v250 offset:0
  s_waitcnt lgkmcnt(10)
  v_mfma_f32_16x16x32_bf16 v[140:143], a[216:219], a[44:47], v[140:143]
  buffer_load_dwordx4 v[222:225], v230, s[52:55], 0 offen offset:512
  v_mfma_f32_16x16x32_bf16 v[140:143], a[220:223], a[60:63], v[140:143]
  buffer_store_dwordx4 v[24:27], v1, s[20:23], s29 offen offset:2048 sc1
  ds_read_b64_tr_b16 a[210:211], v250 offset:1024
  s_waitcnt lgkmcnt(10)
  v_mfma_f32_16x16x32_bf16 v[136:139], a[220:223], a[56:59], v[136:139]
  v_mfma_f32_16x16x32_bf16 v[136:139], a[216:219], a[40:43], v[136:139]
  ds_read_b64_tr_b16 a[212:213], v250 offset:8192
  buffer_load_dword v226, v228, s[52:55], 0 offen offset:1024
  v_mfma_f32_16x16x32_bf16 v[132:135], a[216:219], a[36:39], v[132:135]
  v_mfma_f32_16x16x32_bf16 v[132:135], a[220:223], a[52:55], v[132:135]
  ds_read_b64_tr_b16 a[214:215], v250 offset:9216
  v_mfma_f32_16x16x32_bf16 v[128:131], a[220:223], a[48:51], v[128:131]
  v_mfma_f32_16x16x32_bf16 v[128:131], a[216:219], a[32:35], v[128:131]
  ds_read_b64_tr_b16 a[216:217], v251 offset:0
  s_waitcnt lgkmcnt(9)
  v_mfma_f32_16x16x32_bf16 v[144:147], a[192:195], a[32:35], v[144:147]
  s_waitcnt vmcnt(22)
  s_barrier
  v_mfma_f32_16x16x32_bf16 v[144:147], a[196:199], a[48:51], v[144:147]
  ds_read_b64_tr_b16 a[218:219], v251 offset:1024
  s_add_u32 m0, s37, 49152
  v_mfma_f32_16x16x32_bf16 v[148:151], a[196:199], a[52:55], v[148:151]
  v_mfma_f32_16x16x32_bf16 v[148:151], a[192:195], a[36:39], v[148:151]
  ds_read_b64_tr_b16 a[220:221], v251 offset:8192
  v_mfma_f32_16x16x32_bf16 v[152:155], a[192:195], a[40:43], v[152:155]
  s_add_u32 s34, s32, 2097152
  v_mfma_f32_16x16x32_bf16 v[152:155], a[196:199], a[56:59], v[152:155]
  ds_read_b64_tr_b16 a[222:223], v251 offset:9216
  v_mfma_f32_16x16x32_bf16 v[156:159], a[196:199], a[60:63], v[156:159]
  v_mfma_f32_16x16x32_bf16 v[156:159], a[192:195], a[44:47], v[156:159]
  ds_read_b64_tr_b16 a[192:193], v244 offset:16384
  buffer_load_dwordx4 v4, s[8:11], s34 offen offset:0 lds
  s_waitcnt lgkmcnt(9)
  v_mfma_f32_16x16x32_bf16 v[172:175], a[200:203], a[44:47], v[172:175]
  v_mfma_f32_16x16x32_bf16 v[172:175], a[204:207], a[60:63], v[172:175]
  ds_read_b64_tr_b16 a[194:195], v244 offset:17408
  v_mfma_f32_16x16x32_bf16 v[168:171], a[204:207], a[56:59], v[168:171]
  v_mfma_f32_16x16x32_bf16 v[168:171], a[200:203], a[40:43], v[168:171]
  ds_read_b64_tr_b16 a[196:197], v244 offset:24576
  buffer_load_dwordx4 v5, s[8:11], s34 offen offset:1024 lds
  v_mfma_f32_16x16x32_bf16 v[164:167], a[200:203], a[36:39], v[164:167]
  buffer_store_dwordx4 v[28:31], v1, s[20:23], s29 offen offset:3072 sc1
  v_mfma_f32_16x16x32_bf16 v[164:167], a[204:207], a[52:55], v[164:167]
  ds_read_b64_tr_b16 a[198:199], v244 offset:25600
  v_mfma_f32_16x16x32_bf16 v[160:163], a[204:207], a[48:51], v[160:163]
  buffer_load_dwordx4 v6, s[8:11], s34 offen offset:2048 lds
  v_mfma_f32_16x16x32_bf16 v[160:163], a[200:203], a[32:35], v[160:163]
  ds_read_b64_tr_b16 a[200:201], v245 offset:16384
  s_waitcnt lgkmcnt(9)
  v_mfma_f32_16x16x32_bf16 v[176:179], a[208:211], a[32:35], v[176:179]
  v_mfma_f32_16x16x32_bf16 v[176:179], a[212:215], a[48:51], v[176:179]
  ds_read_b64_tr_b16 a[202:203], v245 offset:17408
  buffer_load_dwordx4 v7, s[8:11], s34 offen offset:3072 lds
  v_mfma_f32_16x16x32_bf16 v[180:183], a[212:215], a[52:55], v[180:183]
  v_mfma_f32_16x16x32_bf16 v[180:183], a[208:211], a[36:39], v[180:183]
  ds_read_b64_tr_b16 a[204:205], v245 offset:24576
  v_mfma_f32_16x16x32_bf16 v[184:187], a[208:211], a[40:43], v[184:187]
  v_mfma_f32_16x16x32_bf16 v[184:187], a[212:215], a[56:59], v[184:187]
  ds_read_b64_tr_b16 a[206:207], v245 offset:25600
  s_add_u32 m0, s33, 69632
  v_mfma_f32_16x16x32_bf16 v[188:191], a[212:215], a[60:63], v[188:191]
  v_mfma_f32_16x16x32_bf16 v[188:191], a[208:211], a[44:47], v[188:191]
  ds_read_b64_tr_b16 a[208:209], v246 offset:16384
  s_waitcnt lgkmcnt(9)
  v_mfma_f32_16x16x32_bf16 v[204:207], a[216:219], a[44:47], v[204:207]
  v_mfma_f32_16x16x32_bf16 v[204:207], a[220:223], a[60:63], v[204:207]
  ds_read_b64_tr_b16 a[210:211], v246 offset:17408
  s_add_u32 s35, s49, 768
  v_mfma_f32_16x16x32_bf16 v[200:203], a[220:223], a[56:59], v[200:203]
  v_mfma_f32_16x16x32_bf16 v[200:203], a[216:219], a[40:43], v[200:203]
  ds_read_b64_tr_b16 a[212:213], v246 offset:24576
  v_mfma_f32_16x16x32_bf16 v[196:199], a[216:219], a[36:39], v[196:199]
  v_mfma_f32_16x16x32_bf16 v[196:199], a[220:223], a[52:55], v[196:199]
  ds_read_b64_tr_b16 a[214:215], v246 offset:25600
  buffer_load_dwordx4 v12, s[12:15], s35 offen offset:0 lds
  v_mfma_f32_16x16x32_bf16 v[192:195], a[220:223], a[48:51], v[192:195]
  v_mfma_f32_16x16x32_bf16 v[192:195], a[216:219], a[32:35], v[192:195]
  ds_read_b64_tr_b16 a[216:217], v247 offset:16384
  s_waitcnt lgkmcnt(9)
  v_mfma_f32_16x16x32_bf16 v[80:83], a[192:195], a[64:67], v[80:83]
  s_add_u32 s29, s51, 4096
  v_mfma_f32_16x16x32_bf16 v[80:83], a[196:199], a[80:83], v[80:83]
  ds_read_b64_tr_b16 a[218:219], v247 offset:17408
  buffer_load_dwordx4 v13, s[12:15], s35 offen offset:1024 lds
  v_mfma_f32_16x16x32_bf16 v[84:87], a[196:199], a[84:87], v[84:87]
  v_mfma_f32_16x16x32_bf16 v[84:87], a[192:195], a[68:71], v[84:87]
  ds_read_b64_tr_b16 a[220:221], v247 offset:24576
  v_mfma_f32_16x16x32_bf16 v[88:91], a[192:195], a[72:75], v[88:91]
  v_mfma_f32_16x16x32_bf16 v[88:91], a[196:199], a[88:91], v[88:91]
  ds_read_b64_tr_b16 a[222:223], v247 offset:25600
  buffer_load_dwordx4 v14, s[12:15], s35 offen offset:2048 lds
  v_mfma_f32_16x16x32_bf16 v[92:95], a[196:199], a[92:95], v[92:95]
  v_mfma_f32_16x16x32_bf16 v[92:95], a[192:195], a[76:79], v[92:95]
  ds_read_b64_tr_b16 a[192:193], v248 offset:16384
  s_waitcnt lgkmcnt(9)
  v_mfma_f32_16x16x32_bf16 v[108:111], a[200:203], a[76:79], v[108:111]
  v_mfma_f32_16x16x32_bf16 v[108:111], a[204:207], a[92:95], v[108:111]
  ds_read_b64_tr_b16 a[194:195], v248 offset:17408
  buffer_load_dwordx4 v15, s[12:15], s35 offen offset:3072 lds
  v_mfma_f32_16x16x32_bf16 v[104:107], a[204:207], a[88:91], v[104:107]
  v_mfma_f32_16x16x32_bf16 v[104:107], a[200:203], a[72:75], v[104:107]
  ds_read_b64_tr_b16 a[196:197], v248 offset:24576
  v_mfma_f32_16x16x32_bf16 v[100:103], a[200:203], a[68:71], v[100:103]
  v_mfma_f32_16x16x32_bf16 v[100:103], a[204:207], a[84:87], v[100:103]
  ds_read_b64_tr_b16 a[198:199], v248 offset:25600
  v_mfma_f32_16x16x32_bf16 v[96:99], a[204:207], a[80:83], v[96:99]
  v_mfma_f32_16x16x32_bf16 v[96:99], a[200:203], a[64:67], v[96:99]
K_hA0_5:
  s_cbranch_execz K_hA0_6
  ds_read_b64_tr_b16 a[200:201], v249 offset:16384
  s_waitcnt lgkmcnt(9)
  v_mfma_f32_16x16x32_bf16 v[112:115], a[208:211], a[64:67], v[112:115]
  v_mfma_f32_16x16x32_bf16 v[112:115], a[212:215], a[80:83], v[112:115]
  ds_read_b64_tr_b16 a[202:203], v249 offset:17408
  v_mfma_f32_16x16x32_bf16 v[116:119], a[212:215], a[84:87], v[116:119]
  v_mfma_f32_16x16x32_bf16 v[116:119], a[208:211], a[68:71], v[116:119]
  buffer_store_dwordx4 v[32:35], v1, s[20:23], s29 offen offset:0 sc1
  ds_read_b64_tr_b16 a[204:205], v249 offset:24576
  v_mfma_f32_16x16x32_bf16 v[120:123], a[208:211], a[72:75], v[120:123]
  v_mfma_f32_16x16x32_bf16 v[120:123], a[212:215], a[88:91], v[120:123]
  ds_read_b64_tr_b16 a[206:207], v249 offset:25600
  v_mfma_f32_16x16x32_bf16 v[124:127], a[212:215], a[92:95], v[124:127]
  s_waitcnt vmcnt(28)
  ds_read_b128 a[0:3], v240 offset:32768
  v_mfma_f32_16x16x32_bf16 v[124:127], a[208:211], a[76:79], v[124:127]
  ds_read_b64_tr_b16 a[208:209], v250 offset:16384
  s_waitcnt lgkmcnt(10)
  v_mfma_f32_16x16x32_bf16 v[140:143], a[216:219], a[76:79], v[140:143]
  ds_read_b128 a[4:7], v240 offset:34816
  v_mfma_f32_16x16x32_bf16 v[140:143], a[220:223], a[92:95], v[140:143]
  ds_read_b64_tr_b16 a[210:211], v250 offset:17408
  v_mfma_f32_16x16x32_bf16 v[136:139], a[220:223], a[88:91], v[136:139]
  s_add_u32 m0, s33, 0
  v_mfma_f32_16x16x32_bf16 v[136:139], a[216:219], a[72:75], v[136:139]
  ds_read_b64_tr_b16 a[212:213], v250 offset:24576
  ds_read_b128 a[8:11], v240 offset:36864
  s_add_u32 s35, s48, 896
  v_mfma_f32_16x16x32_bf16 v[132:135], a[216:219], a[68:71], v[132:135]
  buffer_load_dwordx4 v12, s[12:15], s35 offen offset:0 lds
  v_mfma_f32_16x16x32_bf16 v[132:135], a[220:223], a[84:87], v[132:135]
  ds_read_b64_tr_b16 a[214:215], v250 offset:25600
  buffer_load_dwordx4 v13, s[12:15], s35 offen offset:1024 lds
  v_mfma_f32_16x16x32_bf16 v[128:131], a[220:223], a[80:83], v[128:131]
  buffer_load_dwordx4 v14, s[12:15], s35 offen offset:2048 lds
  ds_read_b128 a[12:15], v240 offset:38912
  v_mfma_f32_16x16x32_bf16 v[128:131], a[216:219], a[64:67], v[128:131]
  ds_read_b64_tr_b16 a[216:217], v251 offset:16384
  buffer_load_dwordx4 v15, s[12:15], s35 offen offset:3072 lds
  s_waitcnt lgkmcnt(13)
  v_mfma_f32_16x16x32_bf16 v[144:147], a[192:195], a[64:67], v[144:147]
  s_waitcnt vmcnt(26)
  s_barrier
  v_mfma_f32_16x16x32_bf16 v[144:147], a[196:199], a[80:83], v[144:147]
  ds_read_b64_tr_b16 a[218:219], v251 offset:17408
  ds_read_b128 a[16:19], v241 offset:32768
  s_add_u32 m0, s37, 0
  v_mfma_f32_16x16x32_bf16 v[148:151], a[196:199], a[84:87], v[148:151]
  v_mfma_f32_16x16x32_bf16 v[148:151], a[192:195], a[68:71], v[148:151]
  ds_read_b64_tr_b16 a[220:221], v251 offset:24576
  v_mfma_f32_16x16x32_bf16 v[152:155], a[192:195], a[72:75], v[152:155]
  ds_read_b128 a[20:23], v241 offset:34816
  v_mfma_f32_16x16x32_bf16 v[152:155], a[196:199], a[88:91], v[152:155]
  ds_read_b64_tr_b16 a[222:223], v251 offset:25600
  s_add_u32 s34, s32, 2621440
  v_mfma_f32_16x16x32_bf16 v[156:159], a[196:199], a[92:95], v[156:159]
  buffer_store_dwordx4 v[36:39], v1, s[20:23], s29 offen offset:1024 sc1
  v_mfma_f32_16x16x32_bf16 v[156:159], a[192:195], a[76:79], v[156:159]
  ds_read_b64_tr_b16 a[192:193], v244 offset:32768
  ds_read_b128 a[24:27], v241 offset:36864
  s_waitcnt lgkmcnt(15)
  v_mfma_f32_16x16x32_bf16 v[172:175], a[200:203], a[76:79], v[172:175]
  v_mfma_f32_16x16x32_bf16 v[172:175], a[204:207], a[92:95], v[172:175]
  ds_read_b64_tr_b16 a[194:195], v244 offset:33792
  buffer_load_dwordx4 v4, s[8:11], s34 offen offset:0 lds
  v_mfma_f32_16x16x32_bf16 v[168:171], a[204:207], a[88:91], v[168:171]
  ds_read_b128 a[28:31], v241 offset:38912
  v_mfma_f32_16x16x32_bf16 v[168:171], a[200:203], a[72:75], v[168:171]
  ds_read_b64_tr_b16 a[196:197], v244 offset:40960
  v_mfma_f32_16x16x32_bf16 v[164:167], a[200:203], a[68:71], v[164:167]
  v_mfma_f32_16x16x32_bf16 v[164:167], a[204:207], a[84:87], v[164:167]
  ds_read_b64_tr_b16 a[198:199], v244 offset:41984
  buffer_load_dwordx4 v5, s[8:11], s34 offen offset:1024 lds
  v_mfma_f32_16x16x32_bf16 v[160:163], a[204:207], a[80:83], v[160:163]
  v_mfma_f32_16x16x32_bf16 v[160:163], a[200:203], a[64:67], v[160:163]
  ds_read_b64_tr_b16 a[200:201], v245 offset:32768
  s_waitcnt lgkmcnt(14)
  v_mfma_f32_16x16x32_bf16 v[176:179], a[208:211], a[64:67], v[176:179]
  v_mfma_f32_16x16x32_bf16 v[176:179], a[212:215], a[80:83], v[176:179]
  ds_read_b64_tr_b16 a[202:203], v245 offset:33792
  buffer_load_dwordx4 v6, s[8:11], s34 offen offset:2048 lds
  v_mfma_f32_16x16x32_bf16 v[180:183], a[212:215], a[84:87], v[180:183]
  v_mfma_f32_16x16x32_bf16 v[180:183], a[208:211], a[68:71], v[180:183]
  ds_read_b64_tr_b16 a[204:205], v245 offset:40960
  v_mfma_f32_16x16x32_bf16 v[184:187], a[208:211], a[72:75], v[184:187]
  v_mfma_f32_16x16x32_bf16 v[184:187], a[212:215], a[88:91], v[184:187]
  ds_read_b64_tr_b16 a[206:207], v245 offset:41984
  buffer_load_dwordx4 v7, s[8:11], s34 offen offset:3072 lds
  v_mfma_f32_16x16x32_bf16 v[188:191], a[212:215], a[92:95], v[188:191]
  v_mfma_f32_16x16x32_bf16 v[188:191], a[208:211], a[76:79], v[188:191]
  ds_read_b64_tr_b16 a[208:209], v246 offset:32768
  s_waitcnt lgkmcnt(11)
  v_mfma_f32_16x16x32_bf16 v[204:207], a[216:219], a[76:79], v[204:207]
  v_mfma_f32_16x16x32_bf16 v[204:207], a[220:223], a[92:95], v[204:207]
  buffer_store_dwordx4 v[40:43], v1, s[20:23], s29 offen offset:2048 sc1
  ds_read_b64_tr_b16 a[210:211], v246 offset:33792
  v_mfma_f32_16x16x32_bf16 v[200:203], a[220:223], a[88:91], v[200:203]
  v_mfma_f32_16x16x32_bf16 v[200:203], a[216:219], a[72:75], v[200:203]
  ds_read_b64_tr_b16 a[212:213], v246 offset:40960
  v_mfma_f32_16x16x32_bf16 v[196:199], a[216:219], a[68:71], v[196:199]
  v_mfma_f32_16x16x32_bf16 v[196:199], a[220:223], a[84:87], v[196:199]
  ds_read_b64_tr_b16 a[214:215], v246 offset:41984
  s_waitcnt lgkmcnt(10)
  v_mfma_f32_16x16x32_bf16 v[192:195], a[220:223], a[80:83], v[192:195]
  v_mfma_f32_16x16x32_bf16 v[192:195], a[216:219], a[64:67], v[192:195]
  ds_read_b64_tr_b16 a[216:217], v247 offset:32768
  s_waitcnt lgkmcnt(9)
  v_mfma_f32_16x16x32_bf16 v[80:83], a[192:195], a[96:99], v[80:83]
  v_mfma_f32_16x16x32_bf16 v[80:83], a[196:199], a[112:115], v[80:83]
  ds_read_b64_tr_b16 a[218:219], v247 offset:33792
  v_mfma_f32_16x16x32_bf16 v[84:87], a[196:199], a[116:119], v[84:87]
  s_waitcnt vmcnt(20)
  v_mov_b32 v232, 0
  v_mfma_f32_16x16x32_bf16 v[84:87], a[192:195], a[100:103], v[84:87]
  ds_read_b64_tr_b16 a[220:221], v247 offset:40960
  v_lshlrev_b32 v233, 16, v208
  v_mfma_f32_16x16x32_bf16 v[88:91], a[192:195], a[104:107], v[88:91]
  v_and_b32 v234, 0xffff0000, v208
  v_mfma_f32_16x16x32_bf16 v[88:91], a[196:199], a[120:123], v[88:91]
  ds_read_b64_tr_b16 a[222:223], v247 offset:41984
  v_lshlrev_b32 v235, 16, v218
  v_mfma_f32_16x16x32_bf16 v[92:95], a[196:199], a[124:127], v[92:95]
  v_mfma_f32_16x16x32_bf16 v[92:95], a[192:195], a[108:111], v[92:95]
  ds_read_b64_tr_b16 a[192:193], v248 offset:32768
  s_waitcnt lgkmcnt(9)
  v_and_b32 v236, 0xffff0000, v218
  v_mfma_f32_16x16x32_bf16 v[108:111], a[200:203], a[108:111], v[108:111]
  v_mul_f32 v233, v233, v235
  v_mfma_f32_16x16x32_bf16 v[108:111], a[204:207], a[124:127], v[108:111]
  ds_read_b64_tr_b16 a[194:195], v248 offset:33792
  v_mul_f32 v234, v234, v236
  v_mfma_f32_16x16x32_bf16 v[104:107], a[204:207], a[120:123], v[104:107]
  v_mfma_f32_16x16x32_bf16 v[104:107], a[200:203], a[104:107], v[104:107]
  ds_read_b64_tr_b16 a[196:197], v248 offset:40960
  v_cvt_pk_bf16_f32 v237, v233, v234
  v_mfma_f32_16x16x32_bf16 v[100:103], a[200:203], a[100:103], v[100:103]
  buffer_store_dwordx4 v[44:47], v1, s[20:23], s29 offen offset:3072 sc1
K_hA1_5:
  s_cbranch_execz K_hA1_6
  s_add_u32 m0, s33, 4096
  v_lshlrev_b32 v233, 16, v237
  v_mfma_f32_16x16x32_bf16 v[100:103], a[204:207], a[116:119], v[100:103]
  ds_read_b64_tr_b16 a[198:199], v248 offset:41984
  v_and_b32 v234, 0xffff0000, v237
  v_mfma_f32_16x16x32_bf16 v[96:99], a[204:207], a[112:115], v[96:99]
  v_mfma_f32_16x16x32_bf16 v[96:99], a[200:203], a[96:99], v[96:99]
  ds_read_b64_tr_b16 a[200:201], v249 offset:32768
  s_add_u32 s35, s49, 896
  s_waitcnt lgkmcnt(9)
  v_mfma_f32_16x16x32_bf16 v[112:115], a[208:211], a[96:99], v[112:115]
  v_add_f32 v232, v232, v233
  v_add_f32 v232, v232, v234
  v_mfma_f32_16x16x32_bf16 v[112:115], a[212:215], a[112:115], v[112:115]
  ds_read_b64_tr_b16 a[202:203], v249 offset:33792
  v_lshlrev_b32 v233, 16, v209
  v_mfma_f32_16x16x32_bf16 v[116:119], a[212:215], a[116:119], v[116:119]
  v_mfma_f32_16x16x32_bf16 v[116:119], a[208:211], a[100:103], v[116:119]
  ds_read_b64_tr_b16 a[204:205], v249 offset:40960
  buffer_load_dwordx4 v12, s[12:15], s35 offen offset:0 lds
  v_mfma_f32_16x16x32_bf16 v[120:123], a[208:211], a[104:107], v[120:123]
  v_and_b32 v234, 0xffff0000, v209
  v_lshlrev_b32 v235, 16, v219
  v_mfma_f32_16x16x32_bf16 v[120:123], a[212:215], a[120:123], v[120:123]
  ds_read_b64_tr_b16 a[206:207], v249 offset:41984
  v_and_b32 v236, 0xffff0000, v219
  v_mfma_f32_16x16x32_bf16 v[124:127], a[212:215], a[124:127], v[124:127]
  buffer_load_dwordx4 v13, s[12:15], s35 offen offset:1024 lds
  v_mfma_f32_16x16x32_bf16 v[124:127], a[208:211], a[108:111], v[124:127]
  ds_read_b64_tr_b16 a[208:209], v250 offset:32768
  s_waitcnt lgkmcnt(9)
  v_mul_f32 v233, v233, v235
  v_mfma_f32_16x16x32_bf16 v[140:143], a[216:219], a[108:111], v[140:143]
  v_mul_f32 v234, v234, v236
  v_mfma_f32_16x16x32_bf16 v[140:143], a[220:223], a[124:127], v[140:143]
  ds_read_b64_tr_b16 a[210:211], v250 offset:33792
  v_cvt_pk_bf16_f32 v237, v233, v234
  v_mfma_f32_16x16x32_bf16 v[136:139], a[220:223], a[120:123], v[136:139]
  buffer_load_dwordx4 v14, s[12:15], s35 offen offset:2048 lds
  v_lshlrev_b32 v233, 16, v237
  v_mfma_f32_16x16x32_bf16 v[136:139], a[216:219], a[104:107], v[136:139]
  ds_read_b64_tr_b16 a[212:213], v250 offset:40960
  v_mfma_f32_16x16x32_bf16 v[132:135], a[216:219], a[100:103], v[132:135]
  v_and_b32 v234, 0xffff0000, v237
  v_mfma_f32_16x16x32_bf16 v[132:135], a[220:223], a[116:119], v[132:135]
  ds_read_b64_tr_b16 a[214:215], v250 offset:41984
  buffer_load_dwordx4 v15, s[12:15], s35 offen offset:3072 lds
  v_mfma_f32_16x16x32_bf16 v[128:131], a[220:223], a[112:115], v[128:131]
  v_add_f32 v232, v232, v233
  v_add_f32 v232, v232, v234
  v_mfma_f32_16x16x32_bf16 v[128:131], a[216:219], a[96:99], v[128:131]
  ds_read_b64_tr_b16 a[216:217], v251 offset:32768
  s_waitcnt lgkmcnt(9)
  v_lshlrev_b32 v233, 16, v210
  v_mfma_f32_16x16x32_bf16 v[144:147], a[192:195], a[96:99], v[144:147]
  s_waitcnt vmcnt(20)
  s_barrier
  v_mfma_f32_16x16x32_bf16 v[144:147], a[196:199], a[112:115], v[144:147]
  ds_read_b64_tr_b16 a[218:219], v251 offset:33792
  s_add_u32 m0, s37, 16384
  s_add_u32 s29, s51, 8192
  v_mfma_f32_16x16x32_bf16 v[148:151], a[196:199], a[116:119], v[148:151]
  v_and_b32 v234, 0xffff0000, v210
  v_lshlrev_b32 v235, 16, v220
  v_mfma_f32_16x16x32_bf16 v[148:151], a[192:195], a[100:103], v[148:151]
  ds_read_b64_tr_b16 a[220:221], v251 offset:40960
  v_mfma_f32_16x16x32_bf16 v[152:155], a[192:195], a[104:107], v[152:155]
  v_and_b32 v236, 0xffff0000, v220
  v_mfma_f32_16x16x32_bf16 v[152:155], a[196:199], a[120:123], v[152:155]
  ds_read_b64_tr_b16 a[222:223], v251 offset:41984
  s_add_u32 s34, s32, 3145728
  v_mul_f32 v233, v233, v235
  v_mfma_f32_16x16x32_bf16 v[156:159], a[196:199], a[124:127], v[156:159]
  v_mul_f32 v234, v234, v236
  v_mfma_f32_16x16x32_bf16 v[156:159], a[192:195], a[108:111], v[156:159]
  ds_read_b64_tr_b16 a[192:193], v244 offset:49152
  s_waitcnt lgkmcnt(9)
  v_mfma_f32_16x16x32_bf16 v[172:175], a[200:203], a[108:111], v[172:175]
  v_cvt_pk_bf16_f32 v237, v233, v234
  v_mfma_f32_16x16x32_bf16 v[172:175], a[204:207], a[124:127], v[172:175]
  ds_read_b64_tr_b16 a[194:195], v244 offset:50176
  buffer_load_dwordx4 v4, s[8:11], s34 offen offset:0 lds
  v_mfma_f32_16x16x32_bf16 v[168:171], a[204:207], a[120:123], v[168:171]
  v_lshlrev_b32 v233, 16, v237
  v_and_b32 v234, 0xffff0000, v237
  v_mfma_f32_16x16x32_bf16 v[168:171], a[200:203], a[104:107], v[168:171]
  ds_read_b64_tr_b16 a[196:197], v244 offset:57344
  v_mfma_f32_16x16x32_bf16 v[164:167], a[200:203], a[100:103], v[164:167]
  v_add_f32 v232, v232, v233
  v_mfma_f32_16x16x32_bf16 v[164:167], a[204:207], a[116:119], v[164:167]
  ds_read_b64_tr_b16 a[198:199], v244 offset:58368
  buffer_load_dwordx4 v5, s[8:11], s34 offen offset:1024 lds
  v_mfma_f32_16x16x32_bf16 v[160:163], a[204:207], a[112:115], v[160:163]
  v_add_f32 v232, v232, v234
  v_lshlrev_b32 v233, 16, v211
  v_mfma_f32_16x16x32_bf16 v[160:163], a[200:203], a[96:99], v[160:163]
  ds_read_b64_tr_b16 a[200:201], v245 offset:49152
  s_waitcnt lgkmcnt(9)
  v_and_b32 v234, 0xffff0000, v211
  v_mfma_f32_16x16x32_bf16 v[176:179], a[208:211], a[96:99], v[176:179]
  v_mfma_f32_16x16x32_bf16 v[176:179], a[212:215], a[112:115], v[176:179]
  ds_read_b64_tr_b16 a[202:203], v245 offset:50176
  buffer_load_dwordx4 v6, s[8:11], s34 offen offset:2048 lds
  v_mfma_f32_16x16x32_bf16 v[180:183], a[212:215], a[116:119], v[180:183]
  v_lshlrev_b32 v235, 16, v221
  v_and_b32 v236, 0xffff0000, v221
  v_mfma_f32_16x16x32_bf16 v[180:183], a[208:211], a[100:103], v[180:183]
  buffer_store_dwordx4 v[48:51], v1, s[20:23], s29 offen offset:0 sc1
  ds_read_b64_tr_b16 a[204:205], v245 offset:57344
  v_mul_f32 v233, v233, v235
  v_mfma_f32_16x16x32_bf16 v[184:187], a[208:211], a[104:107], v[184:187]
  v_mfma_f32_16x16x32_bf16 v[184:187], a[212:215], a[120:123], v[184:187]
  ds_read_b64_tr_b16 a[206:207], v245 offset:58368
  buffer_load_dwordx4 v7, s[8:11], s34 offen offset:3072 lds
  v_mfma_f32_16x16x32_bf16 v[188:191], a[212:215], a[124:127], v[188:191]
  v_mul_f32 v234, v234, v236
  v_cvt_pk_bf16_f32 v237, v233, v234
  v_mfma_f32_16x16x32_bf16 v[188:191], a[208:211], a[108:111], v[188:191]
  ds_read_b64_tr_b16 a[208:209], v246 offset:49152
  s_waitcnt lgkmcnt(9)
  v_lshlrev_b32 v233, 16, v237
  v_mfma_f32_16x16x32_bf16 v[204:207], a[216:219], a[108:111], v[204:207]
  s_waitcnt vmcnt(21)
  ds_read_b128 a[32:35], v242 offset:0
  v_mfma_f32_16x16x32_bf16 v[204:207], a[220:223], a[124:127], v[204:207]
  ds_read_b64_tr_b16 a[210:211], v246 offset:50176
  v_and_b32 v234, 0xffff0000, v237
  v_mfma_f32_16x16x32_bf16 v[200:203], a[220:223], a[120:123], v[200:203]
  v_add_f32 v232, v232, v233
  v_mfma_f32_16x16x32_bf16 v[200:203], a[216:219], a[104:107], v[200:203]
  ds_read_b64_tr_b16 a[212:213], v246 offset:57344
  ds_read_b128 a[36:39], v242 offset:2048
  v_mfma_f32_16x16x32_bf16 v[196:199], a[216:219], a[100:103], v[196:199]
  v_add_f32 v232, v232, v234
  v_mfma_f32_16x16x32_bf16 v[196:199], a[220:223], a[116:119], v[196:199]
  ds_read_b64_tr_b16 a[214:215], v246 offset:58368
  v_lshlrev_b32 v233, 16, v212
  v_mfma_f32_16x16x32_bf16 v[192:195], a[220:223], a[112:115], v[192:195]
  ds_read_b128 a[40:43], v242 offset:4096
  s_add_u32 m0, s33, 32768
  v_and_b32 v234, 0xffff0000, v212
  v_mfma_f32_16x16x32_bf16 v[192:195], a[216:219], a[96:99], v[192:195]
  ds_read_b64_tr_b16 a[216:217], v247 offset:49152
  s_waitcnt lgkmcnt(12)
  v_lshlrev_b32 v235, 16, v222
  v_mfma_f32_16x16x32_bf16 v[80:83], a[192:195], a[160:163], v[80:83]
K_hA2_5:
  s_cbranch_execz K_hA2_6
  v_mfma_f32_16x16x32_bf16 v[80:83], a[196:199], a[176:179], v[80:83]
  ds_read_b64_tr_b16 a[218:219], v247 offset:50176
  ds_read_b128 a[44:47], v242 offset:6144
  v_mfma_f32_16x16x32_bf16 v[84:87], a[196:199], a[180:183], v[84:87]
  s_add_u32 s35, s48, 1024
  v_and_b32 v236, 0xffff0000, v222
  v_mul_f32 v233, v233, v235
  v_mfma_f32_16x16x32_bf16 v[84:87], a[192:195], a[164:167], v[84:87]
  ds_read_b64_tr_b16 a[220:221], v247 offset:57344
  v_mul_f32 v234, v234, v236
  v_mfma_f32_16x16x32_bf16 v[88:91], a[192:195], a[168:171], v[88:91]
  ds_read_b128 a[48:51], v243 offset:0
  v_accvgpr_write_b32 a64, 0
  v_mfma_f32_16x16x32_bf16 v[88:91], a[196:199], a[184:187], v[88:91]
  ds_read_b64_tr_b16 a[222:223], v247 offset:58368
  v_cvt_pk_bf16_f32 v237, v233, v234
  v_mfma_f32_16x16x32_bf16 v[92:95], a[196:199], a[188:191], v[92:95]
  buffer_store_dwordx4 v[52:55], v1, s[20:23], s29 offen offset:1024 sc1
  buffer_load_dwordx4 v12, s[12:15], s35 offen offset:0 lds
  v_lshlrev_b32 v233, 16, v237
  v_accvgpr_write_b32 a65, 0
  v_accvgpr_write_b32 a66, 0
  v_mfma_f32_16x16x32_bf16 v[92:95], a[192:195], a[172:175], v[92:95]
  ds_read_b64_tr_b16 a[192:193], v248 offset:49152
  ds_read_b128 a[52:55], v243 offset:2048
  s_waitcnt lgkmcnt(15)
  v_mfma_f32_16x16x32_bf16 v[108:111], a[200:203], a[172:175], v[108:111]
  v_and_b32 v234, 0xffff0000, v237
  v_add_f32 v232, v232, v233
  v_mfma_f32_16x16x32_bf16 v[108:111], a[204:207], a[188:191], v[108:111]
  ds_read_b64_tr_b16 a[194:195], v248 offset:50176
  v_accvgpr_write_b32 a67, 0
  v_accvgpr_write_b32 a68, 0
  v_mfma_f32_16x16x32_bf16 v[104:107], a[204:207], a[184:187], v[104:107]
  buffer_load_dwordx4 v13, s[12:15], s35 offen offset:1024 lds
  ds_read_b128 a[56:59], v243 offset:4096
  v_mfma_f32_16x16x32_bf16 v[104:107], a[200:203], a[168:171], v[104:107]
  ds_read_b64_tr_b16 a[196:197], v248 offset:57344
  v_add_f32 v232, v232, v234
  v_accvgpr_write_b32 a69, 0
  v_mfma_f32_16x16x32_bf16 v[100:103], a[200:203], a[164:167], v[100:103]
  v_lshlrev_b32 v233, 16, v213
  v_and_b32 v234, 0xffff0000, v213
  v_mfma_f32_16x16x32_bf16 v[100:103], a[204:207], a[180:183], v[100:103]
  ds_read_b64_tr_b16 a[198:199], v248 offset:58368
  ds_read_b128 a[60:63], v243 offset:6144
  v_mfma_f32_16x16x32_bf16 v[96:99], a[204:207], a[176:179], v[96:99]
  buffer_load_dwordx4 v14, s[12:15], s35 offen offset:2048 lds
  v_lshlrev_b32 v235, 16, v223
  v_mfma_f32_16x16x32_bf16 v[96:99], a[200:203], a[160:163], v[96:99]
  ds_read_b64_tr_b16 a[200:201], v249 offset:49152
  s_waitcnt lgkmcnt(15)
  v_and_b32 v236, 0xffff0000, v223
  v_mfma_f32_16x16x32_bf16 v[112:115], a[208:211], a[160:163], v[112:115]
  v_mul_f32 v233, v233, v235
  v_accvgpr_write_b32 a70, 0
  v_mfma_f32_16x16x32_bf16 v[112:115], a[212:215], a[176:179], v[112:115]
  ds_read_b64_tr_b16 a[202:203], v249 offset:50176
  v_accvgpr_write_b32 a71, 0
  v_mfma_f32_16x16x32_bf16 v[116:119], a[212:215], a[180:183], v[116:119]
  buffer_load_dwordx4 v15, s[12:15], s35 offen offset:3072 lds
  v_mul_f32 v234, v234, v236
  v_mfma_f32_16x16x32_bf16 v[116:119], a[208:211], a[164:167], v[116:119]
  ds_read_b64_tr_b16 a[204:205], v249 offset:57344
  v_cvt_pk_bf16_f32 v237, v233, v234
  v_mfma_f32_16x16x32_bf16 v[120:123], a[208:211], a[168:171], v[120:123]
  v_lshlrev_b32 v233, 16, v237
  v_accvgpr_write_b32 a72, 0
  v_mfma_f32_16x16x32_bf16 v[120:123], a[212:215], a[184:187], v[120:123]
  ds_read_b64_tr_b16 a[206:207], v249 offset:58368
  v_accvgpr_write_b32 a73, 0
  v_mfma_f32_16x16x32_bf16 v[124:127], a[212:215], a[188:191], v[124:127]
  v_and_b32 v234, 0xffff0000, v237
  v_accvgpr_write_b32 a74, 0
  v_mfma_f32_16x16x32_bf16 v[124:127], a[208:211], a[172:175], v[124:127]
  ds_read_b64_tr_b16 a[208:209], v250 offset:49152
  s_waitcnt lgkmcnt(12)
  v_add_f32 v232, v232, v233
  v_mfma_f32_16x16x32_bf16 v[140:143], a[216:219], a[172:175], v[140:143]
  v_add_f32 v232, v232, v234
  v_accvgpr_write_b32 a75, 0
  v_mfma_f32_16x16x32_bf16 v[140:143], a[220:223], a[188:191], v[140:143]
  buffer_store_dwordx4 v[56:59], v1, s[20:23], s29 offen offset:2048 sc1
  ds_read_b64_tr_b16 a[210:211], v250 offset:50176
  v_accvgpr_write_b32 a76, 0
  v_mfma_f32_16x16x32_bf16 v[136:139], a[220:223], a[184:187], v[136:139]
  v_lshlrev_b32 v233, 16, v214
  v_mfma_f32_16x16x32_bf16 v[136:139], a[216:219], a[168:171], v[136:139]
  ds_read_b64_tr_b16 a[212:213], v250 offset:57344
  v_and_b32 v234, 0xffff0000, v214
  v_mfma_f32_16x16x32_bf16 v[132:135], a[216:219], a[164:167], v[132:135]
  v_lshlrev_b32 v235, 16, v224
  v_accvgpr_write_b32 a77, 0
  v_mfma_f32_16x16x32_bf16 v[132:135], a[220:223], a[180:183], v[132:135]
  ds_read_b64_tr_b16 a[214:215], v250 offset:58368
  v_and_b32 v236, 0xffff0000, v224
  v_mfma_f32_16x16x32_bf16 v[128:131], a[220:223], a[176:179], v[128:131]
  v_accvgpr_write_b32 a78, 0
  v_accvgpr_write_b32 a79, 0
  v_mfma_f32_16x16x32_bf16 v[128:131], a[216:219], a[160:163], v[128:131]
  ds_read_b64_tr_b16 a[216:217], v251 offset:49152
  s_waitcnt lgkmcnt(10)
  v_mul_f32 v233, v233, v235
  v_mfma_f32_16x16x32_bf16 v[144:147], a[192:195], a[160:163], v[144:147]
  s_waitcnt vmcnt(17)
  s_barrier
  v_mfma_f32_16x16x32_bf16 v[144:147], a[196:199], a[176:179], v[144:147]
  ds_read_b64_tr_b16 a[218:219], v251 offset:50176
  s_waitcnt lgkmcnt(10)
  v_mul_f32 v234, v234, v236
  v_accvgpr_write_b32 a80, 0
  v_mfma_f32_16x16x32_bf16 v[148:151], a[196:199], a[180:183], v[148:151]
  s_and_b32 s27, s2, 7
  s_lshl_b32 s27, s27, 9
  s_add_u32 s27, s27, 66191360
  buffer_load_dword v3, v253, s[20:23], s27 offen sc1
  v_mfma_f32_16x16x32_bf16 v[148:151], a[192:195], a[164:167], v[148:151]
  ds_read_b64_tr_b16 a[220:221], v251 offset:57344
  s_add_u32 m0, s37, 32768
  v_cvt_pk_bf16_f32 v237, v233, v234
  v_mfma_f32_16x16x32_bf16 v[152:155], a[192:195], a[168:171], v[152:155]
  v_lshlrev_b32 v233, 16, v237
  v_and_b32 v234, 0xffff0000, v237
  v_mfma_f32_16x16x32_bf16 v[152:155], a[196:199], a[184:187], v[152:155]
  ds_read_b64_tr_b16 a[222:223], v251 offset:58368
  v_add_f32 v232, v232, v233
  v_mfma_f32_16x16x32_bf16 v[156:159], a[196:199], a[188:191], v[156:159]
  s_add_u32 s34, s32, 3670016
  v_accvgpr_write_b32 a81, 0
  v_accvgpr_write_b32 a82, 0
  v_mfma_f32_16x16x32_bf16 v[156:159], a[192:195], a[172:175], v[156:159]
  ds_read_b64_tr_b16 a[192:193], v244 offset:0
  s_waitcnt lgkmcnt(9)
  v_add_f32 v232, v232, v234
  v_mfma_f32_16x16x32_bf16 v[172:175], a[200:203], a[172:175], v[172:175]
  v_lshlrev_b32 v233, 16, v215
  v_accvgpr_write_b32 a83, 0
  v_mfma_f32_16x16x32_bf16 v[172:175], a[204:207], a[188:191], v[172:175]
  ds_read_b64_tr_b16 a[194:195], v244 offset:1024
  buffer_load_dwordx4 v4, s[8:11], s34 offen offset:0 lds
  v_mfma_f32_16x16x32_bf16 v[168:171], a[204:207], a[184:187], v[168:171]
  v_and_b32 v234, 0xffff0000, v215
K_hA3_5:
  s_cbranch_execz K_hA3_6
  v_accvgpr_write_b32 a84, 0
  v_mfma_f32_16x16x32_bf16 v[168:171], a[200:203], a[168:171], v[168:171]
  ds_read_b64_tr_b16 a[196:197], v244 offset:8192
  v_lshlrev_b32 v235, 16, v225
  v_mfma_f32_16x16x32_bf16 v[164:167], a[200:203], a[164:167], v[164:167]
  buffer_store_dwordx4 v[60:63], v1, s[20:23], s29 offen offset:3072 sc1
  buffer_load_dwordx4 v5, s[8:11], s34 offen offset:1024 lds
  v_and_b32 v236, 0xffff0000, v225
  v_accvgpr_write_b32 a85, 0
  v_mfma_f32_16x16x32_bf16 v[164:167], a[204:207], a[180:183], v[164:167]
  ds_read_b64_tr_b16 a[198:199], v244 offset:9216
  v_mul_f32 v233, v233, v235
  v_mfma_f32_16x16x32_bf16 v[160:163], a[204:207], a[176:179], v[160:163]
  v_accvgpr_write_b32 a86, 0
  v_accvgpr_write_b32 a87, 0
  v_mfma_f32_16x16x32_bf16 v[160:163], a[200:203], a[160:163], v[160:163]
  ds_read_b64_tr_b16 a[200:201], v245 offset:0
  buffer_load_dwordx4 v6, s[8:11], s34 offen offset:2048 lds
  s_waitcnt lgkmcnt(9)
  v_mfma_f32_16x16x32_bf16 v[176:179], a[208:211], a[160:163], v[176:179]
  v_mul_f32 v234, v234, v236
  v_cvt_pk_bf16_f32 v237, v233, v234
  v_mfma_f32_16x16x32_bf16 v[176:179], a[212:215], a[176:179], v[176:179]
  ds_read_b64_tr_b16 a[202:203], v245 offset:1024
  v_lshlrev_b32 v233, 16, v237
  v_mfma_f32_16x16x32_bf16 v[180:183], a[212:215], a[180:183], v[180:183]
  buffer_load_dwordx4 v7, s[8:11], s34 offen offset:3072 lds
  v_accvgpr_write_b32 a88, 0
  v_mfma_f32_16x16x32_bf16 v[180:183], a[208:211], a[164:167], v[180:183]
  ds_read_b64_tr_b16 a[204:205], v245 offset:8192
  v_and_b32 v234, 0xffff0000, v237
  v_mfma_f32_16x16x32_bf16 v[184:187], a[208:211], a[168:171], v[184:187]
  v_add_f32 v232, v232, v233
  v_accvgpr_write_b32 a89, 0
  v_mfma_f32_16x16x32_bf16 v[184:187], a[212:215], a[184:187], v[184:187]
  ds_read_b64_tr_b16 a[206:207], v245 offset:9216
  s_add_u32 m0, s33, 36864
  v_add_f32 v232, v232, v234
  v_mfma_f32_16x16x32_bf16 v[188:191], a[212:215], a[188:191], v[188:191]
  v_lshlrev_b32 v233, 16, v216
  v_accvgpr_write_b32 a90, 0
  v_mfma_f32_16x16x32_bf16 v[188:191], a[208:211], a[172:175], v[188:191]
  ds_read_b64_tr_b16 a[208:209], v246 offset:0
  s_waitcnt lgkmcnt(9)
  v_accvgpr_write_b32 a91, 0
  v_mfma_f32_16x16x32_bf16 v[204:207], a[216:219], a[172:175], v[204:207]
  v_and_b32 v234, 0xffff0000, v216
  v_mfma_f32_16x16x32_bf16 v[204:207], a[220:223], a[188:191], v[204:207]
  ds_read_b64_tr_b16 a[210:211], v246 offset:1024
  s_add_u32 s35, s49, 1024
  v_lshlrev_b32 v235, 16, v226
  v_mfma_f32_16x16x32_bf16 v[200:203], a[220:223], a[184:187], v[200:203]
  v_and_b32 v236, 0xffff0000, v226
  v_accvgpr_write_b32 a92, 0
  v_mfma_f32_16x16x32_bf16 v[200:203], a[216:219], a[168:171], v[200:203]
  ds_read_b64_tr_b16 a[212:213], v246 offset:8192
  v_accvgpr_write_b32 a93, 0
  v_mfma_f32_16x16x32_bf16 v[196:199], a[216:219], a[164:167], v[196:199]
  v_mul_f32 v233, v233, v235
  v_accvgpr_write_b32 a94, 0
  v_mfma_f32_16x16x32_bf16 v[196:199], a[220:223], a[180:183], v[196:199]
  ds_read_b64_tr_b16 a[214:215], v246 offset:9216
  buffer_load_dwordx4 v12, s[12:15], s35 offen offset:0 lds
  v_mfma_f32_16x16x32_bf16 v[192:195], a[220:223], a[176:179], v[192:195]
  v_mul_f32 v234, v234, v236
  v_cvt_pk_bf16_f32 v237, v233, v234
  v_mfma_f32_16x16x32_bf16 v[192:195], a[216:219], a[160:163], v[192:195]
  ds_read_b64_tr_b16 a[216:217], v247 offset:0
  s_waitcnt lgkmcnt(9)
  v_accvgpr_write_b32 a95, 0
  v_mfma_f32_16x16x32_bf16 v[80:83], a[192:195], a[0:3], v[80:83]
  s_add_u32 s29, s51, 12288
  v_lshlrev_b32 v233, 16, v237
  v_accvgpr_write_b32 a96, 0
  v_mfma_f32_16x16x32_bf16 v[80:83], a[196:199], a[16:19], v[80:83]
  ds_read_b64_tr_b16 a[218:219], v247 offset:1024
  buffer_load_dwordx4 v13, s[12:15], s35 offen offset:1024 lds
  v_mfma_f32_16x16x32_bf16 v[84:87], a[196:199], a[20:23], v[84:87]
  v_and_b32 v234, 0xffff0000, v237
  v_add_f32 v232, v232, v233
  v_mfma_f32_16x16x32_bf16 v[84:87], a[192:195], a[4:7], v[84:87]
  ds_read_b64_tr_b16 a[220:221], v247 offset:8192
  v_accvgpr_write_b32 a97, 0
  v_mfma_f32_16x16x32_bf16 v[88:91], a[192:195], a[8:11], v[88:91]
  v_add_f32 v232, v232, v234
  v_accvgpr_write_b32 a98, 0
  v_mfma_f32_16x16x32_bf16 v[88:91], a[196:199], a[24:27], v[88:91]
  ds_read_b64_tr_b16 a[222:223], v247 offset:9216
  buffer_load_dwordx4 v14, s[12:15], s35 offen offset:2048 lds
  v_mfma_f32_16x16x32_bf16 v[92:95], a[196:199], a[28:31], v[92:95]
  v_add_f32_dpp v232, v232, v232 quad_perm:[1,0,3,2] row_mask:0xf bank_mask:0xf
  s_nop 1
  v_add_f32_dpp v232, v232, v232 quad_perm:[2,3,0,1] row_mask:0xf bank_mask:0xf
  v_mfma_f32_16x16x32_bf16 v[92:95], a[192:195], a[12:15], v[92:95]
  ds_read_b64_tr_b16 a[192:193], v248 offset:0
  s_waitcnt lgkmcnt(9)
  v_accvgpr_write_b32 a99, 0
  v_mfma_f32_16x16x32_bf16 v[108:111], a[200:203], a[12:15], v[108:111]
  v_add_f32_dpp v232, v232, v232 row_half_mirror row_mask:0xf bank_mask:0xf
  v_accvgpr_write_b32 a100, 0
  v_mfma_f32_16x16x32_bf16 v[108:111], a[204:207], a[28:31], v[108:111]
  ds_read_b64_tr_b16 a[194:195], v248 offset:1024
  buffer_load_dwordx4 v15, s[12:15], s35 offen offset:3072 lds
  v_mfma_f32_16x16x32_bf16 v[104:107], a[204:207], a[24:27], v[104:107]
  v_add_f32_dpp v232, v232, v232 row_mirror row_mask:0xf bank_mask:0xf
  v_mov_b32 v233, v232
  v_mfma_f32_16x16x32_bf16 v[104:107], a[200:203], a[8:11], v[104:107]
  ds_read_b64_tr_b16 a[196:197], v248 offset:8192
  v_permlane16_swap_b32 v232, v233
  v_mfma_f32_16x16x32_bf16 v[100:103], a[200:203], a[4:7], v[100:103]
  v_accvgpr_write_b32 a101, 0
  v_mfma_f32_16x16x32_bf16 v[100:103], a[204:207], a[20:23], v[100:103]
  ds_read_b64_tr_b16 a[198:199], v248 offset:9216
  v_add_f32 v232, v232, v233
  v_mfma_f32_16x16x32_bf16 v[96:99], a[204:207], a[16:19], v[96:99]
  v_cvt_pk_bf16_f32 v237, v232, v232
  v_accvgpr_write_b32 a102, 0
  v_mfma_f32_16x16x32_bf16 v[96:99], a[200:203], a[0:3], v[96:99]
  ds_read_b64_tr_b16 a[200:201], v249 offset:0
  s_waitcnt lgkmcnt(9)
  v_lshlrev_b32 v232, 16, v237
  v_mfma_f32_16x16x32_bf16 v[112:115], a[208:211], a[0:3], v[112:115]
  v_accvgpr_write_b32 a103, 0
  v_accvgpr_write_b32 a104, 0
  v_mfma_f32_16x16x32_bf16 v[112:115], a[212:215], a[16:19], v[112:115]
  ds_read_b64_tr_b16 a[202:203], v249 offset:1024
  v_mul_f32 v232, 0xbfb8aa3b, v232
  v_mfma_f32_16x16x32_bf16 v[116:119], a[212:215], a[20:23], v[116:119]
  v_exp_f32 v232, v232
  v_mfma_f32_16x16x32_bf16 v[116:119], a[208:211], a[4:7], v[116:119]
  buffer_store_dwordx4 v[64:67], v1, s[20:23], s29 offen offset:0 sc1
  ds_read_b64_tr_b16 a[204:205], v249 offset:8192
  v_add_f32 v232, 1.0, v232
  v_accvgpr_write_b32 a105, 0
  v_mfma_f32_16x16x32_bf16 v[120:123], a[208:211], a[8:11], v[120:123]
  v_mfma_f32_16x16x32_bf16 v[120:123], a[212:215], a[24:27], v[120:123]
  ds_read_b64_tr_b16 a[206:207], v249 offset:9216
  v_accvgpr_write_b32 a106, 0
  v_mfma_f32_16x16x32_bf16 v[124:127], a[212:215], a[28:31], v[124:127]
  v_rcp_f32 v232, v232
  v_mfma_f32_16x16x32_bf16 v[124:127], a[208:211], a[12:15], v[124:127]
K_hA0_6:
  s_cbranch_execz K_hA0_7
  ds_read_b64_tr_b16 a[208:209], v250 offset:0
  s_waitcnt lgkmcnt(9)
  v_cvt_pk_bf16_f32 v237, v232, v232
  v_mfma_f32_16x16x32_bf16 v[140:143], a[216:219], a[12:15], v[140:143]
  v_lshlrev_b32 v232, 16, v237
  v_accvgpr_write_b32 a107, 0
  v_mfma_f32_16x16x32_bf16 v[140:143], a[220:223], a[28:31], v[140:143]
  ds_read_b64_tr_b16 a[210:211], v250 offset:1024
  s_lshl_b32 s44, s45, 3
  v_accvgpr_write_b32 a108, 0
  v_mfma_f32_16x16x32_bf16 v[136:139], a[220:223], a[24:27], v[136:139]
  s_add_u32 s44, s44, 66060288
  v_accvgpr_write_b32 a109, 0
  v_accvgpr_write_b32 a110, 0
  v_mfma_f32_16x16x32_bf16 v[136:139], a[216:219], a[8:11], v[136:139]
  ds_read_b64_tr_b16 a[212:213], v250 offset:8192
  v_lshrrev_b32 v233, 3, v0
  v_mfma_f32_16x16x32_bf16 v[132:135], a[216:219], a[4:7], v[132:135]
  s_waitcnt vmcnt(22)
  ds_read_b128 a[224:227], v240 offset:0
  v_mfma_f32_16x16x32_bf16 v[132:135], a[220:223], a[20:23], v[132:135]
  ds_read_b64_tr_b16 a[214:215], v250 offset:9216
  v_add_u32 v233, s44, v233
  v_mfma_f32_16x16x32_bf16 v[128:131], a[220:223], a[16:19], v[128:131]
  v_cmp_eq_u32 vcc, 0, v228
  v_mov_b32 v234, 0x7f000000
  s_nop 0
  v_cndmask_b32 v233, v234, v233, vcc
  v_mfma_f32_16x16x32_bf16 v[128:131], a[216:219], a[0:3], v[128:131]
  ds_read_b64_tr_b16 a[216:217], v251 offset:0
  ds_read_b128 a[228:231], v240 offset:2048
  buffer_store_dword v232, v233, s[20:23], 0 offen sc1
  s_waitcnt lgkmcnt(11)
  v_accvgpr_write_b32 a111, 0
  v_mfma_f32_16x16x32_bf16 v[144:147], a[192:195], a[0:3], v[144:147]
  s_waitcnt vmcnt(18)
  s_barrier
  v_mfma_f32_16x16x32_bf16 v[144:147], a[196:199], a[16:19], v[144:147]
  ds_read_b64_tr_b16 a[218:219], v251 offset:1024
  s_add_u32 m0, s37, 49152
  v_subrev_u32 v224, 0, v254
  v_mfma_f32_16x16x32_bf16 v[148:151], a[196:199], a[20:23], v[148:151]
  ds_read_b128 a[232:235], v240 offset:4096
  v_ashrrev_i32 v224, 31, v224
  v_mfma_f32_16x16x32_bf16 v[148:151], a[192:195], a[4:7], v[148:151]
  ds_read_b64_tr_b16 a[220:221], v251 offset:8192
  v_and_b32 v224, 0xff800000, v224
  v_mfma_f32_16x16x32_bf16 v[152:155], a[192:195], a[8:11], v[152:155]
  v_subrev_u32 v225, 1, v254
  v_accvgpr_write_b32 a112, 0
  v_mfma_f32_16x16x32_bf16 v[152:155], a[196:199], a[24:27], v[152:155]
  ds_read_b64_tr_b16 a[222:223], v251 offset:9216
  ds_read_b128 a[236:239], v240 offset:6144
  s_add_u32 s34, s32, 4194304
  v_mfma_f32_16x16x32_bf16 v[156:159], a[196:199], a[28:31], v[156:159]
  buffer_store_dwordx4 v[68:71], v1, s[20:23], s29 offen offset:1024 sc1
  v_ashrrev_i32 v225, 31, v225
  v_and_b32 v225, 0xff800000, v225
  v_accvgpr_write_b32 a113, 0
  v_accvgpr_write_b32 a114, 0
  v_mfma_f32_16x16x32_bf16 v[156:159], a[192:195], a[12:15], v[156:159]
  ds_read_b64_tr_b16 a[192:193], v244 offset:16384
  s_waitcnt lgkmcnt(13)
  v_subrev_u32 v226, 2, v254
  v_accvgpr_write_b32 a115, 0
  v_mfma_f32_16x16x32_bf16 v[172:175], a[200:203], a[12:15], v[172:175]
  ds_read_b128 a[240:243], v241 offset:0
  v_ashrrev_i32 v226, 31, v226
  v_mfma_f32_16x16x32_bf16 v[172:175], a[204:207], a[28:31], v[172:175]
  ds_read_b64_tr_b16 a[194:195], v244 offset:17408
  buffer_load_dwordx4 v4, s[8:11], s34 offen offset:0 lds
  v_accvgpr_write_b32 a116, 0
  v_mfma_f32_16x16x32_bf16 v[168:171], a[204:207], a[24:27], v[168:171]
  v_and_b32 v226, 0xff800000, v226
  v_subrev_u32 v227, 3, v254
  v_mfma_f32_16x16x32_bf16 v[168:171], a[200:203], a[8:11], v[168:171]
  ds_read_b64_tr_b16 a[196:197], v244 offset:24576
  ds_read_b128 a[244:247], v241 offset:2048
  v_accvgpr_write_b32 a117, 0
  v_mfma_f32_16x16x32_bf16 v[164:167], a[200:203], a[4:7], v[164:167]
  v_ashrrev_i32 v227, 31, v227
  v_and_b32 v227, 0xff800000, v227
  v_mfma_f32_16x16x32_bf16 v[164:167], a[204:207], a[20:23], v[164:167]
  ds_read_b64_tr_b16 a[198:199], v244 offset:25600
  buffer_load_dwordx4 v5, s[8:11], s34 offen offset:1024 lds
  v_accvgpr_write_b32 a118, 0
  v_mfma_f32_16x16x32_bf16 v[160:163], a[204:207], a[16:19], v[160:163]
  ds_read_b128 a[248:251], v241 offset:4096
  v_subrev_u32 v228, 16, v254
  v_mfma_f32_16x16x32_bf16 v[160:163], a[200:203], a[0:3], v[160:163]
  ds_read_b64_tr_b16 a[200:201], v245 offset:16384
  s_waitcnt lgkmcnt(15)
  v_ashrrev_i32 v228, 31, v228
  v_accvgpr_write_b32 a119, 0
  v_mfma_f32_16x16x32_bf16 v[176:179], a[208:211], a[0:3], v[176:179]
  v_and_b32 v228, 0xff800000, v228
  v_subrev_u32 v229, 17, v254
  v_mfma_f32_16x16x32_bf16 v[176:179], a[212:215], a[16:19], v[176:179]
  ds_read_b64_tr_b16 a[202:203], v245 offset:17408
  buffer_load_dwordx4 v6, s[8:11], s34 offen offset:2048 lds
  v_accvgpr_write_b32 a120, 0
  v_mfma_f32_16x16x32_bf16 v[180:183], a[212:215], a[20:23], v[180:183]
  ds_read_b128 a[252:255], v241 offset:6144
  v_ashrrev_i32 v229, 31, v229
  v_mfma_f32_16x16x32_bf16 v[180:183], a[208:211], a[4:7], v[180:183]
  ds_read_b64_tr_b16 a[204:205], v245 offset:24576
  v_and_b32 v229, 0xff800000, v229
  v_accvgpr_write_b32 a121, 0
  v_mfma_f32_16x16x32_bf16 v[184:187], a[208:211], a[8:11], v[184:187]
  v_subrev_u32 v230, 18, v254
  v_ashrrev_i32 v230, 31, v230
  v_mfma_f32_16x16x32_bf16 v[184:187], a[212:215], a[24:27], v[184:187]
  ds_read_b64_tr_b16 a[206:207], v245 offset:25600
  buffer_load_dwordx4 v7, s[8:11], s34 offen offset:3072 lds
  v_mfma_f32_16x16x32_bf16 v[188:191], a[212:215], a[28:31], v[188:191]
  v_and_b32 v230, 0xff800000, v230
  v_subrev_u32 v231, 19, v254
  v_mfma_f32_16x16x32_bf16 v[188:191], a[208:211], a[12:15], v[188:191]
  ds_read_b64_tr_b16 a[208:209], v246 offset:16384
  s_waitcnt lgkmcnt(14)
  v_ashrrev_i32 v231, 31, v231
  v_mfma_f32_16x16x32_bf16 v[204:207], a[216:219], a[12:15], v[204:207]
  v_and_b32 v231, 0xff800000, v231
  v_accvgpr_write_b32 a122, 0
  v_mfma_f32_16x16x32_bf16 v[204:207], a[220:223], a[28:31], v[204:207]
  buffer_store_dwordx4 v[72:75], v1, s[20:23], s29 offen offset:2048 sc1
  ds_read_b64_tr_b16 a[210:211], v246 offset:17408
  v_subrev_u32 v232, 32, v254
  v_accvgpr_write_b32 a123, 0
  v_accvgpr_write_b32 a124, 0
  v_mfma_f32_16x16x32_bf16 v[200:203], a[220:223], a[24:27], v[200:203]
  s_getpc_b64 s[92:93]
K_pca:
  s_add_u32 s92, s92, K_go-K_pca
  s_addc_u32 s93, s93, 0
  v_mfma_f32_16x16x32_bf16 v[200:203], a[216:219], a[8:11], v[200:203]
  ds_read_b64_tr_b16 a[212:213], v246 offset:24576
  v_ashrrev_i32 v232, 31, v232
  v_mfma_f32_16x16x32_bf16 v[196:199], a[216:219], a[4:7], v[196:199]
  v_and_b32 v232, 0xff800000, v232
  v_subrev_u32 v233, 33, v254
  v_mfma_f32_16x16x32_bf16 v[196:199], a[220:223], a[20:23], v[196:199]
  ds_read_b64_tr_b16 a[214:215], v246 offset:25600
  s_lshr_b32 s65, s2, 1
  v_ashrrev_i32 v233, 31, v233
  v_mfma_f32_16x16x32_bf16 v[192:195], a[220:223], a[16:19], v[192:195]
  v_and_b32 v233, 0xff800000, v233
K_hA1_6:
  s_cbranch_execz K_hA1_7
  v_accvgpr_write_b32 a125, 0
  v_mfma_f32_16x16x32_bf16 v[192:195], a[216:219], a[0:3], v[192:195]
  ds_read_b64_tr_b16 a[216:217], v247 offset:16384
  s_waitcnt lgkmcnt(11)
  v_subrev_u32 v234, 34, v254
  v_mfma_f32_16x16x32_bf16 v[80:83], a[192:195], a[32:35], v[80:83]
  v_ashrrev_i32 v234, 31, v234
  v_accvgpr_write_b32 a126, 0
  v_accvgpr_write_b32 a127, 0
  v_mfma_f32_16x16x32_bf16 v[80:83], a[196:199], a[48:51], v[80:83]
  ds_read_b64_tr_b16 a[218:219], v247 offset:17408
  s_and_b32 s65, s65, 0x7c
  v_and_b32 v234, 0xff800000, v234
  v_mfma_f32_16x16x32_bf16 v[84:87], a[196:199], a[52:55], v[84:87]
  v_subrev_u32 v235, 35, v254
  v_accvgpr_write_b32 a0, 0
  v_mfma_f32_16x16x32_bf16 v[84:87], a[192:195], a[36:39], v[84:87]
  ds_read_b64_tr_b16 a[220:221], v247 offset:24576
  v_ashrrev_i32 v235, 31, v235
  v_mfma_f32_16x16x32_bf16 v[88:91], a[192:195], a[40:43], v[88:91]
  s_waitcnt lgkmcnt(9)
  v_and_b32 v235, 0xff800000, v235
  v_accvgpr_write_b32 a1, 0
  v_mfma_f32_16x16x32_bf16 v[88:91], a[196:199], a[56:59], v[88:91]
  ds_read_b64_tr_b16 a[222:223], v247 offset:25600
  s_add_u32 s65, s65, s24
  v_subrev_u32 v236, 48, v254
  v_mfma_f32_16x16x32_bf16 v[92:95], a[196:199], a[60:63], v[92:95]
  v_ashrrev_i32 v236, 31, v236
  v_accvgpr_write_b32 a2, 0
  v_mfma_f32_16x16x32_bf16 v[92:95], a[192:195], a[44:47], v[92:95]
  ds_read_b64_tr_b16 a[192:193], v248 offset:16384
  s_waitcnt lgkmcnt(9)
  v_and_b32 v236, 0xff800000, v236
  v_mfma_f32_16x16x32_bf16 v[108:111], a[200:203], a[44:47], v[108:111]
  v_subrev_u32 v237, 49, v254
  v_accvgpr_write_b32 a3, 0
  v_mfma_f32_16x16x32_bf16 v[108:111], a[204:207], a[60:63], v[108:111]
  ds_read_b64_tr_b16 a[194:195], v248 offset:17408
  s_mul_i32 s65, s65, 3
  v_ashrrev_i32 v237, 31, v237
  v_mfma_f32_16x16x32_bf16 v[104:107], a[204:207], a[56:59], v[104:107]
  v_and_b32 v237, 0xff800000, v237
  v_accvgpr_write_b32 a4, 0
  v_mfma_f32_16x16x32_bf16 v[104:107], a[200:203], a[40:43], v[104:107]
  ds_read_b64_tr_b16 a[196:197], v248 offset:24576
  v_subrev_u32 v238, 50, v254
  v_mfma_f32_16x16x32_bf16 v[100:103], a[200:203], a[36:39], v[100:103]
  buffer_store_dwordx4 v[76:79], v1, s[20:23], s29 offen offset:3072 sc1
  v_ashrrev_i32 v238, 31, v238
  v_accvgpr_write_b32 a5, 0
  v_accvgpr_write_b32 a6, 0
  v_mfma_f32_16x16x32_bf16 v[100:103], a[204:207], a[52:55], v[100:103]
  ds_read_b64_tr_b16 a[198:199], v248 offset:25600
  v_min_u32 v8, 2, v0
  v_mfma_f32_16x16x32_bf16 v[96:99], a[204:207], a[48:51], v[96:99]
  v_and_b32 v238, 0xff800000, v238
  v_subrev_u32 v239, 51, v254
  v_mfma_f32_16x16x32_bf16 v[96:99], a[200:203], a[32:35], v[96:99]
  ds_read_b64_tr_b16 a[200:201], v249 offset:16384
  s_waitcnt lgkmcnt(9)
  v_ashrrev_i32 v239, 31, v239
  v_mfma_f32_16x16x32_bf16 v[112:115], a[208:211], a[32:35], v[112:115]
  v_and_b32 v239, 0xff800000, v239
  v_accvgpr_write_b32 a7, 0
  v_mfma_f32_16x16x32_bf16 v[112:115], a[212:215], a[48:51], v[112:115]
  ds_read_b64_tr_b16 a[202:203], v249 offset:17408
  v_add_u32 v8, s65, v8
  v_mfma_f32_16x16x32_bf16 v[116:119], a[212:215], a[52:55], v[116:119]
  v_accvgpr_write_b32 a128, v224
  v_accvgpr_write_b32 a129, v225
  v_mfma_f32_16x16x32_bf16 v[116:119], a[208:211], a[36:39], v[116:119]
  ds_read_b64_tr_b16 a[204:205], v249 offset:24576
  v_accvgpr_write_b32 a130, v226
  v_mfma_f32_16x16x32_bf16 v[120:123], a[208:211], a[40:43], v[120:123]
  v_accvgpr_write_b32 a131, v227
  v_accvgpr_write_b32 a8, 0
  v_accvgpr_write_b32 a9, 0
  v_mfma_f32_16x16x32_bf16 v[120:123], a[212:215], a[56:59], v[120:123]
  ds_read_b64_tr_b16 a[206:207], v249 offset:25600
  v_min_u32 v8, (K_last-K_go)/128-1, v8
  v_mfma_f32_16x16x32_bf16 v[124:127], a[212:215], a[60:63], v[124:127]
  v_accvgpr_write_b32 a132, v228
  v_accvgpr_write_b32 a133, v229
  v_mfma_f32_16x16x32_bf16 v[124:127], a[208:211], a[44:47], v[124:127]
  ds_read_b64_tr_b16 a[208:209], v250 offset:16384
  s_waitcnt lgkmcnt(9)
  v_accvgpr_write_b32 a134, v230
  v_mfma_f32_16x16x32_bf16 v[140:143], a[216:219], a[44:47], v[140:143]
  v_accvgpr_write_b32 a135, v231
  v_accvgpr_write_b32 a10, 0
  v_accvgpr_write_b32 a11, 0
  v_mfma_f32_16x16x32_bf16 v[140:143], a[220:223], a[60:63], v[140:143]
  ds_read_b64_tr_b16 a[210:211], v250 offset:17408
  v_lshlrev_b32 v8, 7, v8
  v_mfma_f32_16x16x32_bf16 v[136:139], a[220:223], a[56:59], v[136:139]
  v_accvgpr_write_b32 a136, v232
  v_accvgpr_write_b32 a137, v233
  v_mfma_f32_16x16x32_bf16 v[136:139], a[216:219], a[40:43], v[136:139]
  ds_read_b64_tr_b16 a[212:213], v250 offset:24576
  v_accvgpr_write_b32 a138, v234
  v_mfma_f32_16x16x32_bf16 v[132:135], a[216:219], a[36:39], v[132:135]
  v_accvgpr_write_b32 a139, v235
  v_accvgpr_write_b32 a12, 0
  v_accvgpr_write_b32 a13, 0
  v_mfma_f32_16x16x32_bf16 v[132:135], a[220:223], a[52:55], v[132:135]
  ds_read_b64_tr_b16 a[214:215], v250 offset:25600
  global_load_dword v255, v8, s[92:93]
  v_mfma_f32_16x16x32_bf16 v[128:131], a[220:223], a[48:51], v[128:131]
  v_accvgpr_write_b32 a140, v236
  v_accvgpr_write_b32 a141, v237
  v_mfma_f32_16x16x32_bf16 v[128:131], a[216:219], a[32:35], v[128:131]
  ds_read_b64_tr_b16 a[216:217], v251 offset:16384
  s_waitcnt lgkmcnt(9)
  v_accvgpr_write_b32 a142, v238
  v_mfma_f32_16x16x32_bf16 v[144:147], a[192:195], a[32:35], v[144:147]
  s_waitcnt vmcnt(14)
  s_barrier
  v_accvgpr_write_b32 a143, v239
  v_mfma_f32_16x16x32_bf16 v[144:147], a[196:199], a[48:51], v[144:147]
  ds_read_b64_tr_b16 a[218:219], v251 offset:17408
  s_mov_b32 s44, 0xe38e38f
  v_accvgpr_write_b32 a14, 0
  v_accvgpr_write_b32 a15, 0
  v_mfma_f32_16x16x32_bf16 v[148:151], a[196:199], a[52:55], v[148:151]
  v_cmp_ne_u32 vcc, 1, v3
  s_cbranch_vccnz K_PK_spin
K_PK_ok:
  v_mfma_f32_16x16x32_bf16 v[148:151], a[192:195], a[36:39], v[148:151]
  ds_read_b64_tr_b16 a[220:221], v251 offset:24576
  s_lshr_b32 s45, s25, 2
  s_lshl_b32 s45, s45, 1
  v_mfma_f32_16x16x32_bf16 v[152:155], a[192:195], a[40:43], v[152:155]
  s_add_u32 s45, s45, 2
  v_accvgpr_write_b32 a16, 0
  v_accvgpr_write_b32 a17, 0
  v_mfma_f32_16x16x32_bf16 v[152:155], a[196:199], a[56:59], v[152:155]
  ds_read_b64_tr_b16 a[222:223], v251 offset:25600
  s_lshr_b32 s46, s24, 1
  v_add_u32 v208, 0, v0
  v_mfma_f32_16x16x32_bf16 v[156:159], a[196:199], a[60:63], v[156:159]
  v_mul_hi_u32 v209, v208, s44
  v_mfma_f32_16x16x32_bf16 v[156:159], a[192:195], a[44:47], v[156:159]
  ds_read_b64_tr_b16 a[192:193], v244 offset:32768
  s_waitcnt lgkmcnt(9)
K_hA2_6:
  s_cbranch_execz K_hA2_7
  v_mul_u32_u24 v210, 18, v209
  v_mfma_f32_16x16x32_bf16 v[172:175], a[200:203], a[44:47], v[172:175]
  v_sub_u32 v208, v208, v210
  v_accvgpr_write_b32 a18, 0
  v_mfma_f32_16x16x32_bf16 v[172:175], a[204:207], a[60:63], v[172:175]
  ds_read_b64_tr_b16 a[194:195], v244 offset:33792
  s_mul_i32 s46, s46, 8192
  v_add_u32 v208, s45, v208
  v_mfma_f32_16x16x32_bf16 v[168:171], a[204:207], a[56:59], v[168:171]
  v_subrev_u32 v210, 18, v208
  v_accvgpr_write_b32 a19, 0
  v_mfma_f32_16x16x32_bf16 v[168:171], a[200:203], a[40:43], v[168:171]
  ds_read_b64_tr_b16 a[196:197], v244 offset:40960
  v_min_u32 v208, v208, v210
  v_mfma_f32_16x16x32_bf16 v[164:167], a[200:203], a[36:39], v[164:167]
  v_accvgpr_write_b32 a20, 0
  v_accvgpr_write_b32 a21, 0
  v_mfma_f32_16x16x32_bf16 v[164:167], a[204:207], a[52:55], v[164:167]
  ds_read_b64_tr_b16 a[198:199], v244 offset:41984
  s_add_u32 s46, s46, s37
  v_mul_u32_u24 v209, 1152, v209
  v_mfma_f32_16x16x32_bf16 v[160:163], a[204:207], a[48:51], v[160:163]
  v_lshl_add_u32 v4, v208, 4, v209
  v_accvgpr_write_b32 a22, 0
  v_mfma_f32_16x16x32_bf16 v[160:163], a[200:203], a[32:35], v[160:163]
  ds_read_b64_tr_b16 a[200:201], v245 offset:32768
  s_waitcnt lgkmcnt(9)
  v_add_u32 v208, 64, v0
  v_mfma_f32_16x16x32_bf16 v[176:179], a[208:211], a[32:35], v[176:179]
  v_mul_hi_u32 v209, v208, s44
  v_mfma_f32_16x16x32_bf16 v[176:179], a[212:215], a[48:51], v[176:179]
  ds_read_b64_tr_b16 a[202:203], v245 offset:33792
  s_add_u32 m0, s46, 65536
  v_mul_u32_u24 v210, 18, v209
  v_mfma_f32_16x16x32_bf16 v[180:183], a[212:215], a[52:55], v[180:183]
  v_sub_u32 v208, v208, v210
  v_accvgpr_write_b32 a23, 0
  v_mfma_f32_16x16x32_bf16 v[180:183], a[208:211], a[36:39], v[180:183]
  ds_read_b64_tr_b16 a[204:205], v245 offset:40960
  v_add_u32 v208, s45, v208
  v_mfma_f32_16x16x32_bf16 v[184:187], a[208:211], a[40:43], v[184:187]
  v_subrev_u32 v210, 18, v208
  v_accvgpr_write_b32 a24, 0
  v_mfma_f32_16x16x32_bf16 v[184:187], a[212:215], a[56:59], v[184:187]
  ds_read_b64_tr_b16 a[206:207], v245 offset:41984
  s_add_u32 s36, s42, 0
  v_min_u32 v208, v208, v210
  v_mfma_f32_16x16x32_bf16 v[188:191], a[212:215], a[60:63], v[188:191]
  v_mul_u32_u24 v209, 1152, v209
  v_accvgpr_write_b32 a25, 0
  v_mfma_f32_16x16x32_bf16 v[188:191], a[208:211], a[44:47], v[188:191]
  ds_read_b64_tr_b16 a[208:209], v246 offset:32768
  s_waitcnt lgkmcnt(9)
  v_accvgpr_write_b32 a26, 0
  v_mfma_f32_16x16x32_bf16 v[204:207], a[216:219], a[44:47], v[204:207]
  v_lshl_add_u32 v5, v208, 4, v209
  v_accvgpr_write_b32 a27, 0
  v_mfma_f32_16x16x32_bf16 v[204:207], a[220:223], a[60:63], v[204:207]
  ds_read_b64_tr_b16 a[210:211], v246 offset:33792
  buffer_load_dwordx4 v1, s[20:23], s36 offen offset:0 sc1 lds
  v_mfma_f32_16x16x32_bf16 v[200:203], a[220:223], a[56:59], v[200:203]
  v_subrev_u32 v5, 1024, v5
  v_add_u32 v208, 128, v0
  v_mfma_f32_16x16x32_bf16 v[200:203], a[216:219], a[40:43], v[200:203]
  ds_read_b64_tr_b16 a[212:213], v246 offset:40960
  v_accvgpr_write_b32 a28, 0
  v_accvgpr_write_b32 a29, 0
  v_mfma_f32_16x16x32_bf16 v[196:199], a[216:219], a[36:39], v[196:199]
  v_mul_hi_u32 v209, v208, s44
  v_mfma_f32_16x16x32_bf16 v[196:199], a[220:223], a[52:55], v[196:199]
  ds_read_b64_tr_b16 a[214:215], v246 offset:41984
  buffer_load_dwordx4 v1, s[20:23], s36 offen offset:1024 sc1 lds
  v_accvgpr_write_b32 a30, 0
  v_mfma_f32_16x16x32_bf16 v[192:195], a[220:223], a[48:51], v[192:195]
  v_mul_u32_u24 v210, 18, v209
  v_sub_u32 v208, v208, v210
  v_mfma_f32_16x16x32_bf16 v[192:195], a[216:219], a[32:35], v[192:195]
  ds_read_b64_tr_b16 a[216:217], v247 offset:32768
  s_waitcnt lgkmcnt(9)
  v_add_u32 v208, s45, v208
  v_accvgpr_write_b32 a31, 0
  v_mfma_f32_16x16x32_bf16 v[80:83], a[192:195], a[224:227], v[80:83]
  s_waitcnt vmcnt(12)
  ds_read_b128 a[160:163], v240 offset:32768
  s_and_b32 s35, s25, 3
  v_mfma_f32_16x16x32_bf16 v[80:83], a[196:199], a[240:243], v[80:83]
  ds_read_b64_tr_b16 a[218:219], v247 offset:33792
  buffer_load_dwordx4 v1, s[20:23], s36 offen offset:2048 sc1 lds
  s_mul_i32 s28, s35, 288
  v_accvgpr_write_b32 a32, 0
  v_mfma_f32_16x16x32_bf16 v[84:87], a[196:199], a[244:247], v[84:87]
  v_subrev_u32 v210, 18, v208
  v_min_u32 v208, v208, v210
  v_mfma_f32_16x16x32_bf16 v[84:87], a[192:195], a[228:231], v[84:87]
  ds_read_b64_tr_b16 a[220:221], v247 offset:40960
  ds_read_b128 a[164:167], v240 offset:34816
  s_lshr_b32 s47, s25, 2
  v_accvgpr_write_b32 a33, 0
  v_mfma_f32_16x16x32_bf16 v[88:91], a[192:195], a[232:235], v[88:91]
  v_mul_u32_u24 v209, 1152, v209
  v_lshl_add_u32 v6, v208, 4, v209
  v_mfma_f32_16x16x32_bf16 v[88:91], a[196:199], a[248:251], v[88:91]
  ds_read_b64_tr_b16 a[222:223], v247 offset:41984
  buffer_load_dwordx4 v1, s[20:23], s36 offen offset:3072 sc1 lds
  s_lshl_b32 s47, s47, 4
  v_accvgpr_write_b32 a34, 0
  v_mfma_f32_16x16x32_bf16 v[92:95], a[196:199], a[252:255], v[92:95]
  ds_read_b128 a[168:171], v240 offset:36864
  v_subrev_u32 v6, 2048, v6
  v_mfma_f32_16x16x32_bf16 v[92:95], a[192:195], a[236:239], v[92:95]
  ds_read_b64_tr_b16 a[192:193], v248 offset:32768
  s_waitcnt lgkmcnt(12)
  v_add_u32 v208, 192, v0
  v_accvgpr_write_b32 a35, 0
  v_mfma_f32_16x16x32_bf16 v[108:111], a[200:203], a[236:239], v[108:111]
  s_add_u32 s47, s47, s24
  v_mul_hi_u32 v209, v208, s44
  v_mfma_f32_16x16x32_bf16 v[108:111], a[204:207], a[252:255], v[108:111]
  ds_read_b64_tr_b16 a[194:195], v248 offset:33792
  ds_read_b128 a[172:175], v240 offset:38912
  s_mul_i32 s47, s47, 36864
  v_accvgpr_write_b32 a36, 0
  v_mfma_f32_16x16x32_bf16 v[104:107], a[204:207], a[248:251], v[104:107]
  v_mul_u32_u24 v210, 18, v209
  v_sub_u32 v208, v208, v210
  v_mfma_f32_16x16x32_bf16 v[104:107], a[200:203], a[232:235], v[104:107]
  ds_read_b64_tr_b16 a[196:197], v248 offset:40960
  s_add_u32 s47, s47, s28
  v_add_u32 v208, s45, v208
  v_accvgpr_write_b32 a37, 0
  v_mfma_f32_16x16x32_bf16 v[100:103], a[200:203], a[228:231], v[100:103]
  ds_read_b128 a[176:179], v241 offset:32768
  v_subrev_u32 v210, 18, v208
  v_mfma_f32_16x16x32_bf16 v[100:103], a[204:207], a[244:247], v[100:103]
  ds_read_b64_tr_b16 a[198:199], v248 offset:41984
  s_add_u32 s28, s35, 0
  v_min_u32 v208, v208, v210
  v_mfma_f32_16x16x32_bf16 v[96:99], a[204:207], a[240:243], v[96:99]
  v_mul_u32_u24 v209, 1152, v209
  v_lshl_add_u32 v7, v208, 4, v209
  v_mfma_f32_16x16x32_bf16 v[96:99], a[200:203], a[224:227], v[96:99]
  ds_read_b64_tr_b16 a[200:201], v249 offset:32768
  ds_read_b128 a[180:183], v241 offset:34816
  s_waitcnt lgkmcnt(15)
  v_mfma_f32_16x16x32_bf16 v[112:115], a[208:211], a[224:227], v[112:115]
K_hA3_6:
  s_cbranch_execz K_hA3_7
  s_and_b32 s28, s28, 3
  v_subrev_u32 v7, 3072, v7
  v_add_u32 v208, 256, v0
  v_mfma_f32_16x16x32_bf16 v[112:115], a[212:215], a[240:243], v[112:115]
  ds_read_b64_tr_b16 a[202:203], v249 offset:33792
  s_mul_i32 s28, s28, 147456
  v_accvgpr_write_b32 a38, 0
  v_mfma_f32_16x16x32_bf16 v[116:119], a[212:215], a[244:247], v[116:119]
  ds_read_b128 a[184:187], v241 offset:36864
  v_accvgpr_write_b32 a39, 0
  v_mfma_f32_16x16x32_bf16 v[116:119], a[208:211], a[228:231], v[116:119]
  ds_read_b64_tr_b16 a[204:205], v249 offset:40960
  s_add_u32 s48, s47, s28
  v_accvgpr_write_b32 a40, 0
  v_accvgpr_write_b32 a41, 0
  v_mfma_f32_16x16x32_bf16 v[120:123], a[208:211], a[232:235], v[120:123]
  v_mul_hi_u32 v209, v208, s44
  v_mfma_f32_16x16x32_bf16 v[120:123], a[212:215], a[248:251], v[120:123]
  ds_read_b64_tr_b16 a[206:207], v249 offset:41984
  ds_read_b128 a[188:191], v241 offset:38912
  s_add_u32 s28, s35, 1
  v_accvgpr_write_b32 a42, 0
  v_mfma_f32_16x16x32_bf16 v[124:127], a[212:215], a[252:255], v[124:127]
  v_mul_u32_u24 v210, 18, v209
  v_sub_u32 v208, v208, v210
  v_mfma_f32_16x16x32_bf16 v[124:127], a[208:211], a[236:239], v[124:127]
  ds_read_b64_tr_b16 a[208:209], v250 offset:32768
  s_waitcnt lgkmcnt(15)
  v_add_u32 v208, s45, v208
  v_mfma_f32_16x16x32_bf16 v[140:143], a[216:219], a[236:239], v[140:143]
  s_and_b32 s28, s28, 3
  v_subrev_u32 v210, 18, v208
  v_min_u32 v208, v208, v210
  v_mfma_f32_16x16x32_bf16 v[140:143], a[220:223], a[252:255], v[140:143]
  ds_read_b64_tr_b16 a[210:211], v250 offset:33792
  s_mul_i32 s28, s28, 147456
  v_mul_u32_u24 v209, 1152, v209
  v_mfma_f32_16x16x32_bf16 v[136:139], a[220:223], a[248:251], v[136:139]
  v_lshl_add_u32 v8, v208, 4, v209
  v_add_u32 v208, 320, v0
  v_mfma_f32_16x16x32_bf16 v[136:139], a[216:219], a[232:235], v[136:139]
  ds_read_b64_tr_b16 a[212:213], v250 offset:40960
  s_add_u32 s49, s47, s28
  v_accvgpr_write_b32 a43, 0
  v_accvgpr_write_b32 a44, 0
  v_accvgpr_write_b32 a45, 0
  v_mfma_f32_16x16x32_bf16 v[132:135], a[216:219], a[228:231], v[132:135]
  v_mul_hi_u32 v209, v208, s44
  v_mfma_f32_16x16x32_bf16 v[132:135], a[220:223], a[244:247], v[132:135]
  ds_read_b64_tr_b16 a[214:215], v250 offset:41984
  s_add_u32 s28, s35, 2
  v_mul_u32_u24 v210, 18, v209
  v_accvgpr_write_b32 a46, 0
  v_mfma_f32_16x16x32_bf16 v[128:131], a[220:223], a[240:243], v[128:131]
  s_and_b32 s28, s28, 3
  v_sub_u32 v208, v208, v210
  v_add_u32 v208, s45, v208
  v_mfma_f32_16x16x32_bf16 v[128:131], a[216:219], a[224:227], v[128:131]
  ds_read_b64_tr_b16 a[216:217], v251 offset:32768
  s_waitcnt lgkmcnt(12)
  v_subrev_u32 v210, 18, v208
  v_accvgpr_write_b32 a47, 0
  v_mfma_f32_16x16x32_bf16 v[144:147], a[192:195], a[224:227], v[144:147]
  s_waitcnt vmcnt(5)
  s_barrier
  v_mfma_f32_16x16x32_bf16 v[144:147], a[196:199], a[240:243], v[144:147]
  ds_read_b64_tr_b16 a[218:219], v251 offset:33792
  s_mul_i32 s28, s28, 147456
  v_min_u32 v208, v208, v210
  v_accvgpr_write_b32 a48, 0
  v_mfma_f32_16x16x32_bf16 v[148:151], a[196:199], a[244:247], v[148:151]
  s_add_u32 s27, s39, 4096
  buffer_store_dword v252, off, s[20:23], s27 sc1
  v_mfma_f32_16x16x32_bf16 v[148:151], a[192:195], a[228:231], v[148:151]
  ds_read_b64_tr_b16 a[220:221], v251 offset:40960
  s_add_u32 s50, s47, s28
  v_mul_u32_u24 v209, 1152, v209
  v_accvgpr_write_b32 a49, 0
  v_mfma_f32_16x16x32_bf16 v[152:155], a[192:195], a[232:235], v[152:155]
  v_lshl_add_u32 v9, v208, 4, v209
  v_subrev_u32 v9, 1024, v9
  v_mfma_f32_16x16x32_bf16 v[152:155], a[196:199], a[248:251], v[152:155]
  ds_read_b64_tr_b16 a[222:223], v251 offset:41984
  s_add_u32 m0, s46, 0
  v_add_u32 v208, 384, v0
  v_accvgpr_write_b32 a50, 0
  v_mfma_f32_16x16x32_bf16 v[156:159], a[196:199], a[252:255], v[156:159]
  s_add_u32 s28, s35, 3
  v_mul_hi_u32 v209, v208, s44
  v_mfma_f32_16x16x32_bf16 v[156:159], a[192:195], a[236:239], v[156:159]
  ds_read_b64_tr_b16 a[192:193], v244 offset:49152
  s_waitcnt lgkmcnt(10)
  v_mul_u32_u24 v210, 18, v209
  v_mfma_f32_16x16x32_bf16 v[172:175], a[200:203], a[236:239], v[172:175]
  s_waitcnt lgkmcnt(9)
  v_sub_u32 v208, v208, v210
  s_and_b32 s28, s28, 3
  v_mfma_f32_16x16x32_bf16 v[172:175], a[204:207], a[252:255], v[172:175]
  ds_read_b64_tr_b16 a[194:195], v244 offset:50176
  s_add_u32 s36, s42, 32768
  v_add_u32 v208, s45, v208
  v_mfma_f32_16x16x32_bf16 v[168:171], a[204:207], a[248:251], v[168:171]
  s_mul_i32 s28, s28, 147456
  v_subrev_u32 v210, 18, v208
  v_accvgpr_write_b32 a51, 0
  v_mfma_f32_16x16x32_bf16 v[168:171], a[200:203], a[232:235], v[168:171]
  ds_read_b64_tr_b16 a[196:197], v244 offset:57344
  s_add_u32 s51, s47, s28
  v_min_u32 v208, v208, v210
  v_mfma_f32_16x16x32_bf16 v[164:167], a[200:203], a[228:231], v[164:167]
  v_mul_u32_u24 v209, 1152, v209
  v_accvgpr_write_b32 a52, 0
  v_accvgpr_write_b32 a53, 0
  v_mfma_f32_16x16x32_bf16 v[164:167], a[204:207], a[244:247], v[164:167]
  ds_read_b64_tr_b16 a[198:199], v244 offset:58368
  buffer_load_dwordx4 v1, s[20:23], s36 offen offset:0 sc1 lds
  s_mul_i32 s32, s24, 9216
  v_mfma_f32_16x16x32_bf16 v[160:163], a[204:207], a[240:243], v[160:163]
  v_lshl_add_u32 v10, v208, 4, v209
  v_subrev_u32 v10, 2048, v10
  v_mfma_f32_16x16x32_bf16 v[160:163], a[200:203], a[224:227], v[160:163]
  ds_read_b64_tr_b16 a[200:201], v245 offset:49152
  s_lshl_b32 s34, s25, 3
  s_waitcnt lgkmcnt(9)
  v_mfma_f32_16x16x32_bf16 v[176:179], a[208:211], a[224:227], v[176:179]
  v_add_u32 v208, 448, v0
  v_accvgpr_write_b32 a54, 0
  v_accvgpr_write_b32 a55, 0
  v_mfma_f32_16x16x32_bf16 v[176:179], a[212:215], a[240:243], v[176:179]
  ds_read_b64_tr_b16 a[202:203], v245 offset:50176
  buffer_load_dwordx4 v1, s[20:23], s36 offen offset:1024 sc1 lds
  s_add_u32 s34, s34, s26
  v_accvgpr_write_b32 a56, 0
  v_mfma_f32_16x16x32_bf16 v[180:183], a[212:215], a[244:247], v[180:183]
  v_mul_hi_u32 v209, v208, s44
  v_mfma_f32_16x16x32_bf16 v[180:183], a[208:211], a[228:231], v[180:183]
  ds_read_b64_tr_b16 a[204:205], v245 offset:57344
  s_lshl_b32 s34, s34, 2
  v_mul_u32_u24 v210, 18, v209
  v_accvgpr_write_b32 a57, 0
  v_mfma_f32_16x16x32_bf16 v[184:187], a[208:211], a[232:235], v[184:187]
  v_sub_u32 v208, v208, v210
  v_add_u32 v208, s45, v208
  v_mfma_f32_16x16x32_bf16 v[184:187], a[212:215], a[248:251], v[184:187]
  ds_read_b64_tr_b16 a[206:207], v245 offset:58368
  buffer_load_dwordx4 v1, s[20:23], s36 offen offset:2048 sc1 lds
  s_add_u32 s34, s34, s24
  v_mfma_f32_16x16x32_bf16 v[188:191], a[212:215], a[252:255], v[188:191]
K_hA0_7:
  s_cbranch_execz K_hA0_8
  v_subrev_u32 v210, 18, v208
  v_min_u32 v208, v208, v210
  v_mfma_f32_16x16x32_bf16 v[188:191], a[208:211], a[236:239], v[188:191]
  ds_read_b64_tr_b16 a[208:209], v246 offset:49152
  s_waitcnt lgkmcnt(9)
  v_mul_u32_u24 v209, 1152, v209
  v_mfma_f32_16x16x32_bf16 v[204:207], a[216:219], a[236:239], v[204:207]
  s_lshl_b32 s34, s34, 14
  v_lshl_add_u32 v11, v208, 4, v209
  v_accvgpr_write_b32 a58, 0
  v_mfma_f32_16x16x32_bf16 v[204:207], a[220:223], a[252:255], v[204:207]
  ds_read_b64_tr_b16 a[210:211], v246 offset:50176
  buffer_load_dwordx4 v1, s[20:23], s36 offen offset:3072 sc1 lds
  s_add_u32 s34, s34, 33554432
  v_mfma_f32_16x16x32_bf16 v[200:203], a[220:223], a[248:251], v[200:203]
  v_subrev_u32 v11, 3072, v11
  v_accvgpr_write_b32 a59, 0
  v_accvgpr_write_b32 a60, 0
  v_mfma_f32_16x16x32_bf16 v[200:203], a[216:219], a[232:235], v[200:203]
  ds_read_b64_tr_b16 a[212:213], v246 offset:57344
  s_lshr_b32 s33, s24, 1
  v_add_u32 v208, 512, v0
  v_mfma_f32_16x16x32_bf16 v[196:199], a[216:219], a[228:231], v[196:199]
  v_mul_hi_u32 v209, v208, s44
  v_mfma_f32_16x16x32_bf16 v[196:199], a[220:223], a[244:247], v[196:199]
  ds_read_b64_tr_b16 a[214:215], v246 offset:58368
  s_mul_i32 s33, s33, 13056
  v_mul_u32_u24 v210, 18, v209
  v_mfma_f32_16x16x32_bf16 v[192:195], a[220:223], a[240:243], v[192:195]
  v_sub_u32 v208, v208, v210
  v_accvgpr_write_b32 a61, 0
  v_accvgpr_write_b32 a62, 0
  v_mfma_f32_16x16x32_bf16 v[192:195], a[216:219], a[224:227], v[192:195]
  ds_read_b64_tr_b16 a[216:217], v247 offset:49152
  s_waitcnt lgkmcnt(9)
  v_add_u32 v208, s45, v208
  v_accvgpr_write_b32 a63, 0
  v_mfma_f32_16x16x32_bf16 v[80:83], a[192:195], a[160:163], v[80:83]
  s_mov_b32 s29, 0x3e0293ee
  v_subrev_u32 v210, 18, v208
  s_add_u32 s33, s33, 137216
  v_mfma_f32_16x16x32_bf16 v[80:83], a[196:199], a[176:179], v[80:83]
  ds_read_b64_tr_b16 a[218:219], v247 offset:50176
  v_min_u32 v208, v208, v210
  v_mfma_f32_16x16x32_bf16 v[84:87], a[196:199], a[180:183], v[84:87]
  s_cmp_eq_u32 s26, 0
  s_cselect_b32 s28, -1, 0
  v_mul_u32_u24 v209, 1152, v209
  v_mfma_f32_16x16x32_bf16 v[84:87], a[192:195], a[164:167], v[84:87]
  ds_read_b64_tr_b16 a[220:221], v247 offset:57344
  v_lshl_add_u32 v12, v208, 4, v209
  v_mfma_f32_16x16x32_bf16 v[88:91], a[192:195], a[168:171], v[88:91]
  v_add_u32 v13, 8192, v1
  v_and_b32 v216, s28, v224
  v_mfma_f32_16x16x32_bf16 v[88:91], a[196:199], a[184:187], v[88:91]
  ds_read_b64_tr_b16 a[222:223], v247 offset:58368
  v_and_b32 v217, s28, v225
  v_mfma_f32_16x16x32_bf16 v[92:95], a[196:199], a[188:191], v[92:95]
  v_add_u32 v14, 16384, v1
  v_and_b32 v218, s28, v226
  v_mfma_f32_16x16x32_bf16 v[92:95], a[192:195], a[172:175], v[92:95]
  ds_read_b64_tr_b16 a[192:193], v248 offset:49152
  s_waitcnt lgkmcnt(9)
  v_add_u32 v15, 24576, v1
  v_mfma_f32_16x16x32_bf16 v[108:111], a[200:203], a[172:175], v[108:111]
  v_accvgpr_write_b32 a144, v4
  v_and_b32 v219, s28, v227
  v_mfma_f32_16x16x32_bf16 v[108:111], a[204:207], a[188:191], v[108:111]
  ds_read_b64_tr_b16 a[194:195], v248 offset:50176
  v_accvgpr_write_b32 a145, v5
  v_mfma_f32_16x16x32_bf16 v[104:107], a[204:207], a[184:187], v[104:107]
  v_accvgpr_write_b32 a146, v6
  v_and_b32 v220, s28, v228
  v_mfma_f32_16x16x32_bf16 v[104:107], a[200:203], a[168:171], v[104:107]
  ds_read_b64_tr_b16 a[196:197], v248 offset:57344
  v_accvgpr_write_b32 a147, v7
  v_mfma_f32_16x16x32_bf16 v[100:103], a[200:203], a[164:167], v[100:103]
  v_accvgpr_write_b32 a148, v8
  v_and_b32 v221, s28, v229
  v_mfma_f32_16x16x32_bf16 v[100:103], a[204:207], a[180:183], v[100:103]
  ds_read_b64_tr_b16 a[198:199], v248 offset:58368
  v_accvgpr_write_b32 a149, v9
  v_mfma_f32_16x16x32_bf16 v[96:99], a[204:207], a[176:179], v[96:99]
  v_accvgpr_write_b32 a150, v10
  v_and_b32 v222, s28, v230
  v_mfma_f32_16x16x32_bf16 v[96:99], a[200:203], a[160:163], v[96:99]
  ds_read_b64_tr_b16 a[200:201], v249 offset:49152
  s_waitcnt lgkmcnt(9)
  v_accvgpr_write_b32 a151, v11
  v_mfma_f32_16x16x32_bf16 v[112:115], a[208:211], a[160:163], v[112:115]
  v_and_b32 v223, s28, v231
  v_mov_b32 v240, 0x3f803f80
  v_mfma_f32_16x16x32_bf16 v[112:115], a[212:215], a[176:179], v[112:115]
  ds_read_b64_tr_b16 a[202:203], v249 offset:50176
  v_mov_b32 v241, 0x3f803f80
  v_mfma_f32_16x16x32_bf16 v[116:119], a[212:215], a[180:183], v[116:119]
  v_mov_b32 v242, 0x3f803f80
  v_mfma_f32_16x16x32_bf16 v[116:119], a[208:211], a[164:167], v[116:119]
  ds_read_b64_tr_b16 a[204:205], v249 offset:57344
  v_mov_b32 v243, 0x3f803f80
  v_mfma_f32_16x16x32_bf16 v[120:123], a[208:211], a[168:171], v[120:123]
  v_mfma_f32_16x16x32_bf16 v[120:123], a[212:215], a[184:187], v[120:123]
  ds_read_b64_tr_b16 a[206:207], v249 offset:58368
  v_mul_f32 v80, s29, v80
  v_mfma_f32_16x16x32_bf16 v[124:127], a[212:215], a[188:191], v[124:127]
  v_mul_f32 v81, s29, v81
  v_mul_f32 v82, s29, v82
  v_mfma_f32_16x16x32_bf16 v[124:127], a[208:211], a[172:175], v[124:127]
  ds_read_b64_tr_b16 a[208:209], v250 offset:49152
  s_waitcnt lgkmcnt(9)
  v_mul_f32 v83, s29, v83
  v_cvt_pk_bf16_f32 v16, v80, v81
  v_cvt_pk_bf16_f32 v17, v82, v83
  v_mfma_f32_16x16x32_bf16 v[140:143], a[216:219], a[172:175], v[140:143]
  v_mul_f32 v96, s29, v96
  v_mul_f32 v97, s29, v97
  v_mul_f32 v98, s29, v98
  v_mfma_f32_16x16x32_bf16 v[140:143], a[220:223], a[188:191], v[140:143]
  ds_read_b64_tr_b16 a[210:211], v250 offset:50176
  v_mul_f32 v99, s29, v99
  v_cvt_pk_bf16_f32 v18, v96, v97
  v_cvt_pk_bf16_f32 v19, v98, v99
  v_mfma_f32_16x16x32_bf16 v[136:139], a[220:223], a[184:187], v[136:139]
  v_mul_f32 v84, s29, v84
  v_mul_f32 v85, s29, v85
  v_mul_f32 v86, s29, v86
  v_mfma_f32_16x16x32_bf16 v[136:139], a[216:219], a[168:171], v[136:139]
  ds_read_b64_tr_b16 a[212:213], v250 offset:57344
  v_mul_f32 v87, s29, v87
  v_cvt_pk_bf16_f32 v32, v84, v85
  v_mfma_f32_16x16x32_bf16 v[132:135], a[216:219], a[164:167], v[132:135]
  v_cvt_pk_bf16_f32 v33, v86, v87
  v_mul_f32 v100, s29, v100
  v_mul_f32 v101, s29, v101
  v_mfma_f32_16x16x32_bf16 v[132:135], a[220:223], a[180:183], v[132:135]
  ds_read_b64_tr_b16 a[214:215], v250 offset:58368
  v_mul_f32 v102, s29, v102
  v_mul_f32 v103, s29, v103
  v_cvt_pk_bf16_f32 v34, v100, v101
  v_mfma_f32_16x16x32_bf16 v[128:131], a[220:223], a[176:179], v[128:131]
  v_cvt_pk_bf16_f32 v35, v102, v103
  v_mul_f32 v88, s29, v88
  v_mul_f32 v89, s29, v89
  v_mfma_f32_16x16x32_bf16 v[128:131], a[216:219], a[160:163], v[128:131]
  ds_read_b64_tr_b16 a[216:217], v251 offset:49152
  s_waitcnt lgkmcnt(9)
  v_mul_f32 v90, s29, v90
  v_mul_f32 v91, s29, v91
  v_cvt_pk_bf16_f32 v48, v88, v89
  v_cvt_pk_bf16_f32 v49, v90, v91
K_hA1_7:
  s_cbranch_execz K_hA1_8
  v_mul_f32 v104, s29, v104
  v_mul_f32 v105, s29, v105
  v_mfma_f32_16x16x32_bf16 v[144:147], a[192:195], a[160:163], v[144:147]
  s_waitcnt vmcnt(5)
  s_barrier
  v_mfma_f32_16x16x32_bf16 v[144:147], a[196:199], a[176:179], v[144:147]
  ds_read_b64_tr_b16 a[218:219], v251 offset:50176
  s_add_u32 m0, s46, 98304
  v_mul_f32 v106, s29, v106
  v_mul_f32 v107, s29, v107
  v_mfma_f32_16x16x32_bf16 v[148:151], a[196:199], a[180:183], v[148:151]
  v_cvt_pk_bf16_f32 v50, v104, v105
  v_cvt_pk_bf16_f32 v51, v106, v107
  v_mul_f32 v92, s29, v92
  v_mfma_f32_16x16x32_bf16 v[148:151], a[192:195], a[164:167], v[148:151]
  ds_read_b64_tr_b16 a[220:221], v251 offset:57344
  v_mul_f32 v93, s29, v93
  v_mul_f32 v94, s29, v94
  v_mul_f32 v95, s29, v95
  v_mfma_f32_16x16x32_bf16 v[152:155], a[192:195], a[168:171], v[152:155]
  v_cvt_pk_bf16_f32 v64, v92, v93
  v_cvt_pk_bf16_f32 v65, v94, v95
  v_mul_f32 v108, s29, v108
  v_mfma_f32_16x16x32_bf16 v[152:155], a[196:199], a[184:187], v[152:155]
  ds_read_b64_tr_b16 a[222:223], v251 offset:58368
  s_add_u32 s36, s42, 16384
  v_mul_f32 v109, s29, v109
  v_mul_f32 v110, s29, v110
  v_mul_f32 v111, s29, v111
  v_cvt_pk_bf16_f32 v66, v108, v109
  v_cvt_pk_bf16_f32 v67, v110, v111
  v_mfma_f32_16x16x32_bf16 v[156:159], a[196:199], a[188:191], v[156:159]
  v_mul_f32 v112, s29, v112
  v_mul_f32 v113, s29, v113
  v_mul_f32 v114, s29, v114
  v_mfma_f32_16x16x32_bf16 v[156:159], a[192:195], a[172:175], v[156:159]
  s_waitcnt lgkmcnt(8)
  v_mul_f32 v115, s29, v115
  v_cvt_pk_bf16_f32 v20, v112, v113
  v_cvt_pk_bf16_f32 v21, v114, v115
  v_mfma_f32_16x16x32_bf16 v[172:175], a[200:203], a[172:175], v[172:175]
  v_mul_f32 v128, s29, v128
  v_mul_f32 v129, s29, v129
  v_mul_f32 v130, s29, v130
  v_mul_f32 v131, s29, v131
  v_cvt_pk_bf16_f32 v22, v128, v129
  v_mfma_f32_16x16x32_bf16 v[172:175], a[204:207], a[188:191], v[172:175]
  ds_read_b128 a[224:227], v2 offset:0
  buffer_load_dwordx4 v1, s[20:23], s36 offen offset:0 sc1 lds
  v_mfma_f32_16x16x32_bf16 v[168:171], a[204:207], a[184:187], v[168:171]
  v_cvt_pk_bf16_f32 v23, v130, v131
  v_mul_f32 v116, s29, v116
  v_mul_f32 v117, s29, v117
  v_mfma_f32_16x16x32_bf16 v[168:171], a[200:203], a[168:171], v[168:171]
  ds_read_b128 a[228:231], v2 offset:1024
  v_mul_f32 v118, s29, v118
  v_mul_f32 v119, s29, v119
  v_mfma_f32_16x16x32_bf16 v[164:167], a[200:203], a[164:167], v[164:167]
  v_cvt_pk_bf16_f32 v36, v116, v117
  v_cvt_pk_bf16_f32 v37, v118, v119
  v_mul_f32 v132, s29, v132
  v_mul_f32 v133, s29, v133
  v_mul_f32 v134, s29, v134
  v_mul_f32 v135, s29, v135
  v_mfma_f32_16x16x32_bf16 v[164:167], a[204:207], a[180:183], v[164:167]
  ds_read_b128 a[232:235], v2 offset:2048
  buffer_load_dwordx4 v1, s[20:23], s36 offen offset:1024 sc1 lds
  v_mfma_f32_16x16x32_bf16 v[160:163], a[204:207], a[176:179], v[160:163]
  v_cvt_pk_bf16_f32 v38, v132, v133
  v_cvt_pk_bf16_f32 v39, v134, v135
  v_mfma_f32_16x16x32_bf16 v[160:163], a[200:203], a[160:163], v[160:163]
  ds_read_b128 a[236:239], v2 offset:3072
  s_waitcnt lgkmcnt(8)
  v_mul_f32 v120, s29, v120
  v_mul_f32 v121, s29, v121
  v_mul_f32 v122, s29, v122
  v_mfma_f32_16x16x32_bf16 v[176:179], a[208:211], a[160:163], v[176:179]
  v_mul_f32 v123, s29, v123
  v_cvt_pk_bf16_f32 v52, v120, v121
  v_cvt_pk_bf16_f32 v53, v122, v123
  v_mfma_f32_16x16x32_bf16 v[176:179], a[212:215], a[176:179], v[176:179]
  buffer_load_dwordx4 v1, s[20:23], s36 offen offset:2048 sc1 lds
  v_mul_f32 v136, s29, v136
  v_mul_f32 v137, s29, v137
  v_mfma_f32_16x16x32_bf16 v[180:183], a[212:215], a[180:183], v[180:183]
  ds_read_b128 a[240:243], v2 offset:4096
  v_mul_f32 v138, s29, v138
  v_mul_f32 v139, s29, v139
  v_cvt_pk_bf16_f32 v54, v136, v137
  v_mfma_f32_16x16x32_bf16 v[180:183], a[208:211], a[164:167], v[180:183]
  v_cvt_pk_bf16_f32 v55, v138, v139
  v_mul_f32 v124, s29, v124
  v_mul_f32 v125, s29, v125
  v_mfma_f32_16x16x32_bf16 v[184:187], a[208:211], a[168:171], v[184:187]
  ds_read_b128 a[244:247], v2 offset:5120
  v_mul_f32 v126, s29, v126
  v_mul_f32 v127, s29, v127
  v_mfma_f32_16x16x32_bf16 v[184:187], a[212:215], a[184:187], v[184:187]
  buffer_load_dwordx4 v1, s[20:23], s36 offen offset:3072 sc1 lds
  v_cvt_pk_bf16_f32 v68, v124, v125
  v_cvt_pk_bf16_f32 v69, v126, v127
  v_mul_f32 v140, s29, v140
  v_mfma_f32_16x16x32_bf16 v[188:191], a[212:215], a[188:191], v[188:191]
  ds_read_b128 a[248:251], v2 offset:6144
  v_mul_f32 v141, s29, v141
  v_mul_f32 v142, s29, v142
  v_mul_f32 v143, s29, v143
  v_cvt_pk_bf16_f32 v70, v140, v141
  v_cvt_pk_bf16_f32 v71, v142, v143
  v_mfma_f32_16x16x32_bf16 v[188:191], a[208:211], a[172:175], v[188:191]
  s_waitcnt lgkmcnt(7)
  v_mul_f32 v144, s29, v144
  v_mul_f32 v145, s29, v145
  v_mul_f32 v146, s29, v146
  v_mfma_f32_16x16x32_bf16 v[204:207], a[216:219], a[172:175], v[204:207]
  ds_read_b128 a[252:255], v2 offset:7168
  v_mul_f32 v147, s29, v147
  v_cvt_pk_bf16_f32 v24, v144, v145
  v_cvt_pk_bf16_f32 v25, v146, v147
  v_mfma_f32_16x16x32_bf16 v[204:207], a[220:223], a[188:191], v[204:207]
  v_mul_f32 v160, s29, v160
  v_mul_f32 v161, s29, v161
  v_mul_f32 v162, s29, v162
  v_mul_f32 v163, s29, v163
  v_cvt_pk_bf16_f32 v26, v160, v161
  v_cvt_pk_bf16_f32 v27, v162, v163
  v_mfma_f32_16x16x32_bf16 v[200:203], a[220:223], a[184:187], v[200:203]
  s_lshl_b32 s27, s25, 7
  s_add_u32 s27, s27, 66195456
  v_and_b32 v3, 28, v253
  buffer_load_dword v3, v3, s[20:23], s27 offen sc1
  v_mfma_f32_16x16x32_bf16 v[200:203], a[216:219], a[168:171], v[200:203]
  v_mul_f32 v148, s29, v148
  v_mul_f32 v149, s29, v149
  v_mul_f32 v150, s29, v150
  v_mfma_f32_16x16x32_bf16 v[196:199], a[216:219], a[164:167], v[196:199]
  v_mul_f32 v151, s29, v151
  v_cvt_pk_bf16_f32 v40, v148, v149
  v_mfma_f32_16x16x32_bf16 v[196:199], a[220:223], a[180:183], v[196:199]
  v_cvt_pk_bf16_f32 v41, v150, v151
  v_mul_f32 v164, s29, v164
  v_mul_f32 v165, s29, v165
  v_mfma_f32_16x16x32_bf16 v[192:195], a[220:223], a[176:179], v[192:195]
  v_mul_f32 v166, s29, v166
  v_mul_f32 v167, s29, v167
  v_cvt_pk_bf16_f32 v42, v164, v165
  v_mfma_f32_16x16x32_bf16 v[192:195], a[216:219], a[160:163], v[192:195]
  s_waitcnt lgkmcnt(0)
  v_cvt_pk_bf16_f32 v43, v166, v167
  v_mul_f32 v152, s29, v152
  v_mul_f32 v153, s29, v153
  v_mfma_f32_16x16x32_bf16 v[80:83], a[224:227], v[16:19], v[216:219]
  ds_read_b128 a[192:195], v2 offset:16384
  v_mul_f32 v154, s29, v154
  v_mul_f32 v155, s29, v155
  v_cvt_pk_bf16_f32 v56, v152, v153
  v_mfma_f32_16x16x32_bf16 v[88:91], a[224:227], v[32:35], 0
  v_cvt_pk_bf16_f32 v57, v154, v155
  v_mul_f32 v168, s29, v168
  v_mul_f32 v169, s29, v169
  v_mfma_f32_16x16x32_bf16 v[96:99], a[224:227], v[48:51], 0
  v_mul_f32 v170, s29, v170
  v_mul_f32 v171, s29, v171
  v_mfma_f32_16x16x32_bf16 v[104:107], a[224:227], v[64:67], 0
  v_cvt_pk_bf16_f32 v58, v168, v169
  v_cvt_pk_bf16_f32 v59, v170, v171
K_hA2_7:
  s_cbranch_execz K_hA2_8
  v_mul_f32 v156, s29, v156
  v_mfma_f32_16x16x32_bf16 v[84:87], a[240:243], v[16:19], v[220:223]
  ds_read_b128 a[208:211], v2 offset:20480
  v_mul_f32 v157, s29, v157
  v_mul_f32 v158, s29, v158
  v_mul_f32 v159, s29, v159
  v_mfma_f32_16x16x32_bf16 v[92:95], a[240:243], v[32:35], 0
  v_cvt_pk_bf16_f32 v72, v156, v157
  v_cvt_pk_bf16_f32 v73, v158, v159
  v_mul_f32 v172, s29, v172
  v_mfma_f32_16x16x32_bf16 v[100:103], a[240:243], v[48:51], 0
  v_mul_f32 v173, s29, v173
  v_mul_f32 v174, s29, v174
  v_mul_f32 v175, s29, v175
  v_cvt_pk_bf16_f32 v74, v172, v173
  v_cvt_pk_bf16_f32 v75, v174, v175
  v_mfma_f32_16x16x32_bf16 v[108:111], a[240:243], v[64:67], 0
  v_mul_f32 v176, s29, v176
  v_mul_f32 v177, s29, v177
  v_mul_f32 v178, s29, v178
  v_mfma_f32_16x16x32_bf16 v[80:83], a[228:231], v[20:23], v[80:83]
  ds_read_b128 a[196:199], v2 offset:17408
  v_mul_f32 v179, s29, v179
  v_cvt_pk_bf16_f32 v28, v176, v177
  v_cvt_pk_bf16_f32 v29, v178, v179
  v_mfma_f32_16x16x32_bf16 v[88:91], a[228:231], v[36:39], v[88:91]
  v_mul_f32 v192, s29, v192
  v_mul_f32 v193, s29, v193
  v_mfma_f32_16x16x32_bf16 v[96:99], a[228:231], v[52:55], v[96:99]
  v_mul_f32 v194, s29, v194
  v_mul_f32 v195, s29, v195
  v_cvt_pk_bf16_f32 v30, v192, v193
  v_mfma_f32_16x16x32_bf16 v[104:107], a[228:231], v[68:71], v[104:107]
  v_cvt_pk_bf16_f32 v31, v194, v195
  v_mul_f32 v180, s29, v180
  v_mul_f32 v181, s29, v181
  v_mfma_f32_16x16x32_bf16 v[84:87], a[244:247], v[20:23], v[84:87]
  ds_read_b128 a[212:215], v2 offset:21504
  v_mul_f32 v182, s29, v182
  v_mul_f32 v183, s29, v183
  v_mfma_f32_16x16x32_bf16 v[92:95], a[244:247], v[36:39], v[92:95]
  v_cvt_pk_bf16_f32 v44, v180, v181
  v_cvt_pk_bf16_f32 v45, v182, v183
  v_mul_f32 v196, s29, v196
  v_mfma_f32_16x16x32_bf16 v[100:103], a[244:247], v[52:55], v[100:103]
  v_mul_f32 v197, s29, v197
  v_mul_f32 v198, s29, v198
  v_mul_f32 v199, s29, v199
  v_mfma_f32_16x16x32_bf16 v[108:111], a[244:247], v[68:71], v[108:111]
  v_cvt_pk_bf16_f32 v46, v196, v197
  v_cvt_pk_bf16_f32 v47, v198, v199
  v_mfma_f32_16x16x32_bf16 v[80:83], a[232:235], v[24:27], v[80:83]
  ds_read_b128 a[200:203], v2 offset:18432
  v_mul_f32 v184, s29, v184
  v_mul_f32 v185, s29, v185
  v_mul_f32 v186, s29, v186
  v_mfma_f32_16x16x32_bf16 v[88:91], a[232:235], v[40:43], v[88:91]
  v_mul_f32 v187, s29, v187
  v_cvt_pk_bf16_f32 v60, v184, v185
  v_cvt_pk_bf16_f32 v61, v186, v187
  v_mfma_f32_16x16x32_bf16 v[96:99], a[232:235], v[56:59], v[96:99]
  v_mul_f32 v200, s29, v200
  v_mul_f32 v201, s29, v201
  v_mfma_f32_16x16x32_bf16 v[104:107], a[232:235], v[72:75], v[104:107]
  v_mul_f32 v202, s29, v202
  v_mul_f32 v203, s29, v203
  v_cvt_pk_bf16_f32 v62, v200, v201
  v_mfma_f32_16x16x32_bf16 v[84:87], a[248:251], v[24:27], v[84:87]
  ds_read_b128 a[216:219], v2 offset:22528
  v_cvt_pk_bf16_f32 v63, v202, v203
  v_mul_f32 v188, s29, v188
  v_mul_f32 v189, s29, v189
  v_mfma_f32_16x16x32_bf16 v[92:95], a[248:251], v[40:43], v[92:95]
  v_mul_f32 v190, s29, v190
  v_mul_f32 v191, s29, v191
  v_mfma_f32_16x16x32_bf16 v[100:103], a[248:251], v[56:59], v[100:103]
  v_cvt_pk_bf16_f32 v76, v188, v189
  v_cvt_pk_bf16_f32 v77, v190, v191
  v_mul_f32 v204, s29, v204
  v_mfma_f32_16x16x32_bf16 v[108:111], a[248:251], v[72:75], v[108:111]
  v_mul_f32 v205, s29, v205
  v_mul_f32 v206, s29, v206
  v_mul_f32 v207, s29, v207
  v_cvt_pk_bf16_f32 v78, v204, v205
  v_cvt_pk_bf16_f32 v79, v206, v207
  v_mfma_f32_16x16x32_bf16 v[80:83], a[236:239], v[28:31], v[80:83]
  ds_read_b128 a[204:207], v2 offset:19456
  s_waitcnt vmcnt(0)
  v_cmp_ne_u32 vcc, 1, v3
  s_cbranch_vccnz K_PV_spin
K_PV_ok:
  s_barrier
  v_mfma_f32_16x16x32_bf16 v[88:91], a[236:239], v[44:47], v[88:91]
  s_lshl_b32 s36, s24, 11
  s_add_u32 m0, s36, 122880
  s_sub_u32 s36, s42, s36
  v_mfma_f32_16x16x32_bf16 v[96:99], a[236:239], v[60:63], v[96:99]
  s_add_u32 s36, s36, 16777216
  buffer_load_dwordx4 v1, s[20:23], s36 offen offset:0 sc1 lds
  v_mfma_f32_16x16x32_bf16 v[104:107], a[236:239], v[76:79], v[104:107]
  buffer_load_dwordx4 v1, s[20:23], s36 offen offset:1024 sc1 lds
  s_add_u32 m0, s46, 8192
  s_add_u32 s36, s42, 16785408
  v_mfma_f32_16x16x32_bf16 v[84:87], a[252:255], v[28:31], v[84:87]
  ds_read_b128 a[220:223], v2 offset:23552
  buffer_load_dwordx4 v1, s[20:23], s36 offen offset:0 sc1 lds
  v_mfma_f32_16x16x32_bf16 v[92:95], a[252:255], v[44:47], v[92:95]
  buffer_load_dwordx4 v1, s[20:23], s36 offen offset:1024 sc1 lds
  buffer_load_dwordx4 v1, s[20:23], s36 offen offset:2048 sc1 lds
  v_mfma_f32_16x16x32_bf16 v[100:103], a[252:255], v[60:63], v[100:103]
  buffer_load_dwordx4 v1, s[20:23], s36 offen offset:3072 sc1 lds
  s_add_u32 m0, s37, 32768
  s_mov_b32 s36, s43
  v_mfma_f32_16x16x32_bf16 v[108:111], a[252:255], v[76:79], v[108:111]
  buffer_load_dwordx4 v1, s[20:23], s36 offen offset:0 sc1 lds
  buffer_load_dwordx4 v1, s[20:23], s36 offen offset:1024 sc1 lds
  buffer_load_dwordx4 v1, s[20:23], s36 offen offset:2048 sc1 lds
  buffer_load_dwordx4 v1, s[20:23], s36 offen offset:3072 sc1 lds
  s_xor_b32 s37, s37, 0x10000
  v_max3_f32 v208, v82, v80, v81
  v_max3_f32 v209, v90, v88, v89
  v_max3_f32 v210, v98, v96, v97
  v_max3_f32 v211, v106, v104, v105
  v_max3_f32 v208, v208, v83, v84
  v_max3_f32 v209, v209, v91, v92
  v_max3_f32 v210, v210, v99, v100
  v_max3_f32 v211, v211, v107, v108
  v_max3_f32 v208, v208, v85, v86
  v_max3_f32 v209, v209, v93, v94
  v_max3_f32 v210, v210, v101, v102
  v_max3_f32 v211, v211, v109, v110
  v_max_f32 v208, v208, v87
  v_max_f32 v209, v209, v95
  v_max_f32 v210, v210, v103
  v_max_f32 v211, v211, v111
  v_mov_b32 v212, v208
  v_mov_b32 v213, v209
  v_mov_b32 v214, v210
  v_mov_b32 v215, v211
  v_permlane16_swap_b32 v208, v212
  v_permlane16_swap_b32 v209, v213
  v_permlane16_swap_b32 v210, v214
  v_permlane16_swap_b32 v211, v215
  v_max_f32 v208, v208, v212
  v_max_f32 v209, v209, v213
  v_max_f32 v210, v210, v214
  v_max_f32 v211, v211, v215
  v_mov_b32 v212, v208
  v_mov_b32 v213, v209
  v_mov_b32 v214, v210
  v_mov_b32 v215, v211
  v_permlane32_swap_b32 v208, v212
  v_permlane32_swap_b32 v209, v213
  v_permlane32_swap_b32 v210, v214
  v_permlane32_swap_b32 v211, v215
  v_max_f32 v208, v208, v212
  v_max_f32 v209, v209, v213
  v_max_f32 v210, v210, v214
  v_max_f32 v211, v211, v215
  v_sub_f32 v176, 0, v208
  v_sub_f32 v177, 0, v208
  v_sub_f32 v178, 0, v208
  v_sub_f32 v179, 0, v208
  v_sub_f32 v180, 0, v209
  v_sub_f32 v181, 0, v209
  v_sub_f32 v182, 0, v209
  v_sub_f32 v183, 0, v209
  v_sub_f32 v184, 0, v210
  v_sub_f32 v185, 0, v210
  v_sub_f32 v186, 0, v210
  v_sub_f32 v187, 0, v210
  v_sub_f32 v188, 0, v211
K_hA3_7:
  s_cbranch_execz K_hA3_8
  v_sub_f32 v189, 0, v211
  v_sub_f32 v190, 0, v211
  v_sub_f32 v191, 0, v211
  v_sub_f32 v80, v80, v208
  v_sub_f32 v81, v81, v208
  v_sub_f32 v82, v82, v208
  v_sub_f32 v83, v83, v208
  v_sub_f32 v84, v84, v208
  v_sub_f32 v85, v85, v208
  v_sub_f32 v86, v86, v208
  v_sub_f32 v87, v87, v208
  v_sub_f32 v88, v88, v209
  v_sub_f32 v89, v89, v209
  v_sub_f32 v90, v90, v209
  v_sub_f32 v91, v91, v209
  v_sub_f32 v92, v92, v209
  v_sub_f32 v93, v93, v209
  v_sub_f32 v94, v94, v209
  v_sub_f32 v95, v95, v209
  v_sub_f32 v96, v96, v210
  v_sub_f32 v97, v97, v210
  v_sub_f32 v98, v98, v210
  v_sub_f32 v99, v99, v210
  v_sub_f32 v100, v100, v210
  v_sub_f32 v101, v101, v210
  v_sub_f32 v102, v102, v210
  v_sub_f32 v103, v103, v210
  v_sub_f32 v104, v104, v211
  v_sub_f32 v105, v105, v211
  v_sub_f32 v106, v106, v211
  v_sub_f32 v107, v107, v211
  v_sub_f32 v108, v108, v211
  v_sub_f32 v109, v109, v211
  v_sub_f32 v110, v110, v211
  v_sub_f32 v111, v111, v211
K_go:
  v_mov_b32 v192, 0
  v_mov_b32 v196, 0
  v_mov_b32 v200, 0
  v_mov_b32 v201, 0
  v_mov_b32 v202, 0
  v_mov_b32 v203, 0
  v_mov_b32 v204, 0
  v_mov_b32 v205, 0
  v_mov_b32 v206, 0
  v_mov_b32 v207, 0
  s_cmp_lg_u32 s26, 0
  s_cbranch_scc1 K_I0F
  v_accvgpr_read_b32 v216, a136
  v_add_f32 v216, v176, v216
  v_accvgpr_read_b32 v217, a137
  v_add_f32 v217, v177, v217
  v_accvgpr_read_b32 v218, a138
  v_add_f32 v218, v178, v218
  v_accvgpr_read_b32 v219, a139
  v_add_f32 v219, v179, v219
  v_accvgpr_read_b32 v220, a140
  v_add_f32 v220, v176, v220
  v_accvgpr_read_b32 v221, a141
  v_add_f32 v221, v177, v221
  v_accvgpr_read_b32 v222, a142
  v_add_f32 v222, v178, v222
  v_accvgpr_read_b32 v223, a143
  v_add_f32 v223, v179, v223
  s_waitcnt lgkmcnt(0)
  v_mfma_f32_16x16x32_bf16 v[112:115], a[192:195], v[16:19], v[216:219]
  v_exp_f32 v208, v80
  v_mfma_f32_16x16x32_bf16 v[112:115], a[196:199], v[20:23], v[112:115]
  s_xor_b32 m0, s37, 0x1c000
  v_exp_f32 v209, v81
  v_mfma_f32_16x16x32_bf16 v[112:115], a[200:203], v[24:27], v[112:115]
  v_exp_f32 v210, v88
  v_mfma_f32_16x16x32_bf16 v[112:115], a[204:207], v[28:31], v[112:115]
  v_cvt_pk_bf16_f32 v144, v208, v209
  v_mfma_f32_16x16x32_bf16 v[120:123], a[204:207], v[44:47], v[180:183]
  v_exp_f32 v211, v89
  v_add_f32 v192, v192, v208
  v_add_f32 v192, v192, v209
  v_mfma_f32_16x16x32_bf16 v[120:123], a[200:203], v[40:43], v[120:123]
  v_exp_f32 v212, v96
  v_mfma_f32_16x16x32_bf16 v[120:123], a[196:199], v[36:39], v[120:123]
  buffer_load_dwordx4 v13, s[20:23], s36 offen offset:0 sc1 lds
  v_cvt_pk_bf16_f32 v148, v210, v211
  v_exp_f32 v213, v97
  v_add_f32 v196, v196, v210
  v_add_f32 v196, v196, v211
  v_mfma_f32_16x16x32_bf16 v[120:123], a[192:195], v[32:35], v[120:123]
  v_exp_f32 v214, v104
  v_mfma_f32_16x16x32_bf16 v[128:131], a[192:195], v[48:51], v[184:187]
  v_cvt_pk_bf16_f32 v152, v212, v213
  v_exp_f32 v215, v105
  v_mfma_f32_16x16x32_bf16 v[128:131], a[196:199], v[52:55], v[128:131]
  v_exp_f32 v208, v82
  v_mfma_f32_16x16x32_bf16 v[128:131], a[200:203], v[56:59], v[128:131]
  v_cvt_pk_bf16_f32 v156, v214, v215
  v_exp_f32 v209, v83
  v_mfma_f32_16x16x32_bf16 v[128:131], a[204:207], v[60:63], v[128:131]
  v_exp_f32 v210, v90
  v_mfma_f32_16x16x32_bf16 v[136:139], a[204:207], v[76:79], v[188:191]
  buffer_load_dwordx4 v13, s[20:23], s36 offen offset:1024 sc1 lds
  v_cvt_pk_bf16_f32 v145, v208, v209
  v_exp_f32 v211, v91
  v_add_f32 v192, v192, v208
  v_add_f32 v192, v192, v209
  v_mfma_f32_16x16x32_bf16 v[136:139], a[200:203], v[72:75], v[136:139]
  v_exp_f32 v212, v98
  v_mfma_f32_16x16x32_bf16 v[136:139], a[196:199], v[68:71], v[136:139]
  v_cvt_pk_bf16_f32 v149, v210, v211
  v_exp_f32 v213, v99
  v_add_f32 v196, v196, v210
  v_add_f32 v196, v196, v211
  v_mfma_f32_16x16x32_bf16 v[136:139], a[192:195], v[64:67], v[136:139]
  v_exp_f32 v214, v106
  v_mfma_f32_16x16x32_bf16 v[116:119], a[208:211], v[16:19], v[220:223]
  ds_read_b128 a[192:195], v2 offset:32768
  v_cvt_pk_bf16_f32 v153, v212, v213
  v_exp_f32 v215, v107
  v_mfma_f32_16x16x32_bf16 v[116:119], a[212:215], v[20:23], v[116:119]
  v_exp_f32 v208, v84
  v_mfma_f32_16x16x32_bf16 v[116:119], a[216:219], v[24:27], v[116:119]
  ds_read_b128 a[196:199], v2 offset:33792
  buffer_load_dwordx4 v13, s[20:23], s36 offen offset:2048 sc1 lds
  v_cvt_pk_bf16_f32 v157, v214, v215
  v_exp_f32 v209, v85
  v_mfma_f32_16x16x32_bf16 v[116:119], a[220:223], v[28:31], v[116:119]
  v_exp_f32 v210, v92
  v_mfma_f32_16x16x32_bf16 v[124:127], a[220:223], v[44:47], v[180:183]
  ds_read_b128 a[200:203], v2 offset:34816
  v_cvt_pk_bf16_f32 v146, v208, v209
  v_exp_f32 v211, v93
  v_add_f32 v192, v192, v208
  v_add_f32 v192, v192, v209
  v_mfma_f32_16x16x32_bf16 v[124:127], a[216:219], v[40:43], v[124:127]
  v_exp_f32 v212, v100
  v_mfma_f32_16x16x32_bf16 v[124:127], a[212:215], v[36:39], v[124:127]
  ds_read_b128 a[204:207], v2 offset:35840
  v_cvt_pk_bf16_f32 v150, v210, v211
  v_exp_f32 v213, v101
  v_add_f32 v196, v196, v210
  v_add_f32 v196, v196, v211
  v_mfma_f32_16x16x32_bf16 v[124:127], a[208:211], v[32:35], v[124:127]
  v_exp_f32 v214, v108
  v_accvgpr_read_b32 v216, a128
  v_add_f32 v216, v180, v216
  v_mfma_f32_16x16x32_bf16 v[132:135], a[208:211], v[48:51], v[184:187]
  buffer_load_dwordx4 v13, s[20:23], s36 offen offset:3072 sc1 lds
  v_cvt_pk_bf16_f32 v154, v212, v213
  v_exp_f32 v215, v109
  v_accvgpr_read_b32 v217, a129
  v_add_f32 v217, v181, v217
  v_mfma_f32_16x16x32_bf16 v[132:135], a[212:215], v[52:55], v[132:135]
  v_exp_f32 v208, v86
  v_accvgpr_read_b32 v218, a130
  v_add_f32 v218, v182, v218
  v_mfma_f32_16x16x32_bf16 v[132:135], a[216:219], v[56:59], v[132:135]
  v_cvt_pk_bf16_f32 v158, v214, v215
  v_exp_f32 v209, v87
  v_accvgpr_read_b32 v219, a131
  v_add_f32 v219, v183, v219
  v_mfma_f32_16x16x32_bf16 v[132:135], a[220:223], v[60:63], v[132:135]
  v_exp_f32 v210, v94
  v_accvgpr_read_b32 v220, a132
  v_mfma_f32_16x16x32_bf16 v[140:143], a[220:223], v[76:79], v[188:191]
  v_cvt_pk_bf16_f32 v147, v208, v209
  v_exp_f32 v211, v95
  v_add_f32 v192, v192, v208
  v_add_f32 v192, v192, v209
  v_add_f32 v220, v180, v220
  v_accvgpr_read_b32 v221, a133
  v_mfma_f32_16x16x32_bf16 v[140:143], a[216:219], v[72:75], v[140:143]
  v_exp_f32 v212, v102
  v_add_f32 v221, v181, v221
  v_accvgpr_read_b32 v222, a134
  v_mfma_f32_16x16x32_bf16 v[140:143], a[212:215], v[68:71], v[140:143]
  v_cvt_pk_bf16_f32 v151, v210, v211
  v_exp_f32 v213, v103
  v_add_f32 v196, v196, v210
  v_add_f32 v196, v196, v211
  v_add_f32 v222, v182, v222
  v_accvgpr_read_b32 v223, a135
  v_mfma_f32_16x16x32_bf16 v[140:143], a[208:211], v[64:67], v[140:143]
  ds_read_b128 a[208:211], v2 offset:36864
  ds_read_b128 a[212:215], v2 offset:37888
  ds_read_b128 a[216:219], v2 offset:38912
  ds_read_b128 a[220:223], v2 offset:39936
  v_exp_f32 v214, v110
  v_cvt_pk_bf16_f32 v155, v212, v213
  v_exp_f32 v215, v111
  s_nop 0
  v_cvt_pk_bf16_f32 v159, v214, v215
  v_add_f32 v223, v183, v223
  s_waitcnt vmcnt(8) lgkmcnt(4)
  s_barrier
  v_mfma_f32_16x16x32_bf16 v[88:91], a[192:195], v[32:35], v[216:219]
  v_exp_f32 v208, v112
  v_mfma_f32_16x16x32_bf16 v[88:91], a[196:199], v[36:39], v[88:91]
  s_mov_b32 m0, s37
  v_exp_f32 v209, v113
  v_mfma_f32_16x16x32_bf16 v[88:91], a[200:203], v[40:43], v[88:91]
  buffer_load_dwordx4 v14, s[20:23], s36 offen offset:0 sc1 lds
  v_exp_f32 v210, v120
  v_mfma_f32_16x16x32_bf16 v[88:91], a[204:207], v[44:47], v[88:91]
  buffer_load_dwordx4 v14, s[20:23], s36 offen offset:1024 sc1 lds
  v_cvt_pk_bf16_f32 v160, v208, v209
  v_exp_f32 v211, v121
  v_add_f32 v192, v192, v208
  v_add_f32 v192, v192, v209
  v_mfma_f32_16x16x32_bf16 v[96:99], a[204:207], v[60:63], v[184:187]
  buffer_load_dwordx4 v14, s[20:23], s36 offen offset:2048 sc1 lds
  v_exp_f32 v212, v128
  v_mfma_f32_16x16x32_bf16 v[96:99], a[200:203], v[56:59], v[96:99]
  buffer_load_dwordx4 v14, s[20:23], s36 offen offset:3072 sc1 lds
  v_cvt_pk_bf16_f32 v164, v210, v211
  v_exp_f32 v213, v129
  v_add_f32 v196, v196, v210
  v_add_f32 v196, v196, v211
  v_exp_f32 v214, v136
  v_mfma_f32_16x16x32_bf16 v[96:99], a[196:199], v[52:55], v[96:99]
  s_and_b32 s92, s24, 1
  v_cvt_pk_bf16_f32 v168, v212, v213
  v_exp_f32 v215, v137
  v_mfma_f32_16x16x32_bf16 v[96:99], a[192:195], v[48:51], v[96:99]
  s_lshl_b32 s92, s92, 11
  v_exp_f32 v208, v114
  v_mfma_f32_16x16x32_bf16 v[104:107], a[192:195], v[64:67], v[188:191]
  s_mul_i32 s93, s3, 4224
  v_cvt_pk_bf16_f32 v172, v214, v215
  v_exp_f32 v209, v115
  v_exp_f32 v210, v122
  v_mfma_f32_16x16x32_bf16 v[104:107], a[196:199], v[68:71], v[104:107]
  s_add_u32 s93, s93, 56623104
  v_cvt_pk_bf16_f32 v161, v208, v209
  v_exp_f32 v211, v123
  v_add_f32 v192, v192, v208
  v_add_f32 v192, v192, v209
  v_mfma_f32_16x16x32_bf16 v[104:107], a[200:203], v[72:75], v[104:107]
  s_add_u32 s93, s93, s92
  v_exp_f32 v212, v130
  v_mfma_f32_16x16x32_bf16 v[104:107], a[204:207], v[76:79], v[104:107]
  s_waitcnt lgkmcnt(0)
  v_cvt_pk_bf16_f32 v165, v210, v211
  v_exp_f32 v213, v131
  v_add_f32 v196, v196, v210
  v_add_f32 v196, v196, v211
  v_exp_f32 v214, v138
  v_mfma_f32_16x16x32_bf16 v[92:95], a[208:211], v[32:35], v[220:223]
  ds_read_b128 a[192:195], v2 offset:49152
  s_add_u32 m0, s33, s92
  v_cvt_pk_bf16_f32 v169, v212, v213
  v_exp_f32 v215, v139
  v_mfma_f32_16x16x32_bf16 v[92:95], a[212:215], v[36:39], v[92:95]
  buffer_load_dwordx4 v1, s[20:23], s93 offen offset:0 sc1 lds
  v_exp_f32 v208, v116
  v_mfma_f32_16x16x32_bf16 v[92:95], a[216:219], v[40:43], v[92:95]
  ds_read_b128 a[196:199], v2 offset:50176
  buffer_load_dwordx4 v1, s[20:23], s93 offen offset:1024 sc1 lds
  v_cvt_pk_bf16_f32 v173, v214, v215
  v_exp_f32 v209, v117
  v_exp_f32 v210, v124
  v_mfma_f32_16x16x32_bf16 v[92:95], a[220:223], v[44:47], v[92:95]
  s_lshl_b32 s93, s3, 12
  v_cvt_pk_bf16_f32 v162, v208, v209
  v_exp_f32 v211, v125
  v_add_f32 v192, v192, v208
  v_add_f32 v192, v192, v209
  v_mfma_f32_16x16x32_bf16 v[100:103], a[220:223], v[60:63], v[184:187]
  ds_read_b128 a[200:203], v2 offset:51200
  s_add_u32 s93, s93, s92
  v_exp_f32 v212, v132
  v_mfma_f32_16x16x32_bf16 v[100:103], a[216:219], v[56:59], v[100:103]
  s_add_u32 s92, s92, 8832
  v_cvt_pk_bf16_f32 v166, v210, v211
  v_exp_f32 v213, v133
  v_add_f32 v196, v196, v210
  v_add_f32 v196, v196, v211
  v_exp_f32 v214, v140
  v_mfma_f32_16x16x32_bf16 v[100:103], a[212:215], v[52:55], v[100:103]
  ds_read_b128 a[204:207], v2 offset:52224
  s_add_u32 m0, s33, s92
  v_cvt_pk_bf16_f32 v170, v212, v213
  v_exp_f32 v215, v141
  v_accvgpr_read_b32 v216, a136
  v_add_f32 v216, v180, v216
  v_accvgpr_read_b32 v217, a137
  v_mfma_f32_16x16x32_bf16 v[100:103], a[208:211], v[48:51], v[100:103]
  buffer_load_dwordx4 v1, s[60:63], s93 offen offset:0 lds
  v_exp_f32 v208, v118
  v_add_f32 v217, v181, v217
  v_accvgpr_read_b32 v218, a138
  v_add_f32 v218, v182, v218
  v_mfma_f32_16x16x32_bf16 v[108:111], a[208:211], v[64:67], v[188:191]
  buffer_load_dwordx4 v1, s[60:63], s93 offen offset:1024 lds
  v_cvt_pk_bf16_f32 v174, v214, v215
  v_exp_f32 v209, v119
  v_exp_f32 v210, v126
  v_accvgpr_read_b32 v219, a139
  v_add_f32 v219, v183, v219
  v_mfma_f32_16x16x32_bf16 v[108:111], a[212:215], v[68:71], v[108:111]
  v_cvt_pk_bf16_f32 v163, v208, v209
  v_exp_f32 v211, v127
  v_add_f32 v192, v192, v208
  v_add_f32 v192, v192, v209
  v_accvgpr_read_b32 v220, a140
  v_add_f32 v220, v180, v220
  v_accvgpr_read_b32 v221, a141
  v_mfma_f32_16x16x32_bf16 v[108:111], a[216:219], v[72:75], v[108:111]
  v_exp_f32 v212, v134
  v_add_f32 v221, v181, v221
  v_accvgpr_read_b32 v222, a142
  v_add_f32 v222, v182, v222
  v_mfma_f32_16x16x32_bf16 v[108:111], a[220:223], v[76:79], v[108:111]
  ds_read_b128 a[208:211], v2 offset:53248
  ds_read_b128 a[212:215], v2 offset:54272
  ds_read_b128 a[216:219], v2 offset:55296
  ds_read_b128 a[220:223], v2 offset:56320
  ds_read_b128 a[224:227], v2 offset:57344
  ds_read_b128 a[228:231], v2 offset:58368
  ds_read_b128 a[232:235], v2 offset:59392
  ds_read_b128 a[236:239], v2 offset:60416
  v_cvt_pk_bf16_f32 v167, v210, v211
  v_exp_f32 v213, v135
  v_add_f32 v196, v196, v210
  v_add_f32 v196, v196, v211
  v_exp_f32 v214, v142
  v_cvt_pk_bf16_f32 v171, v212, v213
  v_exp_f32 v215, v143
  s_nop 0
  v_cvt_pk_bf16_f32 v175, v214, v215
  v_accvgpr_read_b32 v223, a143
  v_add_f32 v223, v183, v223
K_T3:
K_hA0_8:
  s_cbranch_execz K_hA0_9
  s_waitcnt lgkmcnt(4)
  v_mfma_f32_16x16x32_bf16 v[120:123], a[192:195], v[32:35], v[216:219]
  v_exp_f32 v208, v88
  v_mfma_f32_16x16x32_bf16 v[120:123], a[196:199], v[36:39], v[120:123]
  ds_read_b128 a[240:243], v2 offset:61440
  s_xor_b32 m0, s37, 0x4000
  v_mfma_f32_16x16x32_bf16 v[120:123], a[200:203], v[40:43], v[120:123]
  v_exp_f32 v209, v89
  v_mfma_f32_16x16x32_bf16 v[120:123], a[204:207], v[44:47], v[120:123]
  v_mfma_f32_16x16x32_bf16 v[128:131], a[204:207], v[60:63], v[184:187]
  v_exp_f32 v210, v96
  v_mfma_f32_16x16x32_bf16 v[128:131], a[200:203], v[56:59], v[128:131]
  ds_read_b128 a[244:247], v2 offset:62464
  v_cvt_pk_bf16_f32 v8, v208, v209
  v_mfma_f32_16x16x32_bf16 v[128:131], a[196:199], v[52:55], v[128:131]
  ds_read_b128 a[248:251], v2 offset:63488
  buffer_load_dwordx4 v15, s[20:23], s36 offen offset:0 sc1 lds
  v_mfma_f32_16x16x32_bf16 v[128:131], a[192:195], v[48:51], v[128:131]
  v_exp_f32 v211, v97
  v_mfma_f32_16x16x32_bf16 v[136:139], a[192:195], v[64:67], v[188:191]
  v_add_f32 v196, v196, v208
  v_add_f32 v196, v196, v209
  v_mfma_f32_16x16x32_bf16 v[136:139], a[196:199], v[68:71], v[136:139]
  v_exp_f32 v212, v104
  v_mfma_f32_16x16x32_bf16 v[136:139], a[200:203], v[72:75], v[136:139]
  ds_read_b128 a[252:255], v2 offset:64512
  v_cvt_pk_bf16_f32 v224, v210, v211
  v_mfma_f32_16x16x32_bf16 v[136:139], a[204:207], v[76:79], v[136:139]
  v_exp_f32 v213, v105
  v_mfma_f32_16x16x32_bf16 v[124:127], a[208:211], v[32:35], v[220:223]
  v_xor_b32 v2, 0x10000, v2
  v_mfma_f32_16x16x32_bf16 v[124:127], a[212:215], v[36:39], v[124:127]
  ds_read_b128 a[192:195], v2 offset:0
  v_mfma_f32_16x16x32_bf16 v[124:127], a[216:219], v[40:43], v[124:127]
  v_exp_f32 v214, v90
  v_mfma_f32_16x16x32_bf16 v[124:127], a[220:223], v[44:47], v[124:127]
  v_cvt_pk_bf16_f32 v228, v212, v213
  v_mfma_f32_16x16x32_bf16 v[132:135], a[220:223], v[60:63], v[184:187]
  v_exp_f32 v215, v91
  v_mfma_f32_16x16x32_bf16 v[132:135], a[216:219], v[56:59], v[132:135]
  ds_read_b128 a[196:199], v2 offset:1024
  buffer_load_dwordx4 v15, s[20:23], s36 offen offset:1024 sc1 lds
  v_mfma_f32_16x16x32_bf16 v[132:135], a[212:215], v[52:55], v[132:135]
  v_exp_f32 v208, v98
  v_mfma_f32_16x16x32_bf16 v[132:135], a[208:211], v[48:51], v[132:135]
  ds_read_b128 a[200:203], v2 offset:2048
  v_cvt_pk_bf16_f32 v9, v214, v215
  v_mfma_f32_16x16x32_bf16 v[140:143], a[208:211], v[64:67], v[188:191]
  v_accvgpr_read_b32 v216, a128
  v_add_f32 v216, v184, v216
  v_mfma_f32_16x16x32_bf16 v[140:143], a[212:215], v[68:71], v[140:143]
  v_exp_f32 v209, v99
  v_mfma_f32_16x16x32_bf16 v[140:143], a[216:219], v[72:75], v[140:143]
  v_add_f32 v196, v196, v214
  v_add_f32 v196, v196, v215
  v_mfma_f32_16x16x32_bf16 v[140:143], a[220:223], v[76:79], v[140:143]
  s_waitcnt lgkmcnt(3)
  v_exp_f32 v210, v106
  v_mfma_f32_16x16x32_bf16 a[0:3], a[224:227], v[144:147], a[0:3]
  ds_read_b128 a[204:207], v2 offset:3072
  v_cvt_pk_bf16_f32 v225, v208, v209
  v_mfma_f32_16x16x32_bf16 a[0:3], a[228:231], v[160:163], a[0:3]
  v_exp_f32 v211, v107
  v_mfma_f32_16x16x32_bf16 a[32:35], a[228:231], v[164:167], a[32:35]
  ds_read_b128 a[208:211], v2 offset:4096
  buffer_load_dwordx4 v15, s[20:23], s36 offen offset:2048 sc1 lds
  v_mfma_f32_16x16x32_bf16 a[32:35], a[224:227], v[148:151], a[32:35]
  v_accvgpr_read_b32 v217, a129
  v_add_f32 v217, v185, v217
  v_mfma_f32_16x16x32_bf16 a[64:67], a[224:227], v[152:155], a[64:67]
  v_exp_f32 v212, v92
  v_mfma_f32_16x16x32_bf16 a[64:67], a[228:231], v[168:171], a[64:67]
  ds_read_b128 a[212:215], v2 offset:5120
  v_cvt_pk_bf16_f32 v229, v210, v211
  v_mfma_f32_16x16x32_bf16 a[96:99], a[228:231], v[172:175], a[96:99]
  v_exp_f32 v213, v93
  v_mfma_f32_16x16x32_bf16 a[96:99], a[224:227], v[156:159], a[96:99]
  buffer_load_dwordx4 v15, s[20:23], s36 offen offset:3072 sc1 lds
  v_accvgpr_read_b32 v218, a130
  v_mfma_f32_16x16x32_bf16 a[100:103], a[232:235], v[156:159], a[100:103]
  v_exp_f32 v214, v100
  v_mfma_f32_16x16x32_bf16 a[100:103], a[236:239], v[172:175], a[100:103]
  ds_read_b128 a[216:219], v2 offset:6144
  v_cvt_pk_bf16_f32 v10, v212, v213
  v_mfma_f32_16x16x32_bf16 a[68:71], a[236:239], v[168:171], a[68:71]
  v_add_f32 v218, v186, v218
  v_accvgpr_read_b32 v219, a131
  v_mfma_f32_16x16x32_bf16 a[68:71], a[232:235], v[152:155], a[68:71]
  v_exp_f32 v215, v101
  v_mfma_f32_16x16x32_bf16 a[36:39], a[232:235], v[148:151], a[36:39]
  v_add_f32 v196, v196, v212
  v_add_f32 v196, v196, v213
  v_mfma_f32_16x16x32_bf16 a[36:39], a[236:239], v[164:167], a[36:39]
  v_exp_f32 v208, v108
  v_mfma_f32_16x16x32_bf16 a[4:7], a[236:239], v[160:163], a[4:7]
  ds_read_b128 a[220:223], v2 offset:7168
  v_cvt_pk_bf16_f32 v226, v214, v215
  v_mfma_f32_16x16x32_bf16 a[4:7], a[232:235], v[144:147], a[4:7]
  v_exp_f32 v209, v109
  v_mfma_f32_16x16x32_bf16 a[8:11], a[240:243], v[144:147], a[8:11]
  s_add_u32 s36, s36, 32768
  v_add_f32 v219, v187, v219
  v_accvgpr_read_b32 v220, a132
  v_mfma_f32_16x16x32_bf16 a[8:11], a[244:247], v[160:163], a[8:11]
  ds_read_b128 a[224:227], v2 offset:8192
  v_add_f32 v220, v184, v220
  v_mfma_f32_16x16x32_bf16 a[40:43], a[244:247], v[164:167], a[40:43]
  v_exp_f32 v210, v94
  v_mfma_f32_16x16x32_bf16 a[40:43], a[240:243], v[148:151], a[40:43]
  v_cvt_pk_bf16_f32 v230, v208, v209
  v_accvgpr_read_b32 v221, a133
  v_mfma_f32_16x16x32_bf16 a[72:75], a[240:243], v[152:155], a[72:75]
  v_exp_f32 v211, v95
  v_mfma_f32_16x16x32_bf16 a[72:75], a[244:247], v[168:171], a[72:75]
  ds_read_b128 a[228:231], v2 offset:9216
  v_add_f32 v221, v185, v221
  v_mfma_f32_16x16x32_bf16 a[104:107], a[244:247], v[172:175], a[104:107]
  v_exp_f32 v212, v102
  v_mfma_f32_16x16x32_bf16 a[104:107], a[240:243], v[156:159], a[104:107]
  v_cvt_pk_bf16_f32 v11, v210, v211
  v_mfma_f32_16x16x32_bf16 a[108:111], a[248:251], v[156:159], a[108:111]
  ds_read_b128 a[232:235], v2 offset:10240
  s_xor_b32 s37, s37, 0x10000
  v_accvgpr_read_b32 v222, a134
  v_mfma_f32_16x16x32_bf16 a[108:111], a[252:255], v[172:175], a[108:111]
  v_exp_f32 v213, v103
  v_mfma_f32_16x16x32_bf16 a[76:79], a[252:255], v[168:171], a[76:79]
  v_add_f32 v196, v196, v210
  v_add_f32 v196, v196, v211
  v_mfma_f32_16x16x32_bf16 a[76:79], a[248:251], v[152:155], a[76:79]
  v_exp_f32 v214, v110
  v_mfma_f32_16x16x32_bf16 a[44:47], a[248:251], v[148:151], a[44:47]
  v_cvt_pk_bf16_f32 v227, v212, v213
  v_add_f32 v222, v186, v222
  v_mfma_f32_16x16x32_bf16 a[44:47], a[252:255], v[164:167], a[44:47]
  v_exp_f32 v215, v111
  v_mfma_f32_16x16x32_bf16 a[12:15], a[252:255], v[160:163], a[12:15]
  ds_read_b128 a[236:239], v2 offset:11264
  v_accvgpr_read_b32 v223, a135
  v_mfma_f32_16x16x32_bf16 a[12:15], a[248:251], v[144:147], a[12:15]
  v_add_f32 v223, v187, v223
  v_mfma_f32_16x16x32_bf16 v[200:203], v[240:243], v[152:155], v[200:203]
  v_cvt_pk_bf16_f32 v231, v214, v215
  v_mfma_f32_16x16x32_bf16 v[200:203], v[240:243], v[168:171], v[200:203]
  s_cmp_eq_u32 s26, 7
  s_cbranch_scc1 K_FP
  s_sub_u32 s39, 6, s26
  s_waitcnt vmcnt(12) lgkmcnt(4)
  s_barrier
  v_mfma_f32_16x16x32_bf16 v[96:99], a[192:195], v[48:51], v[184:187]
  v_exp_f32 v208, v120
  v_mfma_f32_16x16x32_bf16 v[96:99], a[196:199], v[52:55], v[96:99]
  ds_read_b128 a[240:243], v2 offset:12288
  s_xor_b32 m0, s37, 0x18000
  v_mfma_f32_16x16x32_bf16 v[96:99], a[200:203], v[56:59], v[96:99]
  v_exp_f32 v209, v121
  v_mfma_f32_16x16x32_bf16 v[96:99], a[204:207], v[60:63], v[96:99]
  ds_read_b128 a[244:247], v2 offset:13312
  v_mfma_f32_16x16x32_bf16 v[104:107], a[204:207], v[76:79], v[188:191]
  v_exp_f32 v210, v128
  v_mfma_f32_16x16x32_bf16 v[104:107], a[200:203], v[72:75], v[104:107]
  ds_read_b128 a[248:251], v2 offset:14336
  v_cvt_pk_bf16_f32 v248, v208, v209
  v_mfma_f32_16x16x32_bf16 v[104:107], a[196:199], v[68:71], v[104:107]
  v_exp_f32 v211, v129
  v_mfma_f32_16x16x32_bf16 v[104:107], a[192:195], v[64:67], v[104:107]
  v_add_f32 v196, v196, v208
  v_add_f32 v196, v196, v209
  v_mfma_f32_16x16x32_bf16 v[100:103], a[208:211], v[48:51], v[184:187]
  v_exp_f32 v212, v136
  v_mfma_f32_16x16x32_bf16 v[100:103], a[212:215], v[52:55], v[100:103]
  ds_read_b128 a[252:255], v2 offset:15360
  v_cvt_pk_bf16_f32 v232, v210, v211
  v_mfma_f32_16x16x32_bf16 v[100:103], a[216:219], v[56:59], v[100:103]
  v_exp_f32 v213, v137
  v_mfma_f32_16x16x32_bf16 v[100:103], a[220:223], v[60:63], v[100:103]
  ds_read_b128 a[192:195], v2 offset:16384
  ds_read_b128 a[196:199], v2 offset:17408
  v_mfma_f32_16x16x32_bf16 v[108:111], a[220:223], v[76:79], v[188:191]
  v_exp_f32 v214, v122
  v_mfma_f32_16x16x32_bf16 v[108:111], a[216:219], v[72:75], v[108:111]
  ds_read_b128 a[200:203], v2 offset:18432
  v_cvt_pk_bf16_f32 v236, v212, v213
  v_mfma_f32_16x16x32_bf16 v[108:111], a[212:215], v[68:71], v[108:111]
  v_exp_f32 v215, v123
  v_mfma_f32_16x16x32_bf16 v[108:111], a[208:211], v[64:67], v[108:111]
  ds_read_b128 a[204:207], v2 offset:19456
  buffer_load_dwordx4 v1, s[20:23], s36 offen offset:0 sc1 lds
  s_waitcnt lgkmcnt(4)
  v_mfma_f32_16x16x32_bf16 a[16:19], a[224:227], v[144:147], a[16:19]
  v_exp_f32 v208, v130
  v_mfma_f32_16x16x32_bf16 a[16:19], a[228:231], v[160:163], a[16:19]
  ds_read_b128 a[208:211], v2 offset:20480
  v_cvt_pk_bf16_f32 v249, v214, v215
  v_mfma_f32_16x16x32_bf16 a[48:51], a[228:231], v[164:167], a[48:51]
  v_exp_f32 v209, v131
  v_mfma_f32_16x16x32_bf16 a[48:51], a[224:227], v[148:151], a[48:51]
  v_add_f32 v196, v196, v214
  v_add_f32 v196, v196, v215
  v_mfma_f32_16x16x32_bf16 a[80:83], a[224:227], v[152:155], a[80:83]
  v_exp_f32 v210, v138
  v_mfma_f32_16x16x32_bf16 a[80:83], a[228:231], v[168:171], a[80:83]
  ds_read_b128 a[212:215], v2 offset:21504
  v_cvt_pk_bf16_f32 v233, v208, v209
  v_mfma_f32_16x16x32_bf16 a[112:115], a[228:231], v[172:175], a[112:115]
  v_exp_f32 v211, v139
  v_mfma_f32_16x16x32_bf16 a[112:115], a[224:227], v[156:159], a[112:115]
  buffer_load_dwordx4 v1, s[20:23], s36 offen offset:1024 sc1 lds
  v_mfma_f32_16x16x32_bf16 a[116:119], a[232:235], v[156:159], a[116:119]
  v_exp_f32 v212, v124
  v_mfma_f32_16x16x32_bf16 a[116:119], a[236:239], v[172:175], a[116:119]
  ds_read_b128 a[216:219], v2 offset:22528
  v_cvt_pk_bf16_f32 v237, v210, v211
  v_mfma_f32_16x16x32_bf16 a[84:87], a[236:239], v[168:171], a[84:87]
  v_exp_f32 v213, v125
  v_mfma_f32_16x16x32_bf16 a[84:87], a[232:235], v[152:155], a[84:87]
  buffer_load_dwordx4 v1, s[20:23], s36 offen offset:2048 sc1 lds
  v_mfma_f32_16x16x32_bf16 a[52:55], a[232:235], v[148:151], a[52:55]
  v_exp_f32 v214, v132
  v_mfma_f32_16x16x32_bf16 a[52:55], a[236:239], v[164:167], a[52:55]
  ds_read_b128 a[220:223], v2 offset:23552
  v_cvt_pk_bf16_f32 v250, v212, v213
  v_mfma_f32_16x16x32_bf16 a[20:23], a[236:239], v[160:163], a[20:23]
  v_exp_f32 v215, v133
  v_mfma_f32_16x16x32_bf16 a[20:23], a[232:235], v[144:147], a[20:23]
  v_add_f32 v196, v196, v212
  v_add_f32 v196, v196, v213
  v_mfma_f32_16x16x32_bf16 a[24:27], a[240:243], v[144:147], a[24:27]
  v_exp_f32 v208, v140
  v_mfma_f32_16x16x32_bf16 a[24:27], a[244:247], v[160:163], a[24:27]
  ds_read_b128 a[224:227], v2 offset:24576
  v_cvt_pk_bf16_f32 v234, v214, v215
  v_mfma_f32_16x16x32_bf16 a[56:59], a[244:247], v[164:167], a[56:59]
  v_exp_f32 v209, v141
  v_mfma_f32_16x16x32_bf16 a[56:59], a[240:243], v[148:151], a[56:59]
  v_mfma_f32_16x16x32_bf16 a[88:91], a[240:243], v[152:155], a[88:91]
  v_exp_f32 v210, v126
  v_mfma_f32_16x16x32_bf16 a[88:91], a[244:247], v[168:171], a[88:91]
  ds_read_b128 a[228:231], v2 offset:25600
  v_cvt_pk_bf16_f32 v238, v208, v209
  v_mfma_f32_16x16x32_bf16 a[120:123], a[244:247], v[172:175], a[120:123]
  v_exp_f32 v211, v127
  v_mfma_f32_16x16x32_bf16 a[120:123], a[240:243], v[156:159], a[120:123]
  buffer_load_dwordx4 v1, s[20:23], s36 offen offset:3072 sc1 lds
  v_mfma_f32_16x16x32_bf16 a[124:127], a[248:251], v[156:159], a[124:127]
  v_exp_f32 v212, v134
  v_mfma_f32_16x16x32_bf16 a[124:127], a[252:255], v[172:175], a[124:127]
  ds_read_b128 a[232:235], v2 offset:26624
  v_cvt_pk_bf16_f32 v251, v210, v211
  v_mfma_f32_16x16x32_bf16 a[92:95], a[252:255], v[168:171], a[92:95]
  v_exp_f32 v213, v135
  v_mfma_f32_16x16x32_bf16 a[92:95], a[248:251], v[152:155], a[92:95]
  v_add_f32 v196, v196, v210
  v_add_f32 v196, v196, v211
  v_mfma_f32_16x16x32_bf16 a[60:63], a[248:251], v[148:151], a[60:63]
  v_exp_f32 v214, v142
  v_mfma_f32_16x16x32_bf16 a[60:63], a[252:255], v[164:167], a[60:63]
  ds_read_b128 a[236:239], v2 offset:27648
  v_cvt_pk_bf16_f32 v235, v212, v213
  v_mfma_f32_16x16x32_bf16 a[28:31], a[252:255], v[160:163], a[28:31]
  v_exp_f32 v215, v143
  v_mfma_f32_16x16x32_bf16 a[28:31], a[248:251], v[144:147], a[28:31]
  v_mfma_f32_16x16x32_bf16 v[204:207], v[240:243], v[156:159], v[204:207]
  v_cvt_pk_bf16_f32 v239, v214, v215
  v_mfma_f32_16x16x32_bf16 v[204:207], v[240:243], v[172:175], v[204:207]
  s_waitcnt lgkmcnt(4)
  v_mfma_f32_16x16x32_bf16 v[128:131], a[192:195], v[48:51], v[184:187]
  v_exp_f32 v208, v96
  v_mfma_f32_16x16x32_bf16 v[128:131], a[196:199], v[52:55], v[128:131]
  ds_read_b128 a[240:243], v2 offset:28672
  s_xor_b32 m0, s37, 0x1c000
  v_mfma_f32_16x16x32_bf16 v[128:131], a[200:203], v[56:59], v[128:131]
  v_exp_f32 v209, v97
  v_mfma_f32_16x16x32_bf16 v[128:131], a[204:207], v[60:63], v[128:131]
  ds_read_b128 a[244:247], v2 offset:29696
  v_mfma_f32_16x16x32_bf16 v[136:139], a[204:207], v[76:79], v[188:191]
  v_mfma_f32_16x16x32_bf16 v[136:139], a[200:203], v[72:75], v[136:139]
  v_exp_f32 v210, v104
  v_mfma_f32_16x16x32_bf16 v[136:139], a[196:199], v[68:71], v[136:139]
  ds_read_b128 a[248:251], v2 offset:30720
  v_cvt_pk_bf16_f32 v152, v208, v209
  v_mfma_f32_16x16x32_bf16 v[136:139], a[192:195], v[64:67], v[136:139]
  v_exp_f32 v211, v105
  v_mfma_f32_16x16x32_bf16 v[132:135], a[208:211], v[48:51], v[184:187]
  ds_read_b128 a[252:255], v2 offset:31744
  buffer_load_dwordx4 v13, s[20:23], s36 offen offset:0 sc1 lds
  v_mfma_f32_16x16x32_bf16 v[132:135], a[212:215], v[52:55], v[132:135]
  ds_read_b128 a[192:195], v2 offset:32768
  v_mfma_f32_16x16x32_bf16 v[132:135], a[216:219], v[56:59], v[132:135]
  v_exp_f32 v212, v98
  v_mfma_f32_16x16x32_bf16 v[132:135], a[220:223], v[60:63], v[132:135]
  ds_read_b128 a[196:199], v2 offset:33792
  v_cvt_pk_bf16_f32 v156, v210, v211
  v_mfma_f32_16x16x32_bf16 v[140:143], a[220:223], v[76:79], v[188:191]
  v_exp_f32 v213, v99
  v_mfma_f32_16x16x32_bf16 v[140:143], a[216:219], v[72:75], v[140:143]
  ds_read_b128 a[200:203], v2 offset:34816
  v_mfma_f32_16x16x32_bf16 v[140:143], a[212:215], v[68:71], v[140:143]
  v_mfma_f32_16x16x32_bf16 v[140:143], a[208:211], v[64:67], v[140:143]
  s_waitcnt lgkmcnt(3)
  v_exp_f32 v214, v106
  v_mfma_f32_16x16x32_bf16 a[32:35], a[224:227], v[8:11], a[32:35]
  ds_read_b128 a[204:207], v2 offset:35840
  v_cvt_pk_bf16_f32 v153, v212, v213
  v_mfma_f32_16x16x32_bf16 a[32:35], a[228:231], v[248:251], a[32:35]
  v_exp_f32 v215, v107
  v_mfma_f32_16x16x32_bf16 a[64:67], a[228:231], v[232:235], a[64:67]
  ds_read_b128 a[208:211], v2 offset:36864
  buffer_load_dwordx4 v13, s[20:23], s36 offen offset:1024 sc1 lds
  v_mfma_f32_16x16x32_bf16 a[64:67], a[224:227], v[224:227], a[64:67]
  v_mfma_f32_16x16x32_bf16 a[96:99], a[224:227], v[228:231], a[96:99]
  v_exp_f32 v208, v100
  v_mfma_f32_16x16x32_bf16 a[96:99], a[228:231], v[236:239], a[96:99]
  ds_read_b128 a[212:215], v2 offset:37888
  v_cvt_pk_bf16_f32 v157, v214, v215
  v_mfma_f32_16x16x32_bf16 a[100:103], a[232:235], v[228:231], a[100:103]
  v_exp_f32 v209, v101
  v_mfma_f32_16x16x32_bf16 a[100:103], a[236:239], v[236:239], a[100:103]
  ds_read_b128 a[216:219], v2 offset:38912
K_hA1_8:
  s_cbranch_execz K_hA1_9
  v_mfma_f32_16x16x32_bf16 a[68:71], a[236:239], v[232:235], a[68:71]
  buffer_load_dwordx4 v13, s[20:23], s36 offen offset:2048 sc1 lds
  v_mfma_f32_16x16x32_bf16 a[68:71], a[232:235], v[224:227], a[68:71]
  v_exp_f32 v210, v108
  v_mfma_f32_16x16x32_bf16 a[36:39], a[232:235], v[8:11], a[36:39]
  ds_read_b128 a[220:223], v2 offset:39936
  v_cvt_pk_bf16_f32 v154, v208, v209
  v_mfma_f32_16x16x32_bf16 a[36:39], a[236:239], v[248:251], a[36:39]
  v_exp_f32 v211, v109
  v_mfma_f32_16x16x32_bf16 a[40:43], a[240:243], v[8:11], a[40:43]
  v_mfma_f32_16x16x32_bf16 a[40:43], a[244:247], v[248:251], a[40:43]
  ds_read_b128 a[224:227], v2 offset:40960
  v_mfma_f32_16x16x32_bf16 a[72:75], a[244:247], v[232:235], a[72:75]
  v_exp_f32 v212, v102
  v_mfma_f32_16x16x32_bf16 a[72:75], a[240:243], v[224:227], a[72:75]
  v_cvt_pk_bf16_f32 v158, v210, v211
  v_mfma_f32_16x16x32_bf16 a[104:107], a[240:243], v[228:231], a[104:107]
  v_exp_f32 v213, v103
  v_mfma_f32_16x16x32_bf16 a[104:107], a[244:247], v[236:239], a[104:107]
  ds_read_b128 a[228:231], v2 offset:41984
  buffer_load_dwordx4 v13, s[20:23], s36 offen offset:3072 sc1 lds
  v_mfma_f32_16x16x32_bf16 a[108:111], a[248:251], v[228:231], a[108:111]
  v_mfma_f32_16x16x32_bf16 a[108:111], a[252:255], v[236:239], a[108:111]
  v_exp_f32 v214, v110
  v_mfma_f32_16x16x32_bf16 a[76:79], a[252:255], v[232:235], a[76:79]
  ds_read_b128 a[232:235], v2 offset:43008
  v_cvt_pk_bf16_f32 v155, v212, v213
  v_mfma_f32_16x16x32_bf16 a[76:79], a[248:251], v[224:227], a[76:79]
  v_exp_f32 v215, v111
  v_mfma_f32_16x16x32_bf16 a[44:47], a[248:251], v[8:11], a[44:47]
  ds_read_b128 a[236:239], v2 offset:44032
  v_mfma_f32_16x16x32_bf16 a[44:47], a[252:255], v[248:251], a[44:47]
  v_mfma_f32_16x16x32_bf16 v[200:203], v[240:243], v[224:227], v[200:203]
  v_cvt_pk_bf16_f32 v159, v214, v215
  v_mfma_f32_16x16x32_bf16 v[200:203], v[240:243], v[232:235], v[200:203]
  s_waitcnt vmcnt(12) lgkmcnt(4)
  s_barrier
  v_mfma_f32_16x16x32_bf16 v[96:99], a[192:195], v[48:51], v[184:187]
  v_exp_f32 v208, v128
  v_mfma_f32_16x16x32_bf16 v[96:99], a[196:199], v[52:55], v[96:99]
  ds_read_b128 a[240:243], v2 offset:45056
  s_mov_b32 m0, s37
  v_mfma_f32_16x16x32_bf16 v[96:99], a[200:203], v[56:59], v[96:99]
  v_exp_f32 v209, v129
  v_mfma_f32_16x16x32_bf16 v[96:99], a[204:207], v[60:63], v[96:99]
  ds_read_b128 a[244:247], v2 offset:46080
  v_mfma_f32_16x16x32_bf16 v[104:107], a[204:207], v[76:79], v[188:191]
  v_mfma_f32_16x16x32_bf16 v[104:107], a[200:203], v[72:75], v[104:107]
  v_exp_f32 v210, v136
  v_mfma_f32_16x16x32_bf16 v[104:107], a[196:199], v[68:71], v[104:107]
  ds_read_b128 a[248:251], v2 offset:47104
  v_cvt_pk_bf16_f32 v168, v208, v209
  v_mfma_f32_16x16x32_bf16 v[104:107], a[192:195], v[64:67], v[104:107]
  v_exp_f32 v211, v137
  v_mfma_f32_16x16x32_bf16 v[100:103], a[208:211], v[48:51], v[184:187]
  ds_read_b128 a[252:255], v2 offset:48128
  buffer_load_dwordx4 v14, s[20:23], s36 offen offset:0 sc1 lds
  v_mfma_f32_16x16x32_bf16 v[100:103], a[212:215], v[52:55], v[100:103]
  ds_read_b128 a[192:195], v2 offset:49152
  v_mfma_f32_16x16x32_bf16 v[100:103], a[216:219], v[56:59], v[100:103]
  v_exp_f32 v212, v130
  v_mfma_f32_16x16x32_bf16 v[100:103], a[220:223], v[60:63], v[100:103]
  ds_read_b128 a[196:199], v2 offset:50176
  v_cvt_pk_bf16_f32 v172, v210, v211
  v_mfma_f32_16x16x32_bf16 v[108:111], a[220:223], v[76:79], v[188:191]
  v_exp_f32 v213, v131
  v_mfma_f32_16x16x32_bf16 v[108:111], a[216:219], v[72:75], v[108:111]
  ds_read_b128 a[200:203], v2 offset:51200
  v_mfma_f32_16x16x32_bf16 v[108:111], a[212:215], v[68:71], v[108:111]
  v_mfma_f32_16x16x32_bf16 v[108:111], a[208:211], v[64:67], v[108:111]
  s_waitcnt lgkmcnt(3)
  v_exp_f32 v214, v138
  v_mfma_f32_16x16x32_bf16 a[48:51], a[224:227], v[8:11], a[48:51]
  ds_read_b128 a[204:207], v2 offset:52224
  v_cvt_pk_bf16_f32 v169, v212, v213
  v_mfma_f32_16x16x32_bf16 a[48:51], a[228:231], v[248:251], a[48:51]
  v_exp_f32 v215, v139
  v_mfma_f32_16x16x32_bf16 a[80:83], a[228:231], v[232:235], a[80:83]
  ds_read_b128 a[208:211], v2 offset:53248
  buffer_load_dwordx4 v14, s[20:23], s36 offen offset:1024 sc1 lds
  v_mfma_f32_16x16x32_bf16 a[80:83], a[224:227], v[224:227], a[80:83]
  v_mfma_f32_16x16x32_bf16 a[112:115], a[224:227], v[228:231], a[112:115]
  v_exp_f32 v208, v132
  v_mfma_f32_16x16x32_bf16 a[112:115], a[228:231], v[236:239], a[112:115]
  ds_read_b128 a[212:215], v2 offset:54272
  v_cvt_pk_bf16_f32 v173, v214, v215
  v_mfma_f32_16x16x32_bf16 a[116:119], a[232:235], v[228:231], a[116:119]
  v_exp_f32 v209, v133
  v_mfma_f32_16x16x32_bf16 a[116:119], a[236:239], v[236:239], a[116:119]
  ds_read_b128 a[216:219], v2 offset:55296
  v_mfma_f32_16x16x32_bf16 a[84:87], a[236:239], v[232:235], a[84:87]
  buffer_load_dwordx4 v14, s[20:23], s36 offen offset:2048 sc1 lds
  v_mfma_f32_16x16x32_bf16 a[84:87], a[232:235], v[224:227], a[84:87]
  v_exp_f32 v210, v140
  v_mfma_f32_16x16x32_bf16 a[52:55], a[232:235], v[8:11], a[52:55]
  ds_read_b128 a[220:223], v2 offset:56320
  v_cvt_pk_bf16_f32 v170, v208, v209
  v_mfma_f32_16x16x32_bf16 a[52:55], a[236:239], v[248:251], a[52:55]
  v_exp_f32 v211, v141
  v_mfma_f32_16x16x32_bf16 a[56:59], a[240:243], v[8:11], a[56:59]
  v_mfma_f32_16x16x32_bf16 a[56:59], a[244:247], v[248:251], a[56:59]
  ds_read_b128 a[224:227], v2 offset:57344
  v_mfma_f32_16x16x32_bf16 a[88:91], a[244:247], v[232:235], a[88:91]
  v_exp_f32 v212, v134
  v_mfma_f32_16x16x32_bf16 a[88:91], a[240:243], v[224:227], a[88:91]
  v_cvt_pk_bf16_f32 v174, v210, v211
  v_mfma_f32_16x16x32_bf16 a[120:123], a[240:243], v[228:231], a[120:123]
  v_exp_f32 v213, v135
  v_mfma_f32_16x16x32_bf16 a[120:123], a[244:247], v[236:239], a[120:123]
  ds_read_b128 a[228:231], v2 offset:58368
  buffer_load_dwordx4 v14, s[20:23], s36 offen offset:3072 sc1 lds
  v_mfma_f32_16x16x32_bf16 a[124:127], a[248:251], v[228:231], a[124:127]
  v_mfma_f32_16x16x32_bf16 a[124:127], a[252:255], v[236:239], a[124:127]
  v_exp_f32 v214, v142
  v_mfma_f32_16x16x32_bf16 a[92:95], a[252:255], v[232:235], a[92:95]
  ds_read_b128 a[232:235], v2 offset:59392
  v_cvt_pk_bf16_f32 v171, v212, v213
  v_mfma_f32_16x16x32_bf16 a[92:95], a[248:251], v[224:227], a[92:95]
  v_exp_f32 v215, v143
  v_mfma_f32_16x16x32_bf16 a[60:63], a[248:251], v[8:11], a[60:63]
  ds_read_b128 a[236:239], v2 offset:60416
  v_mfma_f32_16x16x32_bf16 a[60:63], a[252:255], v[248:251], a[60:63]
  v_mfma_f32_16x16x32_bf16 v[204:207], v[240:243], v[228:231], v[204:207]
  v_cvt_pk_bf16_f32 v175, v214, v215
  v_mfma_f32_16x16x32_bf16 v[204:207], v[240:243], v[236:239], v[204:207]
  v_mov_b32 v193, v192
  v_mov_b32 v197, v196
  s_nop 0
  v_permlane16_swap_b32 v192, v193
  v_permlane16_swap_b32 v196, v197
  v_add_f32 v192, v192, v193
  v_add_f32 v196, v196, v197
  v_mov_b32 v193, v192
  v_mov_b32 v197, v196
  s_nop 0
  v_permlane32_swap_b32 v192, v193
  v_permlane32_swap_b32 v196, v197
  v_add_f32 v192, v192, v193
  v_add_f32 v196, v196, v197
  v_rcp_f32 v182, v192
  s_add_u32 s35, s34, 0
  v_mov_b32 v183, v182
  v_accvgpr_read_b32 v144, a0
  v_accvgpr_read_b32 v145, a1
  v_accvgpr_read_b32 v146, a2
  v_accvgpr_read_b32 v147, a3
  v_accvgpr_read_b32 v148, a4
  v_accvgpr_read_b32 v149, a5
  v_accvgpr_read_b32 v150, a6
  v_accvgpr_read_b32 v151, a7
  v_pk_mul_f32 v[144:145], v[144:145], v[182:183]
  v_pk_mul_f32 v[146:147], v[146:147], v[182:183]
  v_pk_mul_f32 v[148:149], v[148:149], v[182:183]
  v_pk_mul_f32 v[150:151], v[150:151], v[182:183]
  v_cvt_pk_bf16_f32 v80, v144, v145
  v_cvt_pk_bf16_f32 v81, v146, v147
  v_cvt_pk_bf16_f32 v82, v148, v149
  v_cvt_pk_bf16_f32 v83, v150, v151
  buffer_store_dwordx4 v[80:83], v1, s[20:23], s35 offen offset:0 sc1
  v_accvgpr_read_b32 v160, a8
  v_accvgpr_read_b32 v161, a9
  v_accvgpr_read_b32 v162, a10
  v_accvgpr_read_b32 v163, a11
  v_accvgpr_read_b32 v164, a12
  v_accvgpr_read_b32 v165, a13
  v_accvgpr_read_b32 v166, a14
  v_accvgpr_read_b32 v167, a15
  v_pk_mul_f32 v[160:161], v[160:161], v[182:183]
  v_pk_mul_f32 v[162:163], v[162:163], v[182:183]
  v_pk_mul_f32 v[164:165], v[164:165], v[182:183]
  v_pk_mul_f32 v[166:167], v[166:167], v[182:183]
  v_cvt_pk_bf16_f32 v84, v160, v161
  v_cvt_pk_bf16_f32 v85, v162, v163
  v_cvt_pk_bf16_f32 v86, v164, v165
  v_cvt_pk_bf16_f32 v87, v166, v167
  buffer_store_dwordx4 v[84:87], v1, s[20:23], s35 offen offset:1024 sc1
  v_accvgpr_read_b32 v144, a16
  v_accvgpr_read_b32 v145, a17
  v_accvgpr_read_b32 v146, a18
  v_accvgpr_read_b32 v147, a19
  v_accvgpr_read_b32 v148, a20
  v_accvgpr_read_b32 v149, a21
  v_accvgpr_read_b32 v150, a22
  v_accvgpr_read_b32 v151, a23
  v_pk_mul_f32 v[144:145], v[144:145], v[182:183]
  v_pk_mul_f32 v[146:147], v[146:147], v[182:183]
  v_pk_mul_f32 v[148:149], v[148:149], v[182:183]
  v_pk_mul_f32 v[150:151], v[150:151], v[182:183]
  v_cvt_pk_bf16_f32 v88, v144, v145
  v_cvt_pk_bf16_f32 v89, v146, v147
  v_cvt_pk_bf16_f32 v90, v148, v149
  v_cvt_pk_bf16_f32 v91, v150, v151
  buffer_store_dwordx4 v[88:91], v1, s[20:23], s35 offen offset:2048 sc1
  v_accvgpr_read_b32 v160, a24
  v_accvgpr_read_b32 v161, a25
  v_accvgpr_read_b32 v162, a26
  v_accvgpr_read_b32 v163, a27
  v_accvgpr_read_b32 v164, a28
  v_accvgpr_read_b32 v165, a29
  v_accvgpr_read_b32 v166, a30
  v_accvgpr_read_b32 v167, a31
  v_pk_mul_f32 v[160:161], v[160:161], v[182:183]
  v_pk_mul_f32 v[162:163], v[162:163], v[182:183]
  v_pk_mul_f32 v[164:165], v[164:165], v[182:183]
  v_pk_mul_f32 v[166:167], v[166:167], v[182:183]
  v_cvt_pk_bf16_f32 v92, v160, v161
  v_cvt_pk_bf16_f32 v93, v162, v163
  v_cvt_pk_bf16_f32 v94, v164, v165
  v_cvt_pk_bf16_f32 v95, v166, v167
  buffer_store_dwordx4 v[92:95], v1, s[20:23], s35 offen offset:3072 sc1
  v_rcp_f32 v182, v196
  s_add_u32 s35, s34, 4096
  v_mov_b32 v183, v182
  v_accvgpr_read_b32 v144, a32
  v_accvgpr_read_b32 v145, a33
  v_accvgpr_read_b32 v146, a34
  v_accvgpr_read_b32 v147, a35
  v_accvgpr_read_b32 v148, a36
  v_accvgpr_read_b32 v149, a37
  v_accvgpr_read_b32 v150, a38
  v_accvgpr_read_b32 v151, a39
  v_pk_mul_f32 v[144:145], v[144:145], v[182:183]
  v_pk_mul_f32 v[146:147], v[146:147], v[182:183]
  v_pk_mul_f32 v[148:149], v[148:149], v[182:183]
  v_pk_mul_f32 v[150:151], v[150:151], v[182:183]
  v_cvt_pk_bf16_f32 v112, v144, v145
  v_cvt_pk_bf16_f32 v113, v146, v147
  v_cvt_pk_bf16_f32 v114, v148, v149
  v_cvt_pk_bf16_f32 v115, v150, v151
  buffer_store_dwordx4 v[112:115], v1, s[20:23], s35 offen offset:0 sc1
  v_accvgpr_read_b32 v160, a40
  v_accvgpr_read_b32 v161, a41
  v_accvgpr_read_b32 v162, a42
  v_accvgpr_read_b32 v163, a43
  v_accvgpr_read_b32 v164, a44
  v_accvgpr_read_b32 v165, a45
  v_accvgpr_read_b32 v166, a46
  v_accvgpr_read_b32 v167, a47
  v_pk_mul_f32 v[160:161], v[160:161], v[182:183]
  v_pk_mul_f32 v[162:163], v[162:163], v[182:183]
  v_pk_mul_f32 v[164:165], v[164:165], v[182:183]
  v_pk_mul_f32 v[166:167], v[166:167], v[182:183]
  v_cvt_pk_bf16_f32 v116, v160, v161
  v_cvt_pk_bf16_f32 v117, v162, v163
  v_cvt_pk_bf16_f32 v118, v164, v165
  v_cvt_pk_bf16_f32 v119, v166, v167
  buffer_store_dwordx4 v[116:119], v1, s[20:23], s35 offen offset:1024 sc1
  v_accvgpr_read_b32 v144, a48
  v_accvgpr_read_b32 v145, a49
  v_accvgpr_read_b32 v146, a50
  v_accvgpr_read_b32 v147, a51
  v_accvgpr_read_b32 v148, a52
  v_accvgpr_read_b32 v149, a53
  v_accvgpr_read_b32 v150, a54
  v_accvgpr_read_b32 v151, a55
  v_pk_mul_f32 v[144:145], v[144:145], v[182:183]
  v_pk_mul_f32 v[146:147], v[146:147], v[182:183]
  v_pk_mul_f32 v[148:149], v[148:149], v[182:183]
  v_pk_mul_f32 v[150:151], v[150:151], v[182:183]
  v_cvt_pk_bf16_f32 v120, v144, v145
  v_cvt_pk_bf16_f32 v121, v146, v147
  v_cvt_pk_bf16_f32 v122, v148, v149
  v_cvt_pk_bf16_f32 v123, v150, v151
  buffer_store_dwordx4 v[120:123], v1, s[20:23], s35 offen offset:2048 sc1
  v_accvgpr_read_b32 v160, a56
  v_accvgpr_read_b32 v161, a57
  v_accvgpr_read_b32 v162, a58
  v_accvgpr_read_b32 v163, a59
  v_accvgpr_read_b32 v164, a60
  v_accvgpr_read_b32 v165, a61
  v_accvgpr_read_b32 v166, a62
  v_accvgpr_read_b32 v167, a63
  v_pk_mul_f32 v[160:161], v[160:161], v[182:183]
  v_pk_mul_f32 v[162:163], v[162:163], v[182:183]
  v_pk_mul_f32 v[164:165], v[164:165], v[182:183]
  v_pk_mul_f32 v[166:167], v[166:167], v[182:183]
  v_cvt_pk_bf16_f32 v124, v160, v161
  v_cvt_pk_bf16_f32 v125, v162, v163
  v_cvt_pk_bf16_f32 v126, v164, v165
  v_cvt_pk_bf16_f32 v127, v166, v167
  buffer_store_dwordx4 v[124:127], v1, s[20:23], s35 offen offset:3072 sc1
  v_and_b32 v144, 15, v0
  v_lshrrev_b32 v145, 4, v0
  v_lshlrev_b32 v146, 5, v144
  v_lshl_add_u32 v250, v145, 3, v146
  s_and_b32 s28, s24, 1
  s_lshl_b32 s29, s28, 8
  s_sub_u32 s29, s33, s29
  v_sub_u32 v3, 15, v144
  v_and_b32 v244, 1, v3
  v_mul_u32_u24 v244, 4160, v244
  v_lshrrev_b32 v3, 1, v3
  v_lshl_add_u32 v3, v3, 2, v244
  v_lshl_add_u32 v3, v145, 4, v3
  v_add_u32 v3, s29, v3
  v_add_u32 v244, 3328, v3
  v_add_u32 v245, 2304, v3
  v_add_u32 v246, 1280, v3
  v_add_u32 v247, 256, v3
  v_lshl_add_u32 v248, v145, 4, v146
  s_add_u32 s27, s29, 8608
  v_add_u32 v248, s27, v248
  s_lshl_b32 s29, s28, 11
  s_add_u32 s27, s33, 2552
  s_sub_u32 s27, s27, s29
  v_sub_u32 v249, s27, v250
  s_lshl_b32 s29, s28, 12
  s_add_u32 s27, s33, 4160
  s_add_u32 s28, s27, s29
  v_add_u32 v251, s28, v1
  s_xor_b32 s29, s29, 4096
  s_add_u32 s28, s27, s29
  v_add_u32 v255, s28, v1
  v_and_b32 v3, 1, v145
  v_mul_u32_u24 v3, 504, v3
  v_add_u32 v250, v250, v3
  v_accvgpr_read_b32 v4, a144
  v_accvgpr_read_b32 v5, a145
  v_accvgpr_read_b32 v6, a146
  v_accvgpr_read_b32 v7, a147
  v_accvgpr_read_b32 v8, a148
  v_accvgpr_read_b32 v9, a149
  v_accvgpr_read_b32 v10, a150
  v_accvgpr_read_b32 v11, a151
.p2align 3
K_HALF3:
  s_waitcnt lgkmcnt(4)
  v_mfma_f32_16x16x32_bf16 v[128:131], a[192:195], v[48:51], v[184:187]
  v_exp_f32 v208, v96
  v_mfma_f32_16x16x32_bf16 v[128:131], a[196:199], v[52:55], v[128:131]
  ds_read_b128 a[240:243], v2 offset:61440
  v_mfma_f32_16x16x32_bf16 v[128:131], a[200:203], v[56:59], v[128:131]
  s_xor_b32 m0, s37, 0x4000
  v_exp_f32 v209, v97
  v_mfma_f32_16x16x32_bf16 v[128:131], a[204:207], v[60:63], v[128:131]
  ds_read_b128 a[244:247], v2 offset:62464
  buffer_load_dwordx4 v15, s[20:23], s36 offen offset:0 sc1 lds
  v_mfma_f32_16x16x32_bf16 v[136:139], a[204:207], v[76:79], v[188:191]
  v_exp_f32 v210, v104
  v_mfma_f32_16x16x32_bf16 v[136:139], a[200:203], v[72:75], v[136:139]
  ds_read_b128 a[248:251], v2 offset:63488
  v_cvt_pk_bf16_f32 v224, v208, v209
  v_mfma_f32_16x16x32_bf16 v[136:139], a[196:199], v[68:71], v[136:139]
  v_exp_f32 v211, v105
  v_mfma_f32_16x16x32_bf16 v[136:139], a[192:195], v[64:67], v[136:139]
  ds_read_b128 a[252:255], v2 offset:64512
  v_xor_b32 v2, 0x10000, v2
  v_mfma_f32_16x16x32_bf16 v[132:135], a[208:211], v[48:51], v[184:187]
  v_exp_f32 v212, v98
  v_mfma_f32_16x16x32_bf16 v[132:135], a[212:215], v[52:55], v[132:135]
  ds_read_b128 a[192:195], v2 offset:0
  v_cvt_pk_bf16_f32 v228, v210, v211
  v_mfma_f32_16x16x32_bf16 v[132:135], a[216:219], v[56:59], v[132:135]
  v_exp_f32 v213, v99
  v_mfma_f32_16x16x32_bf16 v[132:135], a[220:223], v[60:63], v[132:135]
  ds_read_b128 a[196:199], v2 offset:1024
  buffer_load_dwordx4 v15, s[20:23], s36 offen offset:1024 sc1 lds
  v_mfma_f32_16x16x32_bf16 v[140:143], a[220:223], v[76:79], v[188:191]
  v_exp_f32 v214, v106
  v_mfma_f32_16x16x32_bf16 v[140:143], a[216:219], v[72:75], v[140:143]
  ds_read_b128 a[200:203], v2 offset:2048
  v_cvt_pk_bf16_f32 v225, v212, v213
  v_mfma_f32_16x16x32_bf16 v[140:143], a[212:215], v[68:71], v[140:143]
  v_exp_f32 v215, v107
  v_mfma_f32_16x16x32_bf16 v[140:143], a[208:211], v[64:67], v[140:143]
  ds_read_b128 a[204:207], v2 offset:3072
  s_waitcnt lgkmcnt(4)
  v_mfma_f32_16x16x32_bf16 a[64:67], a[224:227], v[152:155], a[64:67]
  v_exp_f32 v208, v100
  v_mfma_f32_16x16x32_bf16 a[64:67], a[228:231], v[168:171], a[64:67]
  ds_read_b128 a[208:211], v2 offset:4096
  v_cvt_pk_bf16_f32 v229, v214, v215
  v_mfma_f32_16x16x32_bf16 a[96:99], a[228:231], v[172:175], a[96:99]
  v_exp_f32 v209, v101
  v_mfma_f32_16x16x32_bf16 a[96:99], a[224:227], v[156:159], a[96:99]
  ds_read_b128 a[212:215], v2 offset:5120
  buffer_load_dwordx4 v15, s[20:23], s36 offen offset:2048 sc1 lds
  v_mfma_f32_16x16x32_bf16 a[100:103], a[232:235], v[156:159], a[100:103]
  v_exp_f32 v210, v108
  v_mfma_f32_16x16x32_bf16 a[100:103], a[236:239], v[172:175], a[100:103]
  ds_read_b128 a[216:219], v2 offset:6144
  v_cvt_pk_bf16_f32 v226, v208, v209
  v_mfma_f32_16x16x32_bf16 a[68:71], a[236:239], v[168:171], a[68:71]
  v_exp_f32 v211, v109
  v_mfma_f32_16x16x32_bf16 a[68:71], a[232:235], v[152:155], a[68:71]
  ds_read_b128 a[220:223], v2 offset:7168
  v_mfma_f32_16x16x32_bf16 a[72:75], a[240:243], v[152:155], a[72:75]
  v_exp_f32 v212, v102
  v_mfma_f32_16x16x32_bf16 a[72:75], a[244:247], v[168:171], a[72:75]
  ds_read_b128 a[224:227], v2 offset:8192
  v_cvt_pk_bf16_f32 v230, v210, v211
  v_mfma_f32_16x16x32_bf16 a[104:107], a[244:247], v[172:175], a[104:107]
  v_exp_f32 v213, v103
  v_mfma_f32_16x16x32_bf16 a[104:107], a[240:243], v[156:159], a[104:107]
  ds_read_b128 a[228:231], v2 offset:9216
  buffer_load_dwordx4 v15, s[20:23], s36 offen offset:3072 sc1 lds
  v_mfma_f32_16x16x32_bf16 a[108:111], a[248:251], v[156:159], a[108:111]
  s_add_u32 s36, s36, 32768
  v_exp_f32 v214, v110
  v_mfma_f32_16x16x32_bf16 a[108:111], a[252:255], v[172:175], a[108:111]
  ds_read_b128 a[232:235], v2 offset:10240
  v_cvt_pk_bf16_f32 v227, v212, v213
  v_mfma_f32_16x16x32_bf16 a[76:79], a[252:255], v[168:171], a[76:79]
  s_xor_b32 s37, s37, 0x10000
  v_exp_f32 v215, v111
  v_mfma_f32_16x16x32_bf16 a[76:79], a[248:251], v[152:155], a[76:79]
  ds_read_b128 a[236:239], v2 offset:11264
  v_mfma_f32_16x16x32_bf16 v[200:203], v[240:243], v[152:155], v[200:203]
  v_cvt_pk_bf16_f32 v231, v214, v215
  v_mfma_f32_16x16x32_bf16 v[200:203], v[240:243], v[168:171], v[200:203]
  s_waitcnt vmcnt(12) lgkmcnt(4)
  s_barrier
  v_mfma_f32_16x16x32_bf16 v[96:99], a[192:195], v[48:51], v[184:187]
  v_exp_f32 v208, v128
  v_mfma_f32_16x16x32_bf16 v[96:99], a[196:199], v[52:55], v[96:99]
  ds_read_b128 a[240:243], v2 offset:12288
  v_mfma_f32_16x16x32_bf16 v[96:99], a[200:203], v[56:59], v[96:99]
  s_xor_b32 m0, s37, 0x18000
  v_exp_f32 v209, v129
  v_mfma_f32_16x16x32_bf16 v[96:99], a[204:207], v[60:63], v[96:99]
  ds_read_b128 a[244:247], v2 offset:13312
  buffer_load_dwordx4 v1, s[20:23], s36 offen offset:0 sc1 lds
  v_mfma_f32_16x16x32_bf16 v[104:107], a[204:207], v[76:79], v[188:191]
  v_exp_f32 v210, v136
  v_mfma_f32_16x16x32_bf16 v[104:107], a[200:203], v[72:75], v[104:107]
  ds_read_b128 a[248:251], v2 offset:14336
  v_cvt_pk_bf16_f32 v232, v208, v209
  v_mfma_f32_16x16x32_bf16 v[104:107], a[196:199], v[68:71], v[104:107]
  v_exp_f32 v211, v137
  v_mfma_f32_16x16x32_bf16 v[104:107], a[192:195], v[64:67], v[104:107]
  ds_read_b128 a[252:255], v2 offset:15360
  v_mfma_f32_16x16x32_bf16 v[100:103], a[208:211], v[48:51], v[184:187]
  v_exp_f32 v212, v130
  v_mfma_f32_16x16x32_bf16 v[100:103], a[212:215], v[52:55], v[100:103]
  ds_read_b128 a[192:195], v2 offset:16384
  v_cvt_pk_bf16_f32 v236, v210, v211
  v_mfma_f32_16x16x32_bf16 v[100:103], a[216:219], v[56:59], v[100:103]
  v_exp_f32 v213, v131
  v_mfma_f32_16x16x32_bf16 v[100:103], a[220:223], v[60:63], v[100:103]
  ds_read_b128 a[196:199], v2 offset:17408
  buffer_load_dwordx4 v1, s[20:23], s36 offen offset:1024 sc1 lds
  v_mfma_f32_16x16x32_bf16 v[108:111], a[220:223], v[76:79], v[188:191]
  v_exp_f32 v214, v138
  v_mfma_f32_16x16x32_bf16 v[108:111], a[216:219], v[72:75], v[108:111]
  ds_read_b128 a[200:203], v2 offset:18432
  v_cvt_pk_bf16_f32 v233, v212, v213
  v_mfma_f32_16x16x32_bf16 v[108:111], a[212:215], v[68:71], v[108:111]
  v_exp_f32 v215, v139
  v_mfma_f32_16x16x32_bf16 v[108:111], a[208:211], v[64:67], v[108:111]
  ds_read_b128 a[204:207], v2 offset:19456
  s_waitcnt lgkmcnt(4)
  v_mfma_f32_16x16x32_bf16 a[80:83], a[224:227], v[152:155], a[80:83]
  v_exp_f32 v208, v132
  v_mfma_f32_16x16x32_bf16 a[80:83], a[228:231], v[168:171], a[80:83]
  ds_read_b128 a[208:211], v2 offset:20480
  v_cvt_pk_bf16_f32 v237, v214, v215
  v_mfma_f32_16x16x32_bf16 a[112:115], a[228:231], v[172:175], a[112:115]
  v_exp_f32 v209, v133
  v_mfma_f32_16x16x32_bf16 a[112:115], a[224:227], v[156:159], a[112:115]
  ds_read_b128 a[212:215], v2 offset:21504
  buffer_load_dwordx4 v1, s[20:23], s36 offen offset:2048 sc1 lds
  v_mfma_f32_16x16x32_bf16 a[116:119], a[232:235], v[156:159], a[116:119]
  v_exp_f32 v210, v140
  v_mfma_f32_16x16x32_bf16 a[116:119], a[236:239], v[172:175], a[116:119]
  ds_read_b128 a[216:219], v2 offset:22528
  v_cvt_pk_bf16_f32 v234, v208, v209
  v_mfma_f32_16x16x32_bf16 a[84:87], a[236:239], v[168:171], a[84:87]
  v_exp_f32 v211, v141
  v_mfma_f32_16x16x32_bf16 a[84:87], a[232:235], v[152:155], a[84:87]
  ds_read_b128 a[220:223], v2 offset:23552
  v_mfma_f32_16x16x32_bf16 a[88:91], a[240:243], v[152:155], a[88:91]
  v_exp_f32 v212, v134
  v_mfma_f32_16x16x32_bf16 a[88:91], a[244:247], v[168:171], a[88:91]
  ds_read_b128 a[224:227], v2 offset:24576
  v_cvt_pk_bf16_f32 v238, v210, v211
  v_mfma_f32_16x16x32_bf16 a[120:123], a[244:247], v[172:175], a[120:123]
  v_exp_f32 v213, v135
  v_mfma_f32_16x16x32_bf16 a[120:123], a[240:243], v[156:159], a[120:123]
  ds_read_b128 a[228:231], v2 offset:25600
  buffer_load_dwordx4 v1, s[20:23], s36 offen offset:3072 sc1 lds
  v_mfma_f32_16x16x32_bf16 a[124:127], a[248:251], v[156:159], a[124:127]
  v_exp_f32 v214, v142
  v_mfma_f32_16x16x32_bf16 a[124:127], a[252:255], v[172:175], a[124:127]
  ds_read_b128 a[232:235], v2 offset:26624
  v_cvt_pk_bf16_f32 v235, v212, v213
  v_mfma_f32_16x16x32_bf16 a[92:95], a[252:255], v[168:171], a[92:95]
  v_exp_f32 v215, v143
  v_mfma_f32_16x16x32_bf16 a[92:95], a[248:251], v[152:155], a[92:95]
  ds_read_b128 a[236:239], v2 offset:27648
  v_mfma_f32_16x16x32_bf16 v[204:207], v[240:243], v[156:159], v[204:207]
  v_cvt_pk_bf16_f32 v239, v214, v215
  v_mfma_f32_16x16x32_bf16 v[204:207], v[240:243], v[172:175], v[204:207]
  s_waitcnt lgkmcnt(4)
  v_mfma_f32_16x16x32_bf16 v[128:131], a[192:195], v[48:51], v[184:187]
  v_exp_f32 v208, v96
  v_mfma_f32_16x16x32_bf16 v[128:131], a[196:199], v[52:55], v[128:131]
  ds_read_b128 a[240:243], v2 offset:28672
  v_mfma_f32_16x16x32_bf16 v[128:131], a[200:203], v[56:59], v[128:131]
  s_xor_b32 m0, s37, 0x1c000
  v_exp_f32 v209, v97
  v_mfma_f32_16x16x32_bf16 v[128:131], a[204:207], v[60:63], v[128:131]
  ds_read_b128 a[244:247], v2 offset:29696
  buffer_load_dwordx4 v13, s[20:23], s36 offen offset:0 sc1 lds
  v_mfma_f32_16x16x32_bf16 v[136:139], a[204:207], v[76:79], v[188:191]
  v_exp_f32 v210, v104
  v_mfma_f32_16x16x32_bf16 v[136:139], a[200:203], v[72:75], v[136:139]
  ds_read_b128 a[248:251], v2 offset:30720
  v_cvt_pk_bf16_f32 v152, v208, v209
  v_mfma_f32_16x16x32_bf16 v[136:139], a[196:199], v[68:71], v[136:139]
  v_exp_f32 v211, v105
  v_mfma_f32_16x16x32_bf16 v[136:139], a[192:195], v[64:67], v[136:139]
  ds_read_b128 a[252:255], v2 offset:31744
  v_mfma_f32_16x16x32_bf16 v[132:135], a[208:211], v[48:51], v[184:187]
  v_exp_f32 v212, v98
  v_mfma_f32_16x16x32_bf16 v[132:135], a[212:215], v[52:55], v[132:135]
  ds_read_b128 a[192:195], v2 offset:32768
  v_cvt_pk_bf16_f32 v156, v210, v211
  v_mfma_f32_16x16x32_bf16 v[132:135], a[216:219], v[56:59], v[132:135]
  v_exp_f32 v213, v99
  v_mfma_f32_16x16x32_bf16 v[132:135], a[220:223], v[60:63], v[132:135]
  ds_read_b128 a[196:199], v2 offset:33792
  buffer_load_dwordx4 v13, s[20:23], s36 offen offset:1024 sc1 lds
  v_mfma_f32_16x16x32_bf16 v[140:143], a[220:223], v[76:79], v[188:191]
  v_exp_f32 v214, v106
  v_mfma_f32_16x16x32_bf16 v[140:143], a[216:219], v[72:75], v[140:143]
  ds_read_b128 a[200:203], v2 offset:34816
  v_cvt_pk_bf16_f32 v153, v212, v213
  v_mfma_f32_16x16x32_bf16 v[140:143], a[212:215], v[68:71], v[140:143]
  v_exp_f32 v215, v107
  v_mfma_f32_16x16x32_bf16 v[140:143], a[208:211], v[64:67], v[140:143]
  ds_read_b128 a[204:207], v2 offset:35840
  s_waitcnt lgkmcnt(4)
  v_mfma_f32_16x16x32_bf16 a[64:67], a[224:227], v[224:227], a[64:67]
  v_exp_f32 v208, v100
  v_mfma_f32_16x16x32_bf16 a[64:67], a[228:231], v[232:235], a[64:67]
  ds_read_b128 a[208:211], v2 offset:36864
  v_cvt_pk_bf16_f32 v157, v214, v215
  v_mfma_f32_16x16x32_bf16 a[96:99], a[228:231], v[236:239], a[96:99]
  v_exp_f32 v209, v101
  v_mfma_f32_16x16x32_bf16 a[96:99], a[224:227], v[228:231], a[96:99]
  ds_read_b128 a[212:215], v2 offset:37888
  buffer_load_dwordx4 v13, s[20:23], s36 offen offset:2048 sc1 lds
  v_mfma_f32_16x16x32_bf16 a[100:103], a[232:235], v[228:231], a[100:103]
  v_exp_f32 v210, v108
  v_mfma_f32_16x16x32_bf16 a[100:103], a[236:239], v[236:239], a[100:103]
  ds_read_b128 a[216:219], v2 offset:38912
  v_cvt_pk_bf16_f32 v154, v208, v209
  v_mfma_f32_16x16x32_bf16 a[68:71], a[236:239], v[232:235], a[68:71]
  v_exp_f32 v211, v109
  v_mfma_f32_16x16x32_bf16 a[68:71], a[232:235], v[224:227], a[68:71]
  ds_read_b128 a[220:223], v2 offset:39936
  v_mfma_f32_16x16x32_bf16 a[72:75], a[240:243], v[224:227], a[72:75]
  v_exp_f32 v212, v102
  v_mfma_f32_16x16x32_bf16 a[72:75], a[244:247], v[232:235], a[72:75]
  ds_read_b128 a[224:227], v2 offset:40960
  v_cvt_pk_bf16_f32 v158, v210, v211
  v_mfma_f32_16x16x32_bf16 a[104:107], a[244:247], v[236:239], a[104:107]
  v_exp_f32 v213, v103
  v_mfma_f32_16x16x32_bf16 a[104:107], a[240:243], v[228:231], a[104:107]
  ds_read_b128 a[228:231], v2 offset:41984
  buffer_load_dwordx4 v13, s[20:23], s36 offen offset:3072 sc1 lds
  v_mfma_f32_16x16x32_bf16 a[108:111], a[248:251], v[228:231], a[108:111]
  v_exp_f32 v214, v110
  v_mfma_f32_16x16x32_bf16 a[108:111], a[252:255], v[236:239], a[108:111]
  ds_read_b128 a[232:235], v2 offset:43008
  v_cvt_pk_bf16_f32 v155, v212, v213
  v_mfma_f32_16x16x32_bf16 a[76:79], a[252:255], v[232:235], a[76:79]
  v_exp_f32 v215, v111
  v_mfma_f32_16x16x32_bf16 a[76:79], a[248:251], v[224:227], a[76:79]
  ds_read_b128 a[236:239], v2 offset:44032
  v_mfma_f32_16x16x32_bf16 v[200:203], v[240:243], v[224:227], v[200:203]
  v_cvt_pk_bf16_f32 v159, v214, v215
  v_mfma_f32_16x16x32_bf16 v[200:203], v[240:243], v[232:235], v[200:203]
  s_waitcnt vmcnt(12) lgkmcnt(4)
K_hA2_8:
  s_cbranch_execz K_hA2_9
  s_barrier
  v_mfma_f32_16x16x32_bf16 v[96:99], a[192:195], v[48:51], v[184:187]
  v_exp_f32 v208, v128
  v_mfma_f32_16x16x32_bf16 v[96:99], a[196:199], v[52:55], v[96:99]
  ds_read_b128 a[240:243], v2 offset:45056
  v_mfma_f32_16x16x32_bf16 v[96:99], a[200:203], v[56:59], v[96:99]
  s_mov_b32 m0, s37
  v_exp_f32 v209, v129
  v_mfma_f32_16x16x32_bf16 v[96:99], a[204:207], v[60:63], v[96:99]
  ds_read_b128 a[244:247], v2 offset:46080
  buffer_load_dwordx4 v14, s[20:23], s36 offen offset:0 sc1 lds
  v_mfma_f32_16x16x32_bf16 v[104:107], a[204:207], v[76:79], v[188:191]
  v_exp_f32 v210, v136
  v_mfma_f32_16x16x32_bf16 v[104:107], a[200:203], v[72:75], v[104:107]
  ds_read_b128 a[248:251], v2 offset:47104
  v_cvt_pk_bf16_f32 v168, v208, v209
  v_mfma_f32_16x16x32_bf16 v[104:107], a[196:199], v[68:71], v[104:107]
  v_exp_f32 v211, v137
  v_mfma_f32_16x16x32_bf16 v[104:107], a[192:195], v[64:67], v[104:107]
  ds_read_b128 a[252:255], v2 offset:48128
  v_mfma_f32_16x16x32_bf16 v[100:103], a[208:211], v[48:51], v[184:187]
  v_exp_f32 v212, v130
  v_mfma_f32_16x16x32_bf16 v[100:103], a[212:215], v[52:55], v[100:103]
  ds_read_b128 a[192:195], v2 offset:49152
  v_cvt_pk_bf16_f32 v172, v210, v211
  v_mfma_f32_16x16x32_bf16 v[100:103], a[216:219], v[56:59], v[100:103]
  v_exp_f32 v213, v131
  v_mfma_f32_16x16x32_bf16 v[100:103], a[220:223], v[60:63], v[100:103]
  ds_read_b128 a[196:199], v2 offset:50176
  buffer_load_dwordx4 v14, s[20:23], s36 offen offset:1024 sc1 lds
  v_mfma_f32_16x16x32_bf16 v[108:111], a[220:223], v[76:79], v[188:191]
  v_exp_f32 v214, v138
  v_mfma_f32_16x16x32_bf16 v[108:111], a[216:219], v[72:75], v[108:111]
  ds_read_b128 a[200:203], v2 offset:51200
  v_cvt_pk_bf16_f32 v169, v212, v213
  v_mfma_f32_16x16x32_bf16 v[108:111], a[212:215], v[68:71], v[108:111]
  v_exp_f32 v215, v139
  v_mfma_f32_16x16x32_bf16 v[108:111], a[208:211], v[64:67], v[108:111]
  ds_read_b128 a[204:207], v2 offset:52224
  s_waitcnt lgkmcnt(4)
  v_mfma_f32_16x16x32_bf16 a[80:83], a[224:227], v[224:227], a[80:83]
  v_exp_f32 v208, v132
  v_mfma_f32_16x16x32_bf16 a[80:83], a[228:231], v[232:235], a[80:83]
  ds_read_b128 a[208:211], v2 offset:53248
  v_cvt_pk_bf16_f32 v173, v214, v215
  v_mfma_f32_16x16x32_bf16 a[112:115], a[228:231], v[236:239], a[112:115]
  v_exp_f32 v209, v133
  v_mfma_f32_16x16x32_bf16 a[112:115], a[224:227], v[228:231], a[112:115]
  ds_read_b128 a[212:215], v2 offset:54272
  buffer_load_dwordx4 v14, s[20:23], s36 offen offset:2048 sc1 lds
  v_mfma_f32_16x16x32_bf16 a[116:119], a[232:235], v[228:231], a[116:119]
  v_exp_f32 v210, v140
  v_mfma_f32_16x16x32_bf16 a[116:119], a[236:239], v[236:239], a[116:119]
  ds_read_b128 a[216:219], v2 offset:55296
  v_cvt_pk_bf16_f32 v170, v208, v209
  v_mfma_f32_16x16x32_bf16 a[84:87], a[236:239], v[232:235], a[84:87]
  v_exp_f32 v211, v141
  v_mfma_f32_16x16x32_bf16 a[84:87], a[232:235], v[224:227], a[84:87]
  ds_read_b128 a[220:223], v2 offset:56320
  v_mfma_f32_16x16x32_bf16 a[88:91], a[240:243], v[224:227], a[88:91]
  v_exp_f32 v212, v134
  v_mfma_f32_16x16x32_bf16 a[88:91], a[244:247], v[232:235], a[88:91]
  ds_read_b128 a[224:227], v2 offset:57344
  v_cvt_pk_bf16_f32 v174, v210, v211
  v_mfma_f32_16x16x32_bf16 a[120:123], a[244:247], v[236:239], a[120:123]
  v_exp_f32 v213, v135
  v_mfma_f32_16x16x32_bf16 a[120:123], a[240:243], v[228:231], a[120:123]
  ds_read_b128 a[228:231], v2 offset:58368
  buffer_load_dwordx4 v14, s[20:23], s36 offen offset:3072 sc1 lds
  v_mfma_f32_16x16x32_bf16 a[124:127], a[248:251], v[228:231], a[124:127]
  v_exp_f32 v214, v142
  v_mfma_f32_16x16x32_bf16 a[124:127], a[252:255], v[236:239], a[124:127]
  ds_read_b128 a[232:235], v2 offset:59392
  v_cvt_pk_bf16_f32 v171, v212, v213
  v_mfma_f32_16x16x32_bf16 a[92:95], a[252:255], v[232:235], a[92:95]
  v_exp_f32 v215, v143
  v_mfma_f32_16x16x32_bf16 a[92:95], a[248:251], v[224:227], a[92:95]
  ds_read_b128 a[236:239], v2 offset:60416
  v_mfma_f32_16x16x32_bf16 v[204:207], v[240:243], v[228:231], v[204:207]
  v_cvt_pk_bf16_f32 v175, v214, v215
  v_mfma_f32_16x16x32_bf16 v[204:207], v[240:243], v[236:239], v[204:207]
  s_waitcnt lgkmcnt(4)
  v_mfma_f32_16x16x32_bf16 v[128:131], a[192:195], v[48:51], v[184:187]
  v_exp_f32 v208, v96
  v_mfma_f32_16x16x32_bf16 v[128:131], a[196:199], v[52:55], v[128:131]
  ds_read_b128 a[240:243], v2 offset:61440
  v_mfma_f32_16x16x32_bf16 v[128:131], a[200:203], v[56:59], v[128:131]
  s_xor_b32 m0, s37, 0x4000
  v_exp_f32 v209, v97
  v_mfma_f32_16x16x32_bf16 v[128:131], a[204:207], v[60:63], v[128:131]
  ds_read_b128 a[244:247], v2 offset:62464
  buffer_load_dwordx4 v15, s[20:23], s36 offen offset:0 sc1 lds
  v_mfma_f32_16x16x32_bf16 v[136:139], a[204:207], v[76:79], v[188:191]
  v_exp_f32 v210, v104
  v_mfma_f32_16x16x32_bf16 v[136:139], a[200:203], v[72:75], v[136:139]
  ds_read_b128 a[248:251], v2 offset:63488
  v_cvt_pk_bf16_f32 v224, v208, v209
  v_mfma_f32_16x16x32_bf16 v[136:139], a[196:199], v[68:71], v[136:139]
  v_exp_f32 v211, v105
  v_mfma_f32_16x16x32_bf16 v[136:139], a[192:195], v[64:67], v[136:139]
  ds_read_b128 a[252:255], v2 offset:64512
  v_xor_b32 v2, 0x10000, v2
  v_mfma_f32_16x16x32_bf16 v[132:135], a[208:211], v[48:51], v[184:187]
  v_exp_f32 v212, v98
  v_mfma_f32_16x16x32_bf16 v[132:135], a[212:215], v[52:55], v[132:135]
  ds_read_b128 a[192:195], v2 offset:0
  v_cvt_pk_bf16_f32 v228, v210, v211
  v_mfma_f32_16x16x32_bf16 v[132:135], a[216:219], v[56:59], v[132:135]
  v_exp_f32 v213, v99
  v_mfma_f32_16x16x32_bf16 v[132:135], a[220:223], v[60:63], v[132:135]
  ds_read_b128 a[196:199], v2 offset:1024
  buffer_load_dwordx4 v15, s[20:23], s36 offen offset:1024 sc1 lds
  v_mfma_f32_16x16x32_bf16 v[140:143], a[220:223], v[76:79], v[188:191]
  v_exp_f32 v214, v106
  v_mfma_f32_16x16x32_bf16 v[140:143], a[216:219], v[72:75], v[140:143]
  ds_read_b128 a[200:203], v2 offset:2048
  v_cvt_pk_bf16_f32 v225, v212, v213
  v_mfma_f32_16x16x32_bf16 v[140:143], a[212:215], v[68:71], v[140:143]
  v_exp_f32 v215, v107
  v_mfma_f32_16x16x32_bf16 v[140:143], a[208:211], v[64:67], v[140:143]
  ds_read_b128 a[204:207], v2 offset:3072
  s_waitcnt lgkmcnt(4)
  v_mfma_f32_16x16x32_bf16 a[64:67], a[224:227], v[152:155], a[64:67]
  v_exp_f32 v208, v100
  v_mfma_f32_16x16x32_bf16 a[64:67], a[228:231], v[168:171], a[64:67]
  ds_read_b128 a[208:211], v2 offset:4096
  v_cvt_pk_bf16_f32 v229, v214, v215
  v_mfma_f32_16x16x32_bf16 a[96:99], a[228:231], v[172:175], a[96:99]
  v_exp_f32 v209, v101
  v_mfma_f32_16x16x32_bf16 a[96:99], a[224:227], v[156:159], a[96:99]
  ds_read_b128 a[212:215], v2 offset:5120
  buffer_load_dwordx4 v15, s[20:23], s36 offen offset:2048 sc1 lds
  v_mfma_f32_16x16x32_bf16 a[100:103], a[232:235], v[156:159], a[100:103]
  v_exp_f32 v210, v108
  v_mfma_f32_16x16x32_bf16 a[100:103], a[236:239], v[172:175], a[100:103]
  ds_read_b128 a[216:219], v2 offset:6144
  v_cvt_pk_bf16_f32 v226, v208, v209
  v_mfma_f32_16x16x32_bf16 a[68:71], a[236:239], v[168:171], a[68:71]
  v_exp_f32 v211, v109
  v_mfma_f32_16x16x32_bf16 a[68:71], a[232:235], v[152:155], a[68:71]
  ds_read_b128 a[220:223], v2 offset:7168
  v_mfma_f32_16x16x32_bf16 a[72:75], a[240:243], v[152:155], a[72:75]
  v_exp_f32 v212, v102
  v_mfma_f32_16x16x32_bf16 a[72:75], a[244:247], v[168:171], a[72:75]
  ds_read_b128 a[224:227], v2 offset:8192
  v_cvt_pk_bf16_f32 v230, v210, v211
  v_mfma_f32_16x16x32_bf16 a[104:107], a[244:247], v[172:175], a[104:107]
  v_exp_f32 v213, v103
  v_mfma_f32_16x16x32_bf16 a[104:107], a[240:243], v[156:159], a[104:107]
  ds_read_b128 a[228:231], v2 offset:9216
  buffer_load_dwordx4 v15, s[20:23], s36 offen offset:3072 sc1 lds
  v_mfma_f32_16x16x32_bf16 a[108:111], a[248:251], v[156:159], a[108:111]
  s_add_u32 s36, s36, 32768
  v_exp_f32 v214, v110
  v_mfma_f32_16x16x32_bf16 a[108:111], a[252:255], v[172:175], a[108:111]
  ds_read_b128 a[232:235], v2 offset:10240
  v_cvt_pk_bf16_f32 v227, v212, v213
  v_mfma_f32_16x16x32_bf16 a[76:79], a[252:255], v[168:171], a[76:79]
  s_xor_b32 s37, s37, 0x10000
  v_exp_f32 v215, v111
  v_mfma_f32_16x16x32_bf16 a[76:79], a[248:251], v[152:155], a[76:79]
  ds_read_b128 a[236:239], v2 offset:11264
  v_mfma_f32_16x16x32_bf16 v[200:203], v[240:243], v[152:155], v[200:203]
  v_cvt_pk_bf16_f32 v231, v214, v215
  s_sub_u32 s39, s39, 1
  v_mfma_f32_16x16x32_bf16 v[200:203], v[240:243], v[168:171], v[200:203]
  s_cbranch_scc1 K_F0
  s_waitcnt vmcnt(12) lgkmcnt(4)
  s_barrier
  v_mfma_f32_16x16x32_bf16 v[96:99], a[192:195], v[48:51], v[184:187]
  v_exp_f32 v208, v128
  v_mfma_f32_16x16x32_bf16 v[96:99], a[196:199], v[52:55], v[96:99]
  ds_read_b128 a[240:243], v2 offset:12288
  v_mfma_f32_16x16x32_bf16 v[96:99], a[200:203], v[56:59], v[96:99]
  s_xor_b32 m0, s37, 0x18000
  v_exp_f32 v209, v129
  v_mfma_f32_16x16x32_bf16 v[96:99], a[204:207], v[60:63], v[96:99]
  ds_read_b128 a[244:247], v2 offset:13312
  buffer_load_dwordx4 v1, s[20:23], s36 offen offset:0 sc1 lds
  v_mfma_f32_16x16x32_bf16 v[104:107], a[204:207], v[76:79], v[188:191]
  v_exp_f32 v210, v136
  v_mfma_f32_16x16x32_bf16 v[104:107], a[200:203], v[72:75], v[104:107]
  ds_read_b128 a[248:251], v2 offset:14336
  v_cvt_pk_bf16_f32 v232, v208, v209
  v_mfma_f32_16x16x32_bf16 v[104:107], a[196:199], v[68:71], v[104:107]
  v_exp_f32 v211, v137
  v_mfma_f32_16x16x32_bf16 v[104:107], a[192:195], v[64:67], v[104:107]
  ds_read_b128 a[252:255], v2 offset:15360
  v_mfma_f32_16x16x32_bf16 v[100:103], a[208:211], v[48:51], v[184:187]
  v_exp_f32 v212, v130
  v_mfma_f32_16x16x32_bf16 v[100:103], a[212:215], v[52:55], v[100:103]
  ds_read_b128 a[192:195], v2 offset:16384
  v_cvt_pk_bf16_f32 v236, v210, v211
  v_mfma_f32_16x16x32_bf16 v[100:103], a[216:219], v[56:59], v[100:103]
  v_exp_f32 v213, v131
  v_mfma_f32_16x16x32_bf16 v[100:103], a[220:223], v[60:63], v[100:103]
  ds_read_b128 a[196:199], v2 offset:17408
  buffer_load_dwordx4 v1, s[20:23], s36 offen offset:1024 sc1 lds
  v_mfma_f32_16x16x32_bf16 v[108:111], a[220:223], v[76:79], v[188:191]
  v_exp_f32 v214, v138
  v_mfma_f32_16x16x32_bf16 v[108:111], a[216:219], v[72:75], v[108:111]
  ds_read_b128 a[200:203], v2 offset:18432
  v_cvt_pk_bf16_f32 v233, v212, v213
  v_mfma_f32_16x16x32_bf16 v[108:111], a[212:215], v[68:71], v[108:111]
  v_exp_f32 v215, v139
  v_mfma_f32_16x16x32_bf16 v[108:111], a[208:211], v[64:67], v[108:111]
  ds_read_b128 a[204:207], v2 offset:19456
  s_waitcnt lgkmcnt(4)
  v_mfma_f32_16x16x32_bf16 a[80:83], a[224:227], v[152:155], a[80:83]
  v_exp_f32 v208, v132
  v_mfma_f32_16x16x32_bf16 a[80:83], a[228:231], v[168:171], a[80:83]
  ds_read_b128 a[208:211], v2 offset:20480
  v_cvt_pk_bf16_f32 v237, v214, v215
  v_mfma_f32_16x16x32_bf16 a[112:115], a[228:231], v[172:175], a[112:115]
  v_exp_f32 v209, v133
  v_mfma_f32_16x16x32_bf16 a[112:115], a[224:227], v[156:159], a[112:115]
  ds_read_b128 a[212:215], v2 offset:21504
  buffer_load_dwordx4 v1, s[20:23], s36 offen offset:2048 sc1 lds
  v_mfma_f32_16x16x32_bf16 a[116:119], a[232:235], v[156:159], a[116:119]
  v_exp_f32 v210, v140
  v_mfma_f32_16x16x32_bf16 a[116:119], a[236:239], v[172:175], a[116:119]
  ds_read_b128 a[216:219], v2 offset:22528
  v_cvt_pk_bf16_f32 v234, v208, v209
  v_mfma_f32_16x16x32_bf16 a[84:87], a[236:239], v[168:171], a[84:87]
  v_exp_f32 v211, v141
  v_mfma_f32_16x16x32_bf16 a[84:87], a[232:235], v[152:155], a[84:87]
  ds_read_b128 a[220:223], v2 offset:23552
  v_mfma_f32_16x16x32_bf16 a[88:91], a[240:243], v[152:155], a[88:91]
  v_exp_f32 v212, v134
  v_mfma_f32_16x16x32_bf16 a[88:91], a[244:247], v[168:171], a[88:91]
  ds_read_b128 a[224:227], v2 offset:24576
  v_cvt_pk_bf16_f32 v238, v210, v211
  v_mfma_f32_16x16x32_bf16 a[120:123], a[244:247], v[172:175], a[120:123]
  v_exp_f32 v213, v135
  v_mfma_f32_16x16x32_bf16 a[120:123], a[240:243], v[156:159], a[120:123]
  ds_read_b128 a[228:231], v2 offset:25600
  buffer_load_dwordx4 v1, s[20:23], s36 offen offset:3072 sc1 lds
  v_mfma_f32_16x16x32_bf16 a[124:127], a[248:251], v[156:159], a[124:127]
  v_exp_f32 v214, v142
  v_mfma_f32_16x16x32_bf16 a[124:127], a[252:255], v[172:175], a[124:127]
  ds_read_b128 a[232:235], v2 offset:26624
  v_cvt_pk_bf16_f32 v235, v212, v213
  v_mfma_f32_16x16x32_bf16 a[92:95], a[252:255], v[168:171], a[92:95]
  v_exp_f32 v215, v143
  v_mfma_f32_16x16x32_bf16 a[92:95], a[248:251], v[152:155], a[92:95]
  ds_read_b128 a[236:239], v2 offset:27648
  v_mfma_f32_16x16x32_bf16 v[204:207], v[240:243], v[156:159], v[204:207]
  v_cvt_pk_bf16_f32 v239, v214, v215
  v_mfma_f32_16x16x32_bf16 v[204:207], v[240:243], v[172:175], v[204:207]
  s_waitcnt lgkmcnt(4)
  v_mfma_f32_16x16x32_bf16 v[128:131], a[192:195], v[48:51], v[184:187]
  v_exp_f32 v208, v96
  v_mfma_f32_16x16x32_bf16 v[128:131], a[196:199], v[52:55], v[128:131]
  ds_read_b128 a[240:243], v2 offset:28672
  v_mfma_f32_16x16x32_bf16 v[128:131], a[200:203], v[56:59], v[128:131]
  s_xor_b32 m0, s37, 0x1c000
  v_exp_f32 v209, v97
  v_mfma_f32_16x16x32_bf16 v[128:131], a[204:207], v[60:63], v[128:131]
  ds_read_b128 a[244:247], v2 offset:29696
  buffer_load_dwordx4 v13, s[20:23], s36 offen offset:0 sc1 lds
  v_mfma_f32_16x16x32_bf16 v[136:139], a[204:207], v[76:79], v[188:191]
  v_exp_f32 v210, v104
  v_mfma_f32_16x16x32_bf16 v[136:139], a[200:203], v[72:75], v[136:139]
  ds_read_b128 a[248:251], v2 offset:30720
  v_cvt_pk_bf16_f32 v152, v208, v209
  v_mfma_f32_16x16x32_bf16 v[136:139], a[196:199], v[68:71], v[136:139]
  v_exp_f32 v211, v105
  v_mfma_f32_16x16x32_bf16 v[136:139], a[192:195], v[64:67], v[136:139]
  ds_read_b128 a[252:255], v2 offset:31744
  v_mfma_f32_16x16x32_bf16 v[132:135], a[208:211], v[48:51], v[184:187]
  v_exp_f32 v212, v98
  v_mfma_f32_16x16x32_bf16 v[132:135], a[212:215], v[52:55], v[132:135]
  ds_read_b128 a[192:195], v2 offset:32768
  v_cvt_pk_bf16_f32 v156, v210, v211
  v_mfma_f32_16x16x32_bf16 v[132:135], a[216:219], v[56:59], v[132:135]
  v_exp_f32 v213, v99
  v_mfma_f32_16x16x32_bf16 v[132:135], a[220:223], v[60:63], v[132:135]
  ds_read_b128 a[196:199], v2 offset:33792
  buffer_load_dwordx4 v13, s[20:23], s36 offen offset:1024 sc1 lds
  v_mfma_f32_16x16x32_bf16 v[140:143], a[220:223], v[76:79], v[188:191]
  v_exp_f32 v214, v106
  v_mfma_f32_16x16x32_bf16 v[140:143], a[216:219], v[72:75], v[140:143]
  ds_read_b128 a[200:203], v2 offset:34816
  v_cvt_pk_bf16_f32 v153, v212, v213
  v_mfma_f32_16x16x32_bf16 v[140:143], a[212:215], v[68:71], v[140:143]
  v_exp_f32 v215, v107
  v_mfma_f32_16x16x32_bf16 v[140:143], a[208:211], v[64:67], v[140:143]
  ds_read_b128 a[204:207], v2 offset:35840
  s_waitcnt lgkmcnt(4)
  v_mfma_f32_16x16x32_bf16 a[64:67], a[224:227], v[224:227], a[64:67]
  v_exp_f32 v208, v100
  v_mfma_f32_16x16x32_bf16 a[64:67], a[228:231], v[232:235], a[64:67]
  ds_read_b128 a[208:211], v2 offset:36864
  v_cvt_pk_bf16_f32 v157, v214, v215
  v_mfma_f32_16x16x32_bf16 a[96:99], a[228:231], v[236:239], a[96:99]
  v_exp_f32 v209, v101
  v_mfma_f32_16x16x32_bf16 a[96:99], a[224:227], v[228:231], a[96:99]
  ds_read_b128 a[212:215], v2 offset:37888
  buffer_load_dwordx4 v13, s[20:23], s36 offen offset:2048 sc1 lds
  v_mfma_f32_16x16x32_bf16 a[100:103], a[232:235], v[228:231], a[100:103]
  v_exp_f32 v210, v108
  v_mfma_f32_16x16x32_bf16 a[100:103], a[236:239], v[236:239], a[100:103]
  ds_read_b128 a[216:219], v2 offset:38912
  v_cvt_pk_bf16_f32 v154, v208, v209
  v_mfma_f32_16x16x32_bf16 a[68:71], a[236:239], v[232:235], a[68:71]
  v_exp_f32 v211, v109
  v_mfma_f32_16x16x32_bf16 a[68:71], a[232:235], v[224:227], a[68:71]
  ds_read_b128 a[220:223], v2 offset:39936
  v_mfma_f32_16x16x32_bf16 a[72:75], a[240:243], v[224:227], a[72:75]
  v_exp_f32 v212, v102
  v_mfma_f32_16x16x32_bf16 a[72:75], a[244:247], v[232:235], a[72:75]
  ds_read_b128 a[224:227], v2 offset:40960
  v_cvt_pk_bf16_f32 v158, v210, v211
  v_mfma_f32_16x16x32_bf16 a[104:107], a[244:247], v[236:239], a[104:107]
  v_exp_f32 v213, v103
  v_mfma_f32_16x16x32_bf16 a[104:107], a[240:243], v[228:231], a[104:107]
  ds_read_b128 a[228:231], v2 offset:41984
  buffer_load_dwordx4 v13, s[20:23], s36 offen offset:3072 sc1 lds
  v_mfma_f32_16x16x32_bf16 a[108:111], a[248:251], v[228:231], a[108:111]
  v_exp_f32 v214, v110
  v_mfma_f32_16x16x32_bf16 a[108:111], a[252:255], v[236:239], a[108:111]
  ds_read_b128 a[232:235], v2 offset:43008
  v_cvt_pk_bf16_f32 v155, v212, v213
  v_mfma_f32_16x16x32_bf16 a[76:79], a[252:255], v[232:235], a[76:79]
  v_exp_f32 v215, v111
  v_mfma_f32_16x16x32_bf16 a[76:79], a[248:251], v[224:227], a[76:79]
  ds_read_b128 a[236:239], v2 offset:44032
  v_mfma_f32_16x16x32_bf16 v[200:203], v[240:243], v[224:227], v[200:203]
  v_cvt_pk_bf16_f32 v159, v214, v215
  v_mfma_f32_16x16x32_bf16 v[200:203], v[240:243], v[232:235], v[200:203]
  s_waitcnt vmcnt(12) lgkmcnt(4)
  s_barrier
  v_mfma_f32_16x16x32_bf16 v[96:99], a[192:195], v[48:51], v[184:187]
  v_exp_f32 v208, v128
  v_mfma_f32_16x16x32_bf16 v[96:99], a[196:199], v[52:55], v[96:99]
  ds_read_b128 a[240:243], v2 offset:45056
  v_mfma_f32_16x16x32_bf16 v[96:99], a[200:203], v[56:59], v[96:99]
  s_mov_b32 m0, s37
  v_exp_f32 v209, v129
  v_mfma_f32_16x16x32_bf16 v[96:99], a[204:207], v[60:63], v[96:99]
  ds_read_b128 a[244:247], v2 offset:46080
  buffer_load_dwordx4 v14, s[20:23], s36 offen offset:0 sc1 lds
  v_mfma_f32_16x16x32_bf16 v[104:107], a[204:207], v[76:79], v[188:191]
  v_exp_f32 v210, v136
  v_mfma_f32_16x16x32_bf16 v[104:107], a[200:203], v[72:75], v[104:107]
  ds_read_b128 a[248:251], v2 offset:47104
  v_cvt_pk_bf16_f32 v168, v208, v209
  v_mfma_f32_16x16x32_bf16 v[104:107], a[196:199], v[68:71], v[104:107]
  v_exp_f32 v211, v137
  v_mfma_f32_16x16x32_bf16 v[104:107], a[192:195], v[64:67], v[104:107]
  ds_read_b128 a[252:255], v2 offset:48128
  v_mfma_f32_16x16x32_bf16 v[100:103], a[208:211], v[48:51], v[184:187]
  v_exp_f32 v212, v130
  v_mfma_f32_16x16x32_bf16 v[100:103], a[212:215], v[52:55], v[100:103]
  ds_read_b128 a[192:195], v2 offset:49152
  v_cvt_pk_bf16_f32 v172, v210, v211
  v_mfma_f32_16x16x32_bf16 v[100:103], a[216:219], v[56:59], v[100:103]
  v_exp_f32 v213, v131
  v_mfma_f32_16x16x32_bf16 v[100:103], a[220:223], v[60:63], v[100:103]
  ds_read_b128 a[196:199], v2 offset:50176
  buffer_load_dwordx4 v14, s[20:23], s36 offen offset:1024 sc1 lds
  v_mfma_f32_16x16x32_bf16 v[108:111], a[220:223], v[76:79], v[188:191]
  v_exp_f32 v214, v138
  v_mfma_f32_16x16x32_bf16 v[108:111], a[216:219], v[72:75], v[108:111]
  ds_read_b128 a[200:203], v2 offset:51200
  v_cvt_pk_bf16_f32 v169, v212, v213
  v_mfma_f32_16x16x32_bf16 v[108:111], a[212:215], v[68:71], v[108:111]
  v_exp_f32 v215, v139
  v_mfma_f32_16x16x32_bf16 v[108:111], a[208:211], v[64:67], v[108:111]
  ds_read_b128 a[204:207], v2 offset:52224
  s_waitcnt lgkmcnt(4)
  v_mfma_f32_16x16x32_bf16 a[80:83], a[224:227], v[224:227], a[80:83]
  v_exp_f32 v208, v132
  v_mfma_f32_16x16x32_bf16 a[80:83], a[228:231], v[232:235], a[80:83]
  ds_read_b128 a[208:211], v2 offset:53248
  v_cvt_pk_bf16_f32 v173, v214, v215
  v_mfma_f32_16x16x32_bf16 a[112:115], a[228:231], v[236:239], a[112:115]
  v_exp_f32 v209, v133
  v_mfma_f32_16x16x32_bf16 a[112:115], a[224:227], v[228:231], a[112:115]
  ds_read_b128 a[212:215], v2 offset:54272
  buffer_load_dwordx4 v14, s[20:23], s36 offen offset:2048 sc1 lds
  v_mfma_f32_16x16x32_bf16 a[116:119], a[232:235], v[228:231], a[116:119]
  v_exp_f32 v210, v140
  v_mfma_f32_16x16x32_bf16 a[116:119], a[236:239], v[236:239], a[116:119]
  ds_read_b128 a[216:219], v2 offset:55296
  v_cvt_pk_bf16_f32 v170, v208, v209
  v_mfma_f32_16x16x32_bf16 a[84:87], a[236:239], v[232:235], a[84:87]
  v_exp_f32 v211, v141
  v_mfma_f32_16x16x32_bf16 a[84:87], a[232:235], v[224:227], a[84:87]
  ds_read_b128 a[220:223], v2 offset:56320
  v_mfma_f32_16x16x32_bf16 a[88:91], a[240:243], v[224:227], a[88:91]
  v_exp_f32 v212, v134
  v_mfma_f32_16x16x32_bf16 a[88:91], a[244:247], v[232:235], a[88:91]
  ds_read_b128 a[224:227], v2 offset:57344
  v_cvt_pk_bf16_f32 v174, v210, v211
  v_mfma_f32_16x16x32_bf16 a[120:123], a[244:247], v[236:239], a[120:123]
  v_exp_f32 v213, v135
  v_mfma_f32_16x16x32_bf16 a[120:123], a[240:243], v[228:231], a[120:123]
  ds_read_b128 a[228:231], v2 offset:58368
  buffer_load_dwordx4 v14, s[20:23], s36 offen offset:3072 sc1 lds
  v_mfma_f32_16x16x32_bf16 a[124:127], a[248:251], v[228:231], a[124:127]
  v_exp_f32 v214, v142
  v_mfma_f32_16x16x32_bf16 a[124:127], a[252:255], v[236:239], a[124:127]
  ds_read_b128 a[232:235], v2 offset:59392
  v_cvt_pk_bf16_f32 v171, v212, v213
  v_mfma_f32_16x16x32_bf16 a[92:95], a[252:255], v[232:235], a[92:95]
  v_exp_f32 v215, v143
  v_mfma_f32_16x16x32_bf16 a[92:95], a[248:251], v[224:227], a[92:95]
  ds_read_b128 a[236:239], v2 offset:60416
  v_mfma_f32_16x16x32_bf16 v[204:207], v[240:243], v[228:231], v[204:207]
  v_cvt_pk_bf16_f32 v175, v214, v215
  v_mfma_f32_16x16x32_bf16 v[204:207], v[240:243], v[236:239], v[204:207]
  s_branch K_HALF3
K_F0:
K_hA3_8:
  s_cbranch_execz K_hA3_9
  s_waitcnt vmcnt(12) lgkmcnt(4)
  s_barrier
  v_mfma_f32_16x16x32_bf16 v[96:99], a[192:195], v[48:51], v[216:219]
  v_exp_f32 v208, v128
  v_mfma_f32_16x16x32_bf16 v[96:99], a[196:199], v[52:55], v[96:99]
  ds_read_b128 a[240:243], v2 offset:12288
  s_mov_b32 s27, 66195456
  v_lshlrev_b32 v3, 6, v0
  v_and_b32 v3, 0xf80, v3
  v_and_b32 v195, 16, v1
  v_add_u32 v3, v3, v195
  buffer_load_dwordx4 a[160:163], v3, s[20:23], s27 offen sc1
  v_mfma_f32_16x16x32_bf16 v[96:99], a[200:203], v[56:59], v[96:99]
  s_xor_b32 m0, s37, 0x18000
  v_exp_f32 v209, v129
  v_mfma_f32_16x16x32_bf16 v[96:99], a[204:207], v[60:63], v[96:99]
  ds_read_b128 a[244:247], v2 offset:13312
  buffer_load_dwordx4 v1, s[20:23], s36 offen offset:0 sc1 lds
  v_mfma_f32_16x16x32_bf16 v[104:107], a[204:207], v[76:79], v[188:191]
  v_exp_f32 v210, v136
  v_mfma_f32_16x16x32_bf16 v[104:107], a[200:203], v[72:75], v[104:107]
  ds_read_b128 a[248:251], v2 offset:14336
  v_cvt_pk_bf16_f32 v232, v208, v209
  v_mfma_f32_16x16x32_bf16 v[104:107], a[196:199], v[68:71], v[104:107]
  v_exp_f32 v211, v137
  v_mfma_f32_16x16x32_bf16 v[104:107], a[192:195], v[64:67], v[104:107]
  ds_read_b128 a[252:255], v2 offset:15360
  buffer_load_dwordx4 v1, s[20:23], s36 offen offset:1024 sc1 lds
  v_mfma_f32_16x16x32_bf16 v[100:103], a[208:211], v[48:51], v[220:223]
  v_exp_f32 v212, v130
  v_mfma_f32_16x16x32_bf16 v[100:103], a[212:215], v[52:55], v[100:103]
  ds_read_b128 a[192:195], v2 offset:16384
  v_cvt_pk_bf16_f32 v236, v210, v211
  v_mfma_f32_16x16x32_bf16 v[100:103], a[216:219], v[56:59], v[100:103]
  v_exp_f32 v213, v131
  v_mfma_f32_16x16x32_bf16 v[100:103], a[220:223], v[60:63], v[100:103]
  ds_read_b128 a[196:199], v2 offset:17408
  buffer_load_dwordx4 v1, s[20:23], s36 offen offset:2048 sc1 lds
  buffer_load_dwordx4 v1, s[20:23], s36 offen offset:3072 sc1 lds
  v_mfma_f32_16x16x32_bf16 v[108:111], a[220:223], v[76:79], v[188:191]
  v_exp_f32 v214, v138
  v_mfma_f32_16x16x32_bf16 v[108:111], a[216:219], v[72:75], v[108:111]
  ds_read_b128 a[200:203], v2 offset:18432
  v_cvt_pk_bf16_f32 v233, v212, v213
  v_accvgpr_read_b32 v216, a136
  v_mfma_f32_16x16x32_bf16 v[108:111], a[212:215], v[68:71], v[108:111]
  v_exp_f32 v215, v139
  v_add_f32 v216, v184, v216
  v_mfma_f32_16x16x32_bf16 v[108:111], a[208:211], v[64:67], v[108:111]
  ds_read_b128 a[204:207], v2 offset:19456
  s_waitcnt lgkmcnt(4)
  v_lshlrev_b32 v14, 7, v0
  v_accvgpr_read_b32 v217, a137
  v_mfma_f32_16x16x32_bf16 a[80:83], a[224:227], v[152:155], a[80:83]
  buffer_load_dword v199, v14, s[20:23], s34 offen sc1
  s_lshl_b32 s64, s25, 3
  v_exp_f32 v208, v132
  v_add_f32 v217, v185, v217
  v_mfma_f32_16x16x32_bf16 a[80:83], a[228:231], v[168:171], a[80:83]
  ds_read_b128 a[208:211], v2 offset:20480
  s_add_u32 s64, s64, s26
  v_cvt_pk_bf16_f32 v237, v214, v215
  v_mfma_f32_16x16x32_bf16 a[112:115], a[228:231], v[172:175], a[112:115]
  s_lshl_b32 s64, s64, 2
  v_exp_f32 v209, v133
  v_accvgpr_read_b32 v218, a138
  v_mfma_f32_16x16x32_bf16 a[112:115], a[224:227], v[156:159], a[112:115]
  ds_read_b128 a[212:215], v2 offset:21504
  s_add_u32 s64, s64, s24
  s_mul_i32 s64, s64, 4608
  v_add_f32 v218, v186, v218
  v_mfma_f32_16x16x32_bf16 a[116:119], a[232:235], v[156:159], a[116:119]
  v_exp_f32 v210, v140
  v_accvgpr_read_b32 v219, a139
  v_mfma_f32_16x16x32_bf16 a[116:119], a[236:239], v[172:175], a[116:119]
  ds_read_b128 a[216:219], v2 offset:22528
  v_cvt_pk_bf16_f32 v234, v208, v209
  v_mfma_f32_16x16x32_bf16 a[84:87], a[236:239], v[168:171], a[84:87]
  v_exp_f32 v211, v141
  v_add_f32 v219, v187, v219
  v_mfma_f32_16x16x32_bf16 a[84:87], a[232:235], v[152:155], a[84:87]
  ds_read_b128 a[220:223], v2 offset:23552
  v_min_u32 v13, 35, v0
  v_lshlrev_b32 v13, 7, v13
  v_accvgpr_read_b32 v220, a140
  v_mfma_f32_16x16x32_bf16 a[88:91], a[240:243], v[152:155], a[88:91]
  buffer_load_dword v199, v13, s[16:19], s64 offen
  v_exp_f32 v212, v134
  v_add_f32 v220, v184, v220
  v_mfma_f32_16x16x32_bf16 a[88:91], a[244:247], v[168:171], a[88:91]
  ds_read_b128 a[224:227], v2 offset:24576
  v_cvt_pk_bf16_f32 v238, v210, v211
  v_mfma_f32_16x16x32_bf16 a[120:123], a[244:247], v[172:175], a[120:123]
  v_exp_f32 v213, v135
  v_accvgpr_read_b32 v221, a141
  v_mfma_f32_16x16x32_bf16 a[120:123], a[240:243], v[156:159], a[120:123]
  ds_read_b128 a[228:231], v2 offset:25600
  s_getpc_b64 s[92:93]
K_pcb:
  s_add_u32 s92, s92, K_tail-K_pcb
  s_addc_u32 s93, s93, 0
  v_add_f32 v221, v185, v221
  v_mfma_f32_16x16x32_bf16 a[124:127], a[248:251], v[156:159], a[124:127]
  s_lshr_b32 s65, s2, 1
  v_exp_f32 v214, v142
  v_accvgpr_read_b32 v222, a142
  v_mfma_f32_16x16x32_bf16 a[124:127], a[252:255], v[172:175], a[124:127]
  ds_read_b128 a[232:235], v2 offset:26624
  s_and_b32 s65, s65, 0x7c
  v_cvt_pk_bf16_f32 v235, v212, v213
  v_mfma_f32_16x16x32_bf16 a[92:95], a[252:255], v[168:171], a[92:95]
  s_add_u32 s65, s65, s24
  v_exp_f32 v215, v143
  v_add_f32 v222, v186, v222
  v_mfma_f32_16x16x32_bf16 a[92:95], a[248:251], v[152:155], a[92:95]
  ds_read_b128 a[236:239], v2 offset:27648
  s_mul_i32 s65, s65, 3
  v_min_u32 v15, 2, v0
  v_accvgpr_read_b32 v223, a143
  v_mfma_f32_16x16x32_bf16 v[204:207], v[240:243], v[156:159], v[204:207]
  v_cvt_pk_bf16_f32 v239, v214, v215
  v_add_u32 v15, s65, v15
  v_add_f32 v223, v187, v223
  v_mfma_f32_16x16x32_bf16 v[204:207], v[240:243], v[172:175], v[204:207]
  v_min_u32 v15, (K_last-K_tail)/128-1, v15
  v_lshlrev_b32 v15, 7, v15
  global_load_dword v199, v15, s[92:93]
  s_waitcnt lgkmcnt(4)
  v_mfma_f32_16x16x32_bf16 v[128:131], a[192:195], v[48:51], v[216:219]
  v_exp_f32 v208, v96
  v_mfma_f32_16x16x32_bf16 v[128:131], a[196:199], v[52:55], v[128:131]
  ds_read_b128 a[240:243], v2 offset:28672
  v_mov_b32 v176, 0
  v_mfma_f32_16x16x32_bf16 v[128:131], a[200:203], v[56:59], v[128:131]
  v_exp_f32 v209, v97
  v_mfma_f32_16x16x32_bf16 v[128:131], a[204:207], v[60:63], v[128:131]
  ds_read_b128 a[244:247], v2 offset:29696
  v_mov_b32 v177, 0
  v_mfma_f32_16x16x32_bf16 v[136:139], a[204:207], v[76:79], v[188:191]
  v_exp_f32 v210, v104
  v_mfma_f32_16x16x32_bf16 v[136:139], a[200:203], v[72:75], v[136:139]
  ds_read_b128 a[248:251], v2 offset:30720
  v_cvt_pk_bf16_f32 v152, v208, v209
  v_mfma_f32_16x16x32_bf16 v[136:139], a[196:199], v[68:71], v[136:139]
  v_exp_f32 v211, v105
  v_mfma_f32_16x16x32_bf16 v[136:139], a[192:195], v[64:67], v[136:139]
  ds_read_b128 a[252:255], v2 offset:31744
  v_mov_b32 v178, 0
  v_mfma_f32_16x16x32_bf16 v[132:135], a[208:211], v[48:51], v[220:223]
  v_exp_f32 v212, v98
  v_mfma_f32_16x16x32_bf16 v[132:135], a[212:215], v[52:55], v[132:135]
  ds_read_b128 a[192:195], v2 offset:32768
  v_cvt_pk_bf16_f32 v156, v210, v211
  v_mfma_f32_16x16x32_bf16 v[132:135], a[216:219], v[56:59], v[132:135]
  v_exp_f32 v213, v99
  v_mfma_f32_16x16x32_bf16 v[132:135], a[220:223], v[60:63], v[132:135]
  ds_read_b128 a[196:199], v2 offset:33792
  v_mov_b32 v179, 0
  v_add_u32 v180, 8256, v1
  v_and_b32 v181, 48, v1
  v_mfma_f32_16x16x32_bf16 v[140:143], a[220:223], v[76:79], v[188:191]
  v_exp_f32 v214, v106
  v_mfma_f32_16x16x32_bf16 v[140:143], a[216:219], v[72:75], v[140:143]
  ds_read_b128 a[200:203], v2 offset:34816
  v_cvt_pk_bf16_f32 v153, v212, v213
  v_add_u32 v181, 4096, v181
  v_mfma_f32_16x16x32_bf16 v[140:143], a[212:215], v[68:71], v[140:143]
  v_exp_f32 v215, v107
  v_mfma_f32_16x16x32_bf16 v[140:143], a[208:211], v[64:67], v[140:143]
  ds_read_b128 a[204:207], v2 offset:35840
  s_waitcnt lgkmcnt(4)
  v_accvgpr_read_b32 v216, a128
  v_cmp_gt_u32 vcc, 36, v0
  s_nop 1
  v_cndmask_b32 v180, v181, v180, vcc
  v_mfma_f32_16x16x32_bf16 a[64:67], a[224:227], v[224:227], a[64:67]
  v_exp_f32 v208, v100
  v_mfma_f32_16x16x32_bf16 a[64:67], a[228:231], v[232:235], a[64:67]
  ds_read_b128 a[208:211], v2 offset:36864
  v_cvt_pk_bf16_f32 v157, v214, v215
K_hA0_9:
  s_cbranch_execz K_hA0_10
  v_add_u32 v180, s33, v180
  v_mfma_f32_16x16x32_bf16 a[96:99], a[228:231], v[236:239], a[96:99]
  v_exp_f32 v209, v101
  v_mfma_f32_16x16x32_bf16 a[96:99], a[224:227], v[228:231], a[96:99]
  ds_write_b128 v180, v[176:179]
  ds_read_b128 a[212:215], v2 offset:37888
  v_add_f32 v216, v188, v216
  v_mfma_f32_16x16x32_bf16 a[100:103], a[232:235], v[228:231], a[100:103]
  v_exp_f32 v210, v108
  v_mfma_f32_16x16x32_bf16 a[100:103], a[236:239], v[236:239], a[100:103]
  ds_read_b128 a[216:219], v2 offset:38912
  v_cvt_pk_bf16_f32 v154, v208, v209
  v_mfma_f32_16x16x32_bf16 a[68:71], a[236:239], v[232:235], a[68:71]
  v_exp_f32 v211, v109
  v_mfma_f32_16x16x32_bf16 a[68:71], a[232:235], v[224:227], a[68:71]
  ds_read_b128 a[220:223], v2 offset:39936
  v_accvgpr_read_b32 v217, a129
  v_add_f32 v217, v189, v217
  v_accvgpr_read_b32 v218, a130
  v_mfma_f32_16x16x32_bf16 a[72:75], a[240:243], v[224:227], a[72:75]
  v_exp_f32 v212, v102
  v_mfma_f32_16x16x32_bf16 a[72:75], a[244:247], v[232:235], a[72:75]
  ds_read_b128 a[224:227], v2 offset:40960
  v_cvt_pk_bf16_f32 v158, v210, v211
  v_mfma_f32_16x16x32_bf16 a[104:107], a[244:247], v[236:239], a[104:107]
  v_exp_f32 v213, v103
  v_mfma_f32_16x16x32_bf16 a[104:107], a[240:243], v[228:231], a[104:107]
  ds_read_b128 a[228:231], v2 offset:41984
  v_add_f32 v218, v190, v218
  v_accvgpr_read_b32 v219, a131
  v_add_f32 v219, v191, v219
  v_mfma_f32_16x16x32_bf16 a[108:111], a[248:251], v[228:231], a[108:111]
  v_exp_f32 v214, v110
  v_mfma_f32_16x16x32_bf16 a[108:111], a[252:255], v[236:239], a[108:111]
  ds_read_b128 a[232:235], v2 offset:43008
  v_cvt_pk_bf16_f32 v155, v212, v213
  v_mfma_f32_16x16x32_bf16 a[76:79], a[252:255], v[232:235], a[76:79]
  v_exp_f32 v215, v111
  v_mfma_f32_16x16x32_bf16 a[76:79], a[248:251], v[224:227], a[76:79]
  ds_read_b128 a[236:239], v2 offset:44032
  v_accvgpr_read_b32 v220, a132
  v_mfma_f32_16x16x32_bf16 v[200:203], v[240:243], v[224:227], v[200:203]
  v_cvt_pk_bf16_f32 v159, v214, v215
  v_add_f32 v220, v188, v220
  v_accvgpr_read_b32 v221, a133
  v_add_f32 v221, v189, v221
  v_accvgpr_read_b32 v222, a134
  v_add_f32 v222, v190, v222
  v_accvgpr_read_b32 v223, a135
  v_add_f32 v223, v191, v223
  v_mfma_f32_16x16x32_bf16 v[200:203], v[240:243], v[232:235], v[200:203]
  s_waitcnt vmcnt(7) lgkmcnt(4)
  s_barrier
  v_mfma_f32_16x16x32_bf16 v[104:107], a[192:195], v[64:67], v[216:219]
  ds_read_b128 a[240:243], v2 offset:45056
  v_exp_f32 v208, v128
  v_mfma_f32_16x16x32_bf16 v[104:107], a[196:199], v[68:71], v[104:107]
  v_exp_f32 v209, v129
  v_mfma_f32_16x16x32_bf16 v[104:107], a[200:203], v[72:75], v[104:107]
  ds_read_b128 a[244:247], v2 offset:46080
  ds_read_b128 a[248:251], v2 offset:47104
  v_mfma_f32_16x16x32_bf16 v[104:107], a[204:207], v[76:79], v[104:107]
  v_exp_f32 v210, v136
  v_mfma_f32_16x16x32_bf16 v[108:111], a[208:211], v[64:67], v[220:223]
  ds_read_b128 a[252:255], v2 offset:48128
  ds_read_b128 a[192:195], v2 offset:49152
  v_cvt_pk_bf16_f32 v168, v208, v209
  v_mfma_f32_16x16x32_bf16 v[108:111], a[212:215], v[68:71], v[108:111]
  ds_read_b128 a[196:199], v2 offset:50176
  v_exp_f32 v211, v137
  v_mfma_f32_16x16x32_bf16 v[108:111], a[216:219], v[72:75], v[108:111]
  v_exp_f32 v212, v130
  v_mfma_f32_16x16x32_bf16 v[108:111], a[220:223], v[76:79], v[108:111]
  ds_read_b128 a[200:203], v2 offset:51200
  ds_read_b128 a[204:207], v2 offset:52224
  s_waitcnt lgkmcnt(8)
  v_cvt_pk_bf16_f32 v172, v210, v211
  v_mfma_f32_16x16x32_bf16 a[80:83], a[224:227], v[224:227], a[80:83]
  v_exp_f32 v213, v131
  v_accvgpr_read_b32 v216, a136
  v_mfma_f32_16x16x32_bf16 a[80:83], a[228:231], v[232:235], a[80:83]
  v_exp_f32 v214, v138
  v_add_f32 v216, v188, v216
  v_mfma_f32_16x16x32_bf16 a[112:115], a[228:231], v[236:239], a[112:115]
  ds_read_b128 a[208:211], v2 offset:53248
  v_cvt_pk_bf16_f32 v169, v212, v213
  v_accvgpr_read_b32 v217, a137
  v_mfma_f32_16x16x32_bf16 a[112:115], a[224:227], v[228:231], a[112:115]
  ds_read_b128 a[212:215], v2 offset:54272
  v_exp_f32 v215, v139
  v_add_f32 v217, v189, v217
  v_mfma_f32_16x16x32_bf16 a[116:119], a[232:235], v[228:231], a[116:119]
  v_exp_f32 v208, v132
  v_accvgpr_read_b32 v218, a138
  v_mfma_f32_16x16x32_bf16 a[116:119], a[236:239], v[236:239], a[116:119]
  ds_read_b128 a[216:219], v2 offset:55296
  v_cvt_pk_bf16_f32 v173, v214, v215
  v_add_f32 v218, v190, v218
  v_mfma_f32_16x16x32_bf16 a[84:87], a[236:239], v[232:235], a[84:87]
  v_exp_f32 v209, v133
  v_accvgpr_read_b32 v219, a139
  v_mfma_f32_16x16x32_bf16 a[84:87], a[232:235], v[224:227], a[84:87]
  s_waitcnt lgkmcnt(7)
  v_exp_f32 v210, v140
  v_add_f32 v219, v191, v219
  v_mfma_f32_16x16x32_bf16 a[88:91], a[240:243], v[224:227], a[88:91]
  ds_read_b128 a[220:223], v2 offset:56320
  v_cvt_pk_bf16_f32 v170, v208, v209
  v_mfma_f32_16x16x32_bf16 a[88:91], a[244:247], v[232:235], a[88:91]
  ds_read_b128 a[224:227], v2 offset:57344
  v_exp_f32 v211, v141
  v_accvgpr_read_b32 v220, a140
  v_mfma_f32_16x16x32_bf16 a[120:123], a[244:247], v[236:239], a[120:123]
  v_exp_f32 v212, v134
  v_add_f32 v220, v188, v220
  v_mfma_f32_16x16x32_bf16 a[120:123], a[240:243], v[228:231], a[120:123]
  ds_read_b128 a[228:231], v2 offset:58368
  v_cvt_pk_bf16_f32 v174, v210, v211
  v_accvgpr_read_b32 v221, a141
  v_mfma_f32_16x16x32_bf16 a[124:127], a[248:251], v[228:231], a[124:127]
  v_exp_f32 v213, v135
  v_add_f32 v221, v189, v221
  v_mfma_f32_16x16x32_bf16 a[124:127], a[252:255], v[236:239], a[124:127]
  v_exp_f32 v214, v142
  v_accvgpr_read_b32 v222, a142
  v_mfma_f32_16x16x32_bf16 a[92:95], a[252:255], v[232:235], a[92:95]
  ds_read_b128 a[232:235], v2 offset:59392
  v_cvt_pk_bf16_f32 v171, v212, v213
  v_add_f32 v222, v190, v222
  v_mfma_f32_16x16x32_bf16 a[92:95], a[248:251], v[224:227], a[92:95]
  v_exp_f32 v215, v143
  v_accvgpr_read_b32 v223, a143
  v_mfma_f32_16x16x32_bf16 v[204:207], v[240:243], v[228:231], v[204:207]
  ds_read_b128 a[236:239], v2 offset:60416
  v_cvt_pk_bf16_f32 v175, v214, v215
  v_mfma_f32_16x16x32_bf16 v[204:207], v[240:243], v[236:239], v[204:207]
  v_add_f32 v223, v191, v223
K_F3:
K_hA1_9:
  s_cbranch_execz K_hA1_10
  s_waitcnt lgkmcnt(4)
  v_mfma_f32_16x16x32_bf16 v[136:139], a[192:195], v[64:67], v[216:219]
  v_exp_f32 v208, v104
  v_mfma_f32_16x16x32_bf16 v[136:139], a[196:199], v[68:71], v[136:139]
  ds_read_b128 a[240:243], v2 offset:61440
  ds_read_b128 a[244:247], v2 offset:62464
  v_mfma_f32_16x16x32_bf16 v[136:139], a[200:203], v[72:75], v[136:139]
  ds_read_b128 a[248:251], v2 offset:63488
  v_mfma_f32_16x16x32_bf16 v[136:139], a[204:207], v[76:79], v[136:139]
  v_exp_f32 v209, v105
  v_mfma_f32_16x16x32_bf16 v[140:143], a[208:211], v[64:67], v[220:223]
  ds_read_b128 a[252:255], v2 offset:64512
  v_xor_b32 v2, 0x10000, v2
  v_mfma_f32_16x16x32_bf16 v[140:143], a[212:215], v[68:71], v[140:143]
  s_and_b32 s27, s24, 1
  s_lshl_b32 s27, s27, 11
  s_add_u32 s27, s27, s33
  v_add_u32 v13, s27, v1
  v_mfma_f32_16x16x32_bf16 v[140:143], a[216:219], v[72:75], v[140:143]
  v_exp_f32 v210, v106
  v_mfma_f32_16x16x32_bf16 v[140:143], a[220:223], v[76:79], v[140:143]
  ds_read_b128 v[144:147], v13 offset:0
  s_waitcnt lgkmcnt(5)
  v_cvt_pk_bf16_f32 v228, v208, v209
  v_mfma_f32_16x16x32_bf16 a[64:67], a[224:227], v[152:155], a[64:67]
  ds_read_b32 v148, v13 offset:16
  ds_read_b128 v[160:163], v13 offset:1024
  v_mfma_f32_16x16x32_bf16 a[64:67], a[228:231], v[168:171], a[64:67]
  v_exp_f32 v211, v107
  v_mfma_f32_16x16x32_bf16 a[96:99], a[228:231], v[172:175], a[96:99]
  ds_read_b32 v164, v13 offset:1040
  v_mfma_f32_16x16x32_bf16 a[96:99], a[224:227], v[156:159], a[96:99]
  v_accvgpr_read_b32 v3, a160
  v_accvgpr_read_b32 v195, a161
  v_and_b32 v3, v3, v195
  v_accvgpr_read_b32 v195, a162
  v_and_b32 v3, v3, v195
  v_accvgpr_read_b32 v195, a163
  v_and_b32 v3, v3, v195
  v_cmp_ne_u32 vcc, 1, v3
  s_cbranch_vccnz K_PG_spin
K_PG_ok:
  v_mfma_f32_16x16x32_bf16 a[100:103], a[232:235], v[156:159], a[100:103]
  v_exp_f32 v212, v108
  v_mfma_f32_16x16x32_bf16 a[100:103], a[236:239], v[172:175], a[100:103]
  v_cvt_pk_bf16_f32 v229, v210, v211
  v_mfma_f32_16x16x32_bf16 a[68:71], a[236:239], v[168:171], a[68:71]
  s_lshl_b32 s27, s24, 8
  s_add_u32 s27, s27, 131072
  v_lshl_add_u32 v198, v0, 2, s27
  v_mfma_f32_16x16x32_bf16 a[68:71], a[232:235], v[152:155], a[68:71]
  s_waitcnt lgkmcnt(4)
  v_exp_f32 v213, v109
  v_mfma_f32_16x16x32_bf16 a[72:75], a[240:243], v[152:155], a[72:75]
  ds_write_b32 v198, v194
  v_mfma_f32_16x16x32_bf16 a[72:75], a[244:247], v[168:171], a[72:75]
  ds_read_b128 a[224:227], v2 offset:8192
  v_mov_b32 v198, 131072
  v_mfma_f32_16x16x32_bf16 a[104:107], a[244:247], v[172:175], a[104:107]
  v_exp_f32 v214, v110
  v_mfma_f32_16x16x32_bf16 a[104:107], a[240:243], v[156:159], a[104:107]
  ds_read_b128 a[228:231], v2 offset:9216
  v_cvt_pk_bf16_f32 v230, v212, v213
  v_mfma_f32_16x16x32_bf16 a[108:111], a[248:251], v[156:159], a[108:111]
  s_waitcnt lgkmcnt(3)
  v_alignbit_b32 v144, v145, v144, 16
  v_alignbit_b32 v145, v146, v145, 16
  v_mfma_f32_16x16x32_bf16 a[108:111], a[252:255], v[172:175], a[108:111]
  v_exp_f32 v215, v111
  v_mfma_f32_16x16x32_bf16 a[76:79], a[252:255], v[168:171], a[76:79]
  ds_read_b128 a[232:235], v2 offset:10240
  v_alignbit_b32 v146, v147, v146, 16
  v_mfma_f32_16x16x32_bf16 a[76:79], a[248:251], v[152:155], a[76:79]
  ds_read_b128 a[236:239], v2 offset:11264
  v_alignbit_b32 v147, v148, v147, 16
  v_mfma_f32_16x16x32_bf16 v[200:203], v[240:243], v[152:155], v[200:203]
  v_cvt_pk_bf16_f32 v231, v214, v215
  v_mfma_f32_16x16x32_bf16 v[200:203], v[240:243], v[168:171], v[200:203]
  ds_write_b128 v13, v[144:147] offset:4160
  v_alignbit_b32 v160, v161, v160, 16
  v_alignbit_b32 v161, v162, v161, 16
  v_alignbit_b32 v162, v163, v162, 16
  v_alignbit_b32 v163, v164, v163, 16
  ds_write_b128 v13, v[160:163] offset:5184
  ds_read_b128 a[240:243], v2 offset:12288
  ds_read_b128 a[244:247], v2 offset:13312
  ds_read_b128 a[248:251], v2 offset:14336
  ds_read_b128 a[252:255], v2 offset:15360
  s_waitcnt lgkmcnt(4)
  v_mfma_f32_16x16x32_bf16 a[80:83], a[224:227], v[152:155], a[80:83]
  s_waitcnt vmcnt(0)
  s_barrier
  v_mfma_f32_16x16x32_bf16 a[80:83], a[228:231], v[168:171], a[80:83]
  v_exp_f32 v208, v136
  v_mfma_f32_16x16x32_bf16 a[112:115], a[228:231], v[172:175], a[112:115]
  v_exp_f32 v209, v137
  v_mfma_f32_16x16x32_bf16 a[112:115], a[224:227], v[156:159], a[112:115]
  ds_read_b32 v194, v198
  ds_read2_b32 a[128:129], v244 offset0:176 offset1:177
  ds_read2_b32 a[130:131], v244 offset0:178 offset1:179
  ds_read_b128 a[160:163], v248 offset:192
  v_mfma_f32_16x16x32_bf16 a[116:119], a[232:235], v[156:159], a[116:119]
  ds_read_b128 a[164:167], v248 offset:704
  v_exp_f32 v210, v138
  v_mfma_f32_16x16x32_bf16 a[116:119], a[236:239], v[172:175], a[116:119]
  ds_read_b128 a[224:227], v2 offset:24576
  ds_read_b128 a[228:231], v2 offset:25600
  ds_read_b128 a[168:171], v248 offset:1216
  ds_read_b128 a[172:175], v248 offset:1728
  v_cvt_pk_bf16_f32 v236, v208, v209
  v_mfma_f32_16x16x32_bf16 a[84:87], a[236:239], v[168:171], a[84:87]
  v_exp_f32 v211, v139
  v_mfma_f32_16x16x32_bf16 a[84:87], a[232:235], v[152:155], a[84:87]
  ds_read_b128 a[176:179], v248 offset:2240
  ds_read_b128 a[180:183], v248 offset:2752
  s_waitcnt lgkmcnt(11)
  v_mfma_f32_16x16x32_bf16 a[88:91], a[240:243], v[152:155], a[88:91]
  ds_read_b128 a[232:235], v2 offset:26624
  ds_read_b128 a[184:187], v248 offset:3264
  ds_read_b128 a[188:191], v248 offset:3776
  v_mfma_f32_16x16x32_bf16 a[88:91], a[244:247], v[168:171], a[88:91]
  ds_read2_b32 a[132:133], v244 offset0:48 offset1:49
  ds_read2_b32 a[134:135], v244 offset0:50 offset1:51
  v_exp_f32 v212, v140
  v_mfma_f32_16x16x32_bf16 a[120:123], a[244:247], v[172:175], a[120:123]
  ds_read_b128 a[236:239], v2 offset:27648
  ds_read2_b32 a[136:137], v245 offset0:176 offset1:177
  ds_read2_b32 a[138:139], v245 offset0:178 offset1:179
  v_cvt_pk_bf16_f32 v237, v210, v211
  v_mfma_f32_16x16x32_bf16 a[120:123], a[240:243], v[156:159], a[120:123]
  v_exp_f32 v213, v141
  v_mfma_f32_16x16x32_bf16 a[124:127], a[248:251], v[156:159], a[124:127]
  ds_read2_b32 a[140:141], v245 offset0:48 offset1:49
  ds_read2_b32 a[142:143], v245 offset0:50 offset1:51
  ds_read2_b32 a[144:145], v246 offset0:176 offset1:177
  v_mfma_f32_16x16x32_bf16 a[124:127], a[252:255], v[172:175], a[124:127]
  v_exp_f32 v214, v142
  v_mfma_f32_16x16x32_bf16 a[92:95], a[252:255], v[168:171], a[92:95]
  ds_read2_b32 a[146:147], v246 offset0:178 offset1:179
  ds_read2_b32 a[148:149], v246 offset0:48 offset1:49
  ds_read2_b32 a[150:151], v246 offset0:50 offset1:51
  v_cvt_pk_bf16_f32 v238, v212, v213
  v_mfma_f32_16x16x32_bf16 a[92:95], a[248:251], v[152:155], a[92:95]
  v_exp_f32 v215, v143
  v_mfma_f32_16x16x32_bf16 v[204:207], v[240:243], v[156:159], v[204:207]
  ds_read2_b32 a[152:153], v247 offset0:176 offset1:177
  ds_read2_b32 a[154:155], v247 offset0:178 offset1:179
  v_mfma_f32_16x16x32_bf16 v[204:207], v[240:243], v[172:175], v[204:207]
  ds_read2_b32 a[156:157], v247 offset0:48 offset1:49
  ds_read2_b32 a[158:159], v247 offset0:50 offset1:51
  v_cvt_pk_bf16_f32 v239, v214, v215
  ds_read_b128 a[240:243], v2 offset:28672
  ds_read_b128 a[244:247], v2 offset:29696
  ds_read_b128 a[248:251], v2 offset:30720
  ds_read_b128 a[252:255], v2 offset:31744
  s_waitcnt lgkmcnt(4)
  v_mfma_f32_16x16x32_bf16 a[96:99], a[224:227], v[228:231], a[96:99]
  v_rcp_f32 v14, v200
  v_mfma_f32_16x16x32_bf16 a[96:99], a[228:231], v[236:239], a[96:99]
  s_add_u32 s35, s34, 8192
  v_accvgpr_read_b32 v144, a64
  v_accvgpr_read_b32 v145, a65
  v_accvgpr_read_b32 v146, a66
  v_mfma_f32_16x16x32_bf16 a[100:103], a[232:235], v[228:231], a[100:103]
  ds_read_b128 a[224:227], v2 offset:40960
  v_accvgpr_read_b32 v147, a67
  v_accvgpr_read_b32 v148, a68
  v_accvgpr_read_b32 v149, a69
  v_accvgpr_read_b32 v150, a70
  v_accvgpr_read_b32 v151, a71
  v_mfma_f32_16x16x32_bf16 a[100:103], a[236:239], v[236:239], a[100:103]
  ds_read_b128 a[228:231], v2 offset:41984
  s_waitcnt lgkmcnt(2)
  v_mul_f32 v144, v144, v14
  v_mul_f32 v145, v145, v14
  v_mul_f32 v146, v146, v14
  v_mul_f32 v147, v147, v14
  v_mul_f32 v148, v148, v14
  v_mfma_f32_16x16x32_bf16 a[104:107], a[240:243], v[228:231], a[104:107]
  ds_read_b128 a[232:235], v2 offset:43008
  v_mul_f32 v149, v149, v14
  v_mul_f32 v150, v150, v14
  v_mul_f32 v151, v151, v14
  v_cvt_pk_bf16_f32 v96, v144, v145
  v_cvt_pk_bf16_f32 v97, v146, v147
  v_mfma_f32_16x16x32_bf16 a[104:107], a[244:247], v[236:239], a[104:107]
  ds_read_b128 a[236:239], v2 offset:44032
  v_cvt_pk_bf16_f32 v98, v148, v149
  v_cvt_pk_bf16_f32 v99, v150, v151
  buffer_store_dwordx4 v[96:99], v1, s[20:23], s35 offen offset:0 sc1
  v_accvgpr_read_b32 v160, a72
  v_accvgpr_read_b32 v161, a73
  v_accvgpr_read_b32 v162, a74
  v_accvgpr_read_b32 v163, a75
  v_mfma_f32_16x16x32_bf16 a[108:111], a[248:251], v[228:231], a[108:111]
  v_accvgpr_read_b32 v164, a76
  v_accvgpr_read_b32 v165, a77
  v_accvgpr_read_b32 v166, a78
  v_mfma_f32_16x16x32_bf16 a[108:111], a[252:255], v[236:239], a[108:111]
  v_accvgpr_read_b32 v167, a79
  v_mul_f32 v160, v160, v14
  v_mul_f32 v161, v161, v14
  v_mul_f32 v162, v162, v14
  v_mul_f32 v163, v163, v14
  v_mul_f32 v164, v164, v14
  v_mul_f32 v165, v165, v14
  v_mul_f32 v166, v166, v14
  v_mul_f32 v167, v167, v14
  v_cvt_pk_bf16_f32 v100, v160, v161
  ds_read_b128 a[240:243], v2 offset:45056
  ds_read_b128 a[244:247], v2 offset:46080
  ds_read_b128 a[248:251], v2 offset:47104
  ds_read_b128 a[252:255], v2 offset:48128
  s_waitcnt lgkmcnt(4)
  v_mfma_f32_16x16x32_bf16 a[112:115], a[224:227], v[228:231], a[112:115]
  v_cvt_pk_bf16_f32 v101, v162, v163
  v_cvt_pk_bf16_f32 v102, v164, v165
  v_mfma_f32_16x16x32_bf16 a[112:115], a[228:231], v[236:239], a[112:115]
  v_cvt_pk_bf16_f32 v103, v166, v167
  v_mfma_f32_16x16x32_bf16 a[116:119], a[232:235], v[228:231], a[116:119]
  buffer_store_dwordx4 v[100:103], v1, s[20:23], s35 offen offset:1024 sc1
  v_accvgpr_read_b32 v144, a80
  v_accvgpr_read_b32 v145, a81
  v_accvgpr_read_b32 v146, a82
  v_accvgpr_read_b32 v147, a83
  v_mfma_f32_16x16x32_bf16 a[116:119], a[236:239], v[236:239], a[116:119]
  s_waitcnt lgkmcnt(0)
  v_accvgpr_read_b32 v148, a84
  v_accvgpr_read_b32 v149, a85
  v_mfma_f32_16x16x32_bf16 a[120:123], a[240:243], v[228:231], a[120:123]
  v_accvgpr_read_b32 v150, a86
  v_accvgpr_read_b32 v151, a87
  v_mfma_f32_16x16x32_bf16 a[120:123], a[244:247], v[236:239], a[120:123]
  v_mul_f32 v144, v144, v14
  v_mul_f32 v145, v145, v14
  v_mfma_f32_16x16x32_bf16 a[124:127], a[248:251], v[228:231], a[124:127]
  v_mul_f32 v146, v146, v14
  v_mul_f32 v147, v147, v14
  v_mfma_f32_16x16x32_bf16 a[124:127], a[252:255], v[236:239], a[124:127]
  v_mul_f32 v148, v148, v14
  v_mul_f32 v149, v149, v14
  v_mfma_f32_16x16x32_bf16 v[204:207], v[240:243], v[228:231], v[204:207]
  v_mul_f32 v150, v150, v14
  v_mul_f32 v151, v151, v14
  v_mfma_f32_16x16x32_bf16 v[204:207], v[240:243], v[236:239], v[204:207]
  v_cvt_pk_bf16_f32 v104, v144, v145
  v_cvt_pk_bf16_f32 v105, v146, v147
  v_cvt_pk_bf16_f32 v106, v148, v149
  v_cvt_pk_bf16_f32 v107, v150, v151
  buffer_store_dwordx4 v[104:107], v1, s[20:23], s35 offen offset:2048 sc1
  v_accvgpr_read_b32 v160, a88
  v_accvgpr_read_b32 v161, a89
  v_accvgpr_read_b32 v162, a90
  v_accvgpr_read_b32 v163, a91
  v_accvgpr_read_b32 v164, a92
  v_accvgpr_read_b32 v165, a93
  v_accvgpr_read_b32 v166, a94
  v_accvgpr_read_b32 v167, a95
  v_mul_f32 v160, v160, v14
  v_mul_f32 v161, v161, v14
  v_mul_f32 v162, v162, v14
  v_mul_f32 v163, v163, v14
  v_mul_f32 v164, v164, v14
  v_mul_f32 v165, v165, v14
  v_mul_f32 v166, v166, v14
  v_mul_f32 v167, v167, v14
  v_cvt_pk_bf16_f32 v108, v160, v161
  v_cvt_pk_bf16_f32 v109, v162, v163
  v_cvt_pk_bf16_f32 v110, v164, v165
  v_cvt_pk_bf16_f32 v111, v166, v167
  buffer_store_dwordx4 v[108:111], v1, s[20:23], s35 offen offset:3072 sc1
  s_mov_b32 s95, s0
  s_mov_b32 s65, s3
  s_mov_b32 s1, 0x7f000000
  s_waitcnt lgkmcnt(0)
  v_readfirstlane_b32 s27, v194
  s_nop 0
  s_and_b32 s27, s27, 31
  s_cmp_lt_u32 s26, 4
  s_cselect_b32 s27, 31, s27
  s_cmp_lg_u32 s40, 0
  s_cselect_b32 s38, s38, s27
  s_cmp_lt_u32 s38, 8
  s_cbranch_scc1 K_RX
K_tail:
K_hA2_9:
  s_cbranch_execz K_hA2_10
  s_waitcnt lgkmcnt(0)
  v_mfma_f32_16x16x32_bf16 v[144:147], a[128:131], a[160:163], 0
  ds_read2_b32 a[192:193], v244 offset0:160 offset1:161
  ds_read2_b32 a[194:195], v244 offset0:162 offset1:163
  s_mov_b64 s[44:45], 0
  v_mfma_f32_16x16x32_bf16 v[148:151], a[132:135], a[160:163], 0
  v_cmp_nle_f32_e64 vcc, v192, s41
  s_nop 0
  s_or_b64 s[44:45], s[44:45], vcc
  v_rcp_f32 v14, v204
  v_mfma_f32_16x16x32_bf16 v[148:151], a[128:131], a[164:167], v[148:151]
  s_add_u32 s35, s34, 12288
  v_cmp_nle_f32_e64 vcc, v196, s41
  s_nop 0
  s_or_b64 s[44:45], s[44:45], vcc
  v_accvgpr_read_b32 v208, a96
  v_accvgpr_read_b32 v209, a97
  v_accvgpr_read_b32 v210, a98
  v_mfma_f32_16x16x32_bf16 v[152:155], a[128:131], a[168:171], 0
  v_cmp_nle_f32_e64 vcc, v200, s41
  s_nop 0
  s_or_b64 s[44:45], s[44:45], vcc
  v_accvgpr_read_b32 v211, a99
  v_accvgpr_read_b32 v212, a100
  v_accvgpr_read_b32 v213, a101
  v_mfma_f32_16x16x32_bf16 v[152:155], a[132:135], a[164:167], v[152:155]
  v_cmp_nle_f32_e64 vcc, v204, s41
  s_nop 0
  s_or_b64 s[44:45], s[44:45], vcc
  v_accvgpr_read_b32 v214, a102
  v_accvgpr_read_b32 v215, a103
  v_mfma_f32_16x16x32_bf16 v[152:155], a[136:139], a[160:163], v[152:155]
  s_cmp_lg_u64 s[44:45], 0
  s_cselect_b32 s27, 1, 0
  s_cmp_lg_u32 s40, 0
  s_cselect_b32 s27, 0, s27
  v_mov_b32 v3, s27
  v_mul_f32 v208, v208, v14
  v_mul_f32 v209, v209, v14
  v_mfma_f32_16x16x32_bf16 v[156:159], a[140:143], a[160:163], 0
  s_lshl_b32 s27, s24, 2
  s_add_u32 s27, s27, 163328
  v_mov_b32 v13, s27
  v_mul_f32 v210, v210, v14
  v_mul_f32 v211, v211, v14
  v_mul_f32 v212, v212, v14
  v_mfma_f32_16x16x32_bf16 v[156:159], a[136:139], a[164:167], v[156:159]
  ds_write_b32 v13, v3
  ds_read_b128 a[224:227], v248 offset:128
  ds_read_b128 a[228:231], v248 offset:640
  ds_read_b128 a[232:235], v248 offset:1152
  ds_read_b128 a[236:239], v248 offset:1664
  v_mfma_f32_16x16x32_bf16 v[156:159], a[132:135], a[168:171], v[156:159]
  ds_read_b128 a[240:243], v248 offset:2176
  v_mov_b32 v13, 163328
  v_mfma_f32_16x16x32_bf16 v[156:159], a[128:131], a[172:175], v[156:159]
  ds_read_b128 a[244:247], v248 offset:2688
  v_mul_f32 v213, v213, v14
  v_mul_f32 v214, v214, v14
  v_mfma_f32_16x16x32_bf16 v[160:163], a[128:131], a[176:179], 0
  ds_read_b128 a[248:251], v248 offset:3200
  v_mul_f32 v215, v215, v14
  v_cvt_pk_bf16_f32 v128, v208, v209
  v_cvt_pk_bf16_f32 v129, v210, v211
  v_mfma_f32_16x16x32_bf16 v[160:163], a[132:135], a[172:175], v[160:163]
  ds_read_b128 a[252:255], v248 offset:3712
  v_cvt_pk_bf16_f32 v130, v212, v213
  v_cvt_pk_bf16_f32 v131, v214, v215
  buffer_store_dwordx4 v[128:131], v1, s[20:23], s35 offen offset:0 sc1
  v_accvgpr_read_b32 v216, a104
  v_accvgpr_read_b32 v217, a105
  v_accvgpr_read_b32 v218, a106
  v_accvgpr_read_b32 v219, a107
  v_mfma_f32_16x16x32_bf16 v[160:163], a[136:139], a[168:171], v[160:163]
  s_waitcnt lgkmcnt(8)
  s_barrier
  v_mfma_f32_16x16x32_bf16 v[160:163], a[140:143], a[164:167], v[160:163]
  ds_read_b128 v[176:179], v13
  ds_read2_b32 a[196:197], v244 offset0:32 offset1:33
  v_mfma_f32_16x16x32_bf16 v[160:163], a[144:147], a[160:163], v[160:163]
  ds_read2_b32 a[198:199], v244 offset0:34 offset1:35
  v_accvgpr_read_b32 v220, a108
  v_accvgpr_read_b32 v221, a109
  v_mfma_f32_16x16x32_bf16 v[164:167], a[148:151], a[160:163], 0
  ds_read2_b32 a[200:201], v245 offset0:160 offset1:161
  s_add_u32 m0, s32, 0
  v_accvgpr_read_b32 v222, a110
  v_accvgpr_read_b32 v223, a111
  v_mul_f32 v216, v216, v14
  v_mfma_f32_16x16x32_bf16 v[164:167], a[144:147], a[164:167], v[164:167]
  ds_read2_b32 a[202:203], v245 offset0:162 offset1:163
  v_mul_f32 v217, v217, v14
  v_mul_f32 v218, v218, v14
  v_mfma_f32_16x16x32_bf16 v[164:167], a[140:143], a[168:171], v[164:167]
  ds_read2_b32 a[204:205], v245 offset0:32 offset1:33
  v_mul_f32 v219, v219, v14
  v_mul_f32 v220, v220, v14
  v_mfma_f32_16x16x32_bf16 v[164:167], a[136:139], a[172:175], v[164:167]
  buffer_load_dwordx4 v4, s[16:19], s48 offen offset:0 lds
  v_mul_f32 v221, v221, v14
  v_mul_f32 v222, v222, v14
  v_mul_f32 v223, v223, v14
  v_mfma_f32_16x16x32_bf16 v[164:167], a[132:135], a[176:179], v[164:167]
  ds_read2_b32 a[206:207], v245 offset0:34 offset1:35
  v_cvt_pk_bf16_f32 v132, v216, v217
  v_cvt_pk_bf16_f32 v133, v218, v219
  v_cvt_pk_bf16_f32 v134, v220, v221
  v_cvt_pk_bf16_f32 v135, v222, v223
  v_mfma_f32_16x16x32_bf16 v[164:167], a[128:131], a[180:183], v[164:167]
  buffer_store_dwordx4 v[132:135], v1, s[20:23], s35 offen offset:1024 sc1
  ds_read2_b32 a[208:209], v246 offset0:160 offset1:161
  s_waitcnt lgkmcnt(7)
  v_or_b32 v3, v176, v177
  v_accvgpr_read_b32 v208, a112
  v_accvgpr_read_b32 v209, a113
  v_mfma_f32_16x16x32_bf16 v[168:171], a[128:131], a[184:187], 0
  ds_read2_b32 a[210:211], v246 offset0:162 offset1:163
  v_or3_b32 v3, v3, v178, v179
  v_accvgpr_read_b32 v210, a114
  v_accvgpr_read_b32 v211, a115
  v_accvgpr_read_b32 v212, a116
  v_accvgpr_read_b32 v213, a117
  v_accvgpr_read_b32 v214, a118
  v_mfma_f32_16x16x32_bf16 v[168:171], a[132:135], a[180:183], v[168:171]
  ds_read2_b32 a[212:213], v246 offset0:32 offset1:33
  buffer_load_dwordx4 v5, s[16:19], s48 offen offset:1024 lds
  v_mfma_f32_16x16x32_bf16 v[168:171], a[136:139], a[176:179], v[168:171]
  v_cmp_ne_u32 vcc, 0, v3
  s_cbranch_vccnz K_redo
  v_mfma_f32_16x16x32_bf16 v[168:171], a[140:143], a[172:175], v[168:171]
  ds_read2_b32 a[214:215], v246 offset0:34 offset1:35
  v_accvgpr_read_b32 v215, a119
  v_mul_f32 v208, v208, v14
  v_mfma_f32_16x16x32_bf16 v[168:171], a[144:147], a[168:171], v[168:171]
  ds_read2_b32 a[216:217], v247 offset0:160 offset1:161
  v_mul_f32 v209, v209, v14
  v_mul_f32 v210, v210, v14
  v_mul_f32 v211, v211, v14
  v_mul_f32 v212, v212, v14
  v_mul_f32 v213, v213, v14
  v_mfma_f32_16x16x32_bf16 v[168:171], a[148:151], a[164:167], v[168:171]
  ds_read2_b32 a[218:219], v247 offset0:162 offset1:163
  buffer_load_dwordx4 v6, s[16:19], s48 offen offset:2048 lds
  v_mfma_f32_16x16x32_bf16 v[168:171], a[152:155], a[160:163], v[168:171]
  ds_read2_b32 a[220:221], v247 offset0:32 offset1:33
  v_mul_f32 v214, v214, v14
  v_mul_f32 v215, v215, v14
  v_mfma_f32_16x16x32_bf16 v[172:175], a[156:159], a[160:163], 0
  ds_read2_b32 a[222:223], v247 offset0:34 offset1:35
  v_cvt_pk_bf16_f32 v136, v208, v209
  v_cvt_pk_bf16_f32 v137, v210, v211
  v_cvt_pk_bf16_f32 v138, v212, v213
  v_mfma_f32_16x16x32_bf16 v[172:175], a[152:155], a[164:167], v[172:175]
  v_cvt_pk_bf16_f32 v139, v214, v215
  buffer_store_dwordx4 v[136:139], v1, s[20:23], s35 offen offset:2048 sc1
  v_accvgpr_read_b32 v216, a120
  v_accvgpr_read_b32 v217, a121
  v_accvgpr_read_b32 v218, a122
  v_accvgpr_read_b32 v219, a123
  v_mfma_f32_16x16x32_bf16 v[172:175], a[148:151], a[168:171], v[172:175]
  buffer_load_dwordx4 v7, s[16:19], s48 offen offset:3072 lds
  v_accvgpr_read_b32 v220, a124
  v_mfma_f32_16x16x32_bf16 v[172:175], a[144:147], a[172:175], v[172:175]
  v_accvgpr_read_b32 v221, a125
  v_accvgpr_read_b32 v222, a126
  v_mfma_f32_16x16x32_bf16 v[172:175], a[140:143], a[176:179], v[172:175]
  v_accvgpr_read_b32 v223, a127
  v_mul_f32 v216, v216, v14
  v_mfma_f32_16x16x32_bf16 v[172:175], a[136:139], a[180:183], v[172:175]
  v_mul_f32 v217, v217, v14
  v_mul_f32 v218, v218, v14
  v_mfma_f32_16x16x32_bf16 v[172:175], a[132:135], a[184:187], v[172:175]
  s_add_u32 m0, s32, 4096
  v_mul_f32 v219, v219, v14
  v_mul_f32 v220, v220, v14
  v_mfma_f32_16x16x32_bf16 v[172:175], a[128:131], a[188:191], v[172:175]
  s_waitcnt lgkmcnt(0)
  v_mul_f32 v221, v221, v14
  v_mul_f32 v222, v222, v14
  v_mfma_f32_16x16x32_bf16 v[144:147], a[192:195], a[224:227], v[144:147]
  v_mul_f32 v223, v223, v14
  v_cvt_pk_bf16_f32 v140, v216, v217
  v_mfma_f32_16x16x32_bf16 v[148:151], a[196:199], a[224:227], v[148:151]
K_hA3_9:
  s_cbranch_execz K_hA3_10
  ds_read2_b32 a[128:129], v244 offset0:144 offset1:145
  v_cvt_pk_bf16_f32 v141, v218, v219
  v_cvt_pk_bf16_f32 v142, v220, v221
  v_cvt_pk_bf16_f32 v143, v222, v223
  v_mfma_f32_16x16x32_bf16 v[148:151], a[192:195], a[228:231], v[148:151]
  buffer_store_dwordx4 v[140:143], v1, s[20:23], s35 offen offset:3072 sc1
  ds_read2_b32 a[130:131], v244 offset0:146 offset1:147
  buffer_load_dwordx4 v8, s[16:19], s48 offen offset:0 lds
  v_mfma_f32_16x16x32_bf16 v[152:155], a[192:195], a[232:235], v[152:155]
  ds_read_b128 a[160:163], v248 offset:64
  v_mfma_f32_16x16x32_bf16 v[152:155], a[196:199], a[228:231], v[152:155]
  ds_read_b128 a[164:167], v248 offset:576
  v_mfma_f32_16x16x32_bf16 v[152:155], a[200:203], a[224:227], v[152:155]
  ds_read_b128 a[168:171], v248 offset:1088
  buffer_load_dwordx4 v9, s[16:19], s48 offen offset:1024 lds
  v_mfma_f32_16x16x32_bf16 v[156:159], a[204:207], a[224:227], v[156:159]
  v_mfma_f32_16x16x32_bf16 v[156:159], a[200:203], a[228:231], v[156:159]
  ds_read_b128 a[172:175], v248 offset:1600
  v_mfma_f32_16x16x32_bf16 v[156:159], a[196:199], a[232:235], v[156:159]
  ds_read_b128 a[176:179], v248 offset:2112
  v_mfma_f32_16x16x32_bf16 v[156:159], a[192:195], a[236:239], v[156:159]
  ds_read_b128 a[180:183], v248 offset:2624
  buffer_load_dwordx4 v10, s[16:19], s48 offen offset:2048 lds
  v_mfma_f32_16x16x32_bf16 v[160:163], a[192:195], a[240:243], v[160:163]
  ds_read_b128 a[184:187], v248 offset:3136
  v_mfma_f32_16x16x32_bf16 v[160:163], a[196:199], a[236:239], v[160:163]
  ds_read_b128 a[188:191], v248 offset:3648
  v_mfma_f32_16x16x32_bf16 v[160:163], a[200:203], a[232:235], v[160:163]
  v_mfma_f32_16x16x32_bf16 v[160:163], a[204:207], a[228:231], v[160:163]
  ds_read2_b32 a[132:133], v244 offset0:16 offset1:17
  buffer_load_dwordx4 v11, s[16:19], s48 offen offset:3072 lds
  v_mfma_f32_16x16x32_bf16 v[160:163], a[208:211], a[224:227], v[160:163]
  ds_read2_b32 a[134:135], v244 offset0:18 offset1:19
  v_mfma_f32_16x16x32_bf16 v[164:167], a[212:215], a[224:227], v[164:167]
  ds_read2_b32 a[136:137], v245 offset0:144 offset1:145
  v_mfma_f32_16x16x32_bf16 v[164:167], a[208:211], a[228:231], v[164:167]
  ds_read2_b32 a[138:139], v245 offset0:146 offset1:147
  v_mfma_f32_16x16x32_bf16 v[164:167], a[204:207], a[232:235], v[164:167]
  ds_read2_b32 a[140:141], v245 offset0:16 offset1:17
  s_add_u32 m0, s32, 8192
  v_mfma_f32_16x16x32_bf16 v[164:167], a[200:203], a[236:239], v[164:167]
  v_mfma_f32_16x16x32_bf16 v[164:167], a[196:199], a[240:243], v[164:167]
  ds_read2_b32 a[142:143], v245 offset0:18 offset1:19
  v_mfma_f32_16x16x32_bf16 v[164:167], a[192:195], a[244:247], v[164:167]
  ds_read2_b32 a[144:145], v246 offset0:144 offset1:145
  v_mfma_f32_16x16x32_bf16 v[168:171], a[192:195], a[248:251], v[168:171]
  ds_read2_b32 a[146:147], v246 offset0:146 offset1:147
  buffer_load_dwordx4 v12, s[16:19], s48 offen offset:0 lds
  v_mfma_f32_16x16x32_bf16 v[168:171], a[196:199], a[244:247], v[168:171]
  ds_read2_b32 a[148:149], v246 offset0:16 offset1:17
  v_mfma_f32_16x16x32_bf16 v[168:171], a[200:203], a[240:243], v[168:171]
  ds_read2_b32 a[150:151], v246 offset0:18 offset1:19
  v_mfma_f32_16x16x32_bf16 v[168:171], a[204:207], a[236:239], v[168:171]
  v_mfma_f32_16x16x32_bf16 v[168:171], a[208:211], a[232:235], v[168:171]
  ds_read2_b32 a[152:153], v247 offset0:144 offset1:145
  v_mfma_f32_16x16x32_bf16 v[168:171], a[212:215], a[228:231], v[168:171]
  ds_read2_b32 a[154:155], v247 offset0:146 offset1:147
  s_add_u32 m0, s32, 36864
  v_mfma_f32_16x16x32_bf16 v[168:171], a[216:219], a[224:227], v[168:171]
  ds_read2_b32 a[156:157], v247 offset0:16 offset1:17
  v_mfma_f32_16x16x32_bf16 v[172:175], a[220:223], a[224:227], v[172:175]
  ds_read2_b32 a[158:159], v247 offset0:18 offset1:19
  v_mfma_f32_16x16x32_bf16 v[172:175], a[216:219], a[228:231], v[172:175]
  buffer_load_dwordx4 v4, s[16:19], s49 offen offset:0 lds
  v_mfma_f32_16x16x32_bf16 v[172:175], a[212:215], a[232:235], v[172:175]
  v_mfma_f32_16x16x32_bf16 v[172:175], a[208:211], a[236:239], v[172:175]
  v_mfma_f32_16x16x32_bf16 v[172:175], a[204:207], a[240:243], v[172:175]
  buffer_load_dwordx4 v5, s[16:19], s49 offen offset:1024 lds
  v_mfma_f32_16x16x32_bf16 v[172:175], a[200:203], a[244:247], v[172:175]
  v_mfma_f32_16x16x32_bf16 v[172:175], a[196:199], a[248:251], v[172:175]
  v_mfma_f32_16x16x32_bf16 v[172:175], a[192:195], a[252:255], v[172:175]
  s_waitcnt lgkmcnt(0)
  v_mfma_f32_16x16x32_bf16 v[144:147], a[128:131], a[160:163], v[144:147]
  buffer_load_dwordx4 v6, s[16:19], s49 offen offset:2048 lds
  v_mfma_f32_16x16x32_bf16 v[148:151], a[132:135], a[160:163], v[148:151]
  ds_read2_b32 a[192:193], v244 offset0:128 offset1:129
  v_mfma_f32_16x16x32_bf16 v[148:151], a[128:131], a[164:167], v[148:151]
  ds_read2_b32 a[194:195], v244 offset0:130 offset1:131
  v_mfma_f32_16x16x32_bf16 v[152:155], a[128:131], a[168:171], v[152:155]
  ds_read_b128 a[224:227], v248 offset:0
  buffer_load_dwordx4 v7, s[16:19], s49 offen offset:3072 lds
  v_mfma_f32_16x16x32_bf16 v[152:155], a[132:135], a[164:167], v[152:155]
  ds_read_b128 a[228:231], v248 offset:512
  v_mfma_f32_16x16x32_bf16 v[152:155], a[136:139], a[160:163], v[152:155]
  ds_read_b128 a[232:235], v248 offset:1024
  v_mfma_f32_16x16x32_bf16 v[156:159], a[140:143], a[160:163], v[156:159]
  v_mfma_f32_16x16x32_bf16 v[156:159], a[136:139], a[164:167], v[156:159]
  ds_read_b128 a[236:239], v248 offset:1536
  s_add_u32 m0, s32, 40960
  v_mfma_f32_16x16x32_bf16 v[156:159], a[132:135], a[168:171], v[156:159]
  ds_read_b128 a[240:243], v248 offset:2048
  s_waitcnt vmcnt(9)
  s_and_b32 s27, s25, 3
  s_lshl_b32 s27, s27, 2
  s_add_u32 s27, s27, s31
  buffer_store_dword v252, off, s[20:23], s27 sc1
  v_mfma_f32_16x16x32_bf16 v[156:159], a[128:131], a[172:175], v[156:159]
  ds_read_b128 a[244:247], v248 offset:2560
  v_mfma_f32_16x16x32_bf16 v[160:163], a[128:131], a[176:179], v[160:163]
  ds_read_b128 a[248:251], v248 offset:3072
  buffer_load_dwordx4 v8, s[16:19], s49 offen offset:0 lds
  v_mfma_f32_16x16x32_bf16 v[160:163], a[132:135], a[172:175], v[160:163]
  ds_read_b128 a[252:255], v248 offset:3584
  v_mfma_f32_16x16x32_bf16 v[160:163], a[136:139], a[168:171], v[160:163]
  v_mfma_f32_16x16x32_bf16 v[160:163], a[140:143], a[164:167], v[160:163]
  ds_read2_b32 a[196:197], v244 offset0:0 offset1:1
  buffer_load_dwordx4 v9, s[16:19], s49 offen offset:1024 lds
  v_mfma_f32_16x16x32_bf16 v[160:163], a[144:147], a[160:163], v[160:163]
  ds_read2_b32 a[198:199], v244 offset0:2 offset1:3
  v_mfma_f32_16x16x32_bf16 v[164:167], a[148:151], a[160:163], v[164:167]
  ds_read2_b32 a[200:201], v245 offset0:128 offset1:129
  v_mfma_f32_16x16x32_bf16 v[164:167], a[144:147], a[164:167], v[164:167]
  ds_read2_b32 a[202:203], v245 offset0:130 offset1:131
  v_mfma_f32_16x16x32_bf16 v[164:167], a[140:143], a[168:171], v[164:167]
  ds_read2_b32 a[204:205], v245 offset0:0 offset1:1
  buffer_load_dwordx4 v10, s[16:19], s49 offen offset:2048 lds
  v_mfma_f32_16x16x32_bf16 v[164:167], a[136:139], a[172:175], v[164:167]
  v_lshrrev_b32 v3, 2, v0
  v_mfma_f32_16x16x32_bf16 v[164:167], a[132:135], a[176:179], v[164:167]
  ds_read2_b32 a[206:207], v245 offset0:2 offset1:3
  v_mfma_f32_16x16x32_bf16 v[164:167], a[128:131], a[180:183], v[164:167]
  ds_read2_b32 a[208:209], v246 offset0:128 offset1:129
  v_mul_u32_u24 v3, 288, v3
  v_mfma_f32_16x16x32_bf16 v[168:171], a[128:131], a[184:187], v[168:171]
  ds_read2_b32 a[210:211], v246 offset0:130 offset1:131
  buffer_load_dwordx4 v11, s[16:19], s49 offen offset:3072 lds
  v_mfma_f32_16x16x32_bf16 v[168:171], a[132:135], a[180:183], v[168:171]
  ds_read2_b32 a[212:213], v246 offset0:0 offset1:1
  v_mfma_f32_16x16x32_bf16 v[168:171], a[136:139], a[176:179], v[168:171]
  ds_read2_b32 a[214:215], v246 offset0:2 offset1:3
  v_and_b32 v13, 3, v0
  v_mfma_f32_16x16x32_bf16 v[168:171], a[140:143], a[172:175], v[168:171]
  s_add_u32 m0, s32, 45056
  v_mfma_f32_16x16x32_bf16 v[168:171], a[144:147], a[168:171], v[168:171]
  ds_read2_b32 a[216:217], v247 offset0:128 offset1:129
  v_mfma_f32_16x16x32_bf16 v[168:171], a[148:151], a[164:167], v[168:171]
  ds_read2_b32 a[218:219], v247 offset0:130 offset1:131
  v_lshl_add_u32 v240, v13, 3, v3
  v_mfma_f32_16x16x32_bf16 v[168:171], a[152:155], a[160:163], v[168:171]
  ds_read2_b32 a[220:221], v247 offset0:0 offset1:1
  buffer_load_dwordx4 v12, s[16:19], s49 offen offset:0 lds
  v_mfma_f32_16x16x32_bf16 v[172:175], a[156:159], a[160:163], v[172:175]
  ds_read2_b32 a[222:223], v247 offset0:2 offset1:3
  v_mfma_f32_16x16x32_bf16 v[172:175], a[152:155], a[164:167], v[172:175]
  v_add_u32 v241, 64512, v240
  v_mfma_f32_16x16x32_bf16 v[172:175], a[148:151], a[168:171], v[172:175]
  v_mfma_f32_16x16x32_bf16 v[172:175], a[144:147], a[172:175], v[172:175]
  s_add_u32 m0, s32, 73728
  v_mfma_f32_16x16x32_bf16 v[172:175], a[140:143], a[176:179], v[172:175]
  v_add_u32 v242, 129024, v240
  v_mfma_f32_16x16x32_bf16 v[172:175], a[136:139], a[180:183], v[172:175]
  v_mfma_f32_16x16x32_bf16 v[172:175], a[132:135], a[184:187], v[172:175]
  s_bitcmp1_b32 s65, 0
  s_cselect_b32 s27, 0, 16
  s_lshl_b32 s95, s95, s27
  v_mfma_f32_16x16x32_bf16 v[172:175], a[128:131], a[188:191], v[172:175]
  buffer_load_dwordx4 v4, s[16:19], s50 offen offset:0 lds
  s_waitcnt lgkmcnt(0)
  v_mfma_f32_16x16x32_bf16 v[144:147], a[192:195], a[224:227], v[144:147]
  v_mfma_f32_16x16x32_bf16 v[148:151], a[196:199], a[224:227], v[148:151]
  ds_read_b64 v[232:233], v249 offset:1536
  buffer_load_dwordx4 v5, s[16:19], s50 offen offset:1024 lds
  s_and_b32 s95, s95, 0xffff0000
  v_mfma_f32_16x16x32_bf16 v[148:151], a[192:195], a[228:231], v[148:151]
  ds_read_b64 v[234:235], v249 offset:1024
  v_mfma_f32_16x16x32_bf16 v[152:155], a[192:195], a[232:235], v[152:155]
  ds_read_b64 v[236:237], v249 offset:512
  v_mfma_f32_16x16x32_bf16 v[152:155], a[196:199], a[228:231], v[152:155]
  s_lshl_b32 s65, s65, 12
  ds_read_b64 v[238:239], v249 offset:0
  v_mfma_f32_16x16x32_bf16 v[152:155], a[200:203], a[224:227], v[152:155]
  buffer_load_dwordx4 v6, s[16:19], s50 offen offset:2048 lds
  v_mfma_f32_16x16x32_bf16 v[156:159], a[204:207], a[224:227], v[156:159]
  v_mfma_f32_16x16x32_bf16 v[156:159], a[200:203], a[228:231], v[156:159]
  s_and_b32 s27, s24, 1
  s_lshl_b32 s27, s27, 11
  s_add_u32 s65, s65, s27
  v_mfma_f32_16x16x32_bf16 v[156:159], a[196:199], a[232:235], v[156:159]
  buffer_load_dwordx4 v7, s[16:19], s50 offen offset:3072 lds
  v_mfma_f32_16x16x32_bf16 v[156:159], a[192:195], a[236:239], v[156:159]
  v_mfma_f32_16x16x32_bf16 v[160:163], a[192:195], a[240:243], v[160:163]
  s_add_u32 s65, s65, 62914560
  v_mfma_f32_16x16x32_bf16 v[160:163], a[196:199], a[236:239], v[160:163]
  v_mfma_f32_16x16x32_bf16 v[160:163], a[200:203], a[232:235], v[160:163]
  s_add_u32 m0, s32, 77824
  v_mfma_f32_16x16x32_bf16 v[160:163], a[204:207], a[228:231], v[160:163]
  v_mfma_f32_16x16x32_bf16 v[160:163], a[208:211], a[224:227], v[160:163]
  s_waitcnt vmcnt(14)
  s_barrier
  v_mfma_f32_16x16x32_bf16 v[164:167], a[212:215], a[224:227], v[164:167]
  ds_read_b64_tr_b16 a[144:145], v240 offset:0
  buffer_load_dwordx4 v8, s[16:19], s50 offen offset:0 lds
  v_mfma_f32_16x16x32_bf16 v[164:167], a[208:211], a[228:231], v[164:167]
  ds_read_b64_tr_b16 a[146:147], v240 offset:4608
  v_mfma_f32_16x16x32_bf16 v[164:167], a[204:207], a[232:235], v[164:167]
  ds_read_b64_tr_b16 a[148:149], v240 offset:9216
  v_mfma_f32_16x16x32_bf16 v[164:167], a[200:203], a[236:239], v[164:167]
  buffer_load_dwordx4 v9, s[16:19], s50 offen offset:1024 lds
  v_mfma_f32_16x16x32_bf16 v[164:167], a[196:199], a[240:243], v[164:167]
  ds_read_b64_tr_b16 a[150:151], v240 offset:13824
  v_mfma_f32_16x16x32_bf16 v[164:167], a[192:195], a[244:247], v[164:167]
  ds_read_b64_tr_b16 a[152:153], v240 offset:32
  v_mfma_f32_16x16x32_bf16 v[168:171], a[192:195], a[248:251], v[168:171]
  ds_read_b64_tr_b16 a[154:155], v240 offset:4640
  v_mfma_f32_16x16x32_bf16 v[168:171], a[196:199], a[244:247], v[168:171]
  buffer_load_dwordx4 v10, s[16:19], s50 offen offset:2048 lds
  v_mfma_f32_16x16x32_bf16 v[168:171], a[200:203], a[240:243], v[168:171]
  ds_read_b64_tr_b16 a[156:157], v240 offset:9248
  v_mfma_f32_16x16x32_bf16 v[168:171], a[204:207], a[236:239], v[168:171]
  ds_read_b64_tr_b16 a[158:159], v240 offset:13856
  v_mfma_f32_16x16x32_bf16 v[168:171], a[208:211], a[232:235], v[168:171]
  ds_read_b64_tr_b16 a[160:161], v240 offset:64
  buffer_load_dwordx4 v11, s[16:19], s50 offen offset:3072 lds
  v_mfma_f32_16x16x32_bf16 v[168:171], a[212:215], a[228:231], v[168:171]
  v_mfma_f32_16x16x32_bf16 v[168:171], a[216:219], a[224:227], v[168:171]
  ds_read_b64_tr_b16 a[162:163], v240 offset:4672
  v_mfma_f32_16x16x32_bf16 v[172:175], a[220:223], a[224:227], v[172:175]
  ds_read_b64_tr_b16 a[164:165], v240 offset:9280
  v_mfma_f32_16x16x32_bf16 v[172:175], a[216:219], a[228:231], v[172:175]
  ds_read_b64_tr_b16 a[166:167], v240 offset:13888
  s_add_u32 m0, s32, 81920
  v_mfma_f32_16x16x32_bf16 v[172:175], a[212:215], a[232:235], v[172:175]
  v_mfma_f32_16x16x32_bf16 v[172:175], a[208:211], a[236:239], v[172:175]
  ds_read_b64_tr_b16 a[168:169], v240 offset:96
  v_mfma_f32_16x16x32_bf16 v[172:175], a[204:207], a[240:243], v[172:175]
  ds_read_b64_tr_b16 a[170:171], v240 offset:4704
  buffer_load_dwordx4 v12, s[16:19], s50 offen offset:0 lds
  v_mfma_f32_16x16x32_bf16 v[172:175], a[200:203], a[244:247], v[172:175]
  v_mfma_f32_16x16x32_bf16 v[172:175], a[196:199], a[248:251], v[172:175]
  v_mfma_f32_16x16x32_bf16 v[172:175], a[192:195], a[252:255], v[172:175]
  s_waitcnt lgkmcnt(10)
K_J:
K_hA0_10:
  s_cbranch_execz K_hA0_11
  v_mfma_f32_16x16x32_bf16 a[0:3], a[144:147], v[80:83], 0
  v_mfma_f32_16x16x32_bf16 a[0:3], a[148:151], v[84:87], a[0:3]
  ds_read_b64_tr_b16 a[172:173], v240 offset:9312
  v_mfma_f32_16x16x32_bf16 a[4:7], a[148:151], v[116:119], 0
  ds_read_b64_tr_b16 a[174:175], v240 offset:13920
  v_mfma_f32_16x16x32_bf16 a[4:7], a[144:147], v[112:115], a[4:7]
  v_mfma_f32_16x16x32_bf16 a[8:11], a[144:147], v[96:99], 0
  v_mfma_f32_16x16x32_bf16 a[8:11], a[148:151], v[100:103], a[8:11]
  ds_read_b64_tr_b16 a[176:177], v240 offset:128
  v_mfma_f32_16x16x32_bf16 a[12:15], a[148:151], v[132:135], 0
  s_bitcmp1_b32 s24, 0
  s_cbranch_scc0 K_x2m
  v_swap_b32 v144, v160
  v_swap_b32 v145, v161
  v_swap_b32 v146, v162
  v_swap_b32 v147, v163
  v_swap_b32 v148, v164
  v_swap_b32 v149, v165
  v_swap_b32 v150, v166
  v_swap_b32 v151, v167
  v_swap_b32 v152, v168
  v_swap_b32 v153, v169
  v_swap_b32 v154, v170
  v_swap_b32 v155, v171
  v_swap_b32 v156, v172
  v_swap_b32 v157, v173
  v_swap_b32 v158, v174
  v_swap_b32 v159, v175
K_x2m:
  v_mfma_f32_16x16x32_bf16 a[12:15], a[144:147], v[128:131], a[12:15]
  ds_write_b128 v251, v[160:163] offset:0
  ds_read_b64_tr_b16 a[178:179], v240 offset:4736
  s_waitcnt lgkmcnt(11)
  v_mfma_f32_16x16x32_bf16 a[28:31], a[152:155], v[128:131], 0
  v_and_b32 v3, 12, v253
  buffer_load_dword v3, v3, s[20:23], s31 offen sc1
  v_mfma_f32_16x16x32_bf16 a[28:31], a[156:159], v[132:135], a[28:31]
  ds_write_b128 v251, v[164:167] offset:1024
  ds_read_b64_tr_b16 a[144:145], v240 offset:9344
  v_mfma_f32_16x16x32_bf16 a[24:27], a[156:159], v[100:103], 0
  ds_read_b64_tr_b16 a[146:147], v240 offset:13952
  v_add_u32 v244, 4096, v1
  v_mfma_f32_16x16x32_bf16 a[24:27], a[152:155], v[96:99], a[24:27]
  ds_write_b128 v251, v[168:171] offset:2048
  v_mfma_f32_16x16x32_bf16 a[20:23], a[152:155], v[112:115], 0
  v_add_u32 v245, 8192, v1
  v_add_u32 v246, 12288, v1
  v_mfma_f32_16x16x32_bf16 a[20:23], a[156:159], v[116:119], a[20:23]
  ds_write_b128 v251, v[172:175] offset:3072
  ds_read_b64_tr_b16 a[148:149], v240 offset:160
  v_mfma_f32_16x16x32_bf16 a[16:19], a[156:159], v[84:87], 0
  ds_read_b64_tr_b16 a[150:151], v240 offset:4768
  v_mfma_f32_16x16x32_bf16 a[16:19], a[152:155], v[80:83], a[16:19]
  s_waitcnt lgkmcnt(14)
  v_mfma_f32_16x16x32_bf16 a[32:35], a[160:163], v[80:83], 0
  v_mfma_f32_16x16x32_bf16 a[32:35], a[164:167], v[84:87], a[32:35]
  ds_read_b64_tr_b16 a[152:153], v240 offset:9376
  v_mfma_f32_16x16x32_bf16 a[36:39], a[164:167], v[116:119], 0
  ds_read_b64_tr_b16 a[154:155], v240 offset:13984
  v_mfma_f32_16x16x32_bf16 a[36:39], a[160:163], v[112:115], a[36:39]
  v_mfma_f32_16x16x32_bf16 a[40:43], a[160:163], v[96:99], 0
  v_mfma_f32_16x16x32_bf16 a[40:43], a[164:167], v[100:103], a[40:43]
  ds_read_b64_tr_b16 a[156:157], v240 offset:192
  v_mfma_f32_16x16x32_bf16 a[44:47], a[164:167], v[132:135], 0
  ds_read_b64_tr_b16 a[158:159], v240 offset:4800
  v_mfma_f32_16x16x32_bf16 a[44:47], a[160:163], v[128:131], a[44:47]
  s_waitcnt lgkmcnt(6)
  s_barrier
  v_mfma_f32_16x16x32_bf16 a[60:63], a[168:171], v[128:131], 0
  ds_read_b128 v[160:163], v255 offset:0
  v_mfma_f32_16x16x32_bf16 a[60:63], a[172:175], v[132:135], a[60:63]
  ds_read_b128 v[164:167], v255 offset:1024
  ds_read_b64_tr_b16 a[160:161], v240 offset:9408
  v_mfma_f32_16x16x32_bf16 a[56:59], a[172:175], v[100:103], 0
  ds_read_b128 v[168:171], v255 offset:2048
  ds_read_b64_tr_b16 a[162:163], v240 offset:14016
  v_mfma_f32_16x16x32_bf16 a[56:59], a[168:171], v[96:99], a[56:59]
  ds_read_b128 v[172:175], v255 offset:3072
  v_mfma_f32_16x16x32_bf16 a[52:55], a[168:171], v[112:115], 0
  v_mfma_f32_16x16x32_bf16 a[52:55], a[172:175], v[116:119], a[52:55]
  ds_read_b64_tr_b16 a[164:165], v240 offset:224
  v_mfma_f32_16x16x32_bf16 a[48:51], a[172:175], v[84:87], 0
  ds_read_b64_tr_b16 a[166:167], v240 offset:4832
  v_mfma_f32_16x16x32_bf16 a[48:51], a[168:171], v[80:83], a[48:51]
  v_mfma_f32_16x16x32_bf16 a[64:67], a[176:179], v[80:83], 0
  s_waitcnt vmcnt(0)
  v_cmp_ne_u32 vcc, 1, v3
  s_cbranch_vccnz K_PC_spin
K_PC_ok:
  v_mfma_f32_16x16x32_bf16 a[64:67], a[144:147], v[84:87], a[64:67]
  ds_read_b64_tr_b16 a[168:169], v240 offset:9440
  v_mfma_f32_16x16x32_bf16 a[68:71], a[144:147], v[116:119], 0
  ds_read_b64_tr_b16 a[170:171], v240 offset:14048
  v_mfma_f32_16x16x32_bf16 a[68:71], a[176:179], v[112:115], a[68:71]
  s_and_b32 s92, s25, 3
  s_lshl_b32 s93, s92, 19
  s_sub_u32 s93, s34, s93
  s_add_u32 s92, s92, 1
  v_mfma_f32_16x16x32_bf16 a[72:75], a[176:179], v[96:99], 0
  v_mfma_f32_16x16x32_bf16 a[72:75], a[144:147], v[100:103], a[72:75]
  ds_read_b64_tr_b16 a[172:173], v240 offset:18432
  v_mfma_f32_16x16x32_bf16 a[76:79], a[144:147], v[132:135], 0
  ds_read_b64_tr_b16 a[174:175], v240 offset:23040
  v_mfma_f32_16x16x32_bf16 a[76:79], a[176:179], v[128:131], a[76:79]
  s_waitcnt lgkmcnt(6)
  s_barrier
  v_mfma_f32_16x16x32_bf16 a[92:95], a[148:151], v[128:131], 0
  s_and_b32 s92, s92, 3
  s_lshl_b32 s92, s92, 19
  s_add_u32 s64, s93, s92
  v_mfma_f32_16x16x32_bf16 a[92:95], a[152:155], v[132:135], a[92:95]
  ds_read_b64_tr_b16 a[176:177], v240 offset:27648
  v_and_b32 v224, 0xffff0000, v233
  v_mfma_f32_16x16x32_bf16 a[88:91], a[152:155], v[100:103], 0
  ds_read_b64_tr_b16 a[178:179], v240 offset:32256
  v_lshlrev_b32 v225, 16, v233
  v_mfma_f32_16x16x32_bf16 a[88:91], a[148:151], v[96:99], a[88:91]
  buffer_load_dwordx4 v[16:19], v1, s[20:23], s64 offen offset:0 sc1
  v_and_b32 v226, 0xffff0000, v232
  v_mfma_f32_16x16x32_bf16 a[84:87], a[148:151], v[112:115], 0
  v_lshlrev_b32 v227, 16, v232
  v_fmac_f32 v144, s95, v224
  v_mfma_f32_16x16x32_bf16 a[84:87], a[152:155], v[116:119], a[84:87]
  ds_read_b64_tr_b16 a[144:145], v240 offset:18464
  v_fmac_f32 v145, s95, v225
  v_mfma_f32_16x16x32_bf16 a[80:83], a[152:155], v[84:87], 0
  ds_read_b64_tr_b16 a[146:147], v240 offset:23072
  v_fmac_f32 v146, s95, v226
  v_mfma_f32_16x16x32_bf16 a[80:83], a[148:151], v[80:83], a[80:83]
  buffer_load_dwordx4 v[32:35], v244, s[20:23], s64 offen offset:0 sc1
  v_fmac_f32 v147, s95, v227
  v_mfma_f32_16x16x32_bf16 a[96:99], a[156:159], v[80:83], 0
  v_add_f32 v144, v144, v160
  v_add_f32 v145, v145, v161
  v_mfma_f32_16x16x32_bf16 a[96:99], a[160:163], v[84:87], a[96:99]
  ds_read_b64_tr_b16 a[148:149], v240 offset:27680
  v_add_f32 v146, v146, v162
  v_mfma_f32_16x16x32_bf16 a[100:103], a[160:163], v[116:119], 0
  ds_read_b64_tr_b16 a[150:151], v240 offset:32288
  v_add_f32 v147, v147, v163
  v_mfma_f32_16x16x32_bf16 a[100:103], a[156:159], v[112:115], a[100:103]
  buffer_load_dwordx4 v[48:51], v245, s[20:23], s64 offen offset:0 sc1
  v_cvt_pk_bf16_f32 v144, v144, v145
  v_mfma_f32_16x16x32_bf16 a[104:107], a[156:159], v[96:99], 0
  v_cvt_pk_bf16_f32 v145, v146, v147
  v_mfma_f32_16x16x32_bf16 a[104:107], a[160:163], v[100:103], a[104:107]
  ds_read_b64_tr_b16 a[152:153], v240 offset:18496
  v_and_b32 v228, 0xffff0000, v235
  v_mfma_f32_16x16x32_bf16 a[108:111], a[160:163], v[132:135], 0
  ds_read_b64_tr_b16 a[154:155], v240 offset:23104
  v_lshlrev_b32 v229, 16, v235
  v_mfma_f32_16x16x32_bf16 a[108:111], a[156:159], v[128:131], a[108:111]
  buffer_load_dwordx4 v[64:67], v246, s[20:23], s64 offen offset:0 sc1
  s_waitcnt lgkmcnt(10)
  v_and_b32 v230, 0xffff0000, v234
  v_mfma_f32_16x16x32_bf16 a[124:127], a[164:167], v[128:131], 0
  v_lshlrev_b32 v231, 16, v234
  v_mfma_f32_16x16x32_bf16 a[124:127], a[168:171], v[132:135], a[124:127]
  ds_read_b64_tr_b16 a[156:157], v240 offset:27712
  v_fmac_f32 v148, s95, v228
  v_mfma_f32_16x16x32_bf16 a[120:123], a[168:171], v[100:103], 0
  ds_read_b64_tr_b16 a[158:159], v240 offset:32320
  buffer_load_dwordx4 v[20:23], v1, s[20:23], s64 offen offset:1024 sc1
  v_mfma_f32_16x16x32_bf16 a[120:123], a[164:167], v[96:99], a[120:123]
  v_fmac_f32 v149, s95, v229
  v_fmac_f32 v150, s95, v230
  v_mfma_f32_16x16x32_bf16 a[116:119], a[164:167], v[112:115], 0
  v_fmac_f32 v151, s95, v231
  v_mfma_f32_16x16x32_bf16 a[116:119], a[168:171], v[116:119], a[116:119]
  ds_read_b64_tr_b16 a[160:161], v240 offset:18528
  v_add_f32 v148, v148, v164
  v_mfma_f32_16x16x32_bf16 a[112:115], a[168:171], v[84:87], 0
  ds_read_b64_tr_b16 a[162:163], v240 offset:23136
  buffer_load_dwordx4 v[36:39], v244, s[20:23], s64 offen offset:1024 sc1
  v_mfma_f32_16x16x32_bf16 a[112:115], a[164:167], v[80:83], a[112:115]
  s_waitcnt lgkmcnt(10)
  v_add_f32 v149, v149, v165
  v_add_f32 v150, v150, v166
  v_mfma_f32_16x16x32_bf16 a[0:3], a[172:175], v[88:91], a[0:3]
  v_add_f32 v151, v151, v167
  v_mfma_f32_16x16x32_bf16 a[0:3], a[176:179], v[92:95], a[0:3]
  ds_read_b64_tr_b16 a[164:165], v240 offset:27744
  v_cvt_pk_bf16_f32 v146, v148, v149
  v_mfma_f32_16x16x32_bf16 a[4:7], a[176:179], v[124:127], a[4:7]
  ds_read_b64_tr_b16 a[166:167], v240 offset:32352
  buffer_load_dwordx4 v[52:55], v245, s[20:23], s64 offen offset:1024 sc1
  v_mfma_f32_16x16x32_bf16 a[4:7], a[172:175], v[120:123], a[4:7]
  v_cvt_pk_bf16_f32 v147, v150, v151
  v_permlane16_swap_b32 v144, v146
  v_mfma_f32_16x16x32_bf16 a[8:11], a[172:175], v[104:107], a[8:11]
  v_permlane16_swap_b32 v145, v147
  v_mfma_f32_16x16x32_bf16 a[8:11], a[176:179], v[108:111], a[8:11]
  buffer_store_dwordx4 v[144:147], v250, s[20:23], s65 offen offset:0 sc1
  ds_read_b64_tr_b16 a[168:169], v240 offset:18560
  v_mfma_f32_16x16x32_bf16 a[12:15], a[176:179], v[140:143], a[12:15]
  ds_read_b64_tr_b16 a[170:171], v240 offset:23168
  buffer_load_dwordx4 v[68:71], v246, s[20:23], s64 offen offset:1024 sc1
  v_mfma_f32_16x16x32_bf16 a[12:15], a[172:175], v[136:139], a[12:15]
  v_and_b32 v224, 0xffff0000, v237
  s_waitcnt lgkmcnt(10)
  v_mfma_f32_16x16x32_bf16 a[28:31], a[144:147], v[136:139], a[28:31]
  v_lshlrev_b32 v225, 16, v237
  v_and_b32 v226, 0xffff0000, v236
  v_mfma_f32_16x16x32_bf16 a[28:31], a[148:151], v[140:143], a[28:31]
  ds_read_b64_tr_b16 a[172:173], v240 offset:27776
  v_lshlrev_b32 v227, 16, v236
  v_mfma_f32_16x16x32_bf16 a[24:27], a[148:151], v[108:111], a[24:27]
  ds_read_b64_tr_b16 a[174:175], v240 offset:32384
  buffer_load_dwordx4 v[24:27], v1, s[20:23], s64 offen offset:2048 sc1
  v_mfma_f32_16x16x32_bf16 a[24:27], a[144:147], v[104:107], a[24:27]
  v_fmac_f32 v152, s95, v224
  v_fmac_f32 v153, s95, v225
  v_mfma_f32_16x16x32_bf16 a[20:23], a[144:147], v[120:123], a[20:23]
  v_fmac_f32 v154, s95, v226
  v_fmac_f32 v155, s95, v227
  v_mfma_f32_16x16x32_bf16 a[20:23], a[148:151], v[124:127], a[20:23]
  ds_read_b64_tr_b16 a[176:177], v240 offset:18592
  v_add_f32 v152, v152, v168
  v_mfma_f32_16x16x32_bf16 a[16:19], a[148:151], v[92:95], a[16:19]
  ds_read_b64_tr_b16 a[178:179], v240 offset:23200
  buffer_load_dwordx4 v[40:43], v244, s[20:23], s64 offen offset:2048 sc1
  v_mfma_f32_16x16x32_bf16 a[16:19], a[144:147], v[88:91], a[16:19]
  s_waitcnt lgkmcnt(10)
  v_add_f32 v153, v153, v169
  v_add_f32 v154, v154, v170
  v_mfma_f32_16x16x32_bf16 a[32:35], a[152:155], v[88:91], a[32:35]
  v_add_f32 v155, v155, v171
  v_mfma_f32_16x16x32_bf16 a[32:35], a[156:159], v[92:95], a[32:35]
  ds_read_b64_tr_b16 a[144:145], v240 offset:27808
  buffer_load_dwordx4 v[56:59], v245, s[20:23], s64 offen offset:2048 sc1
  v_mfma_f32_16x16x32_bf16 a[36:39], a[156:159], v[124:127], a[36:39]
  ds_read_b64_tr_b16 a[146:147], v240 offset:32416
  v_cvt_pk_bf16_f32 v152, v152, v153
  v_mfma_f32_16x16x32_bf16 a[36:39], a[152:155], v[120:123], a[36:39]
  v_cvt_pk_bf16_f32 v153, v154, v155
  v_mfma_f32_16x16x32_bf16 a[40:43], a[152:155], v[104:107], a[40:43]
  v_and_b32 v228, 0xffff0000, v239
  v_lshlrev_b32 v229, 16, v239
  v_mfma_f32_16x16x32_bf16 a[40:43], a[156:159], v[108:111], a[40:43]
  ds_read_b64_tr_b16 a[148:149], v240 offset:18624
  buffer_load_dwordx4 v[72:75], v246, s[20:23], s64 offen offset:2048 sc1
  v_mfma_f32_16x16x32_bf16 a[44:47], a[156:159], v[140:143], a[44:47]
  ds_read_b64_tr_b16 a[150:151], v240 offset:23232
  v_and_b32 v230, 0xffff0000, v238
  v_mfma_f32_16x16x32_bf16 a[44:47], a[152:155], v[136:139], a[44:47]
  s_waitcnt lgkmcnt(10)
  v_lshlrev_b32 v231, 16, v238
  v_fmac_f32 v156, s95, v228
  v_mfma_f32_16x16x32_bf16 a[60:63], a[160:163], v[136:139], a[60:63]
  v_fmac_f32 v157, s95, v229
  v_mfma_f32_16x16x32_bf16 a[60:63], a[164:167], v[140:143], a[60:63]
  ds_read_b64_tr_b16 a[152:153], v240 offset:27840
  buffer_load_dwordx4 v[28:31], v1, s[20:23], s64 offen offset:3072 sc1
  v_mfma_f32_16x16x32_bf16 a[56:59], a[164:167], v[108:111], a[56:59]
  ds_read_b64_tr_b16 a[154:155], v240 offset:32448
  v_fmac_f32 v158, s95, v230
  v_mfma_f32_16x16x32_bf16 a[56:59], a[160:163], v[104:107], a[56:59]
  v_fmac_f32 v159, s95, v231
  v_mfma_f32_16x16x32_bf16 a[52:55], a[160:163], v[120:123], a[52:55]
  v_add_f32 v156, v156, v172
  v_add_f32 v157, v157, v173
  v_mfma_f32_16x16x32_bf16 a[52:55], a[164:167], v[124:127], a[52:55]
  ds_read_b64_tr_b16 a[156:157], v240 offset:18656
  buffer_load_dwordx4 v[44:47], v244, s[20:23], s64 offen offset:3072 sc1
  v_mfma_f32_16x16x32_bf16 a[48:51], a[164:167], v[92:95], a[48:51]
  ds_read_b64_tr_b16 a[158:159], v240 offset:23264
  v_add_f32 v158, v158, v174
  v_mfma_f32_16x16x32_bf16 a[48:51], a[160:163], v[88:91], a[48:51]
  s_waitcnt lgkmcnt(10)
  v_add_f32 v159, v159, v175
  v_cvt_pk_bf16_f32 v154, v156, v157
  v_mfma_f32_16x16x32_bf16 a[64:67], a[168:171], v[88:91], a[64:67]
  v_cvt_pk_bf16_f32 v155, v158, v159
  v_mfma_f32_16x16x32_bf16 a[64:67], a[172:175], v[92:95], a[64:67]
  ds_read_b64_tr_b16 a[160:161], v240 offset:27872
  buffer_load_dwordx4 v[60:63], v245, s[20:23], s64 offen offset:3072 sc1
  v_mfma_f32_16x16x32_bf16 a[68:71], a[172:175], v[124:127], a[68:71]
  ds_read_b64_tr_b16 a[162:163], v240 offset:32480
  v_permlane16_swap_b32 v152, v154
  v_mfma_f32_16x16x32_bf16 a[68:71], a[168:171], v[120:123], a[68:71]
  v_permlane16_swap_b32 v153, v155
  buffer_store_dwordx4 v[152:155], v250, s[20:23], s65 offen offset:1024 sc1
  v_mfma_f32_16x16x32_bf16 a[72:75], a[168:171], v[104:107], a[72:75]
  v_mfma_f32_16x16x32_bf16 a[72:75], a[172:175], v[108:111], a[72:75]
  ds_read_b64_tr_b16 a[164:165], v240 offset:36864
  buffer_load_dwordx4 v[76:79], v246, s[20:23], s64 offen offset:3072 sc1
  v_mfma_f32_16x16x32_bf16 a[76:79], a[172:175], v[140:143], a[76:79]
  ds_read_b64_tr_b16 a[166:167], v240 offset:41472
  v_mfma_f32_16x16x32_bf16 a[76:79], a[168:171], v[136:139], a[76:79]
  s_waitcnt lgkmcnt(10)
  v_mfma_f32_16x16x32_bf16 a[92:95], a[176:179], v[136:139], a[92:95]
  v_and_b32 v13, 15, v0
  v_mfma_f32_16x16x32_bf16 a[92:95], a[144:147], v[140:143], a[92:95]
  ds_read_b64_tr_b16 a[168:169], v240 offset:46080
  v_lshrrev_b32 v14, 4, v0
  v_mfma_f32_16x16x32_bf16 a[88:91], a[144:147], v[108:111], a[88:91]
  ds_read_b64_tr_b16 a[170:171], v240 offset:50688
  s_add_u32 m0, s32, 110592
  v_and_b32 v15, 1, v14
  v_mfma_f32_16x16x32_bf16 a[88:91], a[176:179], v[104:107], a[88:91]
  v_mfma_f32_16x16x32_bf16 a[84:87], a[176:179], v[120:123], a[84:87]
  v_lshl_add_u32 v15, v15, 6, v13
  v_mfma_f32_16x16x32_bf16 a[84:87], a[144:147], v[124:127], a[84:87]
  ds_read_b64_tr_b16 a[172:173], v240 offset:36896
  buffer_load_dwordx4 v4, s[16:19], s51 offen offset:0 lds
  v_mfma_f32_16x16x32_bf16 a[80:83], a[144:147], v[92:95], a[80:83]
  ds_read_b64_tr_b16 a[174:175], v240 offset:41504
  v_mul_u32_u24 v247, 1152, v15
  v_mfma_f32_16x16x32_bf16 a[80:83], a[176:179], v[88:91], a[80:83]
  v_lshrrev_b32 v15, 1, v14
  s_waitcnt lgkmcnt(10)
  v_mfma_f32_16x16x32_bf16 a[96:99], a[148:151], v[88:91], a[96:99]
  buffer_load_dwordx4 v5, s[16:19], s51 offen offset:1024 lds
  v_lshl_add_u32 v247, v15, 4, v247
  v_mfma_f32_16x16x32_bf16 a[96:99], a[152:155], v[92:95], a[96:99]
  ds_read_b64_tr_b16 a[176:177], v240 offset:46112
  v_lshlrev_b32 v249, 2, v13
  v_mfma_f32_16x16x32_bf16 a[100:103], a[152:155], v[124:127], a[100:103]
  ds_read_b64_tr_b16 a[178:179], v240 offset:50720
  s_lshl_b32 s44, s26, 7
  v_mfma_f32_16x16x32_bf16 a[100:103], a[148:151], v[120:123], a[100:103]
  buffer_load_dwordx4 v6, s[16:19], s51 offen offset:2048 lds
  v_mfma_f32_16x16x32_bf16 a[104:107], a[148:151], v[104:107], a[104:107]
  s_sub_u32 s45, 1920, s44
  v_mfma_f32_16x16x32_bf16 a[104:107], a[152:155], v[108:111], a[104:107]
  ds_read_b64_tr_b16 a[144:145], v240 offset:36928
  s_lshl_b32 s45, s24, 4
  v_mfma_f32_16x16x32_bf16 a[108:111], a[152:155], v[140:143], a[108:111]
  ds_read_b64_tr_b16 a[146:147], v240 offset:41536
  buffer_load_dwordx4 v7, s[16:19], s51 offen offset:3072 lds
  s_add_u32 s44, s44, s45
  v_mfma_f32_16x16x32_bf16 a[108:111], a[148:151], v[136:139], a[108:111]
  s_waitcnt lgkmcnt(10)
  v_mfma_f32_16x16x32_bf16 a[124:127], a[156:159], v[136:139], a[124:127]
  s_and_b32 s45, s25, 3
  v_mfma_f32_16x16x32_bf16 a[124:127], a[160:163], v[140:143], a[124:127]
  ds_read_b64_tr_b16 a[148:149], v240 offset:46144
  s_add_u32 m0, s32, 114688
  s_mul_i32 s45, s45, 144
K_hA1_10:
  s_cbranch_execz K_hA1_11
  v_mfma_f32_16x16x32_bf16 a[120:123], a[160:163], v[108:111], a[120:123]
  ds_read_b64_tr_b16 a[150:151], v240 offset:50752
  v_mfma_f32_16x16x32_bf16 a[120:123], a[156:159], v[104:107], a[120:123]
  s_lshl_b32 s62, s25, 2
  v_mfma_f32_16x16x32_bf16 a[116:119], a[156:159], v[120:123], a[116:119]
  buffer_load_dwordx4 v8, s[16:19], s51 offen offset:0 lds
  s_and_b32 s62, s62, 0x70
  v_mfma_f32_16x16x32_bf16 a[116:119], a[160:163], v[124:127], a[116:119]
  ds_read_b64_tr_b16 a[152:153], v240 offset:36960
  s_add_u32 s45, s45, s62
  v_mfma_f32_16x16x32_bf16 a[112:115], a[160:163], v[92:95], a[112:115]
  ds_read_b64_tr_b16 a[154:155], v240 offset:41568
  v_mfma_f32_16x16x32_bf16 a[112:115], a[156:159], v[88:91], a[112:115]
  buffer_load_dwordx4 v9, s[16:19], s51 offen offset:1024 lds
  s_waitcnt vmcnt(15)
  s_waitcnt lgkmcnt(10)
  v_mfma_f32_16x16x32_bf16 a[0:3], a[164:167], v[16:19], a[0:3]
  s_mul_i32 s52, s44, 1152
  s_lshl_b32 s62, s45, 1
  v_mfma_f32_16x16x32_bf16 a[0:3], a[168:171], v[20:23], a[0:3]
  ds_read_b64_tr_b16 a[156:157], v240 offset:46176
  s_add_u32 s52, s52, s62
  v_mfma_f32_16x16x32_bf16 a[4:7], a[168:171], v[36:39], a[4:7]
  ds_read_b64_tr_b16 a[158:159], v240 offset:50784
  buffer_load_dwordx4 v10, s[16:19], s51 offen offset:2048 lds
  v_mfma_f32_16x16x32_bf16 a[4:7], a[164:167], v[32:35], a[4:7]
  s_lshl_b32 s53, s45, 12
  v_mfma_f32_16x16x32_bf16 a[8:11], a[164:167], v[48:51], a[8:11]
  s_lshl_b32 s62, s44, 1
  v_mfma_f32_16x16x32_bf16 a[8:11], a[168:171], v[52:55], a[8:11]
  ds_read_b64_tr_b16 a[160:161], v240 offset:36992
  buffer_load_dwordx4 v11, s[16:19], s51 offen offset:3072 lds
  s_add_u32 s53, s53, s62
  v_mfma_f32_16x16x32_bf16 a[12:15], a[168:171], v[68:71], a[12:15]
  ds_read_b64_tr_b16 a[162:163], v240 offset:41600
  v_mfma_f32_16x16x32_bf16 a[12:15], a[164:167], v[64:67], a[12:15]
  s_add_u32 s53, s53, 62914560
  s_waitcnt lgkmcnt(10)
  v_mfma_f32_16x16x32_bf16 a[28:31], a[172:175], v[64:67], a[28:31]
  s_add_u32 m0, s32, 118784
  s_lshl_b32 s54, s44, 2
  v_mfma_f32_16x16x32_bf16 a[28:31], a[176:179], v[68:71], a[28:31]
  ds_read_b64_tr_b16 a[164:165], v240 offset:46208
  v_mfma_f32_16x16x32_bf16 a[24:27], a[176:179], v[52:55], a[24:27]
  ds_read_b64_tr_b16 a[166:167], v240 offset:50816
  s_add_u32 s54, s54, 66060288
  v_mfma_f32_16x16x32_bf16 a[24:27], a[172:175], v[48:51], a[24:27]
  buffer_load_dwordx4 v12, s[16:19], s51 offen offset:0 lds
  s_lshl_b32 s44, s26, 7
  v_mfma_f32_16x16x32_bf16 a[20:23], a[172:175], v[32:35], a[20:23]
  s_sub_u32 s45, 1920, s44
  v_mfma_f32_16x16x32_bf16 a[20:23], a[176:179], v[36:39], a[20:23]
  ds_read_b64_tr_b16 a[168:169], v240 offset:37024
  v_mfma_f32_16x16x32_bf16 a[16:19], a[176:179], v[20:23], a[16:19]
  ds_read_b64_tr_b16 a[170:171], v240 offset:41632
  s_mov_b32 s44, s45
  v_mfma_f32_16x16x32_bf16 a[16:19], a[172:175], v[16:19], a[16:19]
  s_lshl_b32 s45, s24, 4
  s_waitcnt lgkmcnt(10)
  v_mfma_f32_16x16x32_bf16 a[32:35], a[144:147], v[16:19], a[32:35]
  s_and_b32 s92, s25, 3
  s_lshl_b32 s93, s92, 19
  s_sub_u32 s93, s34, s93
  s_add_u32 s92, s92, 2
  v_mfma_f32_16x16x32_bf16 a[32:35], a[148:151], v[20:23], a[32:35]
  ds_read_b64_tr_b16 a[172:173], v240 offset:46240
  s_add_u32 s44, s44, s45
  v_mfma_f32_16x16x32_bf16 a[36:39], a[148:151], v[36:39], a[36:39]
  ds_read_b64_tr_b16 a[174:175], v240 offset:50848
  s_and_b32 s45, s25, 3
  v_mfma_f32_16x16x32_bf16 a[36:39], a[144:147], v[32:35], a[36:39]
  s_and_b32 s92, s92, 3
  s_lshl_b32 s92, s92, 19
  s_add_u32 s64, s93, s92
  v_mfma_f32_16x16x32_bf16 a[40:43], a[144:147], v[48:51], a[40:43]
  buffer_load_dwordx4 v[176:179], v1, s[20:23], s64 offen offset:0 sc1
  s_mul_i32 s45, s45, 144
  s_lshl_b32 s62, s25, 2
  v_mfma_f32_16x16x32_bf16 a[40:43], a[148:151], v[52:55], a[40:43]
  ds_read_b64_tr_b16 a[176:177], v240 offset:37056
  v_mfma_f32_16x16x32_bf16 a[44:47], a[148:151], v[68:71], a[44:47]
  ds_read_b64_tr_b16 a[178:179], v240 offset:41664
  s_and_b32 s62, s62, 0x70
  v_mfma_f32_16x16x32_bf16 a[44:47], a[144:147], v[64:67], a[44:47]
  buffer_load_dwordx4 v[192:195], v244, s[20:23], s64 offen offset:0 sc1
  s_add_u32 s45, s45, s62
  s_waitcnt lgkmcnt(10)
  v_mfma_f32_16x16x32_bf16 a[60:63], a[152:155], v[64:67], a[60:63]
  s_mul_i32 s55, s44, 1152
  v_mfma_f32_16x16x32_bf16 a[60:63], a[156:159], v[68:71], a[60:63]
  ds_read_b64_tr_b16 a[144:145], v240 offset:46272
  v_mfma_f32_16x16x32_bf16 a[56:59], a[156:159], v[52:55], a[56:59]
  ds_read_b64_tr_b16 a[146:147], v240 offset:50880
  s_lshl_b32 s62, s45, 1
  v_mfma_f32_16x16x32_bf16 a[56:59], a[152:155], v[48:51], a[56:59]
  buffer_load_dwordx4 v[208:211], v245, s[20:23], s64 offen offset:0 sc1
  s_add_u32 s55, s55, s62
  v_mfma_f32_16x16x32_bf16 a[52:55], a[152:155], v[32:35], a[52:55]
  v_mfma_f32_16x16x32_bf16 a[52:55], a[156:159], v[36:39], a[52:55]
  ds_read_b64_tr_b16 a[148:149], v240 offset:37088
  s_lshl_b32 s56, s45, 12
  v_mfma_f32_16x16x32_bf16 a[48:51], a[156:159], v[20:23], a[48:51]
  ds_read_b64_tr_b16 a[150:151], v240 offset:41696
  buffer_load_dwordx4 v[224:227], v246, s[20:23], s64 offen offset:0 sc1
  s_lshl_b32 s62, s44, 1
  v_mfma_f32_16x16x32_bf16 a[48:51], a[152:155], v[16:19], a[48:51]
  s_add_u32 s56, s56, s62
  s_waitcnt lgkmcnt(10)
  v_mfma_f32_16x16x32_bf16 a[64:67], a[160:163], v[16:19], a[64:67]
  s_waitcnt vmcnt(14)
  s_lshr_b32 s27, s3, 1
  s_lshl_b32 s27, s27, 7
  s_lshl_b32 s28, s24, 2
  s_add_u32 s27, s27, s28
  s_add_u32 s27, s27, 66322432
  buffer_store_dword v252, off, s[20:23], s27 sc1
  buffer_store_dword v252, off, s[20:23], s1 sc1
  v_mfma_f32_16x16x32_bf16 a[64:67], a[164:167], v[20:23], a[64:67]
  ds_read_b64_tr_b16 a[152:153], v240 offset:46304
  buffer_load_dwordx4 v[180:183], v1, s[20:23], s64 offen offset:1024 sc1
  s_add_u32 s56, s56, 62914560
  v_mfma_f32_16x16x32_bf16 a[68:71], a[164:167], v[36:39], a[68:71]
  ds_read_b64_tr_b16 a[154:155], v240 offset:50912
  s_lshl_b32 s57, s44, 2
  v_mfma_f32_16x16x32_bf16 a[68:71], a[160:163], v[32:35], a[68:71]
  s_add_u32 s57, s57, 66060288
  v_mfma_f32_16x16x32_bf16 a[72:75], a[160:163], v[48:51], a[72:75]
  buffer_load_dwordx4 v[196:199], v244, s[20:23], s64 offen offset:1024 sc1
  v_mfma_f32_16x16x32_bf16 a[72:75], a[164:167], v[52:55], a[72:75]
  ds_read_b64_tr_b16 a[156:157], v240 offset:55296
  s_lshl_b32 s44, s26, 7
  v_mfma_f32_16x16x32_bf16 a[76:79], a[164:167], v[68:71], a[76:79]
  ds_read_b64_tr_b16 a[158:159], v240 offset:59904
  s_sub_u32 s45, 1920, s44
  v_mfma_f32_16x16x32_bf16 a[76:79], a[160:163], v[64:67], a[76:79]
  buffer_load_dwordx4 v[212:215], v245, s[20:23], s64 offen offset:1024 sc1
  s_waitcnt lgkmcnt(10)
  v_mfma_f32_16x16x32_bf16 a[92:95], a[168:171], v[64:67], a[92:95]
  s_bitcmp1_b32 s25, 2
  s_cselect_b32 s44, s45, s44
  v_mfma_f32_16x16x32_bf16 a[92:95], a[172:175], v[68:71], a[92:95]
  ds_read_b64_tr_b16 a[160:161], v241 offset:0
  s_lshl_b32 s45, s24, 4
  v_mfma_f32_16x16x32_bf16 a[88:91], a[172:175], v[52:55], a[88:91]
  ds_read_b64_tr_b16 a[162:163], v241 offset:4608
  buffer_load_dwordx4 v[228:231], v246, s[20:23], s64 offen offset:1024 sc1
  s_add_u32 s44, s44, s45
  v_mfma_f32_16x16x32_bf16 a[88:91], a[168:171], v[48:51], a[88:91]
  v_mfma_f32_16x16x32_bf16 a[84:87], a[168:171], v[32:35], a[84:87]
  s_and_b32 s45, s25, 3
  v_mfma_f32_16x16x32_bf16 a[84:87], a[172:175], v[36:39], a[84:87]
  ds_read_b64_tr_b16 a[164:165], v240 offset:55328
  buffer_load_dwordx4 v[184:187], v1, s[20:23], s64 offen offset:2048 sc1
  s_mul_i32 s45, s45, 144
  v_mfma_f32_16x16x32_bf16 a[80:83], a[172:175], v[20:23], a[80:83]
  ds_read_b64_tr_b16 a[166:167], v240 offset:59936
  s_add_u32 s45, s45, 128
  v_mfma_f32_16x16x32_bf16 a[80:83], a[168:171], v[16:19], a[80:83]
  s_waitcnt lgkmcnt(10)
  v_mfma_f32_16x16x32_bf16 a[96:99], a[176:179], v[16:19], a[96:99]
  buffer_load_dwordx4 v[200:203], v244, s[20:23], s64 offen offset:2048 sc1
  s_mul_i32 s58, s44, 1152
  v_mfma_f32_16x16x32_bf16 a[96:99], a[144:147], v[20:23], a[96:99]
  ds_read_b64_tr_b16 a[168:169], v241 offset:32
  s_lshl_b32 s62, s45, 1
  v_mfma_f32_16x16x32_bf16 a[100:103], a[144:147], v[36:39], a[100:103]
  ds_read_b64_tr_b16 a[170:171], v241 offset:4640
  s_add_u32 s58, s58, s62
  v_mfma_f32_16x16x32_bf16 a[100:103], a[176:179], v[32:35], a[100:103]
  buffer_load_dwordx4 v[216:219], v245, s[20:23], s64 offen offset:2048 sc1
  v_mfma_f32_16x16x32_bf16 a[104:107], a[176:179], v[48:51], a[104:107]
  s_lshl_b32 s59, s45, 12
  v_mfma_f32_16x16x32_bf16 a[104:107], a[144:147], v[52:55], a[104:107]
  ds_read_b64_tr_b16 a[172:173], v240 offset:55360
  s_lshl_b32 s62, s44, 1
  v_mfma_f32_16x16x32_bf16 a[108:111], a[144:147], v[68:71], a[108:111]
  ds_read_b64_tr_b16 a[174:175], v240 offset:59968
  buffer_load_dwordx4 v[232:235], v246, s[20:23], s64 offen offset:2048 sc1
  s_add_u32 s59, s59, s62
  v_mfma_f32_16x16x32_bf16 a[108:111], a[176:179], v[64:67], a[108:111]
  s_waitcnt lgkmcnt(10)
  v_mfma_f32_16x16x32_bf16 a[124:127], a[148:151], v[64:67], a[124:127]
  s_add_u32 s59, s59, 62914560
  v_mfma_f32_16x16x32_bf16 a[124:127], a[152:155], v[68:71], a[124:127]
  ds_read_b64_tr_b16 a[176:177], v241 offset:64
  buffer_load_dwordx4 v[188:191], v1, s[20:23], s64 offen offset:3072 sc1
  s_lshl_b32 s60, s44, 2
  v_mfma_f32_16x16x32_bf16 a[120:123], a[152:155], v[52:55], a[120:123]
  ds_read_b64_tr_b16 a[178:179], v241 offset:4672
  s_add_u32 s60, s60, 66060288
  v_mfma_f32_16x16x32_bf16 a[120:123], a[148:151], v[48:51], a[120:123]
  s_lshr_b32 s44, s25, 3
  s_cmp_eq_u32 s44, s24
  s_cselect_b32 s58, s58, 0x7f000000
  s_cselect_b32 s59, s59, 0x7f000000
  s_cselect_b32 s60, s60, 0x7f000000
  v_mfma_f32_16x16x32_bf16 a[116:119], a[148:151], v[32:35], a[116:119]
  buffer_load_dwordx4 v[204:207], v244, s[20:23], s64 offen offset:3072 sc1
  v_mfma_f32_16x16x32_bf16 a[116:119], a[152:155], v[36:39], a[116:119]
  ds_read_b64_tr_b16 a[144:145], v240 offset:55392
  v_lshrrev_b32 v13, 2, v0
  v_mfma_f32_16x16x32_bf16 a[112:115], a[152:155], v[20:23], a[112:115]
  ds_read_b64_tr_b16 a[146:147], v240 offset:60000
  v_mfma_f32_16x16x32_bf16 a[112:115], a[148:151], v[16:19], a[112:115]
  buffer_load_dwordx4 v[220:223], v245, s[20:23], s64 offen offset:3072 sc1
  s_waitcnt vmcnt(26)
  s_waitcnt lgkmcnt(10)
  v_mfma_f32_16x16x32_bf16 a[0:3], a[156:159], v[24:27], a[0:3]
  v_lshlrev_b32 v248, 12, v13
  v_bfe_u32 v14, v0, 1, 1
  v_mfma_f32_16x16x32_bf16 a[0:3], a[160:163], v[28:31], a[0:3]
  ds_read_b64_tr_b16 a[148:149], v241 offset:96
  v_lshl_add_u32 v248, v14, 7, v248
  v_mfma_f32_16x16x32_bf16 a[4:7], a[160:163], v[44:47], a[4:7]
  ds_read_b64_tr_b16 a[150:151], v241 offset:4704
  buffer_load_dwordx4 v[236:239], v246, s[20:23], s64 offen offset:3072 sc1
  v_mfma_f32_16x16x32_bf16 a[4:7], a[156:159], v[40:43], a[4:7]
  v_and_b32 v14, 1, v0
  v_mfma_f32_16x16x32_bf16 a[8:11], a[156:159], v[56:59], a[8:11]
  s_and_b32 s92, s25, 3
  s_lshl_b32 s93, s92, 19
  s_sub_u32 s93, s34, s93
  s_add_u32 s92, s92, 3
  v_mfma_f32_16x16x32_bf16 a[8:11], a[160:163], v[60:63], a[8:11]
  ds_read_b64_tr_b16 a[152:153], v240 offset:55424
  v_lshl_add_u32 v248, v14, 4, v248
  v_mfma_f32_16x16x32_bf16 a[12:15], a[160:163], v[76:79], a[12:15]
  ds_read_b64_tr_b16 a[154:155], v240 offset:60032
  v_lshlrev_b32 v250, 6, v13
  v_mfma_f32_16x16x32_bf16 a[12:15], a[156:159], v[72:75], a[12:15]
  v_and_b32 v14, 3, v0
  s_waitcnt lgkmcnt(10)
  v_mfma_f32_16x16x32_bf16 a[28:31], a[164:167], v[72:75], a[28:31]
  s_and_b32 s92, s92, 3
  s_lshl_b32 s92, s92, 19
  s_add_u32 s64, s93, s92
  v_mfma_f32_16x16x32_bf16 a[28:31], a[168:171], v[76:79], a[28:31]
  ds_read_b64_tr_b16 a[156:157], v241 offset:128
  v_lshl_add_u32 v250, v14, 3, v250
  v_mfma_f32_16x16x32_bf16 a[24:27], a[168:171], v[60:63], a[24:27]
  ds_read_b64_tr_b16 a[158:159], v241 offset:4736
  s_mul_i32 s61, s24, 3072
  s_add_u32 s61, s61, 147456
  v_mfma_f32_16x16x32_bf16 a[24:27], a[164:167], v[56:59], a[24:27]
  v_add_u32 v250, s61, v250
  v_mfma_f32_16x16x32_bf16 a[20:23], a[164:167], v[40:43], a[20:23]
  buffer_load_dwordx4 a[192:195], v1, s[20:23], s64 offen offset:0 sc1
  v_lshrrev_b32 v13, 5, v0
  v_mfma_f32_16x16x32_bf16 a[20:23], a[168:171], v[44:47], a[20:23]
  ds_read_b64_tr_b16 a[160:161], v240 offset:55456
  v_mfma_f32_16x16x32_bf16 a[16:19], a[168:171], v[28:31], a[16:19]
  ds_read_b64_tr_b16 a[162:163], v240 offset:60064
  v_lshlrev_b32 v13, 6, v13
  v_mfma_f32_16x16x32_bf16 a[16:19], a[164:167], v[24:27], a[16:19]
  buffer_load_dwordx4 a[208:211], v244, s[20:23], s64 offen offset:0 sc1
  s_waitcnt lgkmcnt(10)
  v_bfe_u32 v14, v0, 1, 4
  v_mfma_f32_16x16x32_bf16 a[32:35], a[172:175], v[24:27], a[32:35]
  v_add_u32 v13, v13, v14
  v_mfma_f32_16x16x32_bf16 a[32:35], a[176:179], v[28:31], a[32:35]
  ds_read_b64_tr_b16 a[164:165], v241 offset:160
  v_mfma_f32_16x16x32_bf16 a[36:39], a[176:179], v[44:47], a[36:39]
  ds_read_b64_tr_b16 a[166:167], v241 offset:4768
  buffer_load_dwordx4 a[224:227], v245, s[20:23], s64 offen offset:0 sc1
  v_mfma_f32_16x16x32_bf16 a[36:39], a[172:175], v[40:43], a[36:39]
  v_mul_u32_u24 v13, 1152, v13
  v_and_b32 v14, 1, v0
  v_mfma_f32_16x16x32_bf16 a[40:43], a[172:175], v[56:59], a[40:43]
  v_lshl_add_u32 v251, v14, 4, v13
  v_mfma_f32_16x16x32_bf16 a[40:43], a[176:179], v[60:63], a[40:43]
  ds_read_b64_tr_b16 a[168:169], v240 offset:55488
  buffer_load_dwordx4 a[240:243], v246, s[20:23], s64 offen offset:0 sc1
  v_mfma_f32_16x16x32_bf16 a[44:47], a[176:179], v[76:79], a[44:47]
  ds_read_b64_tr_b16 a[170:171], v240 offset:60096
  v_and_b32 v13, 15, v0
  v_mfma_f32_16x16x32_bf16 a[44:47], a[172:175], v[72:75], a[44:47]
  v_lshrrev_b32 v14, 4, v0
  s_waitcnt lgkmcnt(10)
  v_mfma_f32_16x16x32_bf16 a[60:63], a[144:147], v[72:75], a[60:63]
  buffer_load_dwordx4 a[196:199], v1, s[20:23], s64 offen offset:1024 sc1
  v_lshlrev_b32 v13, 5, v13
  v_mfma_f32_16x16x32_bf16 a[60:63], a[148:151], v[76:79], a[60:63]
  ds_read_b64_tr_b16 a[172:173], v241 offset:192
  v_mfma_f32_16x16x32_bf16 a[56:59], a[148:151], v[60:63], a[56:59]
  ds_read_b64_tr_b16 a[174:175], v241 offset:4800
  v_lshl_add_u32 v13, v14, 3, v13
  v_mfma_f32_16x16x32_bf16 a[56:59], a[144:147], v[56:59], a[56:59]
  buffer_load_dwordx4 a[212:215], v244, s[20:23], s64 offen offset:1024 sc1
  v_add_u32 v255, s61, v13
  v_mfma_f32_16x16x32_bf16 a[52:55], a[144:147], v[40:43], a[52:55]
  v_mov_b32 v168, 0
  v_mfma_f32_16x16x32_bf16 a[52:55], a[148:151], v[44:47], a[52:55]
  ds_read_b64_tr_b16 a[176:177], v240 offset:55520
  v_mfma_f32_16x16x32_bf16 a[48:51], a[148:151], v[28:31], a[48:51]
  ds_read_b64_tr_b16 a[178:179], v240 offset:60128
  buffer_load_dwordx4 a[228:231], v245, s[20:23], s64 offen offset:1024 sc1
  v_mfma_f32_16x16x32_bf16 a[48:51], a[144:147], v[24:27], a[48:51]
  s_waitcnt lgkmcnt(10)
  v_mov_b32 v169, 0
  v_mov_b32 v172, 0
  v_mfma_f32_16x16x32_bf16 a[64:67], a[152:155], v[24:27], a[64:67]
  v_mfma_f32_16x16x32_bf16 a[64:67], a[156:159], v[28:31], a[64:67]
  ds_read_b64_tr_b16 a[144:145], v241 offset:224
  buffer_load_dwordx4 a[244:247], v246, s[20:23], s64 offen offset:1024 sc1
  v_mfma_f32_16x16x32_bf16 a[68:71], a[156:159], v[44:47], a[68:71]
  ds_read_b64_tr_b16 a[146:147], v241 offset:4832
  v_mov_b32 v173, 0
  v_mfma_f32_16x16x32_bf16 a[68:71], a[152:155], v[40:43], a[68:71]
  s_waitcnt vmcnt(26)
  s_barrier
  v_mfma_f32_16x16x32_bf16 a[72:75], a[152:155], v[56:59], a[72:75]
  buffer_load_dwordx4 a[200:203], v1, s[20:23], s64 offen offset:2048 sc1
  v_and_b32 v13, 1, v0
  v_mfma_f32_16x16x32_bf16 a[72:75], a[156:159], v[60:63], a[72:75]
  ds_read_b64_tr_b16 a[148:149], v241 offset:9216
  v_lshlrev_b32 v13, 4, v13
  v_mfma_f32_16x16x32_bf16 a[76:79], a[156:159], v[76:79], a[76:79]
  ds_read_b64_tr_b16 a[150:151], v241 offset:13824
  v_mov_b32 v14, 0x3f80
  v_mfma_f32_16x16x32_bf16 a[76:79], a[152:155], v[72:75], a[76:79]
  buffer_load_dwordx4 a[216:219], v244, s[20:23], s64 offen offset:2048 sc1
  s_waitcnt lgkmcnt(10)
  v_lshlrev_b32 v13, v13, v14
  v_mfma_f32_16x16x32_bf16 a[92:95], a[160:163], v[72:75], a[92:95]
  v_bfe_u32 v14, v0, 1, 3
  v_mfma_f32_16x16x32_bf16 a[92:95], a[164:167], v[76:79], a[92:95]
  ds_read_b64_tr_b16 a[152:153], v241 offset:18432
  v_lshrrev_b32 v15, 4, v0
  v_mfma_f32_16x16x32_bf16 a[88:91], a[164:167], v[60:63], a[88:91]
  ds_read_b64_tr_b16 a[154:155], v241 offset:23040
  buffer_load_dwordx4 a[232:235], v245, s[20:23], s64 offen offset:2048 sc1
  v_mfma_f32_16x16x32_bf16 a[88:91], a[160:163], v[56:59], a[88:91]
  v_lshlrev_b32 v15, 1, v15
  v_mfma_f32_16x16x32_bf16 a[84:87], a[160:163], v[40:43], a[84:87]
  v_cmp_eq_u32 vcc, v14, v15
  v_add_u32 v15, 1, v15
  s_nop 0
  v_cndmask_b32 v170, 0, v13, vcc
  v_mfma_f32_16x16x32_bf16 a[84:87], a[164:167], v[44:47], a[84:87]
  ds_read_b64_tr_b16 a[156:157], v241 offset:27648
  buffer_load_dwordx4 a[248:251], v246, s[20:23], s64 offen offset:2048 sc1
  v_mfma_f32_16x16x32_bf16 a[80:83], a[164:167], v[28:31], a[80:83]
  ds_read_b64_tr_b16 a[158:159], v241 offset:32256
  v_mfma_f32_16x16x32_bf16 a[80:83], a[160:163], v[24:27], a[80:83]
  s_waitcnt lgkmcnt(10)
  v_cmp_eq_u32 vcc, v14, v15
  v_and_b32 v14, 7, v0
  s_nop 0
  v_cndmask_b32 v171, 0, v13, vcc
  v_mfma_f32_16x16x32_bf16 a[96:99], a[168:171], v[24:27], a[96:99]
  buffer_load_dwordx4 a[204:207], v1, s[20:23], s64 offen offset:3072 sc1
  v_mfma_f32_16x16x32_bf16 a[96:99], a[172:175], v[28:31], a[96:99]
  ds_read_b64_tr_b16 a[160:161], v241 offset:36864
  v_mfma_f32_16x16x32_bf16 a[100:103], a[172:175], v[44:47], a[100:103]
  ds_read_b64_tr_b16 a[162:163], v241 offset:41472
  v_mfma_f32_16x16x32_bf16 a[100:103], a[168:171], v[40:43], a[100:103]
  buffer_load_dwordx4 a[220:223], v244, s[20:23], s64 offen offset:3072 sc1
  v_mfma_f32_16x16x32_bf16 a[104:107], a[168:171], v[56:59], a[104:107]
  s_lshr_b32 s44, s25, 2
  v_cmp_eq_u32 vcc, s44, v14
  s_nop 1
  v_cndmask_b32 v174, 0, v252, vcc
  v_mfma_f32_16x16x32_bf16 a[104:107], a[172:175], v[60:63], a[104:107]
  ds_read_b64_tr_b16 a[164:165], v241 offset:46080
  v_bfe_u32 v13, v0, 2, 3
  v_mfma_f32_16x16x32_bf16 a[108:111], a[172:175], v[76:79], a[108:111]
  ds_read_b64_tr_b16 a[166:167], v241 offset:50688
  buffer_load_dwordx4 a[236:239], v245, s[20:23], s64 offen offset:3072 sc1
  v_mfma_f32_16x16x32_bf16 a[108:111], a[168:171], v[72:75], a[108:111]
  s_waitcnt lgkmcnt(10)
  v_lshlrev_b32 v13, 7, v13
  v_and_b32 v14, 3, v0
  v_mfma_f32_16x16x32_bf16 a[124:127], a[176:179], v[72:75], a[124:127]
  v_lshl_add_u32 v13, v14, 2, v13
  v_mfma_f32_16x16x32_bf16 a[124:127], a[144:147], v[76:79], a[124:127]
  ds_read_b64_tr_b16 a[168:169], v241 offset:55296
  buffer_load_dwordx4 a[252:255], v246, s[20:23], s64 offen offset:3072 sc1
  v_mfma_f32_16x16x32_bf16 a[120:123], a[144:147], v[60:63], a[120:123]
  ds_read_b64_tr_b16 a[170:171], v241 offset:59904
  v_mfma_f32_16x16x32_bf16 a[120:123], a[176:179], v[56:59], a[120:123]
  s_and_b32 s44, s25, 3
  s_mul_i32 s44, s44, 9216
  s_add_u32 s44, s44, 66322432
  v_mfma_f32_16x16x32_bf16 a[116:119], a[176:179], v[40:43], a[116:119]
  s_lshr_b32 s45, s25, 2
  s_lshl_b32 s45, s45, 10
  v_mfma_f32_16x16x32_bf16 a[116:119], a[144:147], v[44:47], a[116:119]
  ds_read_b64_tr_b16 a[172:173], v242 offset:0
  s_lshr_b32 s62, s25, 3
  s_cmp_eq_u32 s62, s24
  s_cselect_b32 s62, 8192, s45
  v_mfma_f32_16x16x32_bf16 a[112:115], a[144:147], v[28:31], a[112:115]
  ds_read_b64_tr_b16 a[174:175], v242 offset:4608
  v_add_u32 v13, s44, v13
  v_add_u32 v14, s45, v13
  v_add_u32 v13, s62, v13
  v_cmp_gt_u32 vcc, 32, v0
  s_nop 1
  v_cndmask_b32 v175, v13, v14, vcc
  v_mfma_f32_16x16x32_bf16 a[112:115], a[176:179], v[24:27], a[112:115]
  s_waitcnt vmcnt(24)
  s_waitcnt lgkmcnt(10)
  v_mfma_f32_16x16x32_bf16 a[0:3], a[148:151], v[176:179], a[0:3]
  s_lshl_b32 s27, s26, 2
  s_and_b32 s28, s25, 3
  s_add_u32 s27, s27, s28
  s_lshl_b32 s27, s27, 2
  s_add_u32 s27, s27, s24
  s_lshl_b32 s30, s27, 10
  s_mul_i32 s47, s27, 147456
  v_mfma_f32_16x16x32_bf16 a[0:3], a[152:155], v[180:183], a[0:3]
  ds_read_b64_tr_b16 a[176:177], v242 offset:9216
  v_mfma_f32_16x16x32_bf16 a[4:7], a[152:155], v[196:199], a[4:7]
  ds_read_b64_tr_b16 a[178:179], v242 offset:13824
  s_add_u32 m0, s61, 0
  v_mfma_f32_16x16x32_bf16 a[4:7], a[148:151], v[192:195], a[4:7]
  v_mfma_f32_16x16x32_bf16 a[8:11], a[148:151], v[208:211], a[8:11]
  v_mfma_f32_16x16x32_bf16 a[8:11], a[152:155], v[212:215], a[8:11]
  ds_read_b64_tr_b16 a[144:145], v241 offset:9248
  v_mfma_f32_16x16x32_bf16 a[12:15], a[152:155], v[228:231], a[12:15]
  ds_read_b64_tr_b16 a[146:147], v241 offset:13856
  buffer_load_dwordx4 v251, s[12:15], s52 offen lds
  s_add_u32 s30, s30, 66453504
  v_mfma_f32_16x16x32_bf16 a[12:15], a[148:151], v[224:227], a[12:15]
  s_waitcnt vmcnt(17)
  s_waitcnt lgkmcnt(10)
  v_mfma_f32_16x16x32_bf16 a[12:15], a[156:159], v[232:235], a[12:15]
  v_mfma_f32_16x16x32_bf16 a[12:15], a[160:163], v[236:239], a[12:15]
  ds_read_b64_tr_b16 a[148:149], v241 offset:18464
  v_mfma_f32_16x16x32_bf16 a[8:11], a[160:163], v[220:223], a[8:11]
  ds_read_b64_tr_b16 a[150:151], v241 offset:23072
  v_mfma_f32_16x16x32_bf16 a[8:11], a[156:159], v[216:219], a[8:11]
  s_add_u32 m0, s61, 1024
  v_mfma_f32_16x16x32_bf16 a[4:7], a[156:159], v[200:203], a[4:7]
  s_lshr_b32 s28, s25, 2
  s_lshl_b32 s28, s28, 11
  v_mfma_f32_16x16x32_bf16 a[4:7], a[160:163], v[204:207], a[4:7]
  ds_read_b64_tr_b16 a[152:153], v241 offset:27680
  v_mfma_f32_16x16x32_bf16 a[0:3], a[160:163], v[188:191], a[0:3]
  ds_read_b64_tr_b16 a[154:155], v241 offset:32288
  v_mfma_f32_16x16x32_bf16 a[0:3], a[156:159], v[184:187], a[0:3]
  s_waitcnt vmcnt(9)
  s_waitcnt lgkmcnt(10)
  v_mfma_f32_16x16x32_bf16 a[0:3], a[164:167], a[192:195], a[0:3]
  buffer_load_dwordx4 v251, s[12:15], s55 offen lds
  v_mfma_f32_16x16x32_bf16 a[0:3], a[168:171], a[196:199], a[0:3]
  ds_read_b64_tr_b16 a[156:157], v241 offset:36896
  v_mfma_f32_16x16x32_bf16 a[4:7], a[168:171], a[212:215], a[4:7]
  ds_read_b64_tr_b16 a[158:159], v241 offset:41504
  v_mfma_f32_16x16x32_bf16 a[4:7], a[164:167], a[208:211], a[4:7]
  s_add_u32 s47, s47, 67108864
  v_mfma_f32_16x16x32_bf16 a[8:11], a[164:167], a[224:227], a[8:11]
  v_mfma_f32_16x16x32_bf16 a[8:11], a[168:171], a[228:231], a[8:11]
  ds_read_b64_tr_b16 a[160:161], v241 offset:46112
  s_add_u32 m0, s61, 2048
  v_mfma_f32_16x16x32_bf16 a[12:15], a[168:171], a[244:247], a[12:15]
  ds_read_b64_tr_b16 a[162:163], v241 offset:50720
  v_mfma_f32_16x16x32_bf16 a[12:15], a[164:167], a[240:243], a[12:15]
  s_waitcnt vmcnt(2)
  s_waitcnt lgkmcnt(10)
  v_mfma_f32_16x16x32_bf16 a[12:15], a[172:175], a[248:251], a[12:15]
  v_mfma_f32_16x16x32_bf16 a[12:15], a[176:179], a[252:255], a[12:15]
  ds_read_b64_tr_b16 a[164:165], v241 offset:55328
  s_add_u32 s46, s47, s28
  v_mfma_f32_16x16x32_bf16 a[8:11], a[176:179], a[236:239], a[8:11]
  ds_read_b64_tr_b16 a[166:167], v241 offset:59936
  buffer_load_dwordx4 v251, s[12:15], s58 offen lds
  v_mfma_f32_16x16x32_bf16 a[8:11], a[172:175], a[232:235], a[8:11]
  v_mfma_f32_16x16x32_bf16 a[4:7], a[172:175], a[216:219], a[4:7]
  v_mfma_f32_16x16x32_bf16 a[4:7], a[176:179], a[220:223], a[4:7]
  ds_read_b64_tr_b16 a[168:169], v242 offset:32
  v_mfma_f32_16x16x32_bf16 a[0:3], a[176:179], a[204:207], a[0:3]
  ds_read_b64_tr_b16 a[170:171], v242 offset:4640
  v_mfma_f32_16x16x32_bf16 a[0:3], a[172:175], a[200:203], a[0:3]
  s_waitcnt lgkmcnt(10)
  v_mfma_f32_16x16x32_bf16 a[16:19], a[144:147], v[176:179], a[16:19]
  s_lshr_b32 s37, s25, 2
  s_lshl_b32 s36, s37, 14
  s_add_u32 s36, s36, s47
  v_mfma_f32_16x16x32_bf16 a[16:19], a[148:151], v[180:183], a[16:19]
  ds_read_b64_tr_b16 a[172:173], v242 offset:9248
  v_mfma_f32_16x16x32_bf16 a[20:23], a[148:151], v[196:199], a[20:23]
  ds_read_b64_tr_b16 a[174:175], v242 offset:13856
  s_and_b32 s92, s37, 1
  s_lshl_b32 s92, s92, 10
  v_mfma_f32_16x16x32_bf16 a[20:23], a[144:147], v[192:195], a[20:23]
  s_lshr_b32 s28, s25, 2
  s_add_u32 s28, s28, 1
  v_mfma_f32_16x16x32_bf16 a[24:27], a[144:147], v[208:211], a[24:27]
  s_add_u32 s92, s92, s47
  s_add_u32 s92, s92, 131072
  v_mfma_f32_16x16x32_bf16 a[24:27], a[148:151], v[212:215], a[24:27]
  ds_read_b64_tr_b16 a[176:177], v241 offset:9280
  s_sub_u32 s29, s28, 9
  s_min_u32 s28, s28, s29
  v_mfma_f32_16x16x32_bf16 a[28:31], a[148:151], v[228:231], a[28:31]
  ds_read_b64_tr_b16 a[178:179], v241 offset:13888
  s_lshl_b32 s28, s28, 14
  s_add_u32 s29, s46, s28
  v_mfma_f32_16x16x32_bf16 a[28:31], a[144:147], v[224:227], a[28:31]
  s_waitcnt lgkmcnt(10)
  v_accvgpr_read_b32 v148, a0
  v_accvgpr_read_b32 v149, a1
  v_mfma_f32_16x16x32_bf16 a[28:31], a[152:155], v[232:235], a[28:31]
  s_lshr_b32 s93, s25, 3
  s_cmp_eq_u32 s93, s24
  s_cselect_b32 s43, s92, 0x7f000000
  s_and_b32 s27, s25, 28
  s_lshl_b32 s27, s27, 5
  s_add_u32 s27, s27, s30
  v_and_b32 v14, 28, v253
  v_add_u32 v14, s27, v14
  v_mfma_f32_16x16x32_bf16 a[28:31], a[156:159], v[236:239], a[28:31]
  ds_read_b64_tr_b16 a[144:145], v241 offset:18496
  s_mov_b32 s39, 0
  v_accvgpr_read_b32 v150, a2
  v_mfma_f32_16x16x32_bf16 a[24:27], a[156:159], v[220:223], a[24:27]
  ds_read_b64_tr_b16 a[146:147], v241 offset:23104
  s_mov_b32 s94, 100000
  v_accvgpr_read_b32 v151, a3
  v_mfma_f32_16x16x32_bf16 a[24:27], a[152:155], v[216:219], a[24:27]
  v_accvgpr_read_b32 v152, a4
  v_accvgpr_read_b32 v153, a5
  v_mfma_f32_16x16x32_bf16 a[20:23], a[152:155], v[200:203], a[20:23]
  v_accvgpr_write_b32 a180, 0
  v_accvgpr_read_b32 v154, a6
  v_mfma_f32_16x16x32_bf16 a[20:23], a[156:159], v[204:207], a[20:23]
  ds_read_b64_tr_b16 a[148:149], v241 offset:27712
  v_accvgpr_read_b32 v155, a7
  v_mfma_f32_16x16x32_bf16 a[16:19], a[156:159], v[188:191], a[16:19]
  ds_read_b64_tr_b16 a[150:151], v241 offset:32320
  v_accvgpr_write_b32 a181, 0
  v_mfma_f32_16x16x32_bf16 a[16:19], a[152:155], v[184:187], a[16:19]
  s_waitcnt lgkmcnt(10)
  v_cvt_pk_bf16_f32 v144, v148, v149
  v_cvt_pk_bf16_f32 v145, v150, v151
  v_mfma_f32_16x16x32_bf16 a[16:19], a[160:163], a[192:195], a[16:19]
  v_accvgpr_write_b32 a182, 0
  v_cvt_pk_bf16_f32 v146, v152, v153
  v_mfma_f32_16x16x32_bf16 a[16:19], a[164:167], a[196:199], a[16:19]
  ds_read_b64_tr_b16 a[152:153], v241 offset:36928
  v_cvt_pk_bf16_f32 v147, v154, v155
  v_mfma_f32_16x16x32_bf16 a[20:23], a[164:167], a[212:215], a[20:23]
  buffer_store_dwordx4 v[144:147], v1, s[20:23], s29 offen offset:0 sc1
  ds_read_b64_tr_b16 a[154:155], v241 offset:41536
  v_accvgpr_write_b32 a183, 0
  v_accvgpr_read_b32 v160, a8
  v_accvgpr_read_b32 v161, a9
  v_mfma_f32_16x16x32_bf16 a[20:23], a[160:163], a[208:211], a[20:23]
  v_accvgpr_read_b32 v162, a10
  v_accvgpr_read_b32 v163, a11
  v_mfma_f32_16x16x32_bf16 a[24:27], a[160:163], a[224:227], a[24:27]
  v_accvgpr_write_b32 a184, 0
  v_accvgpr_read_b32 v164, a12
  v_mfma_f32_16x16x32_bf16 a[24:27], a[164:167], a[228:231], a[24:27]
  ds_read_b64_tr_b16 a[156:157], v241 offset:46144
  v_accvgpr_read_b32 v165, a13
  v_mfma_f32_16x16x32_bf16 a[28:31], a[164:167], a[244:247], a[28:31]
  ds_read_b64_tr_b16 a[158:159], v241 offset:50752
  v_accvgpr_write_b32 a185, 0
  v_mfma_f32_16x16x32_bf16 a[28:31], a[160:163], a[240:243], a[28:31]
  s_waitcnt lgkmcnt(10)
  v_accvgpr_read_b32 v166, a14
  v_accvgpr_read_b32 v167, a15
  v_mfma_f32_16x16x32_bf16 a[28:31], a[168:171], a[248:251], a[28:31]
  v_accvgpr_write_b32 a186, 0
  v_cvt_pk_bf16_f32 v156, v160, v161
  v_mfma_f32_16x16x32_bf16 a[28:31], a[172:175], a[252:255], a[28:31]
  ds_read_b64_tr_b16 a[160:161], v241 offset:55360
  v_cvt_pk_bf16_f32 v157, v162, v163
  v_mfma_f32_16x16x32_bf16 a[24:27], a[172:175], a[236:239], a[24:27]
  ds_read_b64_tr_b16 a[162:163], v241 offset:59968
  v_accvgpr_write_b32 a187, 0
  v_mfma_f32_16x16x32_bf16 a[24:27], a[168:171], a[232:235], a[24:27]
  v_cvt_pk_bf16_f32 v158, v164, v165
  v_cvt_pk_bf16_f32 v159, v166, v167
  v_mfma_f32_16x16x32_bf16 a[20:23], a[168:171], a[216:219], a[20:23]
  buffer_store_dwordx4 v[156:159], v1, s[20:23], s29 offen offset:1024 sc1
  s_mov_b32 s41, 0
  v_mfma_f32_16x16x32_bf16 a[20:23], a[172:175], a[220:223], a[20:23]
  ds_read_b64_tr_b16 a[164:165], v242 offset:64
  v_mfma_f32_16x16x32_bf16 a[16:19], a[172:175], a[204:207], a[16:19]
  ds_read_b64_tr_b16 a[166:167], v242 offset:4672
  v_mfma_f32_16x16x32_bf16 a[16:19], a[168:171], a[200:203], a[16:19]
  s_waitcnt lgkmcnt(10)
  v_mfma_f32_16x16x32_bf16 a[32:35], a[176:179], v[176:179], a[32:35]
  v_mfma_f32_16x16x32_bf16 a[32:35], a[144:147], v[180:183], a[32:35]
  ds_read_b64_tr_b16 a[168:169], v242 offset:9280
  v_mfma_f32_16x16x32_bf16 a[36:39], a[144:147], v[196:199], a[36:39]
  ds_read_b64_tr_b16 a[170:171], v242 offset:13888
  s_lshr_b32 s28, s25, 2
  s_add_u32 s28, s28, 2
  v_mfma_f32_16x16x32_bf16 a[36:39], a[176:179], v[192:195], a[36:39]
  s_sub_u32 s29, s28, 9
  s_min_u32 s28, s28, s29
  v_mfma_f32_16x16x32_bf16 a[40:43], a[176:179], v[208:211], a[40:43]
  s_lshl_b32 s28, s28, 14
K_hA2_10:
  s_cbranch_execz K_hA2_11
  s_add_u32 s29, s46, s28
  v_accvgpr_read_b32 v148, a16
  v_mfma_f32_16x16x32_bf16 a[40:43], a[144:147], v[212:215], a[40:43]
  ds_read_b64_tr_b16 a[172:173], v241 offset:9312
  v_accvgpr_read_b32 v149, a17
  v_mfma_f32_16x16x32_bf16 a[44:47], a[144:147], v[228:231], a[44:47]
  ds_read_b64_tr_b16 a[174:175], v241 offset:13920
  v_accvgpr_read_b32 v150, a18
  v_mfma_f32_16x16x32_bf16 a[44:47], a[176:179], v[224:227], a[44:47]
  v_accvgpr_read_b32 v151, a19
  s_waitcnt lgkmcnt(10)
  v_mfma_f32_16x16x32_bf16 a[44:47], a[148:151], v[232:235], a[44:47]
  v_accvgpr_read_b32 v152, a20
  v_mfma_f32_16x16x32_bf16 a[44:47], a[152:155], v[236:239], a[44:47]
  ds_read_b64_tr_b16 a[176:177], v241 offset:18528
  v_accvgpr_read_b32 v153, a21
  v_mfma_f32_16x16x32_bf16 a[40:43], a[152:155], v[220:223], a[40:43]
  ds_read_b64_tr_b16 a[178:179], v241 offset:23136
  v_accvgpr_read_b32 v154, a22
  v_mfma_f32_16x16x32_bf16 a[40:43], a[148:151], v[216:219], a[40:43]
  v_accvgpr_read_b32 v155, a23
  v_mfma_f32_16x16x32_bf16 a[36:39], a[148:151], v[200:203], a[36:39]
  v_cvt_pk_bf16_f32 v144, v148, v149
  v_mfma_f32_16x16x32_bf16 a[36:39], a[152:155], v[204:207], a[36:39]
  ds_read_b64_tr_b16 a[144:145], v241 offset:27744
  v_cvt_pk_bf16_f32 v145, v150, v151
  v_mfma_f32_16x16x32_bf16 a[32:35], a[152:155], v[188:191], a[32:35]
  ds_read_b64_tr_b16 a[146:147], v241 offset:32352
  v_cvt_pk_bf16_f32 v146, v152, v153
  v_mfma_f32_16x16x32_bf16 a[32:35], a[148:151], v[184:187], a[32:35]
  v_cvt_pk_bf16_f32 v147, v154, v155
  s_waitcnt lgkmcnt(10)
  v_mfma_f32_16x16x32_bf16 a[32:35], a[156:159], a[192:195], a[32:35]
  buffer_store_dwordx4 v[144:147], v1, s[20:23], s29 offen offset:0 sc1
  v_accvgpr_read_b32 v160, a24
  v_mfma_f32_16x16x32_bf16 a[32:35], a[160:163], a[196:199], a[32:35]
  ds_read_b64_tr_b16 a[148:149], v241 offset:36960
  v_accvgpr_read_b32 v161, a25
  v_mfma_f32_16x16x32_bf16 a[36:39], a[160:163], a[212:215], a[36:39]
  ds_read_b64_tr_b16 a[150:151], v241 offset:41568
  v_accvgpr_read_b32 v162, a26
  v_mfma_f32_16x16x32_bf16 a[36:39], a[156:159], a[208:211], a[36:39]
  v_accvgpr_read_b32 v163, a27
  v_mfma_f32_16x16x32_bf16 a[40:43], a[156:159], a[224:227], a[40:43]
  v_accvgpr_read_b32 v164, a28
  v_mfma_f32_16x16x32_bf16 a[40:43], a[160:163], a[228:231], a[40:43]
  ds_read_b64_tr_b16 a[152:153], v241 offset:46176
  v_accvgpr_read_b32 v165, a29
  v_mfma_f32_16x16x32_bf16 a[44:47], a[160:163], a[244:247], a[44:47]
  ds_read_b64_tr_b16 a[154:155], v241 offset:50784
  v_accvgpr_read_b32 v166, a30
  v_mfma_f32_16x16x32_bf16 a[44:47], a[156:159], a[240:243], a[44:47]
  v_accvgpr_read_b32 v167, a31
  s_waitcnt lgkmcnt(10)
  v_mfma_f32_16x16x32_bf16 a[44:47], a[164:167], a[248:251], a[44:47]
  v_cvt_pk_bf16_f32 v156, v160, v161
  v_mfma_f32_16x16x32_bf16 a[44:47], a[168:171], a[252:255], a[44:47]
  ds_read_b64_tr_b16 a[156:157], v241 offset:55392
  v_cvt_pk_bf16_f32 v157, v162, v163
  v_mfma_f32_16x16x32_bf16 a[40:43], a[168:171], a[236:239], a[40:43]
  ds_read_b64_tr_b16 a[158:159], v241 offset:60000
  v_cvt_pk_bf16_f32 v158, v164, v165
  v_mfma_f32_16x16x32_bf16 a[40:43], a[164:167], a[232:235], a[40:43]
  v_cvt_pk_bf16_f32 v159, v166, v167
  v_mfma_f32_16x16x32_bf16 a[36:39], a[164:167], a[216:219], a[36:39]
  buffer_store_dwordx4 v[156:159], v1, s[20:23], s29 offen offset:1024 sc1
  v_mfma_f32_16x16x32_bf16 a[36:39], a[168:171], a[220:223], a[36:39]
  ds_read_b64_tr_b16 a[160:161], v242 offset:96
  v_mfma_f32_16x16x32_bf16 a[32:35], a[168:171], a[204:207], a[32:35]
  ds_read_b64_tr_b16 a[162:163], v242 offset:4704
  v_mfma_f32_16x16x32_bf16 a[32:35], a[164:167], a[200:203], a[32:35]
  s_waitcnt lgkmcnt(10)
  v_mfma_f32_16x16x32_bf16 a[48:51], a[172:175], v[176:179], a[48:51]
  v_mfma_f32_16x16x32_bf16 a[48:51], a[176:179], v[180:183], a[48:51]
  ds_read_b64_tr_b16 a[164:165], v242 offset:9312
  v_mfma_f32_16x16x32_bf16 a[52:55], a[176:179], v[196:199], a[52:55]
  ds_read_b64_tr_b16 a[166:167], v242 offset:13920
  s_lshr_b32 s28, s25, 2
  s_add_u32 s28, s28, 3
  v_mfma_f32_16x16x32_bf16 a[52:55], a[172:175], v[192:195], a[52:55]
  s_sub_u32 s29, s28, 9
  s_min_u32 s28, s28, s29
  v_mfma_f32_16x16x32_bf16 a[56:59], a[172:175], v[208:211], a[56:59]
  s_lshl_b32 s28, s28, 14
  s_add_u32 s29, s46, s28
  v_accvgpr_read_b32 v148, a32
  v_mfma_f32_16x16x32_bf16 a[56:59], a[176:179], v[212:215], a[56:59]
  ds_read_b64_tr_b16 a[168:169], v241 offset:9344
  v_accvgpr_read_b32 v149, a33
  v_mfma_f32_16x16x32_bf16 a[60:63], a[176:179], v[228:231], a[60:63]
  ds_read_b64_tr_b16 a[170:171], v241 offset:13952
  v_accvgpr_read_b32 v150, a34
  v_mfma_f32_16x16x32_bf16 a[60:63], a[172:175], v[224:227], a[60:63]
  v_accvgpr_read_b32 v151, a35
  s_waitcnt lgkmcnt(10)
  v_mfma_f32_16x16x32_bf16 a[60:63], a[144:147], v[232:235], a[60:63]
  s_waitcnt vmcnt(4)
  ds_read_b64 a[0:1], v255 offset:0
  v_mfma_f32_16x16x32_bf16 a[60:63], a[148:151], v[236:239], a[60:63]
  ds_read_b64_tr_b16 a[172:173], v241 offset:18560
  v_accvgpr_read_b32 v152, a36
  v_mfma_f32_16x16x32_bf16 a[56:59], a[148:151], v[220:223], a[56:59]
  ds_read_b64_tr_b16 a[174:175], v241 offset:23168
  v_accvgpr_read_b32 v153, a37
  v_mfma_f32_16x16x32_bf16 a[56:59], a[144:147], v[216:219], a[56:59]
  ds_read_b64 a[2:3], v255 offset:512
  v_accvgpr_read_b32 v154, a38
  v_mfma_f32_16x16x32_bf16 a[52:55], a[144:147], v[200:203], a[52:55]
  v_accvgpr_read_b32 v155, a39
  v_cvt_pk_bf16_f32 v144, v148, v149
  v_mfma_f32_16x16x32_bf16 a[52:55], a[148:151], v[204:207], a[52:55]
  ds_read_b64_tr_b16 a[176:177], v241 offset:27776
  v_cvt_pk_bf16_f32 v145, v150, v151
  v_mfma_f32_16x16x32_bf16 a[48:51], a[148:151], v[188:191], a[48:51]
  ds_read_b64_tr_b16 a[178:179], v241 offset:32384
  v_cvt_pk_bf16_f32 v146, v152, v153
  v_mfma_f32_16x16x32_bf16 a[48:51], a[144:147], v[184:187], a[48:51]
  ds_read_b64 a[4:5], v255 offset:1024
  s_waitcnt lgkmcnt(13)
  v_cvt_pk_bf16_f32 v147, v154, v155
  v_mfma_f32_16x16x32_bf16 a[48:51], a[152:155], a[192:195], a[48:51]
  buffer_store_dwordx4 v[144:147], v1, s[20:23], s29 offen offset:0 sc1
  v_accvgpr_read_b32 v160, a40
  buffer_load_dword v13, v14, s[20:23], 0 offen sc1
  v_mfma_f32_16x16x32_bf16 a[48:51], a[156:159], a[196:199], a[48:51]
  ds_read_b64_tr_b16 a[144:145], v241 offset:36992
  v_accvgpr_read_b32 v161, a41
  v_mfma_f32_16x16x32_bf16 a[52:55], a[156:159], a[212:215], a[52:55]
  ds_read_b64_tr_b16 a[146:147], v241 offset:41600
  v_accvgpr_read_b32 v162, a42
  v_mfma_f32_16x16x32_bf16 a[52:55], a[152:155], a[208:211], a[52:55]
  ds_read_b64 a[6:7], v255 offset:1536
  v_accvgpr_read_b32 v163, a43
  v_mfma_f32_16x16x32_bf16 a[56:59], a[152:155], a[224:227], a[56:59]
  v_accvgpr_read_b32 v164, a44
  v_mfma_f32_16x16x32_bf16 a[56:59], a[156:159], a[228:231], a[56:59]
  ds_read_b64_tr_b16 a[148:149], v241 offset:46208
  v_accvgpr_read_b32 v165, a45
  v_mfma_f32_16x16x32_bf16 a[60:63], a[156:159], a[244:247], a[60:63]
  ds_read_b64_tr_b16 a[150:151], v241 offset:50816
  v_accvgpr_read_b32 v166, a46
  v_mfma_f32_16x16x32_bf16 a[60:63], a[152:155], a[240:243], a[60:63]
  ds_read_b64 a[8:9], v255 offset:2048
  s_waitcnt lgkmcnt(15)
  v_accvgpr_read_b32 v167, a47
  v_mfma_f32_16x16x32_bf16 a[60:63], a[160:163], a[248:251], a[60:63]
  v_cvt_pk_bf16_f32 v156, v160, v161
  v_mfma_f32_16x16x32_bf16 a[60:63], a[164:167], a[252:255], a[60:63]
  ds_read_b64_tr_b16 a[152:153], v241 offset:55424
  v_cvt_pk_bf16_f32 v157, v162, v163
  v_mfma_f32_16x16x32_bf16 a[56:59], a[164:167], a[236:239], a[56:59]
  ds_read_b64_tr_b16 a[154:155], v241 offset:60032
  v_cvt_pk_bf16_f32 v158, v164, v165
  v_mfma_f32_16x16x32_bf16 a[56:59], a[160:163], a[232:235], a[56:59]
  ds_read_b64 a[10:11], v255 offset:2560
  v_cvt_pk_bf16_f32 v159, v166, v167
  v_mfma_f32_16x16x32_bf16 a[52:55], a[160:163], a[216:219], a[52:55]
  buffer_store_dwordx4 v[156:159], v1, s[20:23], s29 offen offset:1024 sc1
  v_mfma_f32_16x16x32_bf16 a[52:55], a[164:167], a[220:223], a[52:55]
  ds_read_b64_tr_b16 a[156:157], v242 offset:128
  v_mfma_f32_16x16x32_bf16 a[48:51], a[164:167], a[204:207], a[48:51]
  ds_read_b64_tr_b16 a[158:159], v242 offset:4736
  v_mfma_f32_16x16x32_bf16 a[48:51], a[160:163], a[200:203], a[48:51]
  s_waitcnt lgkmcnt(15)
  v_mfma_f32_16x16x32_bf16 a[64:67], a[168:171], v[176:179], a[64:67]
  buffer_load_dword v3, v175, s[20:23], 0 offen sc1
  v_mfma_f32_16x16x32_bf16 a[64:67], a[172:175], v[180:183], a[64:67]
  ds_read_b64_tr_b16 a[160:161], v242 offset:9344
  v_mfma_f32_16x16x32_bf16 a[68:71], a[172:175], v[196:199], a[68:71]
  ds_read_b64_tr_b16 a[162:163], v242 offset:13952
  s_lshr_b32 s28, s25, 2
  s_add_u32 s28, s28, 4
  v_mfma_f32_16x16x32_bf16 a[68:71], a[168:171], v[192:195], a[68:71]
  s_sub_u32 s29, s28, 9
  s_min_u32 s28, s28, s29
  v_mfma_f32_16x16x32_bf16 a[72:75], a[168:171], v[208:211], a[72:75]
  s_lshl_b32 s28, s28, 14
  s_add_u32 s29, s46, s28
  v_accvgpr_read_b32 v148, a48
  v_mfma_f32_16x16x32_bf16 a[72:75], a[172:175], v[212:215], a[72:75]
  ds_read_b64_tr_b16 a[164:165], v241 offset:9376
  v_accvgpr_read_b32 v149, a49
  v_mfma_f32_16x16x32_bf16 a[76:79], a[172:175], v[228:231], a[76:79]
  ds_read_b64_tr_b16 a[166:167], v241 offset:13984
  v_accvgpr_read_b32 v150, a50
  v_mfma_f32_16x16x32_bf16 a[76:79], a[168:171], v[224:227], a[76:79]
  v_accvgpr_read_b32 v151, a51
  s_waitcnt lgkmcnt(13)
  v_mfma_f32_16x16x32_bf16 a[76:79], a[176:179], v[232:235], a[76:79]
  v_accvgpr_read_b32 v152, a52
  v_mfma_f32_16x16x32_bf16 a[76:79], a[144:147], v[236:239], a[76:79]
  ds_read_b64_tr_b16 a[168:169], v241 offset:18592
  v_accvgpr_read_b32 v153, a53
  v_mfma_f32_16x16x32_bf16 a[72:75], a[144:147], v[220:223], a[72:75]
  ds_read_b64_tr_b16 a[170:171], v241 offset:23200
  v_accvgpr_read_b32 v154, a54
  v_mfma_f32_16x16x32_bf16 a[72:75], a[176:179], v[216:219], a[72:75]
  v_accvgpr_read_b32 v155, a55
  v_mfma_f32_16x16x32_bf16 a[68:71], a[176:179], v[200:203], a[68:71]
  v_cvt_pk_bf16_f32 v144, v148, v149
  v_mfma_f32_16x16x32_bf16 a[68:71], a[144:147], v[204:207], a[68:71]
  ds_read_b64_tr_b16 a[172:173], v241 offset:27808
  v_cvt_pk_bf16_f32 v145, v150, v151
  v_mfma_f32_16x16x32_bf16 a[64:67], a[144:147], v[188:191], a[64:67]
  ds_read_b64_tr_b16 a[174:175], v241 offset:32416
  v_cvt_pk_bf16_f32 v146, v152, v153
  v_mfma_f32_16x16x32_bf16 a[64:67], a[176:179], v[184:187], a[64:67]
  v_cvt_pk_bf16_f32 v147, v154, v155
  s_waitcnt lgkmcnt(11)
  v_mfma_f32_16x16x32_bf16 a[64:67], a[148:151], a[192:195], a[64:67]
  buffer_store_dwordx4 v[144:147], v1, s[20:23], s29 offen offset:0 sc1
  v_accvgpr_read_b32 v160, a56
  v_mfma_f32_16x16x32_bf16 a[64:67], a[152:155], a[196:199], a[64:67]
  ds_read_b64_tr_b16 a[176:177], v241 offset:37024
  v_accvgpr_read_b32 v161, a57
  v_mfma_f32_16x16x32_bf16 a[68:71], a[152:155], a[212:215], a[68:71]
  ds_read_b64_tr_b16 a[178:179], v241 offset:41632
  v_accvgpr_read_b32 v162, a58
  v_mfma_f32_16x16x32_bf16 a[68:71], a[148:151], a[208:211], a[68:71]
  v_accvgpr_read_b32 v163, a59
  v_mfma_f32_16x16x32_bf16 a[72:75], a[148:151], a[224:227], a[72:75]
  v_accvgpr_read_b32 v164, a60
  v_mfma_f32_16x16x32_bf16 a[72:75], a[152:155], a[228:231], a[72:75]
  ds_read_b64_tr_b16 a[144:145], v241 offset:46240
  v_accvgpr_read_b32 v165, a61
  v_mfma_f32_16x16x32_bf16 a[76:79], a[152:155], a[244:247], a[76:79]
  ds_read_b64_tr_b16 a[146:147], v241 offset:50848
  v_accvgpr_read_b32 v166, a62
  v_mfma_f32_16x16x32_bf16 a[76:79], a[148:151], a[240:243], a[76:79]
  v_accvgpr_read_b32 v167, a63
  s_waitcnt lgkmcnt(10)
  v_mfma_f32_16x16x32_bf16 a[76:79], a[156:159], a[248:251], a[76:79]
  v_cvt_pk_bf16_f32 v156, v160, v161
  v_mfma_f32_16x16x32_bf16 a[76:79], a[160:163], a[252:255], a[76:79]
  ds_read_b64_tr_b16 a[148:149], v241 offset:55456
  v_cvt_pk_bf16_f32 v157, v162, v163
  v_mfma_f32_16x16x32_bf16 a[72:75], a[160:163], a[236:239], a[72:75]
  ds_read_b64_tr_b16 a[150:151], v241 offset:60064
  v_cvt_pk_bf16_f32 v158, v164, v165
  v_mfma_f32_16x16x32_bf16 a[72:75], a[156:159], a[232:235], a[72:75]
  v_cvt_pk_bf16_f32 v159, v166, v167
  v_mfma_f32_16x16x32_bf16 a[68:71], a[156:159], a[216:219], a[68:71]
  buffer_store_dwordx4 v[156:159], v1, s[20:23], s29 offen offset:1024 sc1
  v_mfma_f32_16x16x32_bf16 a[68:71], a[160:163], a[220:223], a[68:71]
  ds_read_b64_tr_b16 a[152:153], v242 offset:160
  v_mfma_f32_16x16x32_bf16 a[64:67], a[160:163], a[204:207], a[64:67]
  ds_read_b64_tr_b16 a[154:155], v242 offset:4768
  v_mfma_f32_16x16x32_bf16 a[64:67], a[156:159], a[200:203], a[64:67]
  s_waitcnt lgkmcnt(10)
  v_mfma_f32_16x16x32_bf16 a[80:83], a[164:167], v[176:179], a[80:83]
  v_mfma_f32_16x16x32_bf16 a[80:83], a[168:171], v[180:183], a[80:83]
  ds_read_b64_tr_b16 a[156:157], v242 offset:9376
  v_mfma_f32_16x16x32_bf16 a[84:87], a[168:171], v[196:199], a[84:87]
  ds_read_b64_tr_b16 a[158:159], v242 offset:13984
  s_lshr_b32 s28, s25, 2
  s_add_u32 s28, s28, 5
  v_mfma_f32_16x16x32_bf16 a[84:87], a[164:167], v[192:195], a[84:87]
  s_sub_u32 s29, s28, 9
  s_min_u32 s28, s28, s29
  v_mfma_f32_16x16x32_bf16 a[88:91], a[164:167], v[208:211], a[88:91]
  s_lshl_b32 s28, s28, 14
  s_add_u32 s29, s46, s28
  v_accvgpr_read_b32 v148, a64
  v_mfma_f32_16x16x32_bf16 a[88:91], a[168:171], v[212:215], a[88:91]
  ds_read_b64_tr_b16 a[160:161], v241 offset:9408
  v_accvgpr_read_b32 v149, a65
  v_mfma_f32_16x16x32_bf16 a[92:95], a[168:171], v[228:231], a[92:95]
  ds_read_b64_tr_b16 a[162:163], v241 offset:14016
  v_accvgpr_read_b32 v150, a66
  v_mfma_f32_16x16x32_bf16 a[92:95], a[164:167], v[224:227], a[92:95]
  v_accvgpr_read_b32 v151, a67
  s_waitcnt lgkmcnt(10)
  v_mfma_f32_16x16x32_bf16 a[92:95], a[172:175], v[232:235], a[92:95]
  v_accvgpr_read_b32 v152, a68
  s_waitcnt vmcnt(4)
  v_cmp_eq_u32 vcc, 1, v13
  s_nop 0
  s_mov_b32 s63, vcc_lo
  v_mfma_f32_16x16x32_bf16 a[92:95], a[176:179], v[236:239], a[92:95]
  ds_read_b64_tr_b16 a[164:165], v241 offset:18624
  v_accvgpr_read_b32 v153, a69
  v_mfma_f32_16x16x32_bf16 a[88:91], a[176:179], v[220:223], a[88:91]
  ds_read_b64_tr_b16 a[166:167], v241 offset:23232
  v_accvgpr_read_b32 v154, a70
  v_mfma_f32_16x16x32_bf16 a[88:91], a[172:175], v[216:219], a[88:91]
  v_accvgpr_read_b32 v155, a71
  v_mfma_f32_16x16x32_bf16 a[84:87], a[172:175], v[200:203], a[84:87]
  v_cvt_pk_bf16_f32 v144, v148, v149
  s_bitcmp1_b32 s63, 0
  s_cbranch_scc0 K_pe0
  s_bitset1_b32 s41, 0
  buffer_load_dwordx4 a[20:23], v1, s[20:23], s36 offen offset:0 sc1
  buffer_load_dwordx4 a[24:27], v1, s[20:23], s36 offen offset:1024 sc1
K_pe0:
  v_mfma_f32_16x16x32_bf16 a[84:87], a[176:179], v[204:207], a[84:87]
  ds_read_b64_tr_b16 a[168:169], v241 offset:27840
  v_cvt_pk_bf16_f32 v145, v150, v151
  v_mfma_f32_16x16x32_bf16 a[80:83], a[176:179], v[188:191], a[80:83]
  ds_read_b64_tr_b16 a[170:171], v241 offset:32448
  v_cvt_pk_bf16_f32 v146, v152, v153
  v_mfma_f32_16x16x32_bf16 a[80:83], a[172:175], v[184:187], a[80:83]
  v_cvt_pk_bf16_f32 v147, v154, v155
  s_waitcnt lgkmcnt(10)
  v_mfma_f32_16x16x32_bf16 a[80:83], a[144:147], a[192:195], a[80:83]
  buffer_store_dwordx4 v[144:147], v1, s[20:23], s29 offen offset:0 sc1
  v_accvgpr_read_b32 v160, a72
  v_mfma_f32_16x16x32_bf16 a[80:83], a[148:151], a[196:199], a[80:83]
  ds_read_b64_tr_b16 a[172:173], v241 offset:37056
  v_accvgpr_read_b32 v161, a73
  v_mfma_f32_16x16x32_bf16 a[84:87], a[148:151], a[212:215], a[84:87]
  ds_read_b64_tr_b16 a[174:175], v241 offset:41664
  v_accvgpr_read_b32 v162, a74
  v_mfma_f32_16x16x32_bf16 a[84:87], a[144:147], a[208:211], a[84:87]
  v_accvgpr_read_b32 v163, a75
  v_mfma_f32_16x16x32_bf16 a[88:91], a[144:147], a[224:227], a[88:91]
  v_accvgpr_read_b32 v164, a76
  v_mfma_f32_16x16x32_bf16 a[88:91], a[148:151], a[228:231], a[88:91]
  ds_read_b64_tr_b16 a[176:177], v241 offset:46272
  v_accvgpr_read_b32 v165, a77
  v_mfma_f32_16x16x32_bf16 a[92:95], a[148:151], a[244:247], a[92:95]
  ds_read_b64_tr_b16 a[178:179], v241 offset:50880
  v_accvgpr_read_b32 v166, a78
  v_mfma_f32_16x16x32_bf16 a[92:95], a[144:147], a[240:243], a[92:95]
  v_accvgpr_read_b32 v167, a79
  s_waitcnt lgkmcnt(10)
  v_mfma_f32_16x16x32_bf16 a[92:95], a[152:155], a[248:251], a[92:95]
  v_cvt_pk_bf16_f32 v156, v160, v161
  s_bitcmp1_b32 s63, 1
  s_cbranch_scc0 K_pe1
  s_bitset1_b32 s41, 1
  buffer_load_dwordx4 a[28:31], v1, s[20:23], s36 offen offset:2048 sc1
  buffer_load_dwordx4 a[32:35], v1, s[20:23], s36 offen offset:3072 sc1
K_pe1:
  v_mfma_f32_16x16x32_bf16 a[92:95], a[156:159], a[252:255], a[92:95]
  ds_read_b64_tr_b16 a[144:145], v241 offset:55488
  v_cvt_pk_bf16_f32 v157, v162, v163
  v_mfma_f32_16x16x32_bf16 a[88:91], a[156:159], a[236:239], a[88:91]
  ds_read_b64_tr_b16 a[146:147], v241 offset:60096
  v_cvt_pk_bf16_f32 v158, v164, v165
  v_mfma_f32_16x16x32_bf16 a[88:91], a[152:155], a[232:235], a[88:91]
  v_cvt_pk_bf16_f32 v159, v166, v167
  v_mfma_f32_16x16x32_bf16 a[84:87], a[152:155], a[216:219], a[84:87]
  buffer_store_dwordx4 v[156:159], v1, s[20:23], s29 offen offset:1024 sc1
  v_mfma_f32_16x16x32_bf16 a[84:87], a[156:159], a[220:223], a[84:87]
  ds_read_b64_tr_b16 a[148:149], v242 offset:192
  v_mfma_f32_16x16x32_bf16 a[80:83], a[156:159], a[204:207], a[80:83]
  ds_read_b64_tr_b16 a[150:151], v242 offset:4800
  v_mfma_f32_16x16x32_bf16 a[80:83], a[152:155], a[200:203], a[80:83]
  s_waitcnt lgkmcnt(10)
  v_mfma_f32_16x16x32_bf16 a[96:99], a[160:163], v[176:179], a[96:99]
  s_waitcnt vmcnt(4)
  v_cmp_ne_u32 vcc, 1, v3
  s_nop 0
  s_cmp_eq_u64 vcc, 0
  s_cselect_b32 s42, 1, 0
  v_mfma_f32_16x16x32_bf16 a[96:99], a[164:167], v[180:183], a[96:99]
  ds_read_b64_tr_b16 a[152:153], v242 offset:9408
  s_bitcmp1_b32 s63, 2
  s_cbranch_scc0 K_pe2
  s_bitset1_b32 s41, 2
  buffer_load_dwordx4 a[36:39], v244, s[20:23], s36 offen offset:0 sc1
  buffer_load_dwordx4 a[40:43], v244, s[20:23], s36 offen offset:1024 sc1
K_pe2:
  v_mfma_f32_16x16x32_bf16 a[100:103], a[164:167], v[196:199], a[100:103]
  ds_read_b64_tr_b16 a[154:155], v242 offset:14016
  s_lshr_b32 s28, s25, 2
  s_add_u32 s28, s28, 6
  v_mfma_f32_16x16x32_bf16 a[100:103], a[160:163], v[192:195], a[100:103]
  s_sub_u32 s29, s28, 9
  s_min_u32 s28, s28, s29
  v_mfma_f32_16x16x32_bf16 a[104:107], a[160:163], v[208:211], a[104:107]
  s_lshl_b32 s28, s28, 14
  s_add_u32 s29, s46, s28
  v_accvgpr_read_b32 v148, a80
  v_mfma_f32_16x16x32_bf16 a[104:107], a[164:167], v[212:215], a[104:107]
  ds_read_b64_tr_b16 a[156:157], v241 offset:9440
  v_accvgpr_read_b32 v149, a81
  v_mfma_f32_16x16x32_bf16 a[108:111], a[164:167], v[228:231], a[108:111]
  ds_read_b64_tr_b16 a[158:159], v241 offset:14048
  v_accvgpr_read_b32 v150, a82
  v_mfma_f32_16x16x32_bf16 a[108:111], a[160:163], v[224:227], a[108:111]
  v_accvgpr_read_b32 v151, a83
  s_waitcnt lgkmcnt(10)
  v_mfma_f32_16x16x32_bf16 a[108:111], a[168:171], v[232:235], a[108:111]
  v_accvgpr_read_b32 v152, a84
  v_mfma_f32_16x16x32_bf16 a[108:111], a[172:175], v[236:239], a[108:111]
  ds_read_b64_tr_b16 a[160:161], v241 offset:18656
  v_accvgpr_read_b32 v153, a85
  v_mfma_f32_16x16x32_bf16 a[104:107], a[172:175], v[220:223], a[104:107]
  ds_read_b64_tr_b16 a[162:163], v241 offset:23264
  v_accvgpr_read_b32 v154, a86
  v_mfma_f32_16x16x32_bf16 a[104:107], a[168:171], v[216:219], a[104:107]
  v_accvgpr_read_b32 v155, a87
  s_bitcmp1_b32 s63, 3
  s_cbranch_scc0 K_pe3
  s_bitset1_b32 s41, 3
  buffer_load_dwordx4 a[44:47], v244, s[20:23], s36 offen offset:2048 sc1
  buffer_load_dwordx4 a[48:51], v244, s[20:23], s36 offen offset:3072 sc1
K_pe3:
  v_mfma_f32_16x16x32_bf16 a[100:103], a[168:171], v[200:203], a[100:103]
  v_cvt_pk_bf16_f32 v144, v148, v149
  v_mfma_f32_16x16x32_bf16 a[100:103], a[172:175], v[204:207], a[100:103]
  ds_read_b64_tr_b16 a[164:165], v241 offset:27872
  v_cvt_pk_bf16_f32 v145, v150, v151
  v_mfma_f32_16x16x32_bf16 a[96:99], a[172:175], v[188:191], a[96:99]
  ds_read_b64_tr_b16 a[166:167], v241 offset:32480
  v_cvt_pk_bf16_f32 v146, v152, v153
  v_mfma_f32_16x16x32_bf16 a[96:99], a[168:171], v[184:187], a[96:99]
  v_cvt_pk_bf16_f32 v147, v154, v155
  s_waitcnt lgkmcnt(10)
  v_mfma_f32_16x16x32_bf16 a[96:99], a[176:179], a[192:195], a[96:99]
  s_cmp_eq_u32 s42, 0
  s_cbranch_scc1 K_fy0
  s_add_u32 m0, s61, 0
  s_nop 0
  buffer_load_dwordx4 v248, s[20:23], s53 offen sc1 lds
  buffer_load_dword a12, v249, s[20:23], s54 offen sc1
  buffer_load_dword a13, v249, s[20:23], s54 offen offset:256 sc1
K_fy0:
  v_mfma_f32_16x16x32_bf16 a[96:99], a[144:147], a[196:199], a[96:99]
  buffer_store_dwordx4 v[144:147], v1, s[20:23], s29 offen offset:0 sc1
  ds_read_b64_tr_b16 a[168:169], v241 offset:37088
  v_accvgpr_read_b32 v160, a88
  v_accvgpr_read_b32 v161, a89
  v_mfma_f32_16x16x32_bf16 a[100:103], a[144:147], a[212:215], a[100:103]
  ds_read_b64_tr_b16 a[170:171], v241 offset:41696
  v_accvgpr_read_b32 v162, a90
  v_mfma_f32_16x16x32_bf16 a[100:103], a[176:179], a[208:211], a[100:103]
  v_accvgpr_read_b32 v163, a91
  v_mfma_f32_16x16x32_bf16 a[104:107], a[176:179], a[224:227], a[104:107]
  v_accvgpr_read_b32 v164, a92
  s_bitcmp1_b32 s63, 4
  s_cbranch_scc0 K_pe4
  s_bitset1_b32 s41, 4
  buffer_load_dwordx4 a[52:55], v245, s[20:23], s36 offen offset:0 sc1
  buffer_load_dwordx4 a[56:59], v245, s[20:23], s36 offen offset:1024 sc1
K_pe4:
  v_mfma_f32_16x16x32_bf16 a[104:107], a[144:147], a[228:231], a[104:107]
  ds_read_b64_tr_b16 a[172:173], v241 offset:46304
  v_accvgpr_read_b32 v165, a93
  v_mfma_f32_16x16x32_bf16 a[108:111], a[144:147], a[244:247], a[108:111]
  ds_read_b64_tr_b16 a[174:175], v241 offset:50912
  v_accvgpr_read_b32 v166, a94
  v_mfma_f32_16x16x32_bf16 a[108:111], a[176:179], a[240:243], a[108:111]
  v_accvgpr_read_b32 v167, a95
  s_waitcnt lgkmcnt(10)
  v_mfma_f32_16x16x32_bf16 a[108:111], a[148:151], a[248:251], a[108:111]
  s_cmp_eq_u32 s42, 0
  s_cbranch_scc1 K_fy1
  s_add_u32 m0, s61, 1024
  s_nop 0
  buffer_load_dwordx4 v248, s[20:23], s56 offen sc1 lds
  buffer_load_dword a14, v249, s[20:23], s57 offen sc1
  buffer_load_dword a15, v249, s[20:23], s57 offen offset:256 sc1
K_fy1:
  v_mfma_f32_16x16x32_bf16 a[108:111], a[152:155], a[252:255], a[108:111]
  ds_read_b64_tr_b16 a[176:177], v241 offset:55520
  v_cvt_pk_bf16_f32 v156, v160, v161
  v_mfma_f32_16x16x32_bf16 a[104:107], a[152:155], a[236:239], a[104:107]
  ds_read_b64_tr_b16 a[178:179], v241 offset:60128
  v_cvt_pk_bf16_f32 v157, v162, v163
  v_mfma_f32_16x16x32_bf16 a[104:107], a[148:151], a[232:235], a[104:107]
  v_cvt_pk_bf16_f32 v158, v164, v165
  v_cvt_pk_bf16_f32 v159, v166, v167
  v_mfma_f32_16x16x32_bf16 a[100:103], a[148:151], a[216:219], a[100:103]
  buffer_store_dwordx4 v[156:159], v1, s[20:23], s29 offen offset:1024 sc1
  v_mfma_f32_16x16x32_bf16 a[100:103], a[152:155], a[220:223], a[100:103]
  ds_read_b64_tr_b16 a[144:145], v242 offset:224
  v_mfma_f32_16x16x32_bf16 a[96:99], a[152:155], a[204:207], a[96:99]
  ds_read_b64_tr_b16 a[146:147], v242 offset:4832
  s_bitcmp1_b32 s63, 5
  s_cbranch_scc0 K_pe5
  s_bitset1_b32 s41, 5
  buffer_load_dwordx4 a[60:63], v245, s[20:23], s36 offen offset:2048 sc1
  buffer_load_dwordx4 a[64:67], v245, s[20:23], s36 offen offset:3072 sc1
K_pe5:
  v_mfma_f32_16x16x32_bf16 a[96:99], a[148:151], a[200:203], a[96:99]
  s_waitcnt lgkmcnt(10)
  v_mfma_f32_16x16x32_bf16 a[112:115], a[156:159], v[176:179], a[112:115]
  s_cmp_eq_u32 s42, 0
  s_cbranch_scc1 K_fy2
  s_add_u32 m0, s61, 2048
  s_nop 0
  buffer_load_dwordx4 v248, s[20:23], s59 offen sc1 lds
  buffer_load_dword a16, v249, s[20:23], s60 offen sc1
  buffer_load_dword a17, v249, s[20:23], s60 offen offset:256 sc1
K_fy2:
  v_mfma_f32_16x16x32_bf16 a[112:115], a[160:163], v[180:183], a[112:115]
  ds_read_b64_tr_b16 a[148:149], v242 offset:9440
  v_mfma_f32_16x16x32_bf16 a[116:119], a[160:163], v[196:199], a[116:119]
  ds_read_b64_tr_b16 a[150:151], v242 offset:14048
  s_lshr_b32 s28, s25, 2
  s_add_u32 s28, s28, 7
  v_mfma_f32_16x16x32_bf16 a[116:119], a[156:159], v[192:195], a[116:119]
  s_sub_u32 s29, s28, 9
  s_min_u32 s28, s28, s29
  v_mfma_f32_16x16x32_bf16 a[120:123], a[156:159], v[208:211], a[120:123]
  s_lshl_b32 s28, s28, 14
  s_add_u32 s29, s46, s28
  v_accvgpr_read_b32 v148, a96
  v_mfma_f32_16x16x32_bf16 a[120:123], a[160:163], v[212:215], a[120:123]
  ds_read_b64_tr_b16 a[152:153], v240 offset:256
  v_accvgpr_read_b32 v149, a97
  v_mfma_f32_16x16x32_bf16 a[124:127], a[160:163], v[228:231], a[124:127]
  ds_read_b64_tr_b16 a[154:155], v240 offset:4864
  v_accvgpr_read_b32 v150, a98
  v_mfma_f32_16x16x32_bf16 a[124:127], a[156:159], v[224:227], a[124:127]
  v_accvgpr_read_b32 v151, a99
  s_waitcnt lgkmcnt(10)
  v_mfma_f32_16x16x32_bf16 a[124:127], a[164:167], v[232:235], a[124:127]
  v_accvgpr_read_b32 v152, a100
  s_bitcmp1_b32 s63, 6
  s_cbranch_scc0 K_pe6
  s_bitset1_b32 s41, 6
  buffer_load_dwordx4 a[68:71], v246, s[20:23], s36 offen offset:0 sc1
  buffer_load_dwordx4 a[72:75], v246, s[20:23], s36 offen offset:1024 sc1
K_pe6:
  v_mfma_f32_16x16x32_bf16 a[124:127], a[168:171], v[236:239], a[124:127]
  ds_read_b64_tr_b16 a[156:157], v240 offset:9472
  v_accvgpr_read_b32 v153, a101
  v_mfma_f32_16x16x32_bf16 a[120:123], a[168:171], v[220:223], a[120:123]
  ds_read_b64_tr_b16 a[158:159], v240 offset:14080
  v_accvgpr_read_b32 v154, a102
  v_mfma_f32_16x16x32_bf16 a[120:123], a[164:167], v[216:219], a[120:123]
  v_accvgpr_read_b32 v155, a103
  v_mfma_f32_16x16x32_bf16 a[116:119], a[164:167], v[200:203], a[116:119]
  v_cvt_pk_bf16_f32 v144, v148, v149
  v_mfma_f32_16x16x32_bf16 a[116:119], a[168:171], v[204:207], a[116:119]
  ds_read_b64_tr_b16 a[160:161], v240 offset:18688
  v_cvt_pk_bf16_f32 v145, v150, v151
  v_mfma_f32_16x16x32_bf16 a[112:115], a[168:171], v[188:191], a[112:115]
  ds_read_b64_tr_b16 a[162:163], v240 offset:23296
  v_cvt_pk_bf16_f32 v146, v152, v153
  v_mfma_f32_16x16x32_bf16 a[112:115], a[164:167], v[184:187], a[112:115]
  v_cvt_pk_bf16_f32 v147, v154, v155
  s_waitcnt lgkmcnt(10)
  v_mfma_f32_16x16x32_bf16 a[112:115], a[172:175], a[192:195], a[112:115]
  buffer_store_dwordx4 v[144:147], v1, s[20:23], s29 offen offset:0 sc1
  v_accvgpr_read_b32 v160, a104
  v_mfma_f32_16x16x32_bf16 a[112:115], a[176:179], a[196:199], a[112:115]
  ds_read_b64_tr_b16 a[164:165], v240 offset:27904
  v_accvgpr_read_b32 v161, a105
  v_mfma_f32_16x16x32_bf16 a[116:119], a[176:179], a[212:215], a[116:119]
  ds_read_b64_tr_b16 a[166:167], v240 offset:32512
  v_accvgpr_read_b32 v162, a106
  v_mfma_f32_16x16x32_bf16 a[116:119], a[172:175], a[208:211], a[116:119]
  v_accvgpr_read_b32 v163, a107
  s_bitcmp1_b32 s63, 7
  s_cbranch_scc0 K_pe7
  s_bitset1_b32 s41, 7
  buffer_load_dwordx4 a[76:79], v246, s[20:23], s36 offen offset:2048 sc1
  buffer_load_dwordx4 a[80:83], v246, s[20:23], s36 offen offset:3072 sc1
K_pe7:
  v_mfma_f32_16x16x32_bf16 a[120:123], a[172:175], a[224:227], a[120:123]
  v_accvgpr_read_b32 v164, a108
  v_mfma_f32_16x16x32_bf16 a[120:123], a[176:179], a[228:231], a[120:123]
  ds_read_b64_tr_b16 a[168:169], v240 offset:37120
  v_accvgpr_read_b32 v165, a109
  v_mfma_f32_16x16x32_bf16 a[124:127], a[176:179], a[244:247], a[124:127]
  ds_read_b64_tr_b16 a[170:171], v240 offset:41728
  v_accvgpr_read_b32 v166, a110
  v_mfma_f32_16x16x32_bf16 a[124:127], a[172:175], a[240:243], a[124:127]
  v_accvgpr_read_b32 v167, a111
  s_waitcnt lgkmcnt(10)
  v_mfma_f32_16x16x32_bf16 a[124:127], a[144:147], a[248:251], a[124:127]
  v_cvt_pk_bf16_f32 v156, v160, v161
  v_mfma_f32_16x16x32_bf16 a[124:127], a[148:151], a[252:255], a[124:127]
  ds_read_b64_tr_b16 a[172:173], v240 offset:46336
  v_cvt_pk_bf16_f32 v157, v162, v163
  v_mfma_f32_16x16x32_bf16 a[120:123], a[148:151], a[236:239], a[120:123]
  ds_read_b64_tr_b16 a[174:175], v240 offset:50944
  v_cvt_pk_bf16_f32 v158, v164, v165
K_hA3_10:
  s_cbranch_execz K_hA3_11
  v_mfma_f32_16x16x32_bf16 a[120:123], a[144:147], a[232:235], a[120:123]
  v_cvt_pk_bf16_f32 v159, v166, v167
  v_mfma_f32_16x16x32_bf16 a[116:119], a[144:147], a[216:219], a[116:119]
  buffer_store_dwordx4 v[156:159], v1, s[20:23], s29 offen offset:1024 sc1
  v_mfma_f32_16x16x32_bf16 a[116:119], a[148:151], a[220:223], a[116:119]
  ds_read_b64_tr_b16 a[176:177], v240 offset:55552
  v_mfma_f32_16x16x32_bf16 a[112:115], a[148:151], a[204:207], a[112:115]
  ds_read_b64_tr_b16 a[178:179], v240 offset:60160
  v_mfma_f32_16x16x32_bf16 a[112:115], a[144:147], a[200:203], a[112:115]
  s_waitcnt lgkmcnt(10)
  v_mfma_f32_16x16x32_bf16 a[128:131], a[152:155], v[80:83], 0
  v_mfma_f32_16x16x32_bf16 a[128:131], a[156:159], v[84:87], a[128:131]
  ds_read_b64_tr_b16 a[144:145], v241 offset:256
  v_mfma_f32_16x16x32_bf16 a[132:135], a[156:159], v[116:119], 0
  ds_read_b64_tr_b16 a[146:147], v241 offset:4864
  s_lshr_b32 s28, s25, 2
  s_add_u32 s28, s28, 8
  v_mfma_f32_16x16x32_bf16 a[132:135], a[152:155], v[112:115], a[132:135]
  s_sub_u32 s29, s28, 9
  s_min_u32 s28, s28, s29
  v_mfma_f32_16x16x32_bf16 a[136:139], a[152:155], v[96:99], 0
  s_lshl_b32 s28, s28, 14
  s_add_u32 s29, s46, s28
  v_accvgpr_read_b32 v148, a112
  v_mfma_f32_16x16x32_bf16 a[136:139], a[156:159], v[100:103], a[136:139]
  ds_read_b64_tr_b16 a[148:149], v241 offset:9472
  v_accvgpr_read_b32 v149, a113
  v_mfma_f32_16x16x32_bf16 a[140:143], a[156:159], v[132:135], 0
  ds_read_b64_tr_b16 a[150:151], v241 offset:14080
  v_accvgpr_read_b32 v150, a114
  v_mfma_f32_16x16x32_bf16 a[140:143], a[152:155], v[128:131], a[140:143]
  s_waitcnt lgkmcnt(10)
  v_accvgpr_read_b32 v151, a115
  v_accvgpr_read_b32 v152, a116
  v_mfma_f32_16x16x32_bf16 a[140:143], a[160:163], v[136:139], a[140:143]
  v_accvgpr_read_b32 v153, a117
  v_accvgpr_read_b32 v154, a118
  v_mfma_f32_16x16x32_bf16 a[140:143], a[164:167], v[140:143], a[140:143]
  ds_read_b64_tr_b16 a[152:153], v241 offset:18688
  v_accvgpr_read_b32 v155, a119
  v_mfma_f32_16x16x32_bf16 a[136:139], a[164:167], v[108:111], a[136:139]
  ds_read_b64_tr_b16 a[154:155], v241 offset:23296
  v_cvt_pk_bf16_f32 v144, v148, v149
  v_mfma_f32_16x16x32_bf16 a[136:139], a[160:163], v[104:107], a[136:139]
  v_cvt_pk_bf16_f32 v145, v150, v151
  v_cvt_pk_bf16_f32 v146, v152, v153
  v_mfma_f32_16x16x32_bf16 a[132:135], a[160:163], v[120:123], a[132:135]
  v_cvt_pk_bf16_f32 v147, v154, v155
  v_mfma_f32_16x16x32_bf16 a[132:135], a[164:167], v[124:127], a[132:135]
  buffer_store_dwordx4 v[144:147], v1, s[20:23], s29 offen offset:0 sc1
  ds_read_b64_tr_b16 a[156:157], v241 offset:27904
  v_accvgpr_read_b32 v160, a120
  v_accvgpr_read_b32 v161, a121
  v_accvgpr_read_b32 v162, a122
  v_mfma_f32_16x16x32_bf16 a[128:131], a[164:167], v[92:95], a[128:131]
  ds_read_b64_tr_b16 a[158:159], v241 offset:32512
  v_accvgpr_read_b32 v163, a123
  v_mfma_f32_16x16x32_bf16 a[128:131], a[160:163], v[88:91], a[128:131]
  s_waitcnt lgkmcnt(10)
  v_accvgpr_read_b32 v164, a124
  v_accvgpr_read_b32 v165, a125
  v_mfma_f32_16x16x32_bf16 a[128:131], a[168:171], v[16:19], a[128:131]
  v_accvgpr_read_b32 v166, a126
  v_accvgpr_read_b32 v167, a127
  v_mfma_f32_16x16x32_bf16 a[128:131], a[172:175], v[20:23], a[128:131]
  ds_read_b64_tr_b16 a[160:161], v241 offset:37120
  v_cvt_pk_bf16_f32 v156, v160, v161
  v_mfma_f32_16x16x32_bf16 a[132:135], a[172:175], v[36:39], a[132:135]
  v_cvt_pk_bf16_f32 v157, v162, v163
  v_cvt_pk_bf16_f32 v158, v164, v165
  v_cvt_pk_bf16_f32 v159, v166, v167
  buffer_store_dwordx4 v[156:159], v1, s[20:23], s29 offen offset:1024 sc1
  ds_read_b64_tr_b16 a[162:163], v241 offset:41728
  v_mfma_f32_16x16x32_bf16 a[132:135], a[168:171], v[32:35], a[132:135]
  v_mfma_f32_16x16x32_bf16 a[136:139], a[168:171], v[48:51], a[136:139]
  v_mfma_f32_16x16x32_bf16 a[136:139], a[172:175], v[52:55], a[136:139]
  ds_read_b64_tr_b16 a[164:165], v241 offset:46336
  v_mfma_f32_16x16x32_bf16 a[140:143], a[172:175], v[68:71], a[140:143]
  ds_read_b64_tr_b16 a[166:167], v241 offset:50944
  v_mfma_f32_16x16x32_bf16 a[140:143], a[168:171], v[64:67], a[140:143]
  s_waitcnt lgkmcnt(10)
  v_mfma_f32_16x16x32_bf16 a[140:143], a[176:179], v[72:75], a[140:143]
  v_accvgpr_write_b32 a116, 0
  v_mfma_f32_16x16x32_bf16 a[140:143], a[144:147], v[76:79], a[140:143]
  ds_read_b64_tr_b16 a[168:169], v241 offset:55552
  v_accvgpr_write_b32 a117, 0
  v_mfma_f32_16x16x32_bf16 a[136:139], a[144:147], v[60:63], a[136:139]
  ds_read_b64_tr_b16 a[170:171], v241 offset:60160
  v_accvgpr_write_b32 a118, 0
  v_mfma_f32_16x16x32_bf16 a[136:139], a[176:179], v[56:59], a[136:139]
  v_accvgpr_write_b32 a119, 0
  v_mfma_f32_16x16x32_bf16 a[132:135], a[176:179], v[40:43], a[132:135]
  v_mfma_f32_16x16x32_bf16 a[132:135], a[144:147], v[44:47], a[132:135]
  ds_read_b64_tr_b16 a[172:173], v242 offset:256
  v_accvgpr_write_b32 a120, 0
  v_mfma_f32_16x16x32_bf16 a[128:131], a[144:147], v[28:31], a[128:131]
  ds_read_b64_tr_b16 a[174:175], v242 offset:4864
  v_accvgpr_write_b32 a121, 0
  v_mfma_f32_16x16x32_bf16 a[128:131], a[176:179], v[24:27], a[128:131]
  v_accvgpr_write_b32 a122, 0
  s_waitcnt lgkmcnt(10)
  v_mfma_f32_16x16x32_bf16 a[128:131], a[148:151], v[176:179], a[128:131]
  v_mfma_f32_16x16x32_bf16 a[128:131], a[152:155], v[180:183], a[128:131]
  ds_read_b64_tr_b16 a[176:177], v242 offset:9472
  v_accvgpr_write_b32 a123, 0
  v_mfma_f32_16x16x32_bf16 a[132:135], a[152:155], v[196:199], a[132:135]
  ds_read_b64_tr_b16 a[178:179], v242 offset:14080
  s_and_b32 s27, s25, 28
  s_lshl_b32 s27, s27, 5
  s_add_u32 s27, s27, s30
  v_and_b32 v3, 28, v253
  buffer_load_dword v3, v3, s[20:23], s27 offen sc1
  v_mfma_f32_16x16x32_bf16 a[132:135], a[148:151], v[192:195], a[132:135]
  v_accvgpr_write_b32 a124, 0
  v_accvgpr_write_b32 a125, 0
  v_mfma_f32_16x16x32_bf16 a[136:139], a[148:151], v[208:211], a[136:139]
  v_mfma_f32_16x16x32_bf16 a[136:139], a[152:155], v[212:215], a[136:139]
  v_accvgpr_write_b32 a126, 0
  v_mfma_f32_16x16x32_bf16 a[140:143], a[152:155], v[228:231], a[140:143]
  v_accvgpr_write_b32 a127, 0
  v_mfma_f32_16x16x32_bf16 a[140:143], a[148:151], v[224:227], a[140:143]
  v_accvgpr_write_b32 a188, 0
  s_waitcnt lgkmcnt(8)
  v_mfma_f32_16x16x32_bf16 a[140:143], a[156:159], v[232:235], a[140:143]
  v_mfma_f32_16x16x32_bf16 a[140:143], a[160:163], v[236:239], a[140:143]
  v_accvgpr_write_b32 a189, 0
  v_mfma_f32_16x16x32_bf16 a[136:139], a[160:163], v[220:223], a[136:139]
  v_accvgpr_write_b32 a190, 0
  v_mfma_f32_16x16x32_bf16 a[136:139], a[156:159], v[216:219], a[136:139]
  v_accvgpr_write_b32 a191, 0
  v_mfma_f32_16x16x32_bf16 a[132:135], a[156:159], v[200:203], a[132:135]
  v_mfma_f32_16x16x32_bf16 a[132:135], a[160:163], v[204:207], a[132:135]
  v_mfma_f32_16x16x32_bf16 a[128:131], a[160:163], v[188:191], a[128:131]
  v_mfma_f32_16x16x32_bf16 a[128:131], a[156:159], v[184:187], a[128:131]
  s_waitcnt lgkmcnt(4)
  v_mfma_f32_16x16x32_bf16 a[128:131], a[164:167], a[192:195], a[128:131]
  v_mfma_f32_16x16x32_bf16 a[128:131], a[168:171], a[196:199], a[128:131]
  v_mfma_f32_16x16x32_bf16 a[132:135], a[168:171], a[212:215], a[132:135]
  v_mfma_f32_16x16x32_bf16 a[132:135], a[164:167], a[208:211], a[132:135]
  v_mfma_f32_16x16x32_bf16 a[136:139], a[164:167], a[224:227], a[136:139]
  v_mfma_f32_16x16x32_bf16 a[136:139], a[168:171], a[228:231], a[136:139]
  v_mfma_f32_16x16x32_bf16 a[140:143], a[168:171], a[244:247], a[140:143]
  v_and_b32 v12, 7, v0
  v_mfma_f32_16x16x32_bf16 a[140:143], a[164:167], a[240:243], a[140:143]
  v_lshlrev_b32 v12, 7, v12
  s_waitcnt lgkmcnt(0)
  v_mfma_f32_16x16x32_bf16 a[140:143], a[172:175], a[248:251], a[140:143]
  s_waitcnt vmcnt(1)
  s_and_b32 s27, s25, 28
  s_add_u32 s27, s27, s30
  buffer_store_dword v252, v12, s[20:23], s27 offen sc1
  v_mfma_f32_16x16x32_bf16 a[140:143], a[176:179], a[252:255], a[140:143]
  v_mfma_f32_16x16x32_bf16 a[136:139], a[176:179], a[236:239], a[136:139]
  v_mfma_f32_16x16x32_bf16 a[136:139], a[172:175], a[232:235], a[136:139]
  v_mfma_f32_16x16x32_bf16 a[132:135], a[172:175], a[216:219], a[132:135]
  v_mfma_f32_16x16x32_bf16 a[132:135], a[176:179], a[220:223], a[132:135]
  v_mfma_f32_16x16x32_bf16 a[128:131], a[176:179], a[204:207], a[128:131]
  v_mfma_f32_16x16x32_bf16 a[128:131], a[172:175], a[200:203], a[128:131]
  s_waitcnt vmcnt(1)
  s_cmp_lg_u32 s42, 0
  s_cbranch_scc1 K_ppl
  v_mov_b32 v14, v3
  s_branch K_PY_spin
K_PY_ok:
  v_mov_b32 v3, v14
  s_add_u32 m0, s61, 0
  s_nop 0
  buffer_load_dwordx4 v248, s[20:23], s53 offen sc1 lds
  buffer_load_dword a12, v249, s[20:23], s54 offen sc1
  buffer_load_dword a13, v249, s[20:23], s54 offen offset:256 sc1
  s_add_u32 m0, s61, 1024
  s_nop 0
  buffer_load_dwordx4 v248, s[20:23], s56 offen sc1 lds
  buffer_load_dword a14, v249, s[20:23], s57 offen sc1
  buffer_load_dword a15, v249, s[20:23], s57 offen offset:256 sc1
  s_add_u32 m0, s61, 2048
  s_nop 0
  buffer_load_dwordx4 v248, s[20:23], s59 offen sc1 lds
  buffer_load_dword a16, v249, s[20:23], s60 offen sc1
  buffer_load_dword a17, v249, s[20:23], s60 offen offset:256 sc1
  s_waitcnt vmcnt(0)
K_ppl:
  v_or_b32 v3, v3, v174
  v_cmp_eq_u32 vcc, 1, v3
  s_nop 0
  s_andn2_b32 s40, vcc_lo, s39
  s_and_b32 s40, s40, 0xff
  s_cbranch_scc0 K_ppn
  s_bitcmp1_b32 s40, 0
  s_cbranch_scc0 K_pl0
  buffer_load_dwordx4 a[84:87], v1, s[20:23], s43 offen offset:0 sc1
  s_bitcmp1_b32 s41, 0
  s_cbranch_scc1 K_pl0
  s_cmp_eq_u32 s37, 0
  s_cselect_b32 s27, 0x7f000000, s36
  buffer_load_dwordx4 a[20:23], v1, s[20:23], s27 offen offset:0 sc1
  buffer_load_dwordx4 a[24:27], v1, s[20:23], s27 offen offset:1024 sc1
K_pl0:
  s_bitcmp1_b32 s40, 1
  s_cbranch_scc0 K_pl1
  buffer_load_dwordx4 a[88:91], v1, s[20:23], s43 offen offset:2048 sc1
  s_bitcmp1_b32 s41, 1
  s_cbranch_scc1 K_pl1
  s_cmp_eq_u32 s37, 1
  s_cselect_b32 s27, 0x7f000000, s36
  buffer_load_dwordx4 a[28:31], v1, s[20:23], s27 offen offset:2048 sc1
  buffer_load_dwordx4 a[32:35], v1, s[20:23], s27 offen offset:3072 sc1
K_pl1:
  s_bitcmp1_b32 s40, 2
  s_cbranch_scc0 K_pl2
  buffer_load_dwordx4 a[92:95], v244, s[20:23], s43 offen offset:0 sc1
  s_bitcmp1_b32 s41, 2
  s_cbranch_scc1 K_pl2
  s_cmp_eq_u32 s37, 2
  s_cselect_b32 s27, 0x7f000000, s36
  buffer_load_dwordx4 a[36:39], v244, s[20:23], s27 offen offset:0 sc1
  buffer_load_dwordx4 a[40:43], v244, s[20:23], s27 offen offset:1024 sc1
K_pl2:
  s_bitcmp1_b32 s40, 3
  s_cbranch_scc0 K_pl3
  buffer_load_dwordx4 a[96:99], v244, s[20:23], s43 offen offset:2048 sc1
  s_bitcmp1_b32 s41, 3
  s_cbranch_scc1 K_pl3
  s_cmp_eq_u32 s37, 3
  s_cselect_b32 s27, 0x7f000000, s36
  buffer_load_dwordx4 a[44:47], v244, s[20:23], s27 offen offset:2048 sc1
  buffer_load_dwordx4 a[48:51], v244, s[20:23], s27 offen offset:3072 sc1
K_pl3:
  s_bitcmp1_b32 s40, 4
  s_cbranch_scc0 K_pl4
  buffer_load_dwordx4 a[100:103], v245, s[20:23], s43 offen offset:0 sc1
  s_bitcmp1_b32 s41, 4
  s_cbranch_scc1 K_pl4
  s_cmp_eq_u32 s37, 4
  s_cselect_b32 s27, 0x7f000000, s36
  buffer_load_dwordx4 a[52:55], v245, s[20:23], s27 offen offset:0 sc1
  buffer_load_dwordx4 a[56:59], v245, s[20:23], s27 offen offset:1024 sc1
K_pl4:
  s_bitcmp1_b32 s40, 5
  s_cbranch_scc0 K_pl5
  buffer_load_dwordx4 a[104:107], v245, s[20:23], s43 offen offset:2048 sc1
  s_bitcmp1_b32 s41, 5
  s_cbranch_scc1 K_pl5
  s_cmp_eq_u32 s37, 5
  s_cselect_b32 s27, 0x7f000000, s36
  buffer_load_dwordx4 a[60:63], v245, s[20:23], s27 offen offset:2048 sc1
  buffer_load_dwordx4 a[64:67], v245, s[20:23], s27 offen offset:3072 sc1
K_pl5:
  s_bitcmp1_b32 s40, 6
  s_cbranch_scc0 K_pl6
  buffer_load_dwordx4 a[108:111], v246, s[20:23], s43 offen offset:0 sc1
  s_bitcmp1_b32 s41, 6
  s_cbranch_scc1 K_pl6
  s_cmp_eq_u32 s37, 6
  s_cselect_b32 s27, 0x7f000000, s36
  buffer_load_dwordx4 a[68:71], v246, s[20:23], s27 offen offset:0 sc1
  buffer_load_dwordx4 a[72:75], v246, s[20:23], s27 offen offset:1024 sc1
K_pl6:
  s_bitcmp1_b32 s40, 7
  s_cbranch_scc0 K_pl7
  buffer_load_dwordx4 a[112:115], v246, s[20:23], s43 offen offset:2048 sc1
  s_bitcmp1_b32 s41, 7
  s_cbranch_scc1 K_pl7
  s_cmp_eq_u32 s37, 7
  s_cselect_b32 s27, 0x7f000000, s36
  buffer_load_dwordx4 a[76:79], v246, s[20:23], s27 offen offset:2048 sc1
  buffer_load_dwordx4 a[80:83], v246, s[20:23], s27 offen offset:3072 sc1
K_pl7:
  s_cmp_lg_u32 s39, 0
  s_cbranch_scc1 K_noga
  ds_read_b64_tr_b16 v[132:133], v250 offset:0
  ds_read_b64_tr_b16 v[134:135], v250 offset:32
  ds_read_b64_tr_b16 v[136:137], v250 offset:1024
  ds_read_b64_tr_b16 v[138:139], v250 offset:1056
  ds_read_b64_tr_b16 v[140:141], v250 offset:2048
  ds_read_b64_tr_b16 v[142:143], v250 offset:2080
  v_accvgpr_read_b32 v80, a12
  v_accvgpr_read_b32 v81, a13
  v_accvgpr_read_b32 v82, a0
  v_accvgpr_read_b32 v83, a1
  v_accvgpr_read_b32 v84, a2
  v_accvgpr_read_b32 v85, a3
  v_lshlrev_b32 v128, 16, v82
  v_and_b32 v129, 0xffff0000, v82
  v_lshlrev_b32 v130, 16, v83
  v_and_b32 v131, 0xffff0000, v83
  v_mul_f32 v128, v128, v80
  v_mul_f32 v129, v129, v80
  v_mul_f32 v130, v130, v80
  v_mul_f32 v131, v131, v80
  v_sub_f32 v80, 1.0, v80
  s_waitcnt lgkmcnt(5)
  v_lshlrev_b32 v88, 16, v132
  v_and_b32 v89, 0xffff0000, v132
  v_lshlrev_b32 v90, 16, v133
  v_and_b32 v91, 0xffff0000, v133
  v_pk_mul_f32 v[88:89], v[88:89], v[128:129]
  v_pk_mul_f32 v[90:91], v[90:91], v[130:131]
  v_accvgpr_read_b32 v128, a128
  v_accvgpr_read_b32 v129, a129
  v_accvgpr_read_b32 v130, a130
  v_accvgpr_read_b32 v131, a131
  v_fmac_f32 v88, v128, v80
  v_fmac_f32 v89, v129, v80
  v_fmac_f32 v90, v130, v80
  v_fmac_f32 v91, v131, v80
  v_lshlrev_b32 v128, 16, v84
  v_and_b32 v129, 0xffff0000, v84
  v_lshlrev_b32 v130, 16, v85
  v_and_b32 v131, 0xffff0000, v85
  v_mul_f32 v128, v128, v81
  v_mul_f32 v129, v129, v81
  v_mul_f32 v130, v130, v81
  v_mul_f32 v131, v131, v81
  v_sub_f32 v81, 1.0, v81
  s_waitcnt lgkmcnt(4)
  v_lshlrev_b32 v92, 16, v134
  v_and_b32 v93, 0xffff0000, v134
  v_lshlrev_b32 v94, 16, v135
  v_and_b32 v95, 0xffff0000, v135
  v_pk_mul_f32 v[92:93], v[92:93], v[128:129]
  v_pk_mul_f32 v[94:95], v[94:95], v[130:131]
  v_accvgpr_read_b32 v128, a132
  v_accvgpr_read_b32 v129, a133
  v_accvgpr_read_b32 v130, a134
  v_accvgpr_read_b32 v131, a135
  v_fmac_f32 v92, v128, v81
  v_fmac_f32 v93, v129, v81
  v_fmac_f32 v94, v130, v81
  v_fmac_f32 v95, v131, v81
  v_accvgpr_read_b32 v96, a14
  v_accvgpr_read_b32 v97, a15
  v_accvgpr_read_b32 v98, a4
  v_accvgpr_read_b32 v99, a5
  v_accvgpr_read_b32 v100, a6
  v_accvgpr_read_b32 v101, a7
  v_lshlrev_b32 v128, 16, v98
  v_and_b32 v129, 0xffff0000, v98
  v_lshlrev_b32 v130, 16, v99
  v_and_b32 v131, 0xffff0000, v99
  v_mul_f32 v128, v128, v96
  v_mul_f32 v129, v129, v96
  v_mul_f32 v130, v130, v96
  v_mul_f32 v131, v131, v96
  v_sub_f32 v96, 1.0, v96
  s_waitcnt lgkmcnt(3)
  v_lshlrev_b32 v104, 16, v136
  v_and_b32 v105, 0xffff0000, v136
  v_lshlrev_b32 v106, 16, v137
  v_and_b32 v107, 0xffff0000, v137
  v_pk_mul_f32 v[104:105], v[104:105], v[128:129]
  v_pk_mul_f32 v[106:107], v[106:107], v[130:131]
  v_accvgpr_read_b32 v128, a136
  v_accvgpr_read_b32 v129, a137
  v_accvgpr_read_b32 v130, a138
  v_accvgpr_read_b32 v131, a139
  v_fmac_f32 v104, v128, v96
  v_fmac_f32 v105, v129, v96
  v_fmac_f32 v106, v130, v96
  v_fmac_f32 v107, v131, v96
  v_lshlrev_b32 v128, 16, v100
  v_and_b32 v129, 0xffff0000, v100
  v_lshlrev_b32 v130, 16, v101
  v_and_b32 v131, 0xffff0000, v101
  v_mul_f32 v128, v128, v97
  v_mul_f32 v129, v129, v97
  v_mul_f32 v130, v130, v97
  v_mul_f32 v131, v131, v97
  v_sub_f32 v97, 1.0, v97
  s_waitcnt lgkmcnt(2)
  v_lshlrev_b32 v108, 16, v138
  v_and_b32 v109, 0xffff0000, v138
  v_lshlrev_b32 v110, 16, v139
  v_and_b32 v111, 0xffff0000, v139
  v_pk_mul_f32 v[108:109], v[108:109], v[128:129]
  v_pk_mul_f32 v[110:111], v[110:111], v[130:131]
  v_accvgpr_read_b32 v128, a140
  v_accvgpr_read_b32 v129, a141
  v_accvgpr_read_b32 v130, a142
  v_accvgpr_read_b32 v131, a143
  v_fmac_f32 v108, v128, v97
  v_fmac_f32 v109, v129, v97
  v_fmac_f32 v110, v130, v97
  v_fmac_f32 v111, v131, v97
  v_accvgpr_read_b32 v112, a16
  v_accvgpr_read_b32 v113, a17
  v_accvgpr_read_b32 v114, a8
  v_accvgpr_read_b32 v115, a9
  v_accvgpr_read_b32 v116, a10
  v_accvgpr_read_b32 v117, a11
  v_lshlrev_b32 v128, 16, v114
  v_and_b32 v129, 0xffff0000, v114
  v_lshlrev_b32 v130, 16, v115
  v_and_b32 v131, 0xffff0000, v115
  v_mul_f32 v128, v128, v112
  v_mul_f32 v129, v129, v112
  v_mul_f32 v130, v130, v112
  v_mul_f32 v131, v131, v112
  v_sub_f32 v112, 1.0, v112
  s_waitcnt lgkmcnt(1)
  v_lshlrev_b32 v120, 16, v140
  v_and_b32 v121, 0xffff0000, v140
  v_lshlrev_b32 v122, 16, v141
  v_and_b32 v123, 0xffff0000, v141
  v_pk_mul_f32 v[120:121], v[120:121], v[128:129]
  v_pk_mul_f32 v[122:123], v[122:123], v[130:131]
  v_lshlrev_b32 v128, 16, v116
  v_and_b32 v129, 0xffff0000, v116
  v_lshlrev_b32 v130, 16, v117
  v_and_b32 v131, 0xffff0000, v117
  v_mul_f32 v128, v128, v113
  v_mul_f32 v129, v129, v113
  v_mul_f32 v130, v130, v113
  v_mul_f32 v131, v131, v113
  v_sub_f32 v113, 1.0, v113
  s_waitcnt lgkmcnt(0)
  v_lshlrev_b32 v124, 16, v142
  v_and_b32 v125, 0xffff0000, v142
  v_lshlrev_b32 v126, 16, v143
  v_and_b32 v127, 0xffff0000, v143
  v_pk_mul_f32 v[124:125], v[124:125], v[128:129]
  v_pk_mul_f32 v[126:127], v[126:127], v[130:131]
K_noga:
  s_or_b32 s39, s39, s40
  s_cmp_eq_u32 s39, 0xff
  s_cbranch_scc1 K_np
  s_and_b32 s27, s25, 28
  s_lshl_b32 s27, s27, 5
  s_add_u32 s27, s27, s30
  v_and_b32 v3, 28, v253
  buffer_load_dword v3, v3, s[20:23], s27 offen sc1
K_np:
  s_waitcnt vmcnt(0)
  s_bitcmp1_b32 s40, 0
  s_cbranch_scc0 K_pm0
  v_mfma_f32_16x16x32_bf16 a[116:119], v[170:173], a[20:23], a[116:119]
  v_mfma_f32_16x16x32_bf16 a[120:123], v[168:171], a[20:23], a[120:123]
  v_mfma_f32_16x16x32_bf16 a[124:127], v[170:173], a[24:27], a[124:127]
  v_mfma_f32_16x16x32_bf16 a[188:191], v[168:171], a[24:27], a[188:191]
  v_mfma_f32_16x16x32_bf16 a[180:183], v[170:173], a[84:87], a[180:183]
  v_mfma_f32_16x16x32_bf16 a[184:187], v[168:171], a[84:87], a[184:187]
K_pm0:
  s_bitcmp1_b32 s40, 1
  s_cbranch_scc0 K_pm1
  v_mfma_f32_16x16x32_bf16 a[116:119], v[170:173], a[28:31], a[116:119]
  v_mfma_f32_16x16x32_bf16 a[120:123], v[168:171], a[28:31], a[120:123]
  v_mfma_f32_16x16x32_bf16 a[124:127], v[170:173], a[32:35], a[124:127]
  v_mfma_f32_16x16x32_bf16 a[188:191], v[168:171], a[32:35], a[188:191]
  v_mfma_f32_16x16x32_bf16 a[180:183], v[170:173], a[88:91], a[180:183]
  v_mfma_f32_16x16x32_bf16 a[184:187], v[168:171], a[88:91], a[184:187]
K_pm1:
  s_bitcmp1_b32 s40, 2
  s_cbranch_scc0 K_pm2
  v_mfma_f32_16x16x32_bf16 a[116:119], v[170:173], a[36:39], a[116:119]
  v_mfma_f32_16x16x32_bf16 a[120:123], v[168:171], a[36:39], a[120:123]
  v_mfma_f32_16x16x32_bf16 a[124:127], v[170:173], a[40:43], a[124:127]
  v_mfma_f32_16x16x32_bf16 a[188:191], v[168:171], a[40:43], a[188:191]
  v_mfma_f32_16x16x32_bf16 a[180:183], v[170:173], a[92:95], a[180:183]
  v_mfma_f32_16x16x32_bf16 a[184:187], v[168:171], a[92:95], a[184:187]
K_pm2:
  s_bitcmp1_b32 s40, 3
  s_cbranch_scc0 K_pm3
  v_mfma_f32_16x16x32_bf16 a[116:119], v[170:173], a[44:47], a[116:119]
  v_mfma_f32_16x16x32_bf16 a[120:123], v[168:171], a[44:47], a[120:123]
  v_mfma_f32_16x16x32_bf16 a[124:127], v[170:173], a[48:51], a[124:127]
  v_mfma_f32_16x16x32_bf16 a[188:191], v[168:171], a[48:51], a[188:191]
  v_mfma_f32_16x16x32_bf16 a[180:183], v[170:173], a[96:99], a[180:183]
  v_mfma_f32_16x16x32_bf16 a[184:187], v[168:171], a[96:99], a[184:187]
K_pm3:
  s_bitcmp1_b32 s40, 4
  s_cbranch_scc0 K_pm4
  v_mfma_f32_16x16x32_bf16 a[116:119], v[170:173], a[52:55], a[116:119]
  v_mfma_f32_16x16x32_bf16 a[120:123], v[168:171], a[52:55], a[120:123]
  v_mfma_f32_16x16x32_bf16 a[124:127], v[170:173], a[56:59], a[124:127]
  v_mfma_f32_16x16x32_bf16 a[188:191], v[168:171], a[56:59], a[188:191]
  v_mfma_f32_16x16x32_bf16 a[180:183], v[170:173], a[100:103], a[180:183]
  v_mfma_f32_16x16x32_bf16 a[184:187], v[168:171], a[100:103], a[184:187]
K_pm4:
  s_bitcmp1_b32 s40, 5
  s_cbranch_scc0 K_pm5
  v_mfma_f32_16x16x32_bf16 a[116:119], v[170:173], a[60:63], a[116:119]
  v_mfma_f32_16x16x32_bf16 a[120:123], v[168:171], a[60:63], a[120:123]
  v_mfma_f32_16x16x32_bf16 a[124:127], v[170:173], a[64:67], a[124:127]
  v_mfma_f32_16x16x32_bf16 a[188:191], v[168:171], a[64:67], a[188:191]
  v_mfma_f32_16x16x32_bf16 a[180:183], v[170:173], a[104:107], a[180:183]
  v_mfma_f32_16x16x32_bf16 a[184:187], v[168:171], a[104:107], a[184:187]
K_pm5:
  s_bitcmp1_b32 s40, 6
  s_cbranch_scc0 K_pm6
  v_mfma_f32_16x16x32_bf16 a[116:119], v[170:173], a[68:71], a[116:119]
  v_mfma_f32_16x16x32_bf16 a[120:123], v[168:171], a[68:71], a[120:123]
  v_mfma_f32_16x16x32_bf16 a[124:127], v[170:173], a[72:75], a[124:127]
  v_mfma_f32_16x16x32_bf16 a[188:191], v[168:171], a[72:75], a[188:191]
  v_mfma_f32_16x16x32_bf16 a[180:183], v[170:173], a[108:111], a[180:183]
  v_mfma_f32_16x16x32_bf16 a[184:187], v[168:171], a[108:111], a[184:187]
K_pm6:
  s_bitcmp1_b32 s40, 7
  s_cbranch_scc0 K_pm7
  v_mfma_f32_16x16x32_bf16 a[116:119], v[170:173], a[76:79], a[116:119]
  v_mfma_f32_16x16x32_bf16 a[120:123], v[168:171], a[76:79], a[120:123]
  v_mfma_f32_16x16x32_bf16 a[124:127], v[170:173], a[80:83], a[124:127]
  v_mfma_f32_16x16x32_bf16 a[188:191], v[168:171], a[80:83], a[188:191]
  v_mfma_f32_16x16x32_bf16 a[180:183], v[170:173], a[112:115], a[180:183]
  v_mfma_f32_16x16x32_bf16 a[184:187], v[168:171], a[112:115], a[184:187]
K_pm7:
  s_cmp_eq_u32 s39, 0xff
  s_cbranch_scc1 K_ppd
  s_branch K_ppl
K_ppn:
  s_sleep 2
  s_and_b32 s27, s25, 28
  s_lshl_b32 s27, s27, 5
  s_add_u32 s27, s27, s30
  v_and_b32 v3, 28, v253
  buffer_load_dword v3, v3, s[20:23], s27 offen sc1
  s_waitcnt vmcnt(0)
  s_sub_u32 s94, s94, 1
  s_cbranch_scc0 K_ppl
K_ppd:
  s_nop 0
  v_accvgpr_read_b32 v144, a116
  v_accvgpr_read_b32 v145, a117
  v_accvgpr_read_b32 v146, a118
  v_accvgpr_read_b32 v147, a119
  v_fma_f32 v144, v144, v80, v88
  v_fma_f32 v145, v145, v80, v89
  v_fma_f32 v146, v146, v80, v90
  v_fma_f32 v147, v147, v80, v91
  v_accvgpr_read_b32 v148, a120
  v_accvgpr_read_b32 v149, a121
  v_accvgpr_read_b32 v150, a122
  v_accvgpr_read_b32 v151, a123
  v_fma_f32 v148, v148, v81, v92
  v_fma_f32 v149, v149, v81, v93
  v_fma_f32 v150, v150, v81, v94
  v_fma_f32 v151, v151, v81, v95
  v_cvt_pk_bf16_f32 v144, v144, v145
  v_cvt_pk_bf16_f32 v145, v146, v147
  v_cvt_pk_bf16_f32 v146, v148, v149
  v_cvt_pk_bf16_f32 v147, v150, v151
  s_nop 0
  v_permlane16_swap_b32 v144, v146
  v_permlane16_swap_b32 v145, v147
  buffer_store_dwordx4 v[144:147], v247, s[4:7], s52 offen sc1
  v_accvgpr_read_b32 v152, a124
  v_accvgpr_read_b32 v153, a125
  v_accvgpr_read_b32 v154, a126
  v_accvgpr_read_b32 v155, a127
  v_fma_f32 v152, v152, v96, v104
  v_fma_f32 v153, v153, v96, v105
  v_fma_f32 v154, v154, v96, v106
  v_fma_f32 v155, v155, v96, v107
  v_accvgpr_read_b32 v156, a188
  v_accvgpr_read_b32 v157, a189
  v_accvgpr_read_b32 v158, a190
  v_accvgpr_read_b32 v159, a191
  v_fma_f32 v156, v156, v97, v108
  v_fma_f32 v157, v157, v97, v109
  v_fma_f32 v158, v158, v97, v110
  v_fma_f32 v159, v159, v97, v111
  v_cvt_pk_bf16_f32 v152, v152, v153
  v_cvt_pk_bf16_f32 v153, v154, v155
  v_cvt_pk_bf16_f32 v154, v156, v157
  v_cvt_pk_bf16_f32 v155, v158, v159
  s_nop 0
  v_permlane16_swap_b32 v152, v154
  v_permlane16_swap_b32 v153, v155
  buffer_store_dwordx4 v[152:155], v247, s[4:7], s55 offen sc1
  v_accvgpr_read_b32 v160, a180
  v_accvgpr_read_b32 v161, a181
  v_accvgpr_read_b32 v162, a182
  v_accvgpr_read_b32 v163, a183
  v_fma_f32 v160, v160, v112, v120
  v_fma_f32 v161, v161, v112, v121
  v_fma_f32 v162, v162, v112, v122
  v_fma_f32 v163, v163, v112, v123
  v_accvgpr_read_b32 v164, a184
  v_accvgpr_read_b32 v165, a185
  v_accvgpr_read_b32 v166, a186
  v_accvgpr_read_b32 v167, a187
  v_fma_f32 v164, v164, v113, v124
  v_fma_f32 v165, v165, v113, v125
  v_fma_f32 v166, v166, v113, v126
  v_fma_f32 v167, v167, v113, v127
  v_cvt_pk_bf16_f32 v160, v160, v161
  v_cvt_pk_bf16_f32 v161, v162, v163
  v_cvt_pk_bf16_f32 v162, v164, v165
  v_cvt_pk_bf16_f32 v163, v166, v167
  s_nop 0
  v_permlane16_swap_b32 v160, v162
  v_permlane16_swap_b32 v161, v163
  buffer_store_dwordx4 v[160:163], v247, s[4:7], s58 offen sc1
K_fin:
K_end:
  s_endpgm
K_I0F:
K_hA0_11:
  s_cbranch_execz K_hA0_12
  v_accvgpr_read_b32 v216, a128
  v_add_f32 v216, v176, v216
  v_accvgpr_read_b32 v217, a129
  v_add_f32 v217, v177, v217
  v_accvgpr_read_b32 v218, a130
  v_add_f32 v218, v178, v218
  v_accvgpr_read_b32 v219, a131
  v_add_f32 v219, v179, v219
  v_accvgpr_read_b32 v220, a132
  v_add_f32 v220, v176, v220
  v_accvgpr_read_b32 v221, a133
  v_add_f32 v221, v177, v221
  v_accvgpr_read_b32 v222, a134
  v_add_f32 v222, v178, v222
  v_accvgpr_read_b32 v223, a135
  v_add_f32 v223, v179, v223
  s_sub_u32 s39, s26, 1
  s_waitcnt lgkmcnt(0)
  v_mfma_f32_16x16x32_bf16 v[112:115], a[192:195], v[16:19], v[176:179]
  v_exp_f32 v208, v80
  v_mfma_f32_16x16x32_bf16 v[112:115], a[196:199], v[20:23], v[112:115]
  s_xor_b32 m0, s37, 0x1c000
  v_exp_f32 v209, v81
  v_mfma_f32_16x16x32_bf16 v[112:115], a[200:203], v[24:27], v[112:115]
  v_exp_f32 v210, v88
  v_mfma_f32_16x16x32_bf16 v[112:115], a[204:207], v[28:31], v[112:115]
  v_cvt_pk_bf16_f32 v144, v208, v209
  v_mfma_f32_16x16x32_bf16 v[120:123], a[204:207], v[44:47], v[180:183]
  v_exp_f32 v211, v89
  v_add_f32 v192, v192, v208
  v_add_f32 v192, v192, v209
  v_mfma_f32_16x16x32_bf16 v[120:123], a[200:203], v[40:43], v[120:123]
  v_exp_f32 v212, v96
  v_mfma_f32_16x16x32_bf16 v[120:123], a[196:199], v[36:39], v[120:123]
  buffer_load_dwordx4 v13, s[20:23], s36 offen offset:0 sc1 lds
  v_cvt_pk_bf16_f32 v148, v210, v211
  v_exp_f32 v213, v97
  v_add_f32 v196, v196, v210
  v_add_f32 v196, v196, v211
  v_mfma_f32_16x16x32_bf16 v[120:123], a[192:195], v[32:35], v[120:123]
  v_exp_f32 v214, v104
  v_mfma_f32_16x16x32_bf16 v[128:131], a[192:195], v[48:51], v[184:187]
  v_cvt_pk_bf16_f32 v152, v212, v213
  v_exp_f32 v215, v105
  v_mfma_f32_16x16x32_bf16 v[128:131], a[196:199], v[52:55], v[128:131]
  v_exp_f32 v208, v82
  v_mfma_f32_16x16x32_bf16 v[128:131], a[200:203], v[56:59], v[128:131]
  v_cvt_pk_bf16_f32 v156, v214, v215
  v_exp_f32 v209, v83
  v_mfma_f32_16x16x32_bf16 v[128:131], a[204:207], v[60:63], v[128:131]
  v_exp_f32 v210, v90
  v_mfma_f32_16x16x32_bf16 v[136:139], a[204:207], v[76:79], v[188:191]
  buffer_load_dwordx4 v13, s[20:23], s36 offen offset:1024 sc1 lds
K_hA1_11:
  s_cbranch_execz K_hA1_12
  v_cvt_pk_bf16_f32 v145, v208, v209
  v_exp_f32 v211, v91
  v_add_f32 v192, v192, v208
  v_add_f32 v192, v192, v209
  v_mfma_f32_16x16x32_bf16 v[136:139], a[200:203], v[72:75], v[136:139]
  v_exp_f32 v212, v98
  v_mfma_f32_16x16x32_bf16 v[136:139], a[196:199], v[68:71], v[136:139]
  v_cvt_pk_bf16_f32 v149, v210, v211
  v_exp_f32 v213, v99
  v_add_f32 v196, v196, v210
  v_add_f32 v196, v196, v211
  v_mfma_f32_16x16x32_bf16 v[136:139], a[192:195], v[64:67], v[136:139]
  v_exp_f32 v214, v106
  v_mfma_f32_16x16x32_bf16 v[116:119], a[208:211], v[16:19], v[176:179]
  ds_read_b128 a[192:195], v2 offset:32768
  v_cvt_pk_bf16_f32 v153, v212, v213
  v_exp_f32 v215, v107
  v_mfma_f32_16x16x32_bf16 v[116:119], a[212:215], v[20:23], v[116:119]
  v_exp_f32 v208, v84
  v_mfma_f32_16x16x32_bf16 v[116:119], a[216:219], v[24:27], v[116:119]
  ds_read_b128 a[196:199], v2 offset:33792
  buffer_load_dwordx4 v13, s[20:23], s36 offen offset:2048 sc1 lds
  v_cvt_pk_bf16_f32 v157, v214, v215
  v_exp_f32 v209, v85
  v_mfma_f32_16x16x32_bf16 v[116:119], a[220:223], v[28:31], v[116:119]
  v_exp_f32 v210, v92
  v_mfma_f32_16x16x32_bf16 v[124:127], a[220:223], v[44:47], v[180:183]
  ds_read_b128 a[200:203], v2 offset:34816
  v_cvt_pk_bf16_f32 v146, v208, v209
  v_exp_f32 v211, v93
  v_add_f32 v192, v192, v208
  v_add_f32 v192, v192, v209
  v_mfma_f32_16x16x32_bf16 v[124:127], a[216:219], v[40:43], v[124:127]
  v_exp_f32 v212, v100
  v_mfma_f32_16x16x32_bf16 v[124:127], a[212:215], v[36:39], v[124:127]
  ds_read_b128 a[204:207], v2 offset:35840
  v_cvt_pk_bf16_f32 v150, v210, v211
  v_exp_f32 v213, v101
  v_add_f32 v196, v196, v210
  v_add_f32 v196, v196, v211
  v_mfma_f32_16x16x32_bf16 v[124:127], a[208:211], v[32:35], v[124:127]
  v_exp_f32 v214, v108
  v_mfma_f32_16x16x32_bf16 v[132:135], a[208:211], v[48:51], v[184:187]
  buffer_load_dwordx4 v13, s[20:23], s36 offen offset:3072 sc1 lds
  v_cvt_pk_bf16_f32 v154, v212, v213
  v_exp_f32 v215, v109
  v_mfma_f32_16x16x32_bf16 v[132:135], a[212:215], v[52:55], v[132:135]
  v_exp_f32 v208, v86
  v_mfma_f32_16x16x32_bf16 v[132:135], a[216:219], v[56:59], v[132:135]
  v_cvt_pk_bf16_f32 v158, v214, v215
  v_exp_f32 v209, v87
  v_mfma_f32_16x16x32_bf16 v[132:135], a[220:223], v[60:63], v[132:135]
  v_exp_f32 v210, v94
  v_mfma_f32_16x16x32_bf16 v[140:143], a[220:223], v[76:79], v[188:191]
  v_cvt_pk_bf16_f32 v147, v208, v209
  v_exp_f32 v211, v95
  v_add_f32 v192, v192, v208
  v_add_f32 v192, v192, v209
  v_mfma_f32_16x16x32_bf16 v[140:143], a[216:219], v[72:75], v[140:143]
  v_exp_f32 v212, v102
  v_mfma_f32_16x16x32_bf16 v[140:143], a[212:215], v[68:71], v[140:143]
  v_cvt_pk_bf16_f32 v151, v210, v211
  v_exp_f32 v213, v103
  v_add_f32 v196, v196, v210
  v_add_f32 v196, v196, v211
  v_mfma_f32_16x16x32_bf16 v[140:143], a[208:211], v[64:67], v[140:143]
  ds_read_b128 a[208:211], v2 offset:36864
  ds_read_b128 a[212:215], v2 offset:37888
  ds_read_b128 a[216:219], v2 offset:38912
  ds_read_b128 a[220:223], v2 offset:39936
  v_exp_f32 v214, v110
  v_cvt_pk_bf16_f32 v155, v212, v213
  v_exp_f32 v215, v111
  s_nop 0
  v_cvt_pk_bf16_f32 v159, v214, v215
  s_waitcnt vmcnt(8) lgkmcnt(4)
  s_barrier
  v_mfma_f32_16x16x32_bf16 v[80:83], a[192:195], v[16:19], v[176:179]
  v_exp_f32 v208, v112
  v_mfma_f32_16x16x32_bf16 v[80:83], a[196:199], v[20:23], v[80:83]
  s_mov_b32 m0, s37
  v_exp_f32 v209, v113
  v_mfma_f32_16x16x32_bf16 v[80:83], a[200:203], v[24:27], v[80:83]
  v_exp_f32 v210, v120
  v_mfma_f32_16x16x32_bf16 v[80:83], a[204:207], v[28:31], v[80:83]
  v_cvt_pk_bf16_f32 v160, v208, v209
  v_mfma_f32_16x16x32_bf16 v[88:91], a[204:207], v[44:47], v[180:183]
  v_exp_f32 v211, v121
  v_add_f32 v192, v192, v208
  v_add_f32 v192, v192, v209
  v_mfma_f32_16x16x32_bf16 v[88:91], a[200:203], v[40:43], v[88:91]
  v_exp_f32 v212, v128
  v_mfma_f32_16x16x32_bf16 v[88:91], a[196:199], v[36:39], v[88:91]
  buffer_load_dwordx4 v14, s[20:23], s36 offen offset:0 sc1 lds
  v_cvt_pk_bf16_f32 v164, v210, v211
  v_exp_f32 v213, v129
  v_add_f32 v196, v196, v210
  v_add_f32 v196, v196, v211
  v_mfma_f32_16x16x32_bf16 v[88:91], a[192:195], v[32:35], v[88:91]
  v_exp_f32 v214, v136
  v_mfma_f32_16x16x32_bf16 v[96:99], a[192:195], v[48:51], v[184:187]
  v_cvt_pk_bf16_f32 v168, v212, v213
  v_exp_f32 v215, v137
  v_mfma_f32_16x16x32_bf16 v[96:99], a[196:199], v[52:55], v[96:99]
  v_exp_f32 v208, v114
  v_mfma_f32_16x16x32_bf16 v[96:99], a[200:203], v[56:59], v[96:99]
  v_cvt_pk_bf16_f32 v172, v214, v215
  v_exp_f32 v209, v115
  v_mfma_f32_16x16x32_bf16 v[96:99], a[204:207], v[60:63], v[96:99]
  v_exp_f32 v210, v122
  v_mfma_f32_16x16x32_bf16 v[104:107], a[204:207], v[76:79], v[188:191]
  buffer_load_dwordx4 v14, s[20:23], s36 offen offset:1024 sc1 lds
  v_cvt_pk_bf16_f32 v161, v208, v209
  v_exp_f32 v211, v123
  v_add_f32 v192, v192, v208
  v_add_f32 v192, v192, v209
  v_mfma_f32_16x16x32_bf16 v[104:107], a[200:203], v[72:75], v[104:107]
  v_exp_f32 v212, v130
  v_mfma_f32_16x16x32_bf16 v[104:107], a[196:199], v[68:71], v[104:107]
  v_cvt_pk_bf16_f32 v165, v210, v211
  v_exp_f32 v213, v131
  v_add_f32 v196, v196, v210
  v_add_f32 v196, v196, v211
  v_mfma_f32_16x16x32_bf16 v[104:107], a[192:195], v[64:67], v[104:107]
  s_waitcnt lgkmcnt(0)
  v_exp_f32 v214, v138
  v_mfma_f32_16x16x32_bf16 v[84:87], a[208:211], v[16:19], v[176:179]
  ds_read_b128 a[192:195], v2 offset:49152
  v_cvt_pk_bf16_f32 v169, v212, v213
  v_exp_f32 v215, v139
  v_mfma_f32_16x16x32_bf16 v[84:87], a[212:215], v[20:23], v[84:87]
  v_exp_f32 v208, v116
  v_mfma_f32_16x16x32_bf16 v[84:87], a[216:219], v[24:27], v[84:87]
  ds_read_b128 a[196:199], v2 offset:50176
  buffer_load_dwordx4 v14, s[20:23], s36 offen offset:2048 sc1 lds
  v_cvt_pk_bf16_f32 v173, v214, v215
  v_exp_f32 v209, v117
  v_mfma_f32_16x16x32_bf16 v[84:87], a[220:223], v[28:31], v[84:87]
  v_exp_f32 v210, v124
  v_mfma_f32_16x16x32_bf16 v[92:95], a[220:223], v[44:47], v[180:183]
  ds_read_b128 a[200:203], v2 offset:51200
  v_cvt_pk_bf16_f32 v162, v208, v209
  v_exp_f32 v211, v125
  v_add_f32 v192, v192, v208
  v_add_f32 v192, v192, v209
  v_mfma_f32_16x16x32_bf16 v[92:95], a[216:219], v[40:43], v[92:95]
  v_exp_f32 v212, v132
  v_mfma_f32_16x16x32_bf16 v[92:95], a[212:215], v[36:39], v[92:95]
  ds_read_b128 a[204:207], v2 offset:52224
  v_cvt_pk_bf16_f32 v166, v210, v211
  v_exp_f32 v213, v133
  v_add_f32 v196, v196, v210
  v_add_f32 v196, v196, v211
  v_mfma_f32_16x16x32_bf16 v[92:95], a[208:211], v[32:35], v[92:95]
  v_exp_f32 v214, v140
  v_mfma_f32_16x16x32_bf16 v[100:103], a[208:211], v[48:51], v[184:187]
  buffer_load_dwordx4 v14, s[20:23], s36 offen offset:3072 sc1 lds
  v_cvt_pk_bf16_f32 v170, v212, v213
  v_exp_f32 v215, v141
  v_mfma_f32_16x16x32_bf16 v[100:103], a[212:215], v[52:55], v[100:103]
  v_exp_f32 v208, v118
  v_mfma_f32_16x16x32_bf16 v[100:103], a[216:219], v[56:59], v[100:103]
  v_cvt_pk_bf16_f32 v174, v214, v215
  v_exp_f32 v209, v119
  v_mfma_f32_16x16x32_bf16 v[100:103], a[220:223], v[60:63], v[100:103]
  v_exp_f32 v210, v126
  v_mfma_f32_16x16x32_bf16 v[108:111], a[220:223], v[76:79], v[188:191]
  v_cvt_pk_bf16_f32 v163, v208, v209
  v_exp_f32 v211, v127
  v_add_f32 v192, v192, v208
  v_add_f32 v192, v192, v209
  v_mfma_f32_16x16x32_bf16 v[108:111], a[216:219], v[72:75], v[108:111]
  v_exp_f32 v212, v134
  v_mfma_f32_16x16x32_bf16 v[108:111], a[212:215], v[68:71], v[108:111]
  v_cvt_pk_bf16_f32 v167, v210, v211
  v_exp_f32 v213, v135
  v_add_f32 v196, v196, v210
  v_add_f32 v196, v196, v211
  v_mfma_f32_16x16x32_bf16 v[108:111], a[208:211], v[64:67], v[108:111]
  ds_read_b128 a[208:211], v2 offset:53248
  ds_read_b128 a[212:215], v2 offset:54272
  ds_read_b128 a[216:219], v2 offset:55296
  ds_read_b128 a[220:223], v2 offset:56320
  ds_read_b128 a[224:227], v2 offset:57344
  ds_read_b128 a[228:231], v2 offset:58368
  ds_read_b128 a[232:235], v2 offset:59392
  ds_read_b128 a[236:239], v2 offset:60416
  v_exp_f32 v214, v142
  v_cvt_pk_bf16_f32 v171, v212, v213
  v_exp_f32 v215, v143
  s_nop 0
  v_cvt_pk_bf16_f32 v175, v214, v215
.p2align 3
K_FULL3:
  s_waitcnt lgkmcnt(4)
  v_mfma_f32_16x16x32_bf16 v[112:115], a[192:195], v[16:19], v[176:179]
  v_exp_f32 v208, v80
  v_mfma_f32_16x16x32_bf16 v[112:115], a[196:199], v[20:23], v[112:115]
  ds_read_b128 a[240:243], v2 offset:61440
  v_mfma_f32_16x16x32_bf16 v[112:115], a[200:203], v[24:27], v[112:115]
  s_xor_b32 m0, s37, 0x4000
  v_exp_f32 v209, v81
  v_mfma_f32_16x16x32_bf16 v[112:115], a[204:207], v[28:31], v[112:115]
  buffer_load_dwordx4 v15, s[20:23], s36 offen offset:0 sc1 lds
  v_mfma_f32_16x16x32_bf16 v[120:123], a[204:207], v[44:47], v[180:183]
  v_exp_f32 v210, v88
  v_mfma_f32_16x16x32_bf16 v[120:123], a[200:203], v[40:43], v[120:123]
  ds_read_b128 a[244:247], v2 offset:62464
  v_cvt_pk_bf16_f32 v4, v208, v209
  v_mfma_f32_16x16x32_bf16 v[120:123], a[196:199], v[36:39], v[120:123]
  v_exp_f32 v211, v89
  v_mfma_f32_16x16x32_bf16 v[120:123], a[192:195], v[32:35], v[120:123]
  v_add_f32 v192, v192, v208
  v_add_f32 v192, v192, v209
  v_mfma_f32_16x16x32_bf16 v[128:131], a[192:195], v[48:51], v[184:187]
  v_exp_f32 v212, v96
  v_mfma_f32_16x16x32_bf16 v[128:131], a[196:199], v[52:55], v[128:131]
  ds_read_b128 a[248:251], v2 offset:63488
  v_cvt_pk_bf16_f32 v8, v210, v211
  v_mfma_f32_16x16x32_bf16 v[128:131], a[200:203], v[56:59], v[128:131]
  v_exp_f32 v213, v97
  v_mfma_f32_16x16x32_bf16 v[128:131], a[204:207], v[60:63], v[128:131]
  v_add_f32 v196, v196, v210
  v_add_f32 v196, v196, v211
  v_mfma_f32_16x16x32_bf16 v[136:139], a[204:207], v[76:79], v[188:191]
  v_exp_f32 v214, v104
  v_mfma_f32_16x16x32_bf16 v[136:139], a[200:203], v[72:75], v[136:139]
  ds_read_b128 a[252:255], v2 offset:64512
  v_cvt_pk_bf16_f32 v224, v212, v213
  v_mfma_f32_16x16x32_bf16 v[136:139], a[196:199], v[68:71], v[136:139]
  v_exp_f32 v215, v105
  v_mfma_f32_16x16x32_bf16 v[136:139], a[192:195], v[64:67], v[136:139]
  v_xor_b32 v2, 0x10000, v2
  v_mfma_f32_16x16x32_bf16 v[116:119], a[208:211], v[16:19], v[176:179]
  v_exp_f32 v208, v82
  v_mfma_f32_16x16x32_bf16 v[116:119], a[212:215], v[20:23], v[116:119]
  ds_read_b128 a[192:195], v2 offset:0
  v_cvt_pk_bf16_f32 v228, v214, v215
  v_mfma_f32_16x16x32_bf16 v[116:119], a[216:219], v[24:27], v[116:119]
  v_exp_f32 v209, v83
  v_mfma_f32_16x16x32_bf16 v[116:119], a[220:223], v[28:31], v[116:119]
  buffer_load_dwordx4 v15, s[20:23], s36 offen offset:1024 sc1 lds
  v_mfma_f32_16x16x32_bf16 v[124:127], a[220:223], v[44:47], v[180:183]
  v_exp_f32 v210, v90
  v_mfma_f32_16x16x32_bf16 v[124:127], a[216:219], v[40:43], v[124:127]
  ds_read_b128 a[196:199], v2 offset:1024
  v_cvt_pk_bf16_f32 v5, v208, v209
  v_mfma_f32_16x16x32_bf16 v[124:127], a[212:215], v[36:39], v[124:127]
  v_exp_f32 v211, v91
  v_mfma_f32_16x16x32_bf16 v[124:127], a[208:211], v[32:35], v[124:127]
  v_add_f32 v192, v192, v208
  v_add_f32 v192, v192, v209
  v_mfma_f32_16x16x32_bf16 v[132:135], a[208:211], v[48:51], v[184:187]
  v_exp_f32 v212, v98
  v_mfma_f32_16x16x32_bf16 v[132:135], a[212:215], v[52:55], v[132:135]
  ds_read_b128 a[200:203], v2 offset:2048
  v_cvt_pk_bf16_f32 v9, v210, v211
  v_mfma_f32_16x16x32_bf16 v[132:135], a[216:219], v[56:59], v[132:135]
  v_exp_f32 v213, v99
  v_mfma_f32_16x16x32_bf16 v[132:135], a[220:223], v[60:63], v[132:135]
  v_add_f32 v196, v196, v210
  v_add_f32 v196, v196, v211
  v_mfma_f32_16x16x32_bf16 v[140:143], a[220:223], v[76:79], v[188:191]
  v_exp_f32 v214, v106
  v_mfma_f32_16x16x32_bf16 v[140:143], a[216:219], v[72:75], v[140:143]
  ds_read_b128 a[204:207], v2 offset:3072
  v_cvt_pk_bf16_f32 v225, v212, v213
  v_mfma_f32_16x16x32_bf16 v[140:143], a[212:215], v[68:71], v[140:143]
  v_exp_f32 v215, v107
  v_mfma_f32_16x16x32_bf16 v[140:143], a[208:211], v[64:67], v[140:143]
  s_waitcnt lgkmcnt(4)
  v_mfma_f32_16x16x32_bf16 a[0:3], a[224:227], v[144:147], a[0:3]
  v_exp_f32 v208, v84
  v_mfma_f32_16x16x32_bf16 a[0:3], a[228:231], v[160:163], a[0:3]
  ds_read_b128 a[208:211], v2 offset:4096
  v_cvt_pk_bf16_f32 v229, v214, v215
  v_mfma_f32_16x16x32_bf16 a[32:35], a[228:231], v[164:167], a[32:35]
  v_exp_f32 v209, v85
  v_mfma_f32_16x16x32_bf16 a[32:35], a[224:227], v[148:151], a[32:35]
  buffer_load_dwordx4 v15, s[20:23], s36 offen offset:2048 sc1 lds
  v_mfma_f32_16x16x32_bf16 a[64:67], a[224:227], v[152:155], a[64:67]
  v_exp_f32 v210, v92
  v_mfma_f32_16x16x32_bf16 a[64:67], a[228:231], v[168:171], a[64:67]
  ds_read_b128 a[212:215], v2 offset:5120
  v_cvt_pk_bf16_f32 v6, v208, v209
  v_mfma_f32_16x16x32_bf16 a[96:99], a[228:231], v[172:175], a[96:99]
  v_exp_f32 v211, v93
  v_mfma_f32_16x16x32_bf16 a[96:99], a[224:227], v[156:159], a[96:99]
  v_add_f32 v192, v192, v208
  v_add_f32 v192, v192, v209
  v_mfma_f32_16x16x32_bf16 a[100:103], a[232:235], v[156:159], a[100:103]
  v_exp_f32 v212, v100
  v_mfma_f32_16x16x32_bf16 a[100:103], a[236:239], v[172:175], a[100:103]
  ds_read_b128 a[216:219], v2 offset:6144
  v_cvt_pk_bf16_f32 v10, v210, v211
  v_mfma_f32_16x16x32_bf16 a[68:71], a[236:239], v[168:171], a[68:71]
  v_exp_f32 v213, v101
  v_mfma_f32_16x16x32_bf16 a[68:71], a[232:235], v[152:155], a[68:71]
  v_add_f32 v196, v196, v210
  v_add_f32 v196, v196, v211
  v_mfma_f32_16x16x32_bf16 a[36:39], a[232:235], v[148:151], a[36:39]
  v_exp_f32 v214, v108
  v_mfma_f32_16x16x32_bf16 a[36:39], a[236:239], v[164:167], a[36:39]
  ds_read_b128 a[220:223], v2 offset:7168
  v_cvt_pk_bf16_f32 v226, v212, v213
  v_mfma_f32_16x16x32_bf16 a[4:7], a[236:239], v[160:163], a[4:7]
  v_exp_f32 v215, v109
  v_mfma_f32_16x16x32_bf16 a[4:7], a[232:235], v[144:147], a[4:7]
  v_mfma_f32_16x16x32_bf16 a[8:11], a[240:243], v[144:147], a[8:11]
  v_exp_f32 v208, v86
  v_mfma_f32_16x16x32_bf16 a[8:11], a[244:247], v[160:163], a[8:11]
  ds_read_b128 a[224:227], v2 offset:8192
  v_cvt_pk_bf16_f32 v230, v214, v215
  v_mfma_f32_16x16x32_bf16 a[40:43], a[244:247], v[164:167], a[40:43]
  v_exp_f32 v209, v87
  v_mfma_f32_16x16x32_bf16 a[40:43], a[240:243], v[148:151], a[40:43]
  buffer_load_dwordx4 v15, s[20:23], s36 offen offset:3072 sc1 lds
  v_mfma_f32_16x16x32_bf16 a[72:75], a[240:243], v[152:155], a[72:75]
  s_add_u32 s36, s36, 32768
  v_exp_f32 v210, v94
  v_mfma_f32_16x16x32_bf16 a[72:75], a[244:247], v[168:171], a[72:75]
  ds_read_b128 a[228:231], v2 offset:9216
  v_cvt_pk_bf16_f32 v7, v208, v209
  v_mfma_f32_16x16x32_bf16 a[104:107], a[244:247], v[172:175], a[104:107]
  s_xor_b32 s37, s37, 0x10000
  v_exp_f32 v211, v95
  v_mfma_f32_16x16x32_bf16 a[104:107], a[240:243], v[156:159], a[104:107]
  v_add_f32 v192, v192, v208
  v_add_f32 v192, v192, v209
  v_mfma_f32_16x16x32_bf16 a[108:111], a[248:251], v[156:159], a[108:111]
  v_exp_f32 v212, v102
  v_mfma_f32_16x16x32_bf16 a[108:111], a[252:255], v[172:175], a[108:111]
  ds_read_b128 a[232:235], v2 offset:10240
  v_cvt_pk_bf16_f32 v11, v210, v211
  v_mfma_f32_16x16x32_bf16 a[76:79], a[252:255], v[168:171], a[76:79]
  v_exp_f32 v213, v103
  v_mfma_f32_16x16x32_bf16 a[76:79], a[248:251], v[152:155], a[76:79]
  v_add_f32 v196, v196, v210
  v_add_f32 v196, v196, v211
  v_mfma_f32_16x16x32_bf16 a[44:47], a[248:251], v[148:151], a[44:47]
  v_exp_f32 v214, v110
  v_mfma_f32_16x16x32_bf16 a[44:47], a[252:255], v[164:167], a[44:47]
  ds_read_b128 a[236:239], v2 offset:11264
  v_cvt_pk_bf16_f32 v227, v212, v213
  v_mfma_f32_16x16x32_bf16 a[12:15], a[252:255], v[160:163], a[12:15]
  v_exp_f32 v215, v111
  v_mfma_f32_16x16x32_bf16 a[12:15], a[248:251], v[144:147], a[12:15]
  v_mfma_f32_16x16x32_bf16 v[200:203], v[240:243], v[152:155], v[200:203]
  v_cvt_pk_bf16_f32 v231, v214, v215
  s_sub_u32 s39, s39, 1
  v_mfma_f32_16x16x32_bf16 v[200:203], v[240:243], v[168:171], v[200:203]
  s_cbranch_scc1 K_T0
  s_waitcnt vmcnt(12) lgkmcnt(4)
  s_barrier
  v_mfma_f32_16x16x32_bf16 v[80:83], a[192:195], v[16:19], v[176:179]
  v_exp_f32 v208, v112
  v_mfma_f32_16x16x32_bf16 v[80:83], a[196:199], v[20:23], v[80:83]
  ds_read_b128 a[240:243], v2 offset:12288
  v_mfma_f32_16x16x32_bf16 v[80:83], a[200:203], v[24:27], v[80:83]
  s_xor_b32 m0, s37, 0x18000
  v_exp_f32 v209, v113
  v_mfma_f32_16x16x32_bf16 v[80:83], a[204:207], v[28:31], v[80:83]
  buffer_load_dwordx4 v1, s[20:23], s36 offen offset:0 sc1 lds
  v_mfma_f32_16x16x32_bf16 v[88:91], a[204:207], v[44:47], v[180:183]
  v_exp_f32 v210, v120
  v_mfma_f32_16x16x32_bf16 v[88:91], a[200:203], v[40:43], v[88:91]
  ds_read_b128 a[244:247], v2 offset:13312
  v_cvt_pk_bf16_f32 v244, v208, v209
  v_mfma_f32_16x16x32_bf16 v[88:91], a[196:199], v[36:39], v[88:91]
  v_exp_f32 v211, v121
  v_mfma_f32_16x16x32_bf16 v[88:91], a[192:195], v[32:35], v[88:91]
  v_add_f32 v192, v192, v208
  v_add_f32 v192, v192, v209
  v_mfma_f32_16x16x32_bf16 v[96:99], a[192:195], v[48:51], v[184:187]
  v_exp_f32 v212, v128
  v_mfma_f32_16x16x32_bf16 v[96:99], a[196:199], v[52:55], v[96:99]
  ds_read_b128 a[248:251], v2 offset:14336
  v_cvt_pk_bf16_f32 v248, v210, v211
  v_mfma_f32_16x16x32_bf16 v[96:99], a[200:203], v[56:59], v[96:99]
  v_exp_f32 v213, v129
  v_mfma_f32_16x16x32_bf16 v[96:99], a[204:207], v[60:63], v[96:99]
  v_add_f32 v196, v196, v210
  v_add_f32 v196, v196, v211
  v_mfma_f32_16x16x32_bf16 v[104:107], a[204:207], v[76:79], v[188:191]
  v_exp_f32 v214, v136
  v_mfma_f32_16x16x32_bf16 v[104:107], a[200:203], v[72:75], v[104:107]
  ds_read_b128 a[252:255], v2 offset:15360
  v_cvt_pk_bf16_f32 v232, v212, v213
  v_mfma_f32_16x16x32_bf16 v[104:107], a[196:199], v[68:71], v[104:107]
  v_exp_f32 v215, v137
  v_mfma_f32_16x16x32_bf16 v[104:107], a[192:195], v[64:67], v[104:107]
  v_mfma_f32_16x16x32_bf16 v[84:87], a[208:211], v[16:19], v[176:179]
  v_exp_f32 v208, v114
  v_mfma_f32_16x16x32_bf16 v[84:87], a[212:215], v[20:23], v[84:87]
  ds_read_b128 a[192:195], v2 offset:16384
  v_cvt_pk_bf16_f32 v236, v214, v215
  v_mfma_f32_16x16x32_bf16 v[84:87], a[216:219], v[24:27], v[84:87]
  v_exp_f32 v209, v115
  v_mfma_f32_16x16x32_bf16 v[84:87], a[220:223], v[28:31], v[84:87]
  buffer_load_dwordx4 v1, s[20:23], s36 offen offset:1024 sc1 lds
  v_mfma_f32_16x16x32_bf16 v[92:95], a[220:223], v[44:47], v[180:183]
  v_exp_f32 v210, v122
  v_mfma_f32_16x16x32_bf16 v[92:95], a[216:219], v[40:43], v[92:95]
  ds_read_b128 a[196:199], v2 offset:17408
  v_cvt_pk_bf16_f32 v245, v208, v209
  v_mfma_f32_16x16x32_bf16 v[92:95], a[212:215], v[36:39], v[92:95]
  v_exp_f32 v211, v123
  v_mfma_f32_16x16x32_bf16 v[92:95], a[208:211], v[32:35], v[92:95]
  v_add_f32 v192, v192, v208
  v_add_f32 v192, v192, v209
  v_mfma_f32_16x16x32_bf16 v[100:103], a[208:211], v[48:51], v[184:187]
  v_exp_f32 v212, v130
  v_mfma_f32_16x16x32_bf16 v[100:103], a[212:215], v[52:55], v[100:103]
  ds_read_b128 a[200:203], v2 offset:18432
  v_cvt_pk_bf16_f32 v249, v210, v211
  v_mfma_f32_16x16x32_bf16 v[100:103], a[216:219], v[56:59], v[100:103]
  v_exp_f32 v213, v131
  v_mfma_f32_16x16x32_bf16 v[100:103], a[220:223], v[60:63], v[100:103]
  v_add_f32 v196, v196, v210
  v_add_f32 v196, v196, v211
  v_mfma_f32_16x16x32_bf16 v[108:111], a[220:223], v[76:79], v[188:191]
  v_exp_f32 v214, v138
  v_mfma_f32_16x16x32_bf16 v[108:111], a[216:219], v[72:75], v[108:111]
  ds_read_b128 a[204:207], v2 offset:19456
  v_cvt_pk_bf16_f32 v233, v212, v213
  v_mfma_f32_16x16x32_bf16 v[108:111], a[212:215], v[68:71], v[108:111]
  v_exp_f32 v215, v139
  v_mfma_f32_16x16x32_bf16 v[108:111], a[208:211], v[64:67], v[108:111]
  s_waitcnt lgkmcnt(4)
  v_mfma_f32_16x16x32_bf16 a[16:19], a[224:227], v[144:147], a[16:19]
  v_exp_f32 v208, v116
  v_mfma_f32_16x16x32_bf16 a[16:19], a[228:231], v[160:163], a[16:19]
  ds_read_b128 a[208:211], v2 offset:20480
  v_cvt_pk_bf16_f32 v237, v214, v215
  v_mfma_f32_16x16x32_bf16 a[48:51], a[228:231], v[164:167], a[48:51]
  v_exp_f32 v209, v117
  v_mfma_f32_16x16x32_bf16 a[48:51], a[224:227], v[148:151], a[48:51]
  buffer_load_dwordx4 v1, s[20:23], s36 offen offset:2048 sc1 lds
  v_mfma_f32_16x16x32_bf16 a[80:83], a[224:227], v[152:155], a[80:83]
  v_exp_f32 v210, v124
  v_mfma_f32_16x16x32_bf16 a[80:83], a[228:231], v[168:171], a[80:83]
  ds_read_b128 a[212:215], v2 offset:21504
  v_cvt_pk_bf16_f32 v246, v208, v209
  v_mfma_f32_16x16x32_bf16 a[112:115], a[228:231], v[172:175], a[112:115]
  v_exp_f32 v211, v125
  v_mfma_f32_16x16x32_bf16 a[112:115], a[224:227], v[156:159], a[112:115]
  v_add_f32 v192, v192, v208
  v_add_f32 v192, v192, v209
  v_mfma_f32_16x16x32_bf16 a[116:119], a[232:235], v[156:159], a[116:119]
  v_exp_f32 v212, v132
  v_mfma_f32_16x16x32_bf16 a[116:119], a[236:239], v[172:175], a[116:119]
  ds_read_b128 a[216:219], v2 offset:22528
  v_cvt_pk_bf16_f32 v250, v210, v211
  v_mfma_f32_16x16x32_bf16 a[84:87], a[236:239], v[168:171], a[84:87]
  v_exp_f32 v213, v133
  v_mfma_f32_16x16x32_bf16 a[84:87], a[232:235], v[152:155], a[84:87]
  v_add_f32 v196, v196, v210
  v_add_f32 v196, v196, v211
  v_mfma_f32_16x16x32_bf16 a[52:55], a[232:235], v[148:151], a[52:55]
  v_exp_f32 v214, v140
  v_mfma_f32_16x16x32_bf16 a[52:55], a[236:239], v[164:167], a[52:55]
  ds_read_b128 a[220:223], v2 offset:23552
  v_cvt_pk_bf16_f32 v234, v212, v213
  v_mfma_f32_16x16x32_bf16 a[20:23], a[236:239], v[160:163], a[20:23]
  v_exp_f32 v215, v141
  v_mfma_f32_16x16x32_bf16 a[20:23], a[232:235], v[144:147], a[20:23]
  v_mfma_f32_16x16x32_bf16 a[24:27], a[240:243], v[144:147], a[24:27]
  v_exp_f32 v208, v118
  v_mfma_f32_16x16x32_bf16 a[24:27], a[244:247], v[160:163], a[24:27]
  ds_read_b128 a[224:227], v2 offset:24576
  v_cvt_pk_bf16_f32 v238, v214, v215
  v_mfma_f32_16x16x32_bf16 a[56:59], a[244:247], v[164:167], a[56:59]
  v_exp_f32 v209, v119
  v_mfma_f32_16x16x32_bf16 a[56:59], a[240:243], v[148:151], a[56:59]
  buffer_load_dwordx4 v1, s[20:23], s36 offen offset:3072 sc1 lds
  v_mfma_f32_16x16x32_bf16 a[88:91], a[240:243], v[152:155], a[88:91]
  v_exp_f32 v210, v126
  v_mfma_f32_16x16x32_bf16 a[88:91], a[244:247], v[168:171], a[88:91]
  ds_read_b128 a[228:231], v2 offset:25600
  v_cvt_pk_bf16_f32 v247, v208, v209
  v_mfma_f32_16x16x32_bf16 a[120:123], a[244:247], v[172:175], a[120:123]
  v_exp_f32 v211, v127
  v_mfma_f32_16x16x32_bf16 a[120:123], a[240:243], v[156:159], a[120:123]
  v_add_f32 v192, v192, v208
  v_add_f32 v192, v192, v209
  v_mfma_f32_16x16x32_bf16 a[124:127], a[248:251], v[156:159], a[124:127]
  v_exp_f32 v212, v134
  v_mfma_f32_16x16x32_bf16 a[124:127], a[252:255], v[172:175], a[124:127]
  ds_read_b128 a[232:235], v2 offset:26624
  v_cvt_pk_bf16_f32 v251, v210, v211
  v_mfma_f32_16x16x32_bf16 a[92:95], a[252:255], v[168:171], a[92:95]
  v_exp_f32 v213, v135
  v_mfma_f32_16x16x32_bf16 a[92:95], a[248:251], v[152:155], a[92:95]
  v_add_f32 v196, v196, v210
  v_add_f32 v196, v196, v211
  v_mfma_f32_16x16x32_bf16 a[60:63], a[248:251], v[148:151], a[60:63]
  v_exp_f32 v214, v142
  v_mfma_f32_16x16x32_bf16 a[60:63], a[252:255], v[164:167], a[60:63]
  ds_read_b128 a[236:239], v2 offset:27648
  v_cvt_pk_bf16_f32 v235, v212, v213
  v_mfma_f32_16x16x32_bf16 a[28:31], a[252:255], v[160:163], a[28:31]
  v_exp_f32 v215, v143
  v_mfma_f32_16x16x32_bf16 a[28:31], a[248:251], v[144:147], a[28:31]
  v_mfma_f32_16x16x32_bf16 v[204:207], v[240:243], v[156:159], v[204:207]
  v_cvt_pk_bf16_f32 v239, v214, v215
  v_mfma_f32_16x16x32_bf16 v[204:207], v[240:243], v[172:175], v[204:207]
  s_waitcnt lgkmcnt(4)
  v_mfma_f32_16x16x32_bf16 v[112:115], a[192:195], v[16:19], v[176:179]
  v_exp_f32 v208, v80
  v_mfma_f32_16x16x32_bf16 v[112:115], a[196:199], v[20:23], v[112:115]
  ds_read_b128 a[240:243], v2 offset:28672
  v_mfma_f32_16x16x32_bf16 v[112:115], a[200:203], v[24:27], v[112:115]
  s_xor_b32 m0, s37, 0x1c000
  v_exp_f32 v209, v81
  v_mfma_f32_16x16x32_bf16 v[112:115], a[204:207], v[28:31], v[112:115]
  buffer_load_dwordx4 v13, s[20:23], s36 offen offset:0 sc1 lds
  v_mfma_f32_16x16x32_bf16 v[120:123], a[204:207], v[44:47], v[180:183]
  v_exp_f32 v210, v88
  v_mfma_f32_16x16x32_bf16 v[120:123], a[200:203], v[40:43], v[120:123]
  ds_read_b128 a[244:247], v2 offset:29696
  v_cvt_pk_bf16_f32 v144, v208, v209
  v_mfma_f32_16x16x32_bf16 v[120:123], a[196:199], v[36:39], v[120:123]
  v_exp_f32 v211, v89
  v_mfma_f32_16x16x32_bf16 v[120:123], a[192:195], v[32:35], v[120:123]
  v_add_f32 v192, v192, v208
  v_add_f32 v192, v192, v209
  v_mfma_f32_16x16x32_bf16 v[128:131], a[192:195], v[48:51], v[184:187]
  v_exp_f32 v212, v96
  v_mfma_f32_16x16x32_bf16 v[128:131], a[196:199], v[52:55], v[128:131]
  ds_read_b128 a[248:251], v2 offset:30720
  v_cvt_pk_bf16_f32 v148, v210, v211
  v_mfma_f32_16x16x32_bf16 v[128:131], a[200:203], v[56:59], v[128:131]
  v_exp_f32 v213, v97
  v_mfma_f32_16x16x32_bf16 v[128:131], a[204:207], v[60:63], v[128:131]
  v_add_f32 v196, v196, v210
  v_add_f32 v196, v196, v211
  v_mfma_f32_16x16x32_bf16 v[136:139], a[204:207], v[76:79], v[188:191]
  v_exp_f32 v214, v104
  v_mfma_f32_16x16x32_bf16 v[136:139], a[200:203], v[72:75], v[136:139]
  ds_read_b128 a[252:255], v2 offset:31744
  v_cvt_pk_bf16_f32 v152, v212, v213
  v_mfma_f32_16x16x32_bf16 v[136:139], a[196:199], v[68:71], v[136:139]
  v_exp_f32 v215, v105
  v_mfma_f32_16x16x32_bf16 v[136:139], a[192:195], v[64:67], v[136:139]
  v_mfma_f32_16x16x32_bf16 v[116:119], a[208:211], v[16:19], v[176:179]
  v_exp_f32 v208, v82
  v_mfma_f32_16x16x32_bf16 v[116:119], a[212:215], v[20:23], v[116:119]
  ds_read_b128 a[192:195], v2 offset:32768
  v_cvt_pk_bf16_f32 v156, v214, v215
  v_mfma_f32_16x16x32_bf16 v[116:119], a[216:219], v[24:27], v[116:119]
  v_exp_f32 v209, v83
  v_mfma_f32_16x16x32_bf16 v[116:119], a[220:223], v[28:31], v[116:119]
  buffer_load_dwordx4 v13, s[20:23], s36 offen offset:1024 sc1 lds
  v_mfma_f32_16x16x32_bf16 v[124:127], a[220:223], v[44:47], v[180:183]
  v_exp_f32 v210, v90
  v_mfma_f32_16x16x32_bf16 v[124:127], a[216:219], v[40:43], v[124:127]
  ds_read_b128 a[196:199], v2 offset:33792
  v_cvt_pk_bf16_f32 v145, v208, v209
  v_mfma_f32_16x16x32_bf16 v[124:127], a[212:215], v[36:39], v[124:127]
  v_exp_f32 v211, v91
  v_mfma_f32_16x16x32_bf16 v[124:127], a[208:211], v[32:35], v[124:127]
  v_add_f32 v192, v192, v208
  v_add_f32 v192, v192, v209
  v_mfma_f32_16x16x32_bf16 v[132:135], a[208:211], v[48:51], v[184:187]
  v_exp_f32 v212, v98
  v_mfma_f32_16x16x32_bf16 v[132:135], a[212:215], v[52:55], v[132:135]
  ds_read_b128 a[200:203], v2 offset:34816
  v_cvt_pk_bf16_f32 v149, v210, v211
  v_mfma_f32_16x16x32_bf16 v[132:135], a[216:219], v[56:59], v[132:135]
  v_exp_f32 v213, v99
  v_mfma_f32_16x16x32_bf16 v[132:135], a[220:223], v[60:63], v[132:135]
  v_add_f32 v196, v196, v210
  v_add_f32 v196, v196, v211
  v_mfma_f32_16x16x32_bf16 v[140:143], a[220:223], v[76:79], v[188:191]
  v_exp_f32 v214, v106
  v_mfma_f32_16x16x32_bf16 v[140:143], a[216:219], v[72:75], v[140:143]
  ds_read_b128 a[204:207], v2 offset:35840
  v_cvt_pk_bf16_f32 v153, v212, v213
  v_mfma_f32_16x16x32_bf16 v[140:143], a[212:215], v[68:71], v[140:143]
  v_exp_f32 v215, v107
  v_mfma_f32_16x16x32_bf16 v[140:143], a[208:211], v[64:67], v[140:143]
  s_waitcnt lgkmcnt(4)
  v_mfma_f32_16x16x32_bf16 a[0:3], a[224:227], v[4:7], a[0:3]
  v_exp_f32 v208, v84
  v_mfma_f32_16x16x32_bf16 a[0:3], a[228:231], v[244:247], a[0:3]
  ds_read_b128 a[208:211], v2 offset:36864
  v_cvt_pk_bf16_f32 v157, v214, v215
  v_mfma_f32_16x16x32_bf16 a[32:35], a[228:231], v[248:251], a[32:35]
  v_exp_f32 v209, v85
  v_mfma_f32_16x16x32_bf16 a[32:35], a[224:227], v[8:11], a[32:35]
  buffer_load_dwordx4 v13, s[20:23], s36 offen offset:2048 sc1 lds
  v_mfma_f32_16x16x32_bf16 a[64:67], a[224:227], v[224:227], a[64:67]
  v_exp_f32 v210, v92
  v_mfma_f32_16x16x32_bf16 a[64:67], a[228:231], v[232:235], a[64:67]
  ds_read_b128 a[212:215], v2 offset:37888
  v_cvt_pk_bf16_f32 v146, v208, v209
  v_mfma_f32_16x16x32_bf16 a[96:99], a[228:231], v[236:239], a[96:99]
  v_exp_f32 v211, v93
  v_mfma_f32_16x16x32_bf16 a[96:99], a[224:227], v[228:231], a[96:99]
  v_add_f32 v192, v192, v208
  v_add_f32 v192, v192, v209
  v_mfma_f32_16x16x32_bf16 a[100:103], a[232:235], v[228:231], a[100:103]
  v_exp_f32 v212, v100
  v_mfma_f32_16x16x32_bf16 a[100:103], a[236:239], v[236:239], a[100:103]
  ds_read_b128 a[216:219], v2 offset:38912
  v_cvt_pk_bf16_f32 v150, v210, v211
  v_mfma_f32_16x16x32_bf16 a[68:71], a[236:239], v[232:235], a[68:71]
  v_exp_f32 v213, v101
  v_mfma_f32_16x16x32_bf16 a[68:71], a[232:235], v[224:227], a[68:71]
  v_add_f32 v196, v196, v210
  v_add_f32 v196, v196, v211
  v_mfma_f32_16x16x32_bf16 a[36:39], a[232:235], v[8:11], a[36:39]
  v_exp_f32 v214, v108
  v_mfma_f32_16x16x32_bf16 a[36:39], a[236:239], v[248:251], a[36:39]
  ds_read_b128 a[220:223], v2 offset:39936
  v_cvt_pk_bf16_f32 v154, v212, v213
  v_mfma_f32_16x16x32_bf16 a[4:7], a[236:239], v[244:247], a[4:7]
  v_exp_f32 v215, v109
  v_mfma_f32_16x16x32_bf16 a[4:7], a[232:235], v[4:7], a[4:7]
  v_mfma_f32_16x16x32_bf16 a[8:11], a[240:243], v[4:7], a[8:11]
  v_exp_f32 v208, v86
  v_mfma_f32_16x16x32_bf16 a[8:11], a[244:247], v[244:247], a[8:11]
  ds_read_b128 a[224:227], v2 offset:40960
  v_cvt_pk_bf16_f32 v158, v214, v215
  v_mfma_f32_16x16x32_bf16 a[40:43], a[244:247], v[248:251], a[40:43]
  v_exp_f32 v209, v87
  v_mfma_f32_16x16x32_bf16 a[40:43], a[240:243], v[8:11], a[40:43]
  buffer_load_dwordx4 v13, s[20:23], s36 offen offset:3072 sc1 lds
K_hA2_11:
  s_cbranch_execz K_hA2_12
  v_mfma_f32_16x16x32_bf16 a[72:75], a[240:243], v[224:227], a[72:75]
  v_exp_f32 v210, v94
  v_mfma_f32_16x16x32_bf16 a[72:75], a[244:247], v[232:235], a[72:75]
  ds_read_b128 a[228:231], v2 offset:41984
  v_cvt_pk_bf16_f32 v147, v208, v209
  v_mfma_f32_16x16x32_bf16 a[104:107], a[244:247], v[236:239], a[104:107]
  v_exp_f32 v211, v95
  v_mfma_f32_16x16x32_bf16 a[104:107], a[240:243], v[228:231], a[104:107]
  v_add_f32 v192, v192, v208
  v_add_f32 v192, v192, v209
  v_mfma_f32_16x16x32_bf16 a[108:111], a[248:251], v[228:231], a[108:111]
  v_exp_f32 v212, v102
  v_mfma_f32_16x16x32_bf16 a[108:111], a[252:255], v[236:239], a[108:111]
  ds_read_b128 a[232:235], v2 offset:43008
  v_cvt_pk_bf16_f32 v151, v210, v211
  v_mfma_f32_16x16x32_bf16 a[76:79], a[252:255], v[232:235], a[76:79]
  v_exp_f32 v213, v103
  v_mfma_f32_16x16x32_bf16 a[76:79], a[248:251], v[224:227], a[76:79]
  v_add_f32 v196, v196, v210
  v_add_f32 v196, v196, v211
  v_mfma_f32_16x16x32_bf16 a[44:47], a[248:251], v[8:11], a[44:47]
  v_exp_f32 v214, v110
  v_mfma_f32_16x16x32_bf16 a[44:47], a[252:255], v[248:251], a[44:47]
  ds_read_b128 a[236:239], v2 offset:44032
  v_cvt_pk_bf16_f32 v155, v212, v213
  v_mfma_f32_16x16x32_bf16 a[12:15], a[252:255], v[244:247], a[12:15]
  v_exp_f32 v215, v111
  v_mfma_f32_16x16x32_bf16 a[12:15], a[248:251], v[4:7], a[12:15]
  v_mfma_f32_16x16x32_bf16 v[200:203], v[240:243], v[224:227], v[200:203]
  v_cvt_pk_bf16_f32 v159, v214, v215
  v_mfma_f32_16x16x32_bf16 v[200:203], v[240:243], v[232:235], v[200:203]
  s_waitcnt vmcnt(12) lgkmcnt(4)
  s_barrier
  v_mfma_f32_16x16x32_bf16 v[80:83], a[192:195], v[16:19], v[176:179]
  v_exp_f32 v208, v112
  v_mfma_f32_16x16x32_bf16 v[80:83], a[196:199], v[20:23], v[80:83]
  ds_read_b128 a[240:243], v2 offset:45056
  v_mfma_f32_16x16x32_bf16 v[80:83], a[200:203], v[24:27], v[80:83]
  s_mov_b32 m0, s37
  v_exp_f32 v209, v113
  v_mfma_f32_16x16x32_bf16 v[80:83], a[204:207], v[28:31], v[80:83]
  buffer_load_dwordx4 v14, s[20:23], s36 offen offset:0 sc1 lds
  v_mfma_f32_16x16x32_bf16 v[88:91], a[204:207], v[44:47], v[180:183]
  v_exp_f32 v210, v120
  v_mfma_f32_16x16x32_bf16 v[88:91], a[200:203], v[40:43], v[88:91]
  ds_read_b128 a[244:247], v2 offset:46080
  v_cvt_pk_bf16_f32 v160, v208, v209
  v_mfma_f32_16x16x32_bf16 v[88:91], a[196:199], v[36:39], v[88:91]
  v_exp_f32 v211, v121
  v_mfma_f32_16x16x32_bf16 v[88:91], a[192:195], v[32:35], v[88:91]
  v_add_f32 v192, v192, v208
  v_add_f32 v192, v192, v209
  v_mfma_f32_16x16x32_bf16 v[96:99], a[192:195], v[48:51], v[184:187]
  v_exp_f32 v212, v128
  v_mfma_f32_16x16x32_bf16 v[96:99], a[196:199], v[52:55], v[96:99]
  ds_read_b128 a[248:251], v2 offset:47104
  v_cvt_pk_bf16_f32 v164, v210, v211
  v_mfma_f32_16x16x32_bf16 v[96:99], a[200:203], v[56:59], v[96:99]
  v_exp_f32 v213, v129
  v_mfma_f32_16x16x32_bf16 v[96:99], a[204:207], v[60:63], v[96:99]
  v_add_f32 v196, v196, v210
  v_add_f32 v196, v196, v211
  v_mfma_f32_16x16x32_bf16 v[104:107], a[204:207], v[76:79], v[188:191]
  v_exp_f32 v214, v136
  v_mfma_f32_16x16x32_bf16 v[104:107], a[200:203], v[72:75], v[104:107]
  ds_read_b128 a[252:255], v2 offset:48128
  v_cvt_pk_bf16_f32 v168, v212, v213
  v_mfma_f32_16x16x32_bf16 v[104:107], a[196:199], v[68:71], v[104:107]
  v_exp_f32 v215, v137
  v_mfma_f32_16x16x32_bf16 v[104:107], a[192:195], v[64:67], v[104:107]
  v_mfma_f32_16x16x32_bf16 v[84:87], a[208:211], v[16:19], v[176:179]
  v_exp_f32 v208, v114
  v_mfma_f32_16x16x32_bf16 v[84:87], a[212:215], v[20:23], v[84:87]
  ds_read_b128 a[192:195], v2 offset:49152
  v_cvt_pk_bf16_f32 v172, v214, v215
  v_mfma_f32_16x16x32_bf16 v[84:87], a[216:219], v[24:27], v[84:87]
  v_exp_f32 v209, v115
  v_mfma_f32_16x16x32_bf16 v[84:87], a[220:223], v[28:31], v[84:87]
  buffer_load_dwordx4 v14, s[20:23], s36 offen offset:1024 sc1 lds
  v_mfma_f32_16x16x32_bf16 v[92:95], a[220:223], v[44:47], v[180:183]
  v_exp_f32 v210, v122
  v_mfma_f32_16x16x32_bf16 v[92:95], a[216:219], v[40:43], v[92:95]
  ds_read_b128 a[196:199], v2 offset:50176
  v_cvt_pk_bf16_f32 v161, v208, v209
  v_mfma_f32_16x16x32_bf16 v[92:95], a[212:215], v[36:39], v[92:95]
  v_exp_f32 v211, v123
  v_mfma_f32_16x16x32_bf16 v[92:95], a[208:211], v[32:35], v[92:95]
  v_add_f32 v192, v192, v208
  v_add_f32 v192, v192, v209
  v_mfma_f32_16x16x32_bf16 v[100:103], a[208:211], v[48:51], v[184:187]
  v_exp_f32 v212, v130
  v_mfma_f32_16x16x32_bf16 v[100:103], a[212:215], v[52:55], v[100:103]
  ds_read_b128 a[200:203], v2 offset:51200
  v_cvt_pk_bf16_f32 v165, v210, v211
  v_mfma_f32_16x16x32_bf16 v[100:103], a[216:219], v[56:59], v[100:103]
  v_exp_f32 v213, v131
  v_mfma_f32_16x16x32_bf16 v[100:103], a[220:223], v[60:63], v[100:103]
  v_add_f32 v196, v196, v210
  v_add_f32 v196, v196, v211
  v_mfma_f32_16x16x32_bf16 v[108:111], a[220:223], v[76:79], v[188:191]
  v_exp_f32 v214, v138
  v_mfma_f32_16x16x32_bf16 v[108:111], a[216:219], v[72:75], v[108:111]
  ds_read_b128 a[204:207], v2 offset:52224
  v_cvt_pk_bf16_f32 v169, v212, v213
  v_mfma_f32_16x16x32_bf16 v[108:111], a[212:215], v[68:71], v[108:111]
  v_exp_f32 v215, v139
  v_mfma_f32_16x16x32_bf16 v[108:111], a[208:211], v[64:67], v[108:111]
  s_waitcnt lgkmcnt(4)
  v_mfma_f32_16x16x32_bf16 a[16:19], a[224:227], v[4:7], a[16:19]
  v_exp_f32 v208, v116
  v_mfma_f32_16x16x32_bf16 a[16:19], a[228:231], v[244:247], a[16:19]
  ds_read_b128 a[208:211], v2 offset:53248
  v_cvt_pk_bf16_f32 v173, v214, v215
  v_mfma_f32_16x16x32_bf16 a[48:51], a[228:231], v[248:251], a[48:51]
  v_exp_f32 v209, v117
  v_mfma_f32_16x16x32_bf16 a[48:51], a[224:227], v[8:11], a[48:51]
  buffer_load_dwordx4 v14, s[20:23], s36 offen offset:2048 sc1 lds
  v_mfma_f32_16x16x32_bf16 a[80:83], a[224:227], v[224:227], a[80:83]
  v_exp_f32 v210, v124
  v_mfma_f32_16x16x32_bf16 a[80:83], a[228:231], v[232:235], a[80:83]
  ds_read_b128 a[212:215], v2 offset:54272
  v_cvt_pk_bf16_f32 v162, v208, v209
  v_mfma_f32_16x16x32_bf16 a[112:115], a[228:231], v[236:239], a[112:115]
  v_exp_f32 v211, v125
  v_mfma_f32_16x16x32_bf16 a[112:115], a[224:227], v[228:231], a[112:115]
  v_add_f32 v192, v192, v208
  v_add_f32 v192, v192, v209
  v_mfma_f32_16x16x32_bf16 a[116:119], a[232:235], v[228:231], a[116:119]
  v_exp_f32 v212, v132
  v_mfma_f32_16x16x32_bf16 a[116:119], a[236:239], v[236:239], a[116:119]
  ds_read_b128 a[216:219], v2 offset:55296
  v_cvt_pk_bf16_f32 v166, v210, v211
  v_mfma_f32_16x16x32_bf16 a[84:87], a[236:239], v[232:235], a[84:87]
  v_exp_f32 v213, v133
  v_mfma_f32_16x16x32_bf16 a[84:87], a[232:235], v[224:227], a[84:87]
  v_add_f32 v196, v196, v210
  v_add_f32 v196, v196, v211
  v_mfma_f32_16x16x32_bf16 a[52:55], a[232:235], v[8:11], a[52:55]
  v_exp_f32 v214, v140
  v_mfma_f32_16x16x32_bf16 a[52:55], a[236:239], v[248:251], a[52:55]
  ds_read_b128 a[220:223], v2 offset:56320
  v_cvt_pk_bf16_f32 v170, v212, v213
  v_mfma_f32_16x16x32_bf16 a[20:23], a[236:239], v[244:247], a[20:23]
  v_exp_f32 v215, v141
  v_mfma_f32_16x16x32_bf16 a[20:23], a[232:235], v[4:7], a[20:23]
  v_mfma_f32_16x16x32_bf16 a[24:27], a[240:243], v[4:7], a[24:27]
  v_exp_f32 v208, v118
  v_mfma_f32_16x16x32_bf16 a[24:27], a[244:247], v[244:247], a[24:27]
  ds_read_b128 a[224:227], v2 offset:57344
  v_cvt_pk_bf16_f32 v174, v214, v215
  v_mfma_f32_16x16x32_bf16 a[56:59], a[244:247], v[248:251], a[56:59]
  v_exp_f32 v209, v119
  v_mfma_f32_16x16x32_bf16 a[56:59], a[240:243], v[8:11], a[56:59]
  buffer_load_dwordx4 v14, s[20:23], s36 offen offset:3072 sc1 lds
  v_mfma_f32_16x16x32_bf16 a[88:91], a[240:243], v[224:227], a[88:91]
  v_exp_f32 v210, v126
  v_mfma_f32_16x16x32_bf16 a[88:91], a[244:247], v[232:235], a[88:91]
  ds_read_b128 a[228:231], v2 offset:58368
  v_cvt_pk_bf16_f32 v163, v208, v209
  v_mfma_f32_16x16x32_bf16 a[120:123], a[244:247], v[236:239], a[120:123]
  v_exp_f32 v211, v127
  v_mfma_f32_16x16x32_bf16 a[120:123], a[240:243], v[228:231], a[120:123]
  v_add_f32 v192, v192, v208
  v_add_f32 v192, v192, v209
  v_mfma_f32_16x16x32_bf16 a[124:127], a[248:251], v[228:231], a[124:127]
  v_exp_f32 v212, v134
  v_mfma_f32_16x16x32_bf16 a[124:127], a[252:255], v[236:239], a[124:127]
  ds_read_b128 a[232:235], v2 offset:59392
  v_cvt_pk_bf16_f32 v167, v210, v211
  v_mfma_f32_16x16x32_bf16 a[92:95], a[252:255], v[232:235], a[92:95]
  v_exp_f32 v213, v135
  v_mfma_f32_16x16x32_bf16 a[92:95], a[248:251], v[224:227], a[92:95]
  v_add_f32 v196, v196, v210
  v_add_f32 v196, v196, v211
  v_mfma_f32_16x16x32_bf16 a[60:63], a[248:251], v[8:11], a[60:63]
  v_exp_f32 v214, v142
  v_mfma_f32_16x16x32_bf16 a[60:63], a[252:255], v[248:251], a[60:63]
  ds_read_b128 a[236:239], v2 offset:60416
  v_cvt_pk_bf16_f32 v171, v212, v213
  v_mfma_f32_16x16x32_bf16 a[28:31], a[252:255], v[244:247], a[28:31]
  v_exp_f32 v215, v143
  v_mfma_f32_16x16x32_bf16 a[28:31], a[248:251], v[4:7], a[28:31]
  v_mfma_f32_16x16x32_bf16 v[204:207], v[240:243], v[228:231], v[204:207]
  v_cvt_pk_bf16_f32 v175, v214, v215
  v_mfma_f32_16x16x32_bf16 v[204:207], v[240:243], v[236:239], v[204:207]
  s_branch K_FULL3
K_T0:
K_hA3_11:
  s_cbranch_execz K_hA3_12
  s_waitcnt vmcnt(12) lgkmcnt(4)
  s_barrier
  v_mfma_f32_16x16x32_bf16 v[80:83], a[192:195], v[16:19], v[216:219]
  v_exp_f32 v208, v112
  v_mfma_f32_16x16x32_bf16 v[80:83], a[196:199], v[20:23], v[80:83]
  ds_read_b128 a[240:243], v2 offset:12288
  s_xor_b32 m0, s37, 0x18000
  v_mfma_f32_16x16x32_bf16 v[80:83], a[200:203], v[24:27], v[80:83]
  v_exp_f32 v209, v113
  v_mfma_f32_16x16x32_bf16 v[80:83], a[204:207], v[28:31], v[80:83]
  buffer_load_dwordx4 v1, s[20:23], s36 offen offset:0 sc1 lds
  buffer_load_dwordx4 v1, s[20:23], s36 offen offset:1024 sc1 lds
  v_mfma_f32_16x16x32_bf16 v[88:91], a[204:207], v[44:47], v[180:183]
  v_exp_f32 v210, v120
  v_mfma_f32_16x16x32_bf16 v[88:91], a[200:203], v[40:43], v[88:91]
  ds_read_b128 a[244:247], v2 offset:13312
  v_cvt_pk_bf16_f32 v244, v208, v209
  v_mfma_f32_16x16x32_bf16 v[88:91], a[196:199], v[36:39], v[88:91]
  buffer_load_dwordx4 v1, s[20:23], s36 offen offset:2048 sc1 lds
  v_exp_f32 v211, v121
  v_mfma_f32_16x16x32_bf16 v[88:91], a[192:195], v[32:35], v[88:91]
  v_add_f32 v192, v192, v208
  v_add_f32 v192, v192, v209
  v_mfma_f32_16x16x32_bf16 v[96:99], a[192:195], v[48:51], v[184:187]
  v_exp_f32 v212, v128
  v_mfma_f32_16x16x32_bf16 v[96:99], a[196:199], v[52:55], v[96:99]
  ds_read_b128 a[248:251], v2 offset:14336
  v_cvt_pk_bf16_f32 v248, v210, v211
  v_mfma_f32_16x16x32_bf16 v[96:99], a[200:203], v[56:59], v[96:99]
  v_exp_f32 v213, v129
  v_mfma_f32_16x16x32_bf16 v[96:99], a[204:207], v[60:63], v[96:99]
  v_add_f32 v196, v196, v210
  v_add_f32 v196, v196, v211
  v_mfma_f32_16x16x32_bf16 v[104:107], a[204:207], v[76:79], v[188:191]
  v_exp_f32 v214, v136
  v_mfma_f32_16x16x32_bf16 v[104:107], a[200:203], v[72:75], v[104:107]
  ds_read_b128 a[252:255], v2 offset:15360
  v_cvt_pk_bf16_f32 v232, v212, v213
  v_mfma_f32_16x16x32_bf16 v[104:107], a[196:199], v[68:71], v[104:107]
  v_exp_f32 v215, v137
  v_mfma_f32_16x16x32_bf16 v[104:107], a[192:195], v[64:67], v[104:107]
  buffer_load_dwordx4 v1, s[20:23], s36 offen offset:3072 sc1 lds
  v_mov_b32 v194, 1
  v_mfma_f32_16x16x32_bf16 v[84:87], a[208:211], v[16:19], v[220:223]
  v_exp_f32 v208, v114
  v_mfma_f32_16x16x32_bf16 v[84:87], a[212:215], v[20:23], v[84:87]
  ds_read_b128 a[192:195], v2 offset:16384
  v_cvt_pk_bf16_f32 v236, v214, v215
  v_mfma_f32_16x16x32_bf16 v[84:87], a[216:219], v[24:27], v[84:87]
  v_exp_f32 v209, v115
  v_mfma_f32_16x16x32_bf16 v[84:87], a[220:223], v[28:31], v[84:87]
  v_lshlrev_b32 v198, 24, v0
  s_lshl_b32 s92, s26, 5
  v_mfma_f32_16x16x32_bf16 v[92:95], a[220:223], v[44:47], v[180:183]
  s_add_u32 s92, s92, 4
  v_exp_f32 v210, v122
  v_mfma_f32_16x16x32_bf16 v[92:95], a[216:219], v[40:43], v[92:95]
  ds_read_b128 a[196:199], v2 offset:17408
  s_or_b32 s93, s24, s40
  v_cvt_pk_bf16_f32 v245, v208, v209
  v_mfma_f32_16x16x32_bf16 v[92:95], a[212:215], v[36:39], v[92:95]
  s_lshr_b32 s64, s26, 2
  v_exp_f32 v211, v123
  v_mfma_f32_16x16x32_bf16 v[92:95], a[208:211], v[32:35], v[92:95]
  s_xor_b32 s64, s64, 1
  v_add_f32 v192, v192, v208
  v_add_f32 v192, v192, v209
  v_accvgpr_read_b32 v216, a136
  v_mfma_f32_16x16x32_bf16 v[100:103], a[208:211], v[48:51], v[184:187]
  s_or_b32 s93, s93, s64
  s_cselect_b32 s92, 0x7f000000, s92
  v_exp_f32 v212, v130
  v_mfma_f32_16x16x32_bf16 v[100:103], a[212:215], v[52:55], v[100:103]
  ds_read_b128 a[200:203], v2 offset:18432
  v_cvt_pk_bf16_f32 v249, v210, v211
  v_add_f32 v216, v176, v216
  v_mfma_f32_16x16x32_bf16 v[100:103], a[216:219], v[56:59], v[100:103]
  v_exp_f32 v213, v131
  v_mfma_f32_16x16x32_bf16 v[100:103], a[220:223], v[60:63], v[100:103]
  v_add_f32 v196, v196, v210
  v_add_f32 v196, v196, v211
  v_mfma_f32_16x16x32_bf16 v[108:111], a[220:223], v[76:79], v[188:191]
  v_exp_f32 v214, v138
  v_mfma_f32_16x16x32_bf16 v[108:111], a[216:219], v[72:75], v[108:111]
  ds_read_b128 a[204:207], v2 offset:19456
  v_cvt_pk_bf16_f32 v233, v212, v213
  v_mfma_f32_16x16x32_bf16 v[108:111], a[212:215], v[68:71], v[108:111]
  v_exp_f32 v215, v139
  v_mfma_f32_16x16x32_bf16 v[108:111], a[208:211], v[64:67], v[108:111]
  buffer_atomic_add v194, v198, s[56:59], s92 offen sc0 sc1
  s_and_b32 s92, s24, 1
  s_waitcnt lgkmcnt(4)
  v_mfma_f32_16x16x32_bf16 a[16:19], a[224:227], v[144:147], a[16:19]
  s_lshl_b32 s92, s92, 11
  v_exp_f32 v208, v116
  v_mfma_f32_16x16x32_bf16 a[16:19], a[228:231], v[160:163], a[16:19]
  ds_read_b128 a[208:211], v2 offset:20480
  s_mul_i32 s93, s3, 4224
  v_cvt_pk_bf16_f32 v237, v214, v215
  v_mfma_f32_16x16x32_bf16 a[48:51], a[228:231], v[164:167], a[48:51]
  s_add_u32 s93, s93, 56623104
  v_exp_f32 v209, v117
  v_mfma_f32_16x16x32_bf16 a[48:51], a[224:227], v[148:151], a[48:51]
  s_add_u32 s93, s93, s92
  s_add_u32 m0, s33, s92
  v_accvgpr_read_b32 v217, a137
  v_add_f32 v217, v177, v217
  v_accvgpr_read_b32 v218, a138
  v_mfma_f32_16x16x32_bf16 a[80:83], a[224:227], v[152:155], a[80:83]
  buffer_load_dwordx4 v1, s[20:23], s93 offen offset:0 sc1 lds
  v_exp_f32 v210, v124
  v_add_f32 v218, v178, v218
  v_mfma_f32_16x16x32_bf16 a[80:83], a[228:231], v[168:171], a[80:83]
  ds_read_b128 a[212:215], v2 offset:21504
  buffer_load_dwordx4 v1, s[20:23], s93 offen offset:1024 sc1 lds
  v_cvt_pk_bf16_f32 v246, v208, v209
  v_mfma_f32_16x16x32_bf16 a[112:115], a[228:231], v[172:175], a[112:115]
  v_exp_f32 v211, v125
  v_mfma_f32_16x16x32_bf16 a[112:115], a[224:227], v[156:159], a[112:115]
  s_lshl_b32 s93, s3, 12
  v_add_f32 v192, v192, v208
  v_add_f32 v192, v192, v209
  v_accvgpr_read_b32 v219, a139
  v_mfma_f32_16x16x32_bf16 a[116:119], a[232:235], v[156:159], a[116:119]
  v_exp_f32 v212, v132
  v_mfma_f32_16x16x32_bf16 a[116:119], a[236:239], v[172:175], a[116:119]
  ds_read_b128 a[216:219], v2 offset:22528
  s_add_u32 s93, s93, s92
  v_cvt_pk_bf16_f32 v250, v210, v211
  v_add_f32 v219, v179, v219
  v_mfma_f32_16x16x32_bf16 a[84:87], a[236:239], v[168:171], a[84:87]
  v_exp_f32 v213, v133
  v_mfma_f32_16x16x32_bf16 a[84:87], a[232:235], v[152:155], a[84:87]
  s_add_u32 s92, s92, 8832
  v_add_f32 v196, v196, v210
  v_add_f32 v196, v196, v211
  v_mfma_f32_16x16x32_bf16 a[52:55], a[232:235], v[148:151], a[52:55]
  s_add_u32 m0, s33, s92
  v_exp_f32 v214, v140
  v_mfma_f32_16x16x32_bf16 a[52:55], a[236:239], v[164:167], a[52:55]
  ds_read_b128 a[220:223], v2 offset:23552
  v_cvt_pk_bf16_f32 v234, v212, v213
  v_mfma_f32_16x16x32_bf16 a[20:23], a[236:239], v[160:163], a[20:23]
  v_exp_f32 v215, v141
  v_mfma_f32_16x16x32_bf16 a[20:23], a[232:235], v[144:147], a[20:23]
  buffer_load_dwordx4 v1, s[60:63], s93 offen offset:0 lds
  buffer_load_dwordx4 v1, s[60:63], s93 offen offset:1024 lds
  v_mfma_f32_16x16x32_bf16 a[24:27], a[240:243], v[144:147], a[24:27]
  v_exp_f32 v208, v118
  v_mfma_f32_16x16x32_bf16 a[24:27], a[244:247], v[160:163], a[24:27]
  ds_read_b128 a[224:227], v2 offset:24576
  v_cvt_pk_bf16_f32 v238, v214, v215
  v_mfma_f32_16x16x32_bf16 a[56:59], a[244:247], v[164:167], a[56:59]
  s_lshl_b32 s64, s2, 2
  v_exp_f32 v209, v119
  v_mfma_f32_16x16x32_bf16 a[56:59], a[240:243], v[148:151], a[56:59]
  s_add_u32 s64, s64, s24
  v_accvgpr_read_b32 v220, a140
  v_add_f32 v220, v176, v220
  v_accvgpr_read_b32 v221, a141
  v_mfma_f32_16x16x32_bf16 a[88:91], a[240:243], v[152:155], a[88:91]
  v_exp_f32 v210, v126
  v_add_f32 v221, v177, v221
  v_mfma_f32_16x16x32_bf16 a[88:91], a[244:247], v[168:171], a[88:91]
  ds_read_b128 a[228:231], v2 offset:25600
  s_sub_u32 s64, s64, 256
  v_cvt_pk_bf16_f32 v247, v208, v209
  v_mfma_f32_16x16x32_bf16 a[120:123], a[244:247], v[172:175], a[120:123]
  v_exp_f32 v211, v127
  v_mfma_f32_16x16x32_bf16 a[120:123], a[240:243], v[156:159], a[120:123]
  s_mul_i32 s65, s64, 4608
  v_add_f32 v192, v192, v208
  v_add_f32 v192, v192, v209
  v_accvgpr_read_b32 v222, a142
  v_mfma_f32_16x16x32_bf16 a[124:127], a[248:251], v[156:159], a[124:127]
  v_exp_f32 v212, v134
  v_mfma_f32_16x16x32_bf16 a[124:127], a[252:255], v[172:175], a[124:127]
  ds_read_b128 a[232:235], v2 offset:26624
  v_cvt_pk_bf16_f32 v251, v210, v211
  v_add_f32 v222, v178, v222
  v_mfma_f32_16x16x32_bf16 a[92:95], a[252:255], v[168:171], a[92:95]
  v_exp_f32 v213, v135
  v_mfma_f32_16x16x32_bf16 a[92:95], a[248:251], v[152:155], a[92:95]
  v_add_f32 v196, v196, v210
  v_add_f32 v196, v196, v211
  v_mfma_f32_16x16x32_bf16 a[60:63], a[248:251], v[148:151], a[60:63]
  v_exp_f32 v214, v142
  v_accvgpr_read_b32 v223, a143
  v_mfma_f32_16x16x32_bf16 a[60:63], a[252:255], v[164:167], a[60:63]
  ds_read_b128 a[236:239], v2 offset:27648
  v_cvt_pk_bf16_f32 v235, v212, v213
  v_mfma_f32_16x16x32_bf16 a[28:31], a[252:255], v[160:163], a[28:31]
  v_exp_f32 v215, v143
  v_mfma_f32_16x16x32_bf16 a[28:31], a[248:251], v[144:147], a[28:31]
  v_min_u32 v195, 35, v0
  v_lshlrev_b32 v195, 7, v195
  v_add_f32 v223, v179, v223
  v_mfma_f32_16x16x32_bf16 v[204:207], v[240:243], v[156:159], v[204:207]
  buffer_load_dword v199, v195, s[60:63], s65 offen
  v_cvt_pk_bf16_f32 v239, v214, v215
  v_mfma_f32_16x16x32_bf16 v[204:207], v[240:243], v[172:175], v[204:207]
  buffer_load_dword v199, v195, s[4:7], s65 offen
  s_waitcnt lgkmcnt(4)
  v_mfma_f32_16x16x32_bf16 v[112:115], a[192:195], v[16:19], v[216:219]
  v_exp_f32 v208, v80
  v_mfma_f32_16x16x32_bf16 v[112:115], a[196:199], v[20:23], v[112:115]
  ds_read_b128 a[240:243], v2 offset:28672
  s_xor_b32 m0, s37, 0x1c000
  v_mfma_f32_16x16x32_bf16 v[112:115], a[200:203], v[24:27], v[112:115]
  v_exp_f32 v209, v81
  v_mfma_f32_16x16x32_bf16 v[112:115], a[204:207], v[28:31], v[112:115]
  buffer_load_dwordx4 v13, s[20:23], s36 offen offset:0 sc1 lds
  v_mfma_f32_16x16x32_bf16 v[120:123], a[204:207], v[44:47], v[180:183]
  v_exp_f32 v210, v88
  v_mfma_f32_16x16x32_bf16 v[120:123], a[200:203], v[40:43], v[120:123]
  ds_read_b128 a[244:247], v2 offset:29696
  v_cvt_pk_bf16_f32 v144, v208, v209
  v_mfma_f32_16x16x32_bf16 v[120:123], a[196:199], v[36:39], v[120:123]
  v_exp_f32 v211, v89
  v_mfma_f32_16x16x32_bf16 v[120:123], a[192:195], v[32:35], v[120:123]
  v_add_f32 v192, v192, v208
  v_add_f32 v192, v192, v209
  v_mfma_f32_16x16x32_bf16 v[128:131], a[192:195], v[48:51], v[184:187]
  v_exp_f32 v212, v96
  v_mfma_f32_16x16x32_bf16 v[128:131], a[196:199], v[52:55], v[128:131]
  ds_read_b128 a[248:251], v2 offset:30720
  v_cvt_pk_bf16_f32 v148, v210, v211
  v_mfma_f32_16x16x32_bf16 v[128:131], a[200:203], v[56:59], v[128:131]
  v_exp_f32 v213, v97
  v_mfma_f32_16x16x32_bf16 v[128:131], a[204:207], v[60:63], v[128:131]
  v_add_f32 v196, v196, v210
  v_add_f32 v196, v196, v211
  v_mfma_f32_16x16x32_bf16 v[136:139], a[204:207], v[76:79], v[188:191]
  v_exp_f32 v214, v104
  v_mfma_f32_16x16x32_bf16 v[136:139], a[200:203], v[72:75], v[136:139]
  ds_read_b128 a[252:255], v2 offset:31744
  v_cvt_pk_bf16_f32 v152, v212, v213
  v_mfma_f32_16x16x32_bf16 v[136:139], a[196:199], v[68:71], v[136:139]
  v_exp_f32 v215, v105
  v_mfma_f32_16x16x32_bf16 v[136:139], a[192:195], v[64:67], v[136:139]
  buffer_load_dwordx4 v13, s[20:23], s36 offen offset:1024 sc1 lds
  v_mfma_f32_16x16x32_bf16 v[116:119], a[208:211], v[16:19], v[220:223]
  v_exp_f32 v208, v82
  v_mfma_f32_16x16x32_bf16 v[116:119], a[212:215], v[20:23], v[116:119]
  ds_read_b128 a[192:195], v2 offset:32768
  v_cvt_pk_bf16_f32 v156, v214, v215
  v_mfma_f32_16x16x32_bf16 v[116:119], a[216:219], v[24:27], v[116:119]
  v_exp_f32 v209, v83
  v_mfma_f32_16x16x32_bf16 v[116:119], a[220:223], v[28:31], v[116:119]
  buffer_load_dwordx4 v13, s[20:23], s36 offen offset:2048 sc1 lds
  v_mfma_f32_16x16x32_bf16 v[124:127], a[220:223], v[44:47], v[180:183]
  v_exp_f32 v210, v90
  v_mfma_f32_16x16x32_bf16 v[124:127], a[216:219], v[40:43], v[124:127]
  ds_read_b128 a[196:199], v2 offset:33792
  v_cvt_pk_bf16_f32 v145, v208, v209
  v_mfma_f32_16x16x32_bf16 v[124:127], a[212:215], v[36:39], v[124:127]
  v_exp_f32 v211, v91
  v_mfma_f32_16x16x32_bf16 v[124:127], a[208:211], v[32:35], v[124:127]
  v_add_f32 v192, v192, v208
  v_add_f32 v192, v192, v209
  v_mfma_f32_16x16x32_bf16 v[132:135], a[208:211], v[48:51], v[184:187]
  v_exp_f32 v212, v98
  v_mfma_f32_16x16x32_bf16 v[132:135], a[212:215], v[52:55], v[132:135]
  ds_read_b128 a[200:203], v2 offset:34816
  v_cvt_pk_bf16_f32 v149, v210, v211
  v_mfma_f32_16x16x32_bf16 v[132:135], a[216:219], v[56:59], v[132:135]
  v_exp_f32 v213, v99
  v_mfma_f32_16x16x32_bf16 v[132:135], a[220:223], v[60:63], v[132:135]
  v_add_f32 v196, v196, v210
  v_add_f32 v196, v196, v211
  v_mfma_f32_16x16x32_bf16 v[140:143], a[220:223], v[76:79], v[188:191]
  v_exp_f32 v214, v106
  v_mfma_f32_16x16x32_bf16 v[140:143], a[216:219], v[72:75], v[140:143]
  ds_read_b128 a[204:207], v2 offset:35840
  v_cvt_pk_bf16_f32 v153, v212, v213
  v_mfma_f32_16x16x32_bf16 v[140:143], a[212:215], v[68:71], v[140:143]
  v_exp_f32 v215, v107
  v_mfma_f32_16x16x32_bf16 v[140:143], a[208:211], v[64:67], v[140:143]
  buffer_load_dwordx4 v13, s[20:23], s36 offen offset:3072 sc1 lds
  s_waitcnt lgkmcnt(4)
  v_accvgpr_read_b32 v216, a128
  v_add_f32 v216, v180, v216
  v_mfma_f32_16x16x32_bf16 a[0:3], a[224:227], v[4:7], a[0:3]
  v_exp_f32 v208, v84
  v_mfma_f32_16x16x32_bf16 a[0:3], a[228:231], v[244:247], a[0:3]
  ds_read_b128 a[208:211], v2 offset:36864
  v_cvt_pk_bf16_f32 v157, v214, v215
  v_mfma_f32_16x16x32_bf16 a[32:35], a[228:231], v[248:251], a[32:35]
  v_exp_f32 v209, v85
  v_mfma_f32_16x16x32_bf16 a[32:35], a[224:227], v[8:11], a[32:35]
  v_accvgpr_read_b32 v217, a129
  v_add_f32 v217, v181, v217
  v_accvgpr_read_b32 v218, a130
  v_mfma_f32_16x16x32_bf16 a[64:67], a[224:227], v[224:227], a[64:67]
  s_lshl_b32 s65, s65, 1
  v_exp_f32 v210, v92
  v_add_f32 v218, v182, v218
  v_mfma_f32_16x16x32_bf16 a[64:67], a[228:231], v[232:235], a[64:67]
  ds_read_b128 a[212:215], v2 offset:37888
  v_cvt_pk_bf16_f32 v146, v208, v209
  v_mfma_f32_16x16x32_bf16 a[96:99], a[228:231], v[236:239], a[96:99]
  v_exp_f32 v211, v93
  v_mfma_f32_16x16x32_bf16 a[96:99], a[224:227], v[228:231], a[96:99]
  v_add_f32 v192, v192, v208
  v_add_f32 v192, v192, v209
  v_mfma_f32_16x16x32_bf16 a[100:103], a[232:235], v[228:231], a[100:103]
  v_exp_f32 v212, v100
  v_mfma_f32_16x16x32_bf16 a[100:103], a[236:239], v[236:239], a[100:103]
  ds_read_b128 a[216:219], v2 offset:38912
  v_cvt_pk_bf16_f32 v150, v210, v211
  v_mfma_f32_16x16x32_bf16 a[68:71], a[236:239], v[232:235], a[68:71]
  v_exp_f32 v213, v101
  v_mfma_f32_16x16x32_bf16 a[68:71], a[232:235], v[224:227], a[68:71]
  v_add_f32 v196, v196, v210
  v_add_f32 v196, v196, v211
  v_mfma_f32_16x16x32_bf16 a[36:39], a[232:235], v[8:11], a[36:39]
  v_exp_f32 v214, v108
  v_mfma_f32_16x16x32_bf16 a[36:39], a[236:239], v[248:251], a[36:39]
  ds_read_b128 a[220:223], v2 offset:39936
  v_cvt_pk_bf16_f32 v154, v212, v213
  v_mfma_f32_16x16x32_bf16 a[4:7], a[236:239], v[244:247], a[4:7]
  v_exp_f32 v215, v109
  v_mfma_f32_16x16x32_bf16 a[4:7], a[232:235], v[4:7], a[4:7]
  buffer_load_dword v199, v195, s[16:19], s65 offen
  v_accvgpr_read_b32 v219, a131
  v_add_f32 v219, v183, v219
  v_mfma_f32_16x16x32_bf16 a[8:11], a[240:243], v[4:7], a[8:11]
  v_exp_f32 v208, v86
  v_mfma_f32_16x16x32_bf16 a[8:11], a[244:247], v[244:247], a[8:11]
  ds_read_b128 a[224:227], v2 offset:40960
  v_cvt_pk_bf16_f32 v158, v214, v215
  v_mfma_f32_16x16x32_bf16 a[40:43], a[244:247], v[248:251], a[40:43]
  s_add_u32 s65, s65, 4608
  v_exp_f32 v209, v87
  v_mfma_f32_16x16x32_bf16 a[40:43], a[240:243], v[8:11], a[40:43]
  v_accvgpr_read_b32 v220, a132
  v_add_f32 v220, v180, v220
  v_accvgpr_read_b32 v221, a133
  v_mfma_f32_16x16x32_bf16 a[72:75], a[240:243], v[224:227], a[72:75]
  v_exp_f32 v210, v94
  v_add_f32 v221, v181, v221
  v_mfma_f32_16x16x32_bf16 a[72:75], a[244:247], v[232:235], a[72:75]
  ds_read_b128 a[228:231], v2 offset:41984
  v_cvt_pk_bf16_f32 v147, v208, v209
  v_mfma_f32_16x16x32_bf16 a[104:107], a[244:247], v[236:239], a[104:107]
  v_exp_f32 v211, v95
  v_mfma_f32_16x16x32_bf16 a[104:107], a[240:243], v[228:231], a[104:107]
  v_add_f32 v192, v192, v208
  v_add_f32 v192, v192, v209
  v_mfma_f32_16x16x32_bf16 a[108:111], a[248:251], v[228:231], a[108:111]
  v_exp_f32 v212, v102
  v_mfma_f32_16x16x32_bf16 a[108:111], a[252:255], v[236:239], a[108:111]
  ds_read_b128 a[232:235], v2 offset:43008
  v_cvt_pk_bf16_f32 v151, v210, v211
  v_mfma_f32_16x16x32_bf16 a[76:79], a[252:255], v[232:235], a[76:79]
  v_exp_f32 v213, v103
  v_mfma_f32_16x16x32_bf16 a[76:79], a[248:251], v[224:227], a[76:79]
  v_add_f32 v196, v196, v210
  v_add_f32 v196, v196, v211
  v_mfma_f32_16x16x32_bf16 a[44:47], a[248:251], v[8:11], a[44:47]
  v_exp_f32 v214, v110
  v_mfma_f32_16x16x32_bf16 a[44:47], a[252:255], v[248:251], a[44:47]
  ds_read_b128 a[236:239], v2 offset:44032
  v_cvt_pk_bf16_f32 v155, v212, v213
  v_mfma_f32_16x16x32_bf16 a[12:15], a[252:255], v[244:247], a[12:15]
  v_exp_f32 v215, v111
  v_mfma_f32_16x16x32_bf16 a[12:15], a[248:251], v[4:7], a[12:15]
  buffer_load_dword v199, v195, s[16:19], s65 offen
  v_accvgpr_read_b32 v222, a134
  v_mfma_f32_16x16x32_bf16 v[200:203], v[240:243], v[224:227], v[200:203]
  v_cvt_pk_bf16_f32 v159, v214, v215
  v_add_f32 v222, v182, v222
  v_accvgpr_read_b32 v223, a135
  v_add_f32 v223, v183, v223
  v_mfma_f32_16x16x32_bf16 v[200:203], v[240:243], v[232:235], v[200:203]
  s_waitcnt vmcnt(21) lgkmcnt(4)
  s_barrier
  v_mfma_f32_16x16x32_bf16 v[88:91], a[192:195], v[32:35], v[216:219]
  v_exp_f32 v208, v112
  v_mfma_f32_16x16x32_bf16 v[88:91], a[196:199], v[36:39], v[88:91]
  s_mov_b32 m0, s37
  v_exp_f32 v209, v113
  v_mfma_f32_16x16x32_bf16 v[88:91], a[200:203], v[40:43], v[88:91]
  ds_read_b128 a[240:243], v2 offset:45056
  v_mfma_f32_16x16x32_bf16 v[88:91], a[204:207], v[44:47], v[88:91]
  v_exp_f32 v210, v120
  v_mfma_f32_16x16x32_bf16 v[96:99], a[204:207], v[60:63], v[184:187]
  ds_read_b128 a[244:247], v2 offset:46080
  v_cvt_pk_bf16_f32 v160, v208, v209
  v_mfma_f32_16x16x32_bf16 v[96:99], a[200:203], v[56:59], v[96:99]
  v_exp_f32 v211, v121
  v_mfma_f32_16x16x32_bf16 v[96:99], a[196:199], v[52:55], v[96:99]
  v_add_f32 v192, v192, v208
  v_add_f32 v192, v192, v209
  v_mfma_f32_16x16x32_bf16 v[96:99], a[192:195], v[48:51], v[96:99]
  v_exp_f32 v212, v128
  v_mfma_f32_16x16x32_bf16 v[104:107], a[192:195], v[64:67], v[188:191]
  ds_read_b128 a[248:251], v2 offset:47104
  v_cvt_pk_bf16_f32 v164, v210, v211
  v_mfma_f32_16x16x32_bf16 v[104:107], a[196:199], v[68:71], v[104:107]
  v_exp_f32 v213, v129
  v_mfma_f32_16x16x32_bf16 v[104:107], a[200:203], v[72:75], v[104:107]
  v_add_f32 v196, v196, v210
  v_add_f32 v196, v196, v211
  v_mfma_f32_16x16x32_bf16 v[104:107], a[204:207], v[76:79], v[104:107]
  v_exp_f32 v214, v136
  v_mfma_f32_16x16x32_bf16 v[92:95], a[208:211], v[32:35], v[220:223]
  ds_read_b128 a[252:255], v2 offset:48128
  buffer_load_dwordx4 v14, s[20:23], s36 offen offset:0 sc1 lds
  v_cvt_pk_bf16_f32 v168, v212, v213
  v_mfma_f32_16x16x32_bf16 v[92:95], a[212:215], v[36:39], v[92:95]
  v_exp_f32 v215, v137
  v_mfma_f32_16x16x32_bf16 v[92:95], a[216:219], v[40:43], v[92:95]
  v_exp_f32 v208, v114
  v_mfma_f32_16x16x32_bf16 v[92:95], a[220:223], v[44:47], v[92:95]
  ds_read_b128 a[192:195], v2 offset:49152
  v_cvt_pk_bf16_f32 v172, v214, v215
  v_mfma_f32_16x16x32_bf16 v[100:103], a[220:223], v[60:63], v[184:187]
  v_exp_f32 v209, v115
  v_mfma_f32_16x16x32_bf16 v[100:103], a[216:219], v[56:59], v[100:103]
  v_exp_f32 v210, v122
  v_mfma_f32_16x16x32_bf16 v[100:103], a[212:215], v[52:55], v[100:103]
  ds_read_b128 a[196:199], v2 offset:50176
  v_cvt_pk_bf16_f32 v161, v208, v209
  v_accvgpr_read_b32 v216, a136
  v_mfma_f32_16x16x32_bf16 v[100:103], a[208:211], v[48:51], v[100:103]
  v_exp_f32 v211, v123
  v_mfma_f32_16x16x32_bf16 v[108:111], a[208:211], v[64:67], v[188:191]
  v_add_f32 v192, v192, v208
  v_add_f32 v192, v192, v209
  v_add_f32 v216, v180, v216
  v_mfma_f32_16x16x32_bf16 v[108:111], a[212:215], v[68:71], v[108:111]
  v_exp_f32 v212, v130
  v_mfma_f32_16x16x32_bf16 v[108:111], a[216:219], v[72:75], v[108:111]
  ds_read_b128 a[200:203], v2 offset:51200
  v_cvt_pk_bf16_f32 v165, v210, v211
K_hA0_12:
  s_cbranch_execz K_hA0_13
  v_mfma_f32_16x16x32_bf16 v[108:111], a[220:223], v[76:79], v[108:111]
  buffer_load_dwordx4 v14, s[20:23], s36 offen offset:1024 sc1 lds
  s_waitcnt lgkmcnt(3)
  v_exp_f32 v213, v131
  v_accvgpr_read_b32 v217, a137
  v_mfma_f32_16x16x32_bf16 a[16:19], a[224:227], v[4:7], a[16:19]
  v_add_f32 v196, v196, v210
  v_add_f32 v196, v196, v211
  v_mfma_f32_16x16x32_bf16 a[16:19], a[228:231], v[244:247], a[16:19]
  v_exp_f32 v214, v138
  v_add_f32 v217, v181, v217
  v_mfma_f32_16x16x32_bf16 a[48:51], a[228:231], v[248:251], a[48:51]
  ds_read_b128 a[204:207], v2 offset:52224
  v_cvt_pk_bf16_f32 v169, v212, v213
  v_mfma_f32_16x16x32_bf16 a[48:51], a[224:227], v[8:11], a[48:51]
  v_exp_f32 v215, v139
  v_mfma_f32_16x16x32_bf16 a[80:83], a[224:227], v[224:227], a[80:83]
  v_exp_f32 v208, v116
  v_accvgpr_read_b32 v218, a138
  v_mfma_f32_16x16x32_bf16 a[80:83], a[228:231], v[232:235], a[80:83]
  ds_read_b128 a[208:211], v2 offset:53248
  v_cvt_pk_bf16_f32 v173, v214, v215
  v_mfma_f32_16x16x32_bf16 a[112:115], a[228:231], v[236:239], a[112:115]
  v_exp_f32 v209, v117
  v_add_f32 v218, v182, v218
  v_mfma_f32_16x16x32_bf16 a[112:115], a[224:227], v[228:231], a[112:115]
  v_exp_f32 v210, v124
  v_mfma_f32_16x16x32_bf16 a[116:119], a[232:235], v[228:231], a[116:119]
  ds_read_b128 a[212:215], v2 offset:54272
  v_cvt_pk_bf16_f32 v162, v208, v209
  v_mfma_f32_16x16x32_bf16 a[116:119], a[236:239], v[236:239], a[116:119]
  v_exp_f32 v211, v125
  v_accvgpr_read_b32 v219, a139
  v_mfma_f32_16x16x32_bf16 a[84:87], a[236:239], v[232:235], a[84:87]
  buffer_load_dwordx4 v14, s[20:23], s36 offen offset:2048 sc1 lds
  v_add_f32 v192, v192, v208
  v_add_f32 v192, v192, v209
  v_mfma_f32_16x16x32_bf16 a[84:87], a[232:235], v[224:227], a[84:87]
  v_exp_f32 v212, v132
  v_add_f32 v219, v183, v219
  v_mfma_f32_16x16x32_bf16 a[52:55], a[232:235], v[8:11], a[52:55]
  ds_read_b128 a[216:219], v2 offset:55296
  v_cvt_pk_bf16_f32 v166, v210, v211
  v_mfma_f32_16x16x32_bf16 a[52:55], a[236:239], v[248:251], a[52:55]
  v_exp_f32 v213, v133
  v_mfma_f32_16x16x32_bf16 a[20:23], a[236:239], v[244:247], a[20:23]
  v_add_f32 v196, v196, v210
  v_add_f32 v196, v196, v211
  v_accvgpr_read_b32 v220, a140
  v_mfma_f32_16x16x32_bf16 a[20:23], a[232:235], v[4:7], a[20:23]
  v_exp_f32 v214, v140
  v_mfma_f32_16x16x32_bf16 a[24:27], a[240:243], v[4:7], a[24:27]
  ds_read_b128 a[220:223], v2 offset:56320
  v_cvt_pk_bf16_f32 v170, v212, v213
  v_add_f32 v220, v180, v220
  v_mfma_f32_16x16x32_bf16 a[24:27], a[244:247], v[244:247], a[24:27]
  v_exp_f32 v215, v141
  v_mfma_f32_16x16x32_bf16 a[56:59], a[244:247], v[248:251], a[56:59]
  v_exp_f32 v208, v118
  v_mfma_f32_16x16x32_bf16 a[56:59], a[240:243], v[8:11], a[56:59]
  ds_read_b128 a[224:227], v2 offset:57344
  v_cvt_pk_bf16_f32 v174, v214, v215
  v_accvgpr_read_b32 v221, a141
  v_mfma_f32_16x16x32_bf16 a[88:91], a[240:243], v[224:227], a[88:91]
  v_exp_f32 v209, v119
  v_mfma_f32_16x16x32_bf16 a[88:91], a[244:247], v[232:235], a[88:91]
  buffer_load_dwordx4 v14, s[20:23], s36 offen offset:3072 sc1 lds
  v_exp_f32 v210, v126
  v_add_f32 v221, v181, v221
  v_mfma_f32_16x16x32_bf16 a[120:123], a[244:247], v[236:239], a[120:123]
  ds_read_b128 a[228:231], v2 offset:58368
  v_cvt_pk_bf16_f32 v163, v208, v209
  v_mfma_f32_16x16x32_bf16 a[120:123], a[240:243], v[228:231], a[120:123]
  v_exp_f32 v211, v127
  v_mfma_f32_16x16x32_bf16 a[124:127], a[248:251], v[228:231], a[124:127]
  v_add_f32 v192, v192, v208
  v_add_f32 v192, v192, v209
  v_mfma_f32_16x16x32_bf16 a[124:127], a[252:255], v[236:239], a[124:127]
  v_exp_f32 v212, v134
  v_mfma_f32_16x16x32_bf16 a[92:95], a[252:255], v[232:235], a[92:95]
  ds_read_b128 a[232:235], v2 offset:59392
  v_cvt_pk_bf16_f32 v167, v210, v211
  v_mfma_f32_16x16x32_bf16 a[92:95], a[248:251], v[224:227], a[92:95]
  v_exp_f32 v213, v135
  v_mfma_f32_16x16x32_bf16 a[60:63], a[248:251], v[8:11], a[60:63]
  v_add_f32 v196, v196, v210
  v_add_f32 v196, v196, v211
  v_mfma_f32_16x16x32_bf16 a[60:63], a[252:255], v[248:251], a[60:63]
  v_exp_f32 v214, v142
  v_mfma_f32_16x16x32_bf16 a[28:31], a[252:255], v[244:247], a[28:31]
  ds_read_b128 a[236:239], v2 offset:60416
  v_cvt_pk_bf16_f32 v171, v212, v213
  v_mfma_f32_16x16x32_bf16 a[28:31], a[248:251], v[4:7], a[28:31]
  v_exp_f32 v215, v143
  v_mfma_f32_16x16x32_bf16 v[204:207], v[240:243], v[228:231], v[204:207]
  v_cvt_pk_bf16_f32 v175, v214, v215
  v_accvgpr_read_b32 v222, a142
  v_add_f32 v222, v182, v222
  v_accvgpr_read_b32 v223, a143
  v_add_f32 v223, v183, v223
  v_mfma_f32_16x16x32_bf16 v[204:207], v[240:243], v[236:239], v[204:207]
  s_branch K_T3
K_FP:
K_hA1_12:
  s_cbranch_execz K_hAr
  s_waitcnt vmcnt(12) lgkmcnt(4)
  s_barrier
  v_mfma_f32_16x16x32_bf16 v[96:99], a[192:195], v[48:51], v[216:219]
  v_exp_f32 v208, v120
  v_mfma_f32_16x16x32_bf16 v[96:99], a[196:199], v[52:55], v[96:99]
  ds_read_b128 a[240:243], v2 offset:12288
  s_mov_b32 s27, 66195456
  v_lshlrev_b32 v3, 6, v0
  v_and_b32 v3, 0xf80, v3
  v_and_b32 v195, 16, v1
  v_add_u32 v3, v3, v195
  buffer_load_dwordx4 a[160:163], v3, s[20:23], s27 offen sc1
  v_mfma_f32_16x16x32_bf16 v[96:99], a[200:203], v[56:59], v[96:99]
  s_xor_b32 m0, s37, 0x18000
  v_exp_f32 v209, v121
  v_mfma_f32_16x16x32_bf16 v[96:99], a[204:207], v[60:63], v[96:99]
  ds_read_b128 a[244:247], v2 offset:13312
  buffer_load_dwordx4 v1, s[20:23], s36 offen offset:0 sc1 lds
  v_mfma_f32_16x16x32_bf16 v[104:107], a[204:207], v[76:79], v[188:191]
  v_exp_f32 v210, v128
  v_mfma_f32_16x16x32_bf16 v[104:107], a[200:203], v[72:75], v[104:107]
  ds_read_b128 a[248:251], v2 offset:14336
  v_cvt_pk_bf16_f32 v248, v208, v209
  v_mfma_f32_16x16x32_bf16 v[104:107], a[196:199], v[68:71], v[104:107]
  buffer_load_dwordx4 v1, s[20:23], s36 offen offset:1024 sc1 lds
  v_exp_f32 v211, v129
  v_mfma_f32_16x16x32_bf16 v[104:107], a[192:195], v[64:67], v[104:107]
  v_add_f32 v196, v196, v208
  v_add_f32 v196, v196, v209
  v_mfma_f32_16x16x32_bf16 v[100:103], a[208:211], v[48:51], v[220:223]
  v_exp_f32 v212, v136
  v_mfma_f32_16x16x32_bf16 v[100:103], a[212:215], v[52:55], v[100:103]
  ds_read_b128 a[252:255], v2 offset:15360
  v_cvt_pk_bf16_f32 v232, v210, v211
  v_mfma_f32_16x16x32_bf16 v[100:103], a[216:219], v[56:59], v[100:103]
  v_exp_f32 v213, v137
  v_mfma_f32_16x16x32_bf16 v[100:103], a[220:223], v[60:63], v[100:103]
  ds_read_b128 a[192:195], v2 offset:16384
  ds_read_b128 a[196:199], v2 offset:17408
  v_mfma_f32_16x16x32_bf16 v[108:111], a[220:223], v[76:79], v[188:191]
  v_exp_f32 v214, v122
  v_mfma_f32_16x16x32_bf16 v[108:111], a[216:219], v[72:75], v[108:111]
  ds_read_b128 a[200:203], v2 offset:18432
  v_cvt_pk_bf16_f32 v236, v212, v213
  v_accvgpr_read_b32 v216, a136
  v_mfma_f32_16x16x32_bf16 v[108:111], a[212:215], v[68:71], v[108:111]
  v_exp_f32 v215, v123
  v_mfma_f32_16x16x32_bf16 v[108:111], a[208:211], v[64:67], v[108:111]
  ds_read_b128 a[204:207], v2 offset:19456
  buffer_load_dwordx4 v1, s[20:23], s36 offen offset:2048 sc1 lds
  buffer_load_dwordx4 v1, s[20:23], s36 offen offset:3072 sc1 lds
  s_waitcnt lgkmcnt(4)
  v_add_f32 v216, v184, v216
  v_mfma_f32_16x16x32_bf16 a[16:19], a[224:227], v[144:147], a[16:19]
  s_lshl_b32 s64, s25, 3
  v_exp_f32 v208, v130
  v_mfma_f32_16x16x32_bf16 a[16:19], a[228:231], v[160:163], a[16:19]
  ds_read_b128 a[208:211], v2 offset:20480
  s_add_u32 s64, s64, s26
  v_cvt_pk_bf16_f32 v249, v214, v215
  v_accvgpr_read_b32 v217, a137
  v_mfma_f32_16x16x32_bf16 a[48:51], a[228:231], v[164:167], a[48:51]
  s_lshl_b32 s64, s64, 2
  v_exp_f32 v209, v131
  v_mfma_f32_16x16x32_bf16 a[48:51], a[224:227], v[148:151], a[48:51]
  s_add_u32 s64, s64, s24
  v_add_f32 v196, v196, v214
  v_add_f32 v196, v196, v215
  v_mfma_f32_16x16x32_bf16 a[80:83], a[224:227], v[152:155], a[80:83]
  s_mul_i32 s64, s64, 4608
  v_exp_f32 v210, v138
  v_mfma_f32_16x16x32_bf16 a[80:83], a[228:231], v[168:171], a[80:83]
  ds_read_b128 a[212:215], v2 offset:21504
  v_cvt_pk_bf16_f32 v233, v208, v209
  v_mfma_f32_16x16x32_bf16 a[112:115], a[228:231], v[172:175], a[112:115]
  v_exp_f32 v211, v139
  v_mfma_f32_16x16x32_bf16 a[112:115], a[224:227], v[156:159], a[112:115]
  v_min_u32 v13, 35, v0
  v_lshlrev_b32 v13, 7, v13
  v_mfma_f32_16x16x32_bf16 a[116:119], a[232:235], v[156:159], a[116:119]
  v_exp_f32 v212, v124
  v_mfma_f32_16x16x32_bf16 a[116:119], a[236:239], v[172:175], a[116:119]
  ds_read_b128 a[216:219], v2 offset:22528
  v_cvt_pk_bf16_f32 v237, v210, v211
  v_mfma_f32_16x16x32_bf16 a[84:87], a[236:239], v[168:171], a[84:87]
  v_exp_f32 v213, v125
  v_mfma_f32_16x16x32_bf16 a[84:87], a[232:235], v[152:155], a[84:87]
  buffer_load_dword v199, v13, s[16:19], s64 offen
  v_add_f32 v217, v185, v217
  v_accvgpr_read_b32 v218, a138
  v_add_f32 v218, v186, v218
  v_accvgpr_read_b32 v219, a139
  v_mfma_f32_16x16x32_bf16 a[52:55], a[232:235], v[148:151], a[52:55]
  v_exp_f32 v214, v132
  v_mfma_f32_16x16x32_bf16 a[52:55], a[236:239], v[164:167], a[52:55]
  ds_read_b128 a[220:223], v2 offset:23552
  v_cvt_pk_bf16_f32 v250, v212, v213
  v_add_f32 v219, v187, v219
  v_mfma_f32_16x16x32_bf16 a[20:23], a[236:239], v[160:163], a[20:23]
  v_exp_f32 v215, v133
  v_mfma_f32_16x16x32_bf16 a[20:23], a[232:235], v[144:147], a[20:23]
  v_add_f32 v196, v196, v212
  v_add_f32 v196, v196, v213
  v_accvgpr_read_b32 v220, a140
  v_mfma_f32_16x16x32_bf16 a[24:27], a[240:243], v[144:147], a[24:27]
  v_exp_f32 v208, v140
  v_mfma_f32_16x16x32_bf16 a[24:27], a[244:247], v[160:163], a[24:27]
  ds_read_b128 a[224:227], v2 offset:24576
  v_cvt_pk_bf16_f32 v234, v214, v215
  v_add_f32 v220, v184, v220
  v_mfma_f32_16x16x32_bf16 a[56:59], a[244:247], v[164:167], a[56:59]
  v_exp_f32 v209, v141
  v_mfma_f32_16x16x32_bf16 a[56:59], a[240:243], v[148:151], a[56:59]
  s_getpc_b64 s[92:93]
K_pcmc:
  s_add_u32 s92, s92, K_tail-K_pcmc
  s_addc_u32 s93, s93, -1
  v_mfma_f32_16x16x32_bf16 a[88:91], a[240:243], v[152:155], a[88:91]
  s_lshr_b32 s65, s2, 1
  v_exp_f32 v210, v126
  v_accvgpr_read_b32 v221, a141
  v_mfma_f32_16x16x32_bf16 a[88:91], a[244:247], v[168:171], a[88:91]
  ds_read_b128 a[228:231], v2 offset:25600
  s_and_b32 s65, s65, 0x7c
  v_cvt_pk_bf16_f32 v238, v208, v209
  v_mfma_f32_16x16x32_bf16 a[120:123], a[244:247], v[172:175], a[120:123]
  s_add_u32 s65, s65, s24
  v_exp_f32 v211, v127
  v_add_f32 v221, v185, v221
  v_mfma_f32_16x16x32_bf16 a[120:123], a[240:243], v[156:159], a[120:123]
  s_mul_i32 s65, s65, 3
  v_min_u32 v15, 2, v0
  v_add_u32 v15, s65, v15
  v_mfma_f32_16x16x32_bf16 a[124:127], a[248:251], v[156:159], a[124:127]
  v_exp_f32 v212, v134
  v_accvgpr_read_b32 v222, a142
  v_mfma_f32_16x16x32_bf16 a[124:127], a[252:255], v[172:175], a[124:127]
  ds_read_b128 a[232:235], v2 offset:26624
  v_cvt_pk_bf16_f32 v251, v210, v211
  v_mfma_f32_16x16x32_bf16 a[92:95], a[252:255], v[168:171], a[92:95]
  v_exp_f32 v213, v135
  v_mfma_f32_16x16x32_bf16 a[92:95], a[248:251], v[152:155], a[92:95]
  v_add_f32 v196, v196, v210
  v_add_f32 v196, v196, v211
  v_mfma_f32_16x16x32_bf16 a[60:63], a[248:251], v[148:151], a[60:63]
  v_exp_f32 v214, v142
  v_mfma_f32_16x16x32_bf16 a[60:63], a[252:255], v[164:167], a[60:63]
  ds_read_b128 a[236:239], v2 offset:27648
  v_cvt_pk_bf16_f32 v235, v212, v213
  v_mfma_f32_16x16x32_bf16 a[28:31], a[252:255], v[160:163], a[28:31]
  v_exp_f32 v215, v143
  v_mfma_f32_16x16x32_bf16 a[28:31], a[248:251], v[144:147], a[28:31]
  v_min_u32 v15, (K_last-K_tail)/128-1, v15
  v_lshlrev_b32 v15, 7, v15
  v_mfma_f32_16x16x32_bf16 v[204:207], v[240:243], v[156:159], v[204:207]
  global_load_dword v199, v15, s[92:93]
  v_cvt_pk_bf16_f32 v239, v214, v215
  v_mfma_f32_16x16x32_bf16 v[204:207], v[240:243], v[172:175], v[204:207]
  v_add_f32 v222, v186, v222
  v_accvgpr_read_b32 v223, a143
  v_add_f32 v223, v187, v223
  s_waitcnt lgkmcnt(4)
  v_mfma_f32_16x16x32_bf16 v[128:131], a[192:195], v[48:51], v[216:219]
  v_exp_f32 v208, v96
  v_mfma_f32_16x16x32_bf16 v[128:131], a[196:199], v[52:55], v[128:131]
  ds_read_b128 a[240:243], v2 offset:28672
  v_mov_b32 v176, 0
  v_mfma_f32_16x16x32_bf16 v[128:131], a[200:203], v[56:59], v[128:131]
  v_exp_f32 v209, v97
  v_mfma_f32_16x16x32_bf16 v[128:131], a[204:207], v[60:63], v[128:131]
  ds_read_b128 a[244:247], v2 offset:29696
  v_mov_b32 v177, 0
  v_mfma_f32_16x16x32_bf16 v[136:139], a[204:207], v[76:79], v[188:191]
  v_mov_b32 v178, 0
  v_mfma_f32_16x16x32_bf16 v[136:139], a[200:203], v[72:75], v[136:139]
  v_exp_f32 v210, v104
  v_mfma_f32_16x16x32_bf16 v[136:139], a[196:199], v[68:71], v[136:139]
  ds_read_b128 a[248:251], v2 offset:30720
  v_cvt_pk_bf16_f32 v152, v208, v209
  v_mfma_f32_16x16x32_bf16 v[136:139], a[192:195], v[64:67], v[136:139]
  v_exp_f32 v211, v105
  v_mfma_f32_16x16x32_bf16 v[132:135], a[208:211], v[48:51], v[220:223]
  ds_read_b128 a[252:255], v2 offset:31744
  v_mov_b32 v179, 0
  v_mfma_f32_16x16x32_bf16 v[132:135], a[212:215], v[52:55], v[132:135]
  ds_read_b128 a[192:195], v2 offset:32768
  v_add_u32 v180, 8256, v1
  v_mfma_f32_16x16x32_bf16 v[132:135], a[216:219], v[56:59], v[132:135]
  v_exp_f32 v212, v98
  v_mfma_f32_16x16x32_bf16 v[132:135], a[220:223], v[60:63], v[132:135]
  ds_read_b128 a[196:199], v2 offset:33792
  v_cvt_pk_bf16_f32 v156, v210, v211
  v_mfma_f32_16x16x32_bf16 v[140:143], a[220:223], v[76:79], v[188:191]
  v_exp_f32 v213, v99
  v_mfma_f32_16x16x32_bf16 v[140:143], a[216:219], v[72:75], v[140:143]
  ds_read_b128 a[200:203], v2 offset:34816
  v_accvgpr_read_b32 v216, a128
  v_mfma_f32_16x16x32_bf16 v[140:143], a[212:215], v[68:71], v[140:143]
  v_add_f32 v216, v188, v216
  v_and_b32 v181, 48, v1
  v_mfma_f32_16x16x32_bf16 v[140:143], a[208:211], v[64:67], v[140:143]
  s_waitcnt lgkmcnt(3)
  v_exp_f32 v214, v106
  v_add_u32 v181, 4096, v181
  v_mfma_f32_16x16x32_bf16 a[32:35], a[224:227], v[8:11], a[32:35]
  ds_read_b128 a[204:207], v2 offset:35840
  v_cvt_pk_bf16_f32 v153, v212, v213
  v_mfma_f32_16x16x32_bf16 a[32:35], a[228:231], v[248:251], a[32:35]
  v_exp_f32 v215, v107
  v_mfma_f32_16x16x32_bf16 a[64:67], a[228:231], v[232:235], a[64:67]
  ds_read_b128 a[208:211], v2 offset:36864
  v_accvgpr_read_b32 v217, a129
  v_cmp_gt_u32 vcc, 36, v0
  s_nop 1
  v_cndmask_b32 v180, v181, v180, vcc
  v_mfma_f32_16x16x32_bf16 a[64:67], a[224:227], v[224:227], a[64:67]
  v_add_f32 v217, v189, v217
  v_accvgpr_read_b32 v218, a130
  v_mfma_f32_16x16x32_bf16 a[96:99], a[224:227], v[228:231], a[96:99]
  v_exp_f32 v208, v100
  v_add_u32 v180, s33, v180
  v_mfma_f32_16x16x32_bf16 a[96:99], a[228:231], v[236:239], a[96:99]
  ds_read_b128 a[212:215], v2 offset:37888
  v_cvt_pk_bf16_f32 v157, v214, v215
  v_mfma_f32_16x16x32_bf16 a[100:103], a[232:235], v[228:231], a[100:103]
  v_exp_f32 v209, v101
  v_mfma_f32_16x16x32_bf16 a[100:103], a[236:239], v[236:239], a[100:103]
  ds_write_b128 v180, v[176:179]
  ds_read_b128 a[216:219], v2 offset:38912
  v_add_f32 v218, v190, v218
  v_mfma_f32_16x16x32_bf16 a[68:71], a[236:239], v[232:235], a[68:71]
  v_accvgpr_read_b32 v219, a131
  v_add_f32 v219, v191, v219
  v_mfma_f32_16x16x32_bf16 a[68:71], a[232:235], v[224:227], a[68:71]
  v_exp_f32 v210, v108
  v_mfma_f32_16x16x32_bf16 a[36:39], a[232:235], v[8:11], a[36:39]
  ds_read_b128 a[220:223], v2 offset:39936
  v_cvt_pk_bf16_f32 v154, v208, v209
  v_mfma_f32_16x16x32_bf16 a[36:39], a[236:239], v[248:251], a[36:39]
  v_exp_f32 v211, v109
  v_mfma_f32_16x16x32_bf16 a[40:43], a[240:243], v[8:11], a[40:43]
  v_accvgpr_read_b32 v220, a132
  v_mfma_f32_16x16x32_bf16 a[40:43], a[244:247], v[248:251], a[40:43]
  ds_read_b128 a[224:227], v2 offset:40960
  v_add_f32 v220, v188, v220
  v_mfma_f32_16x16x32_bf16 a[72:75], a[244:247], v[232:235], a[72:75]
  v_exp_f32 v212, v102
  v_mfma_f32_16x16x32_bf16 a[72:75], a[240:243], v[224:227], a[72:75]
  v_cvt_pk_bf16_f32 v158, v210, v211
  v_accvgpr_read_b32 v221, a133
  v_mfma_f32_16x16x32_bf16 a[104:107], a[240:243], v[228:231], a[104:107]
  v_exp_f32 v213, v103
  v_mfma_f32_16x16x32_bf16 a[104:107], a[244:247], v[236:239], a[104:107]
  ds_read_b128 a[228:231], v2 offset:41984
  v_add_f32 v221, v189, v221
  v_mfma_f32_16x16x32_bf16 a[108:111], a[248:251], v[228:231], a[108:111]
  v_accvgpr_read_b32 v222, a134
  v_mfma_f32_16x16x32_bf16 a[108:111], a[252:255], v[236:239], a[108:111]
  v_exp_f32 v214, v110
  v_mfma_f32_16x16x32_bf16 a[76:79], a[252:255], v[232:235], a[76:79]
  ds_read_b128 a[232:235], v2 offset:43008
  v_cvt_pk_bf16_f32 v155, v212, v213
  v_mfma_f32_16x16x32_bf16 a[76:79], a[248:251], v[224:227], a[76:79]
  v_exp_f32 v215, v111
  v_mfma_f32_16x16x32_bf16 a[44:47], a[248:251], v[8:11], a[44:47]
  ds_read_b128 a[236:239], v2 offset:44032
  v_add_f32 v222, v190, v222
  v_mfma_f32_16x16x32_bf16 a[44:47], a[252:255], v[248:251], a[44:47]
  v_accvgpr_read_b32 v223, a135
  v_mfma_f32_16x16x32_bf16 v[200:203], v[240:243], v[224:227], v[200:203]
  v_cvt_pk_bf16_f32 v159, v214, v215
  v_add_f32 v223, v191, v223
  v_mfma_f32_16x16x32_bf16 v[200:203], v[240:243], v[232:235], v[200:203]
  s_waitcnt vmcnt(6) lgkmcnt(4)
  s_barrier
  v_mfma_f32_16x16x32_bf16 v[104:107], a[192:195], v[64:67], v[216:219]
  v_exp_f32 v208, v128
  v_mfma_f32_16x16x32_bf16 v[104:107], a[196:199], v[68:71], v[104:107]
  ds_read_b128 a[240:243], v2 offset:45056
  ds_read_b128 a[244:247], v2 offset:46080
  v_mfma_f32_16x16x32_bf16 v[104:107], a[200:203], v[72:75], v[104:107]
  v_exp_f32 v209, v129
  v_mfma_f32_16x16x32_bf16 v[104:107], a[204:207], v[76:79], v[104:107]
  ds_read_b128 a[248:251], v2 offset:47104
  ds_read_b128 a[252:255], v2 offset:48128
  v_mfma_f32_16x16x32_bf16 v[108:111], a[208:211], v[64:67], v[220:223]
  v_exp_f32 v210, v136
  v_mfma_f32_16x16x32_bf16 v[108:111], a[212:215], v[68:71], v[108:111]
  ds_read_b128 a[192:195], v2 offset:49152
  v_cvt_pk_bf16_f32 v168, v208, v209
  v_mfma_f32_16x16x32_bf16 v[108:111], a[216:219], v[72:75], v[108:111]
  v_exp_f32 v211, v137
  v_mfma_f32_16x16x32_bf16 v[108:111], a[220:223], v[76:79], v[108:111]
  ds_read_b128 a[196:199], v2 offset:50176
  ds_read_b128 a[200:203], v2 offset:51200
  s_waitcnt lgkmcnt(7)
  v_mfma_f32_16x16x32_bf16 a[48:51], a[224:227], v[8:11], a[48:51]
  v_exp_f32 v212, v130
  v_mfma_f32_16x16x32_bf16 a[48:51], a[228:231], v[248:251], a[48:51]
  ds_read_b128 a[204:207], v2 offset:52224
  v_cvt_pk_bf16_f32 v172, v210, v211
  v_mfma_f32_16x16x32_bf16 a[80:83], a[228:231], v[232:235], a[80:83]
  v_exp_f32 v213, v131
  v_mfma_f32_16x16x32_bf16 a[80:83], a[224:227], v[224:227], a[80:83]
  ds_read_b128 a[208:211], v2 offset:53248
  v_accvgpr_read_b32 v216, a136
  v_mfma_f32_16x16x32_bf16 a[112:115], a[224:227], v[228:231], a[112:115]
  v_exp_f32 v214, v138
  v_mfma_f32_16x16x32_bf16 a[112:115], a[228:231], v[236:239], a[112:115]
  ds_read_b128 a[212:215], v2 offset:54272
  v_cvt_pk_bf16_f32 v169, v212, v213
  v_mfma_f32_16x16x32_bf16 a[116:119], a[232:235], v[228:231], a[116:119]
  v_exp_f32 v215, v139
  v_mfma_f32_16x16x32_bf16 a[116:119], a[236:239], v[236:239], a[116:119]
  ds_read_b128 a[216:219], v2 offset:55296
  v_add_f32 v216, v188, v216
  v_mfma_f32_16x16x32_bf16 a[84:87], a[236:239], v[232:235], a[84:87]
  v_exp_f32 v208, v132
  v_mfma_f32_16x16x32_bf16 a[84:87], a[232:235], v[224:227], a[84:87]
  v_cvt_pk_bf16_f32 v173, v214, v215
  v_accvgpr_read_b32 v217, a137
  v_mfma_f32_16x16x32_bf16 a[52:55], a[232:235], v[8:11], a[52:55]
  v_exp_f32 v209, v133
  v_mfma_f32_16x16x32_bf16 a[52:55], a[236:239], v[248:251], a[52:55]
  ds_read_b128 a[220:223], v2 offset:56320
  s_waitcnt lgkmcnt(8)
  v_add_f32 v217, v189, v217
  v_accvgpr_read_b32 v218, a138
  v_mfma_f32_16x16x32_bf16 a[56:59], a[240:243], v[8:11], a[56:59]
  v_exp_f32 v210, v140
  v_mfma_f32_16x16x32_bf16 a[56:59], a[244:247], v[248:251], a[56:59]
  ds_read_b128 a[224:227], v2 offset:57344
  v_cvt_pk_bf16_f32 v170, v208, v209
  v_mfma_f32_16x16x32_bf16 a[88:91], a[244:247], v[232:235], a[88:91]
  v_exp_f32 v211, v141
  v_mfma_f32_16x16x32_bf16 a[88:91], a[240:243], v[224:227], a[88:91]
  v_add_f32 v218, v190, v218
  v_accvgpr_read_b32 v219, a139
  v_mfma_f32_16x16x32_bf16 a[120:123], a[240:243], v[228:231], a[120:123]
  v_exp_f32 v212, v134
  v_mfma_f32_16x16x32_bf16 a[120:123], a[244:247], v[236:239], a[120:123]
  ds_read_b128 a[228:231], v2 offset:58368
  v_cvt_pk_bf16_f32 v174, v210, v211
  v_mfma_f32_16x16x32_bf16 a[124:127], a[248:251], v[228:231], a[124:127]
  v_exp_f32 v213, v135
  v_mfma_f32_16x16x32_bf16 a[124:127], a[252:255], v[236:239], a[124:127]
  ds_read_b128 a[232:235], v2 offset:59392
  v_add_f32 v219, v191, v219
  v_mfma_f32_16x16x32_bf16 a[92:95], a[252:255], v[232:235], a[92:95]
  v_exp_f32 v214, v142
  v_mfma_f32_16x16x32_bf16 a[92:95], a[248:251], v[224:227], a[92:95]
  v_cvt_pk_bf16_f32 v171, v212, v213
  v_accvgpr_read_b32 v220, a140
  v_add_f32 v220, v188, v220
  v_mfma_f32_16x16x32_bf16 a[60:63], a[248:251], v[8:11], a[60:63]
  v_exp_f32 v215, v143
  v_mfma_f32_16x16x32_bf16 a[60:63], a[252:255], v[248:251], a[60:63]
  ds_read_b128 a[236:239], v2 offset:60416
  v_accvgpr_read_b32 v221, a141
  v_mfma_f32_16x16x32_bf16 v[204:207], v[240:243], v[228:231], v[204:207]
  v_cvt_pk_bf16_f32 v175, v214, v215
  v_add_f32 v221, v189, v221
  v_mfma_f32_16x16x32_bf16 v[204:207], v[240:243], v[236:239], v[204:207]
  v_accvgpr_read_b32 v222, a142
  v_add_f32 v222, v190, v222
  v_accvgpr_read_b32 v223, a143
  v_add_f32 v223, v191, v223
  v_mov_b32 v193, v192
  v_mov_b32 v197, v196
  s_nop 0
  v_permlane16_swap_b32 v192, v193
  v_permlane16_swap_b32 v196, v197
  v_add_f32 v192, v192, v193
  v_add_f32 v196, v196, v197
  v_mov_b32 v193, v192
  v_mov_b32 v197, v196
  s_nop 0
  v_permlane32_swap_b32 v192, v193
  v_permlane32_swap_b32 v196, v197
  v_add_f32 v192, v192, v193
  v_add_f32 v196, v196, v197
  v_rcp_f32 v182, v192
  s_add_u32 s35, s34, 0
  v_mov_b32 v183, v182
  v_accvgpr_read_b32 v144, a0
  v_accvgpr_read_b32 v145, a1
  v_accvgpr_read_b32 v146, a2
  v_accvgpr_read_b32 v147, a3
  v_accvgpr_read_b32 v148, a4
  v_accvgpr_read_b32 v149, a5
  v_accvgpr_read_b32 v150, a6
  v_accvgpr_read_b32 v151, a7
  v_pk_mul_f32 v[144:145], v[144:145], v[182:183]
  v_pk_mul_f32 v[146:147], v[146:147], v[182:183]
  v_pk_mul_f32 v[148:149], v[148:149], v[182:183]
  v_pk_mul_f32 v[150:151], v[150:151], v[182:183]
  v_cvt_pk_bf16_f32 v80, v144, v145
  v_cvt_pk_bf16_f32 v81, v146, v147
  v_cvt_pk_bf16_f32 v82, v148, v149
  v_cvt_pk_bf16_f32 v83, v150, v151
  buffer_store_dwordx4 v[80:83], v1, s[20:23], s35 offen offset:0 sc1
  v_accvgpr_read_b32 v160, a8
  v_accvgpr_read_b32 v161, a9
  v_accvgpr_read_b32 v162, a10
  v_accvgpr_read_b32 v163, a11
  v_accvgpr_read_b32 v164, a12
  v_accvgpr_read_b32 v165, a13
  v_accvgpr_read_b32 v166, a14
  v_accvgpr_read_b32 v167, a15
  v_pk_mul_f32 v[160:161], v[160:161], v[182:183]
  v_pk_mul_f32 v[162:163], v[162:163], v[182:183]
  v_pk_mul_f32 v[164:165], v[164:165], v[182:183]
  v_pk_mul_f32 v[166:167], v[166:167], v[182:183]
  v_cvt_pk_bf16_f32 v84, v160, v161
  v_cvt_pk_bf16_f32 v85, v162, v163
  v_cvt_pk_bf16_f32 v86, v164, v165
  v_cvt_pk_bf16_f32 v87, v166, v167
  buffer_store_dwordx4 v[84:87], v1, s[20:23], s35 offen offset:1024 sc1
  v_accvgpr_read_b32 v144, a16
  v_accvgpr_read_b32 v145, a17
  v_accvgpr_read_b32 v146, a18
  v_accvgpr_read_b32 v147, a19
  v_accvgpr_read_b32 v148, a20
  v_accvgpr_read_b32 v149, a21
  v_accvgpr_read_b32 v150, a22
  v_accvgpr_read_b32 v151, a23
  v_pk_mul_f32 v[144:145], v[144:145], v[182:183]
  v_pk_mul_f32 v[146:147], v[146:147], v[182:183]
  v_pk_mul_f32 v[148:149], v[148:149], v[182:183]
  v_pk_mul_f32 v[150:151], v[150:151], v[182:183]
  v_cvt_pk_bf16_f32 v88, v144, v145
  v_cvt_pk_bf16_f32 v89, v146, v147
  v_cvt_pk_bf16_f32 v90, v148, v149
  v_cvt_pk_bf16_f32 v91, v150, v151
  buffer_store_dwordx4 v[88:91], v1, s[20:23], s35 offen offset:2048 sc1
  v_accvgpr_read_b32 v160, a24
  v_accvgpr_read_b32 v161, a25
  v_accvgpr_read_b32 v162, a26
  v_accvgpr_read_b32 v163, a27
  v_accvgpr_read_b32 v164, a28
  v_accvgpr_read_b32 v165, a29
  v_accvgpr_read_b32 v166, a30
  v_accvgpr_read_b32 v167, a31
  v_pk_mul_f32 v[160:161], v[160:161], v[182:183]
  v_pk_mul_f32 v[162:163], v[162:163], v[182:183]
  v_pk_mul_f32 v[164:165], v[164:165], v[182:183]
  v_pk_mul_f32 v[166:167], v[166:167], v[182:183]
  v_cvt_pk_bf16_f32 v92, v160, v161
  v_cvt_pk_bf16_f32 v93, v162, v163
  v_cvt_pk_bf16_f32 v94, v164, v165
  v_cvt_pk_bf16_f32 v95, v166, v167
  buffer_store_dwordx4 v[92:95], v1, s[20:23], s35 offen offset:3072 sc1
  v_rcp_f32 v182, v196
  s_add_u32 s35, s34, 4096
  v_mov_b32 v183, v182
  v_accvgpr_read_b32 v144, a32
  v_accvgpr_read_b32 v145, a33
  v_accvgpr_read_b32 v146, a34
  v_accvgpr_read_b32 v147, a35
  v_accvgpr_read_b32 v148, a36
  v_accvgpr_read_b32 v149, a37
  v_accvgpr_read_b32 v150, a38
  v_accvgpr_read_b32 v151, a39
  v_pk_mul_f32 v[144:145], v[144:145], v[182:183]
  v_pk_mul_f32 v[146:147], v[146:147], v[182:183]
  v_pk_mul_f32 v[148:149], v[148:149], v[182:183]
  v_pk_mul_f32 v[150:151], v[150:151], v[182:183]
  v_cvt_pk_bf16_f32 v112, v144, v145
  v_cvt_pk_bf16_f32 v113, v146, v147
  v_cvt_pk_bf16_f32 v114, v148, v149
  v_cvt_pk_bf16_f32 v115, v150, v151
  buffer_store_dwordx4 v[112:115], v1, s[20:23], s35 offen offset:0 sc1
  v_accvgpr_read_b32 v160, a40
  v_accvgpr_read_b32 v161, a41
  v_accvgpr_read_b32 v162, a42
  v_accvgpr_read_b32 v163, a43
  v_accvgpr_read_b32 v164, a44
  v_accvgpr_read_b32 v165, a45
  v_accvgpr_read_b32 v166, a46
  v_accvgpr_read_b32 v167, a47
  v_pk_mul_f32 v[160:161], v[160:161], v[182:183]
  v_pk_mul_f32 v[162:163], v[162:163], v[182:183]
  v_pk_mul_f32 v[164:165], v[164:165], v[182:183]
  v_pk_mul_f32 v[166:167], v[166:167], v[182:183]
  v_cvt_pk_bf16_f32 v116, v160, v161
  v_cvt_pk_bf16_f32 v117, v162, v163
  v_cvt_pk_bf16_f32 v118, v164, v165
  v_cvt_pk_bf16_f32 v119, v166, v167
  buffer_store_dwordx4 v[116:119], v1, s[20:23], s35 offen offset:1024 sc1
  v_accvgpr_read_b32 v144, a48
  v_accvgpr_read_b32 v145, a49
  v_accvgpr_read_b32 v146, a50
  v_accvgpr_read_b32 v147, a51
  v_accvgpr_read_b32 v148, a52
  v_accvgpr_read_b32 v149, a53
  v_accvgpr_read_b32 v150, a54
  v_accvgpr_read_b32 v151, a55
  v_pk_mul_f32 v[144:145], v[144:145], v[182:183]
  v_pk_mul_f32 v[146:147], v[146:147], v[182:183]
  v_pk_mul_f32 v[148:149], v[148:149], v[182:183]
K_hA2_12:
  s_cbranch_execz K_hAr
  v_pk_mul_f32 v[150:151], v[150:151], v[182:183]
  v_cvt_pk_bf16_f32 v120, v144, v145
  v_cvt_pk_bf16_f32 v121, v146, v147
  v_cvt_pk_bf16_f32 v122, v148, v149
  v_cvt_pk_bf16_f32 v123, v150, v151
  buffer_store_dwordx4 v[120:123], v1, s[20:23], s35 offen offset:2048 sc1
  v_accvgpr_read_b32 v160, a56
  v_accvgpr_read_b32 v161, a57
  v_accvgpr_read_b32 v162, a58
  v_accvgpr_read_b32 v163, a59
  v_accvgpr_read_b32 v164, a60
  v_accvgpr_read_b32 v165, a61
  v_accvgpr_read_b32 v166, a62
  v_accvgpr_read_b32 v167, a63
  v_pk_mul_f32 v[160:161], v[160:161], v[182:183]
  v_pk_mul_f32 v[162:163], v[162:163], v[182:183]
  v_pk_mul_f32 v[164:165], v[164:165], v[182:183]
  v_pk_mul_f32 v[166:167], v[166:167], v[182:183]
  v_cvt_pk_bf16_f32 v124, v160, v161
  v_cvt_pk_bf16_f32 v125, v162, v163
  v_cvt_pk_bf16_f32 v126, v164, v165
  v_cvt_pk_bf16_f32 v127, v166, v167
  buffer_store_dwordx4 v[124:127], v1, s[20:23], s35 offen offset:3072 sc1
  v_and_b32 v144, 15, v0
  v_lshrrev_b32 v145, 4, v0
  v_lshlrev_b32 v146, 5, v144
  v_lshl_add_u32 v250, v145, 3, v146
  s_and_b32 s28, s24, 1
  s_lshl_b32 s29, s28, 8
  s_sub_u32 s29, s33, s29
  v_sub_u32 v3, 15, v144
  v_and_b32 v244, 1, v3
  v_mul_u32_u24 v244, 4160, v244
  v_lshrrev_b32 v3, 1, v3
  v_lshl_add_u32 v3, v3, 2, v244
  v_lshl_add_u32 v3, v145, 4, v3
  v_add_u32 v3, s29, v3
  v_add_u32 v244, 3328, v3
  v_add_u32 v245, 2304, v3
  v_add_u32 v246, 1280, v3
  v_add_u32 v247, 256, v3
  v_lshl_add_u32 v248, v145, 4, v146
  s_add_u32 s27, s29, 8608
  v_add_u32 v248, s27, v248
  s_lshl_b32 s29, s28, 11
  s_add_u32 s27, s33, 2552
  s_sub_u32 s27, s27, s29
  v_sub_u32 v249, s27, v250
  s_lshl_b32 s29, s28, 12
  s_add_u32 s27, s33, 4160
  s_add_u32 s28, s27, s29
  v_add_u32 v251, s28, v1
  s_xor_b32 s29, s29, 4096
  s_add_u32 s28, s27, s29
  v_add_u32 v255, s28, v1
  v_and_b32 v3, 1, v145
  v_mul_u32_u24 v3, 504, v3
  v_add_u32 v250, v250, v3
  v_accvgpr_read_b32 v4, a144
  v_accvgpr_read_b32 v5, a145
  v_accvgpr_read_b32 v6, a146
  v_accvgpr_read_b32 v7, a147
  v_accvgpr_read_b32 v8, a148
  v_accvgpr_read_b32 v9, a149
  v_accvgpr_read_b32 v10, a150
  v_accvgpr_read_b32 v11, a151
  s_branch K_F3
K_RX:
K_hA3_12:
  s_cbranch_execz K_hAr
  s_waitcnt lgkmcnt(0)
  v_mfma_f32_16x16x32_bf16 v[176:179], a[128:131], a[160:163], 0
  ds_read2_b32 a[192:193], v244 offset0:160 offset1:161
  ds_read2_b32 a[194:195], v244 offset0:162 offset1:163
  s_mov_b64 s[44:45], 0
  v_mfma_f32_16x16x32_bf16 v[180:183], a[132:135], a[160:163], 0
  v_cmp_nle_f32_e64 vcc, v192, s41
  s_nop 0
  s_or_b64 s[44:45], s[44:45], vcc
  v_rcp_f32 v14, v204
  v_mfma_f32_16x16x32_bf16 v[180:183], a[128:131], a[164:167], v[180:183]
  s_add_u32 s35, s34, 12288
  v_cmp_nle_f32_e64 vcc, v196, s41
  s_nop 0
  s_or_b64 s[44:45], s[44:45], vcc
  v_accvgpr_read_b32 v208, a96
  v_accvgpr_read_b32 v209, a97
  v_accvgpr_read_b32 v210, a98
  v_mfma_f32_16x16x32_bf16 v[184:187], a[128:131], a[168:171], 0
  v_cmp_nle_f32_e64 vcc, v200, s41
  s_nop 0
  s_or_b64 s[44:45], s[44:45], vcc
  v_accvgpr_read_b32 v211, a99
  v_accvgpr_read_b32 v212, a100
  v_accvgpr_read_b32 v213, a101
  v_mfma_f32_16x16x32_bf16 v[184:187], a[132:135], a[164:167], v[184:187]
  v_cmp_nle_f32_e64 vcc, v204, s41
  s_nop 0
  s_or_b64 s[44:45], s[44:45], vcc
  v_accvgpr_read_b32 v214, a102
  v_accvgpr_read_b32 v215, a103
  v_mfma_f32_16x16x32_bf16 v[184:187], a[136:139], a[160:163], v[184:187]
  s_cmp_lg_u64 s[44:45], 0
  s_cselect_b32 s27, 1, 0
  s_cmp_lg_u32 s40, 0
  s_cselect_b32 s27, 0, s27
  v_mov_b32 v3, s27
  v_mul_f32 v208, v208, v14
  v_mul_f32 v209, v209, v14
  v_mfma_f32_16x16x32_bf16 v[188:191], a[140:143], a[160:163], 0
  s_lshl_b32 s27, s24, 2
  s_add_u32 s27, s27, 163328
  v_mov_b32 v13, s27
  v_mul_f32 v210, v210, v14
  v_mul_f32 v211, v211, v14
  v_mul_f32 v212, v212, v14
  v_mfma_f32_16x16x32_bf16 v[188:191], a[136:139], a[164:167], v[188:191]
  ds_write_b32 v13, v3
  ds_read_b128 a[224:227], v248 offset:128
  ds_read_b128 a[228:231], v248 offset:640
  ds_read_b128 a[232:235], v248 offset:1152
  ds_read_b128 a[236:239], v248 offset:1664
  v_mfma_f32_16x16x32_bf16 v[188:191], a[132:135], a[168:171], v[188:191]
  ds_read_b128 a[240:243], v248 offset:2176
  v_mov_b32 v13, 163328
  v_mfma_f32_16x16x32_bf16 v[188:191], a[128:131], a[172:175], v[188:191]
  ds_read_b128 a[244:247], v248 offset:2688
  v_mul_f32 v213, v213, v14
  v_mul_f32 v214, v214, v14
  v_mfma_f32_16x16x32_bf16 v[224:227], a[128:131], a[176:179], 0
  ds_read_b128 a[248:251], v248 offset:3200
  v_mul_f32 v215, v215, v14
  v_cvt_pk_bf16_f32 v128, v208, v209
  v_cvt_pk_bf16_f32 v129, v210, v211
  v_mfma_f32_16x16x32_bf16 v[224:227], a[132:135], a[172:175], v[224:227]
  ds_read_b128 a[252:255], v248 offset:3712
  v_cvt_pk_bf16_f32 v130, v212, v213
  v_cvt_pk_bf16_f32 v131, v214, v215
  buffer_store_dwordx4 v[128:131], v1, s[20:23], s35 offen offset:0 sc1
  v_accvgpr_read_b32 v216, a104
  v_accvgpr_read_b32 v217, a105
  v_accvgpr_read_b32 v218, a106
  v_accvgpr_read_b32 v219, a107
  v_mfma_f32_16x16x32_bf16 v[224:227], a[136:139], a[168:171], v[224:227]
  s_waitcnt lgkmcnt(8)
  s_barrier
  v_mfma_f32_16x16x32_bf16 v[224:227], a[140:143], a[164:167], v[224:227]
  ds_read_b128 v[144:147], v13
  ds_read2_b32 a[196:197], v244 offset0:32 offset1:33
  v_mfma_f32_16x16x32_bf16 v[224:227], a[144:147], a[160:163], v[224:227]
  ds_read2_b32 a[198:199], v244 offset0:34 offset1:35
  v_accvgpr_read_b32 v220, a108
  v_accvgpr_read_b32 v221, a109
  v_mfma_f32_16x16x32_bf16 v[228:231], a[148:151], a[160:163], 0
  ds_read2_b32 a[200:201], v245 offset0:160 offset1:161
  v_accvgpr_read_b32 v222, a110
  v_accvgpr_read_b32 v223, a111
  v_mul_f32 v216, v216, v14
  v_mfma_f32_16x16x32_bf16 v[228:231], a[144:147], a[164:167], v[228:231]
  ds_read2_b32 a[202:203], v245 offset0:162 offset1:163
  v_mul_f32 v217, v217, v14
  v_mul_f32 v218, v218, v14
  v_mfma_f32_16x16x32_bf16 v[228:231], a[140:143], a[168:171], v[228:231]
  ds_read2_b32 a[204:205], v245 offset0:32 offset1:33
  v_mul_f32 v219, v219, v14
  v_mul_f32 v220, v220, v14
  v_mfma_f32_16x16x32_bf16 v[228:231], a[136:139], a[172:175], v[228:231]
  v_mul_f32 v221, v221, v14
  v_mul_f32 v222, v222, v14
  v_mul_f32 v223, v223, v14
  v_mfma_f32_16x16x32_bf16 v[228:231], a[132:135], a[176:179], v[228:231]
  ds_read2_b32 a[206:207], v245 offset0:34 offset1:35
  v_cvt_pk_bf16_f32 v132, v216, v217
  v_cvt_pk_bf16_f32 v133, v218, v219
  v_cvt_pk_bf16_f32 v134, v220, v221
  v_cvt_pk_bf16_f32 v135, v222, v223
  v_mfma_f32_16x16x32_bf16 v[228:231], a[128:131], a[180:183], v[228:231]
  buffer_store_dwordx4 v[132:135], v1, s[20:23], s35 offen offset:1024 sc1
  ds_read2_b32 a[208:209], v246 offset0:160 offset1:161
  s_waitcnt lgkmcnt(7)
  v_or_b32 v3, v144, v145
  v_accvgpr_read_b32 v208, a112
  v_accvgpr_read_b32 v209, a113
  v_mfma_f32_16x16x32_bf16 v[232:235], a[128:131], a[184:187], 0
  ds_read2_b32 a[210:211], v246 offset0:162 offset1:163
  v_or3_b32 v3, v3, v146, v147
  v_mfma_f32_16x16x32_bf16 v[232:235], a[132:135], a[180:183], v[232:235]
  ds_read2_b32 a[212:213], v246 offset0:32 offset1:33
  v_accvgpr_read_b32 v210, a114
  v_accvgpr_read_b32 v211, a115
  v_accvgpr_read_b32 v212, a116
  v_accvgpr_read_b32 v213, a117
  v_accvgpr_read_b32 v214, a118
  v_mfma_f32_16x16x32_bf16 v[232:235], a[136:139], a[176:179], v[232:235]
  v_cmp_ne_u32 vcc, 0, v3
  s_cbranch_vccnz K_redo
  v_mfma_f32_16x16x32_bf16 v[232:235], a[140:143], a[172:175], v[232:235]
  ds_read2_b32 a[214:215], v246 offset0:34 offset1:35
  v_accvgpr_read_b32 v215, a119
  v_mul_f32 v208, v208, v14
  v_mfma_f32_16x16x32_bf16 v[232:235], a[144:147], a[168:171], v[232:235]
  ds_read2_b32 a[216:217], v247 offset0:160 offset1:161
  v_mul_f32 v209, v209, v14
  v_mul_f32 v210, v210, v14
  v_mul_f32 v211, v211, v14
  v_mul_f32 v212, v212, v14
  v_mul_f32 v213, v213, v14
  v_mfma_f32_16x16x32_bf16 v[232:235], a[148:151], a[164:167], v[232:235]
  ds_read2_b32 a[218:219], v247 offset0:162 offset1:163
  s_sub_u32 s47, s33, 26624
  s_mul_i32 s46, s38, 36
  v_mfma_f32_16x16x32_bf16 v[232:235], a[152:155], a[160:163], v[232:235]
  ds_read2_b32 a[220:221], v247 offset0:32 offset1:33
  s_and_b32 s64, s26, 3
  v_mul_f32 v214, v214, v14
  v_mul_f32 v215, v215, v14
  v_mfma_f32_16x16x32_bf16 v[236:239], a[156:159], a[160:163], 0
  ds_read2_b32 a[222:223], v247 offset0:34 offset1:35
  s_add_u32 s46, s46, s64
  v_cvt_pk_bf16_f32 v136, v208, v209
  v_cvt_pk_bf16_f32 v137, v210, v211
  v_cvt_pk_bf16_f32 v138, v212, v213
  v_mfma_f32_16x16x32_bf16 v[236:239], a[152:155], a[164:167], v[236:239]
  s_add_u32 s46, s46, 32
  v_cvt_pk_bf16_f32 v139, v214, v215
  buffer_store_dwordx4 v[136:139], v1, s[20:23], s35 offen offset:2048 sc1
  v_accvgpr_read_b32 v216, a120
  v_accvgpr_read_b32 v217, a121
  v_accvgpr_read_b32 v218, a122
  v_accvgpr_read_b32 v219, a123
  v_mfma_f32_16x16x32_bf16 v[236:239], a[148:151], a[168:171], v[236:239]
  s_lshl_b32 s1, s46, 7
  s_lshl_b32 s64, s24, 2
  v_accvgpr_read_b32 v220, a124
  v_mfma_f32_16x16x32_bf16 v[236:239], a[144:147], a[172:175], v[236:239]
  s_add_u32 s1, s1, s64
  v_accvgpr_read_b32 v221, a125
  v_accvgpr_read_b32 v222, a126
  v_mfma_f32_16x16x32_bf16 v[236:239], a[140:143], a[176:179], v[236:239]
  s_add_u32 s1, s1, 66322432
  v_accvgpr_read_b32 v223, a127
  v_mul_f32 v216, v216, v14
  v_mfma_f32_16x16x32_bf16 v[236:239], a[136:139], a[180:183], v[236:239]
  s_lshl_b32 s64, s46, 2
  v_mul_f32 v217, v217, v14
  v_mul_f32 v218, v218, v14
  v_mfma_f32_16x16x32_bf16 v[236:239], a[132:135], a[184:187], v[236:239]
  s_load_dword s0, s[74:75], s64
  s_lshl_b32 s46, s46, 1
  v_mul_f32 v219, v219, v14
  v_mfma_f32_16x16x32_bf16 v[236:239], a[128:131], a[188:191], v[236:239]
  s_lshr_b32 s64, s24, 1
  v_mul_f32 v220, v220, v14
  v_mul_f32 v221, v221, v14
  s_waitcnt lgkmcnt(0)
  v_mfma_f32_16x16x32_bf16 v[176:179], a[192:195], a[224:227], v[176:179]
  s_add_u32 s46, s46, s64
  v_mul_f32 v222, v222, v14
  v_mul_f32 v223, v223, v14
  v_cvt_pk_bf16_f32 v140, v216, v217
  v_mfma_f32_16x16x32_bf16 v[180:183], a[196:199], a[224:227], v[180:183]
  ds_read2_b32 a[128:129], v244 offset0:144 offset1:145
  s_and_b32 s92, s24, 1
  v_cvt_pk_bf16_f32 v141, v218, v219
  v_cvt_pk_bf16_f32 v142, v220, v221
  v_mfma_f32_16x16x32_bf16 v[180:183], a[192:195], a[228:231], v[180:183]
  s_lshl_b32 s92, s92, 11
  v_cvt_pk_bf16_f32 v143, v222, v223
  buffer_store_dwordx4 v[140:143], v1, s[20:23], s35 offen offset:3072 sc1
  ds_read2_b32 a[130:131], v244 offset0:146 offset1:147
  v_mfma_f32_16x16x32_bf16 v[184:187], a[192:195], a[232:235], v[184:187]
  ds_read_b128 a[160:163], v248 offset:64
  s_mul_i32 s93, s46, 4224
  s_add_u32 s93, s93, 56623104
  v_mfma_f32_16x16x32_bf16 v[184:187], a[196:199], a[228:231], v[184:187]
  ds_read_b128 a[164:167], v248 offset:576
  s_add_u32 s93, s93, s92
  v_mfma_f32_16x16x32_bf16 v[184:187], a[200:203], a[224:227], v[184:187]
  ds_read_b128 a[168:171], v248 offset:1088
  s_add_u32 m0, s47, s92
  v_mfma_f32_16x16x32_bf16 v[188:191], a[204:207], a[224:227], v[188:191]
  buffer_load_dwordx4 v1, s[20:23], s93 offen offset:0 sc1 lds
  v_mfma_f32_16x16x32_bf16 v[188:191], a[200:203], a[228:231], v[188:191]
  ds_read_b128 a[172:175], v248 offset:1600
  buffer_load_dwordx4 v1, s[20:23], s93 offen offset:1024 sc1 lds
  s_lshl_b32 s93, s46, 12
  v_mfma_f32_16x16x32_bf16 v[188:191], a[196:199], a[232:235], v[188:191]
  ds_read_b128 a[176:179], v248 offset:2112
  s_add_u32 s93, s93, s92
  v_mfma_f32_16x16x32_bf16 v[188:191], a[192:195], a[236:239], v[188:191]
  ds_read_b128 a[180:183], v248 offset:2624
  s_add_u32 s92, s92, 8832
  v_mfma_f32_16x16x32_bf16 v[224:227], a[192:195], a[240:243], v[224:227]
  ds_read_b128 a[184:187], v248 offset:3136
  s_add_u32 m0, s47, s92
  v_mfma_f32_16x16x32_bf16 v[224:227], a[196:199], a[236:239], v[224:227]
  ds_read_b128 a[188:191], v248 offset:3648
  buffer_load_dwordx4 v1, s[60:63], s93 offen offset:0 lds
  v_mfma_f32_16x16x32_bf16 v[224:227], a[200:203], a[232:235], v[224:227]
  buffer_load_dwordx4 v1, s[60:63], s93 offen offset:1024 lds
  v_mov_b32 v32, 0
  v_mfma_f32_16x16x32_bf16 v[224:227], a[204:207], a[228:231], v[224:227]
  ds_read2_b32 a[132:133], v244 offset0:16 offset1:17
  v_mov_b32 v33, 0
  v_mfma_f32_16x16x32_bf16 v[224:227], a[208:211], a[224:227], v[224:227]
  ds_read2_b32 a[134:135], v244 offset0:18 offset1:19
  v_mov_b32 v34, 0
  v_mfma_f32_16x16x32_bf16 v[228:231], a[212:215], a[224:227], v[228:231]
  ds_read2_b32 a[136:137], v245 offset0:144 offset1:145
  v_mov_b32 v35, 0
  v_mfma_f32_16x16x32_bf16 v[228:231], a[208:211], a[228:231], v[228:231]
  ds_read2_b32 a[138:139], v245 offset0:146 offset1:147
  v_add_u32 v36, 8256, v1
  v_mfma_f32_16x16x32_bf16 v[228:231], a[204:207], a[232:235], v[228:231]
  ds_read2_b32 a[140:141], v245 offset0:16 offset1:17
  v_and_b32 v37, 48, v1
  v_mfma_f32_16x16x32_bf16 v[228:231], a[200:203], a[236:239], v[228:231]
  v_add_u32 v37, 4096, v37
  v_cmp_gt_u32 vcc, 36, v0
  s_nop 1
  v_cndmask_b32 v36, v37, v36, vcc
  v_mfma_f32_16x16x32_bf16 v[228:231], a[196:199], a[240:243], v[228:231]
  ds_read2_b32 a[142:143], v245 offset0:18 offset1:19
  v_add_u32 v36, s47, v36
  v_mfma_f32_16x16x32_bf16 v[228:231], a[192:195], a[244:247], v[228:231]
  ds_write_b128 v36, v[32:35]
  ds_read2_b32 a[144:145], v246 offset0:144 offset1:145
  v_mfma_f32_16x16x32_bf16 v[232:235], a[192:195], a[248:251], v[232:235]
  ds_read2_b32 a[146:147], v246 offset0:146 offset1:147
  v_mfma_f32_16x16x32_bf16 v[232:235], a[196:199], a[244:247], v[232:235]
  ds_read2_b32 a[148:149], v246 offset0:16 offset1:17
  v_mfma_f32_16x16x32_bf16 v[232:235], a[200:203], a[240:243], v[232:235]
  ds_read2_b32 a[150:151], v246 offset0:18 offset1:19
  v_mfma_f32_16x16x32_bf16 v[232:235], a[204:207], a[236:239], v[232:235]
  v_mfma_f32_16x16x32_bf16 v[232:235], a[208:211], a[232:235], v[232:235]
  ds_read2_b32 a[152:153], v247 offset0:144 offset1:145
  v_mfma_f32_16x16x32_bf16 v[232:235], a[212:215], a[228:231], v[232:235]
  ds_read2_b32 a[154:155], v247 offset0:146 offset1:147
  v_mfma_f32_16x16x32_bf16 v[232:235], a[216:219], a[224:227], v[232:235]
  ds_read2_b32 a[156:157], v247 offset0:16 offset1:17
  v_mfma_f32_16x16x32_bf16 v[236:239], a[220:223], a[224:227], v[236:239]
  ds_read2_b32 a[158:159], v247 offset0:18 offset1:19
  v_mfma_f32_16x16x32_bf16 v[236:239], a[216:219], a[228:231], v[236:239]
  v_mfma_f32_16x16x32_bf16 v[236:239], a[212:215], a[232:235], v[236:239]
  v_mfma_f32_16x16x32_bf16 v[236:239], a[208:211], a[236:239], v[236:239]
  v_mfma_f32_16x16x32_bf16 v[236:239], a[204:207], a[240:243], v[236:239]
  v_mfma_f32_16x16x32_bf16 v[236:239], a[200:203], a[244:247], v[236:239]
  v_mfma_f32_16x16x32_bf16 v[236:239], a[196:199], a[248:251], v[236:239]
  v_mfma_f32_16x16x32_bf16 v[236:239], a[192:195], a[252:255], v[236:239]
  s_waitcnt lgkmcnt(0)
  v_mfma_f32_16x16x32_bf16 v[176:179], a[128:131], a[160:163], v[176:179]
  v_mfma_f32_16x16x32_bf16 v[180:183], a[132:135], a[160:163], v[180:183]
  ds_read2_b32 a[192:193], v244 offset0:128 offset1:129
  v_mfma_f32_16x16x32_bf16 v[180:183], a[128:131], a[164:167], v[180:183]
  ds_read2_b32 a[194:195], v244 offset0:130 offset1:131
  v_mfma_f32_16x16x32_bf16 v[184:187], a[128:131], a[168:171], v[184:187]
  ds_read_b128 a[224:227], v248 offset:0
  v_mfma_f32_16x16x32_bf16 v[184:187], a[132:135], a[164:167], v[184:187]
  ds_read_b128 a[228:231], v248 offset:512
  v_mfma_f32_16x16x32_bf16 v[184:187], a[136:139], a[160:163], v[184:187]
  ds_read_b128 a[232:235], v248 offset:1024
  v_mfma_f32_16x16x32_bf16 v[188:191], a[140:143], a[160:163], v[188:191]
  v_mfma_f32_16x16x32_bf16 v[188:191], a[136:139], a[164:167], v[188:191]
  ds_read_b128 a[236:239], v248 offset:1536
  v_mfma_f32_16x16x32_bf16 v[188:191], a[132:135], a[168:171], v[188:191]
  ds_read_b128 a[240:243], v248 offset:2048
  s_waitcnt vmcnt(4)
  s_and_b32 s27, s25, 3
  s_lshl_b32 s27, s27, 2
  s_add_u32 s27, s27, s31
  buffer_store_dword v252, off, s[20:23], s27 sc1
  v_mfma_f32_16x16x32_bf16 v[188:191], a[128:131], a[172:175], v[188:191]
  ds_read_b128 a[244:247], v248 offset:2560
  v_mfma_f32_16x16x32_bf16 v[224:227], a[128:131], a[176:179], v[224:227]
  ds_read_b128 a[248:251], v248 offset:3072
  v_mfma_f32_16x16x32_bf16 v[224:227], a[132:135], a[172:175], v[224:227]
  ds_read_b128 a[252:255], v248 offset:3584
  v_mfma_f32_16x16x32_bf16 v[224:227], a[136:139], a[168:171], v[224:227]
  v_mfma_f32_16x16x32_bf16 v[224:227], a[140:143], a[164:167], v[224:227]
  ds_read2_b32 a[196:197], v244 offset0:0 offset1:1
  ds_read2_b32 a[198:199], v244 offset0:2 offset1:3
  v_mfma_f32_16x16x32_bf16 v[224:227], a[144:147], a[160:163], v[224:227]
  s_waitcnt vmcnt(1)
  s_barrier
  v_mfma_f32_16x16x32_bf16 v[228:231], a[148:151], a[160:163], v[228:231]
  s_and_b32 s27, s24, 1
  s_lshl_b32 s27, s27, 11
  s_add_u32 s27, s27, s47
  v_add_u32 v13, s27, v1
  v_mfma_f32_16x16x32_bf16 v[228:231], a[144:147], a[164:167], v[228:231]
  ds_read_b128 v[40:43], v13 offset:0
  ds_read2_b32 a[200:201], v245 offset0:128 offset1:129
  v_mfma_f32_16x16x32_bf16 v[228:231], a[140:143], a[168:171], v[228:231]
  ds_read_b32 v44, v13 offset:16
  ds_read2_b32 a[202:203], v245 offset0:130 offset1:131
  v_mfma_f32_16x16x32_bf16 v[228:231], a[136:139], a[172:175], v[228:231]
  ds_read_b128 v[48:51], v13 offset:1024
  ds_read2_b32 a[204:205], v245 offset0:0 offset1:1
  s_add_u32 m0, s32, 0
  v_mfma_f32_16x16x32_bf16 v[228:231], a[132:135], a[176:179], v[228:231]
  ds_read_b32 v52, v13 offset:1040
  ds_read2_b32 a[206:207], v245 offset0:2 offset1:3
  v_mfma_f32_16x16x32_bf16 v[228:231], a[128:131], a[180:183], v[228:231]
  ds_read2_b32 a[208:209], v246 offset0:128 offset1:129
  v_mfma_f32_16x16x32_bf16 v[232:235], a[128:131], a[184:187], v[232:235]
  ds_read2_b32 a[210:211], v246 offset0:130 offset1:131
  buffer_load_dwordx4 v4, s[16:19], s48 offen offset:0 lds
  v_mfma_f32_16x16x32_bf16 v[232:235], a[132:135], a[180:183], v[232:235]
  ds_read2_b32 a[212:213], v246 offset0:0 offset1:1
  v_mfma_f32_16x16x32_bf16 v[232:235], a[136:139], a[176:179], v[232:235]
  ds_read2_b32 a[214:215], v246 offset0:2 offset1:3
  v_mfma_f32_16x16x32_bf16 v[232:235], a[140:143], a[172:175], v[232:235]
  v_mfma_f32_16x16x32_bf16 v[232:235], a[144:147], a[168:171], v[232:235]
  ds_read2_b32 a[216:217], v247 offset0:128 offset1:129
  buffer_load_dwordx4 v5, s[16:19], s48 offen offset:1024 lds
  v_mfma_f32_16x16x32_bf16 v[232:235], a[148:151], a[164:167], v[232:235]
  s_waitcnt lgkmcnt(6)
  v_alignbit_b32 v40, v41, v40, 16
  v_alignbit_b32 v41, v42, v41, 16
  v_mfma_f32_16x16x32_bf16 v[232:235], a[152:155], a[160:163], v[232:235]
  ds_read2_b32 a[218:219], v247 offset0:130 offset1:131
  v_alignbit_b32 v42, v43, v42, 16
  v_mfma_f32_16x16x32_bf16 v[236:239], a[156:159], a[160:163], v[236:239]
  ds_read2_b32 a[220:221], v247 offset0:0 offset1:1
  v_alignbit_b32 v43, v44, v43, 16
  v_mfma_f32_16x16x32_bf16 v[236:239], a[152:155], a[164:167], v[236:239]
  ds_write_b128 v13, v[40:43] offset:4160
  ds_read2_b32 a[222:223], v247 offset0:2 offset1:3
  buffer_load_dwordx4 v6, s[16:19], s48 offen offset:2048 lds
  v_mfma_f32_16x16x32_bf16 v[236:239], a[148:151], a[168:171], v[236:239]
  v_alignbit_b32 v48, v49, v48, 16
  v_mfma_f32_16x16x32_bf16 v[236:239], a[144:147], a[172:175], v[236:239]
  v_alignbit_b32 v49, v50, v49, 16
  v_mfma_f32_16x16x32_bf16 v[236:239], a[140:143], a[176:179], v[236:239]
  v_alignbit_b32 v50, v51, v50, 16
  v_mfma_f32_16x16x32_bf16 v[236:239], a[136:139], a[180:183], v[236:239]
  buffer_load_dwordx4 v7, s[16:19], s48 offen offset:3072 lds
  v_alignbit_b32 v51, v52, v51, 16
  v_mfma_f32_16x16x32_bf16 v[236:239], a[132:135], a[184:187], v[236:239]
  ds_write_b128 v13, v[48:51] offset:5184
  v_mfma_f32_16x16x32_bf16 v[236:239], a[128:131], a[188:191], v[236:239]
  s_waitcnt lgkmcnt(1)
  v_mfma_f32_16x16x32_bf16 v[176:179], a[192:195], a[224:227], v[176:179]
  v_mfma_f32_16x16x32_bf16 v[180:183], a[196:199], a[224:227], v[180:183]
  ds_read_b64 v[24:25], v249 offset:1536
  s_add_u32 m0, s32, 4096
  v_mfma_f32_16x16x32_bf16 v[180:183], a[192:195], a[228:231], v[180:183]
  s_waitcnt lgkmcnt(1)
  s_barrier
  v_mfma_f32_16x16x32_bf16 v[184:187], a[192:195], a[232:235], v[184:187]
  ds_read_b64 v[26:27], v249 offset:1024
  ds_read_b64 v[28:29], v249 offset:512
  v_mfma_f32_16x16x32_bf16 v[184:187], a[196:199], a[228:231], v[184:187]
  s_bitcmp1_b32 s65, 0
  s_cselect_b32 s27, 0, 16
  s_lshl_b32 s95, s95, s27
  v_mfma_f32_16x16x32_bf16 v[184:187], a[200:203], a[224:227], v[184:187]
  ds_read_b64 v[30:31], v249 offset:0
  buffer_load_dwordx4 v8, s[16:19], s48 offen offset:0 lds
  v_mfma_f32_16x16x32_bf16 v[188:191], a[204:207], a[224:227], v[188:191]
  v_subrev_u32 v244, 26624, v244
  v_subrev_u32 v245, 26624, v245
  v_mfma_f32_16x16x32_bf16 v[188:191], a[200:203], a[228:231], v[188:191]
  v_subrev_u32 v246, 26624, v246
  v_mfma_f32_16x16x32_bf16 v[188:191], a[196:199], a[232:235], v[188:191]
  v_subrev_u32 v247, 26624, v247
  v_mfma_f32_16x16x32_bf16 v[188:191], a[192:195], a[236:239], v[188:191]
  buffer_load_dwordx4 v9, s[16:19], s48 offen offset:1024 lds
  s_and_b32 s95, s95, 0xffff0000
  v_subrev_u32 v248, 26624, v248
  v_mfma_f32_16x16x32_bf16 v[224:227], a[192:195], a[240:243], v[224:227]
  v_subrev_u32 v249, 26624, v249
  v_mfma_f32_16x16x32_bf16 v[224:227], a[196:199], a[236:239], v[224:227]
  ds_read2_b32 a[128:129], v244 offset0:176 offset1:177
  v_mfma_f32_16x16x32_bf16 v[224:227], a[200:203], a[232:235], v[224:227]
  ds_read2_b32 a[130:131], v244 offset0:178 offset1:179
  buffer_load_dwordx4 v10, s[16:19], s48 offen offset:2048 lds
  v_mfma_f32_16x16x32_bf16 v[224:227], a[204:207], a[228:231], v[224:227]
  ds_read_b128 a[160:163], v248 offset:192
  v_mfma_f32_16x16x32_bf16 v[224:227], a[208:211], a[224:227], v[224:227]
  ds_read_b128 a[164:167], v248 offset:704
  v_mfma_f32_16x16x32_bf16 v[228:231], a[212:215], a[224:227], v[228:231]
  ds_read_b128 a[168:171], v248 offset:1216
  ds_read_b128 a[172:175], v248 offset:1728
  s_lshl_b32 s65, s65, 12
  v_mfma_f32_16x16x32_bf16 v[228:231], a[208:211], a[228:231], v[228:231]
  ds_read_b128 a[176:179], v248 offset:2240
  buffer_load_dwordx4 v11, s[16:19], s48 offen offset:3072 lds
  v_mfma_f32_16x16x32_bf16 v[228:231], a[204:207], a[232:235], v[228:231]
  ds_read_b128 a[180:183], v248 offset:2752
  v_mfma_f32_16x16x32_bf16 v[228:231], a[200:203], a[236:239], v[228:231]
  ds_read_b128 a[184:187], v248 offset:3264
  v_mfma_f32_16x16x32_bf16 v[228:231], a[196:199], a[240:243], v[228:231]
  ds_read_b128 a[188:191], v248 offset:3776
  v_mfma_f32_16x16x32_bf16 v[228:231], a[192:195], a[244:247], v[228:231]
  ds_read2_b32 a[132:133], v244 offset0:48 offset1:49
  s_add_u32 m0, s32, 8192
  v_mfma_f32_16x16x32_bf16 v[232:235], a[192:195], a[248:251], v[232:235]
  s_and_b32 s27, s24, 1
  s_lshl_b32 s27, s27, 11
  s_add_u32 s65, s65, s27
  v_mfma_f32_16x16x32_bf16 v[232:235], a[196:199], a[244:247], v[232:235]
  ds_read2_b32 a[134:135], v244 offset0:50 offset1:51
  ds_read2_b32 a[136:137], v245 offset0:176 offset1:177
  v_mfma_f32_16x16x32_bf16 v[232:235], a[200:203], a[240:243], v[232:235]
  ds_read2_b32 a[138:139], v245 offset0:178 offset1:179
  v_mfma_f32_16x16x32_bf16 v[232:235], a[204:207], a[236:239], v[232:235]
  ds_read2_b32 a[140:141], v245 offset0:48 offset1:49
  ds_read2_b32 a[142:143], v245 offset0:50 offset1:51
  v_mfma_f32_16x16x32_bf16 v[232:235], a[208:211], a[232:235], v[232:235]
  ds_read2_b32 a[144:145], v246 offset0:176 offset1:177
  buffer_load_dwordx4 v12, s[16:19], s48 offen offset:0 lds
  v_mfma_f32_16x16x32_bf16 v[232:235], a[212:215], a[228:231], v[232:235]
  ds_read2_b32 a[146:147], v246 offset0:178 offset1:179
  v_mfma_f32_16x16x32_bf16 v[232:235], a[216:219], a[224:227], v[232:235]
  s_add_u32 s65, s65, 62914560
  ds_read2_b32 a[148:149], v246 offset0:48 offset1:49
  v_mfma_f32_16x16x32_bf16 v[236:239], a[220:223], a[224:227], v[236:239]
  ds_read2_b32 a[150:151], v246 offset0:50 offset1:51
  s_add_u32 m0, s32, 36864
  v_mfma_f32_16x16x32_bf16 v[236:239], a[216:219], a[228:231], v[236:239]
  ds_read2_b32 a[152:153], v247 offset0:176 offset1:177
  v_mfma_f32_16x16x32_bf16 v[236:239], a[212:215], a[232:235], v[236:239]
  ds_read2_b32 a[154:155], v247 offset0:178 offset1:179
  v_mfma_f32_16x16x32_bf16 v[236:239], a[208:211], a[236:239], v[236:239]
  ds_read2_b32 a[156:157], v247 offset0:48 offset1:49
  v_mfma_f32_16x16x32_bf16 v[236:239], a[204:207], a[240:243], v[236:239]
  ds_read2_b32 a[158:159], v247 offset0:50 offset1:51
  buffer_load_dwordx4 v4, s[16:19], s49 offen offset:0 lds
  v_mfma_f32_16x16x32_bf16 v[236:239], a[200:203], a[244:247], v[236:239]
  v_mfma_f32_16x16x32_bf16 v[236:239], a[196:199], a[248:251], v[236:239]
  v_mfma_f32_16x16x32_bf16 v[236:239], a[192:195], a[252:255], v[236:239]
  s_waitcnt lgkmcnt(0)
  v_mfma_f32_16x16x32_bf16 v[144:147], a[128:131], a[160:163], 0
  buffer_load_dwordx4 v5, s[16:19], s49 offen offset:1024 lds
  v_mfma_f32_16x16x32_bf16 v[148:151], a[132:135], a[160:163], 0
  ds_read2_b32 a[192:193], v244 offset0:160 offset1:161
  v_mfma_f32_16x16x32_bf16 v[148:151], a[128:131], a[164:167], v[148:151]
  ds_read2_b32 a[194:195], v244 offset0:162 offset1:163
  v_mfma_f32_16x16x32_bf16 v[152:155], a[128:131], a[168:171], 0
  ds_read_b128 a[224:227], v248 offset:128
  buffer_load_dwordx4 v6, s[16:19], s49 offen offset:2048 lds
  v_mfma_f32_16x16x32_bf16 v[152:155], a[132:135], a[164:167], v[152:155]
  ds_read_b128 a[228:231], v248 offset:640
  v_mfma_f32_16x16x32_bf16 v[152:155], a[136:139], a[160:163], v[152:155]
  ds_read_b128 a[232:235], v248 offset:1152
  v_mfma_f32_16x16x32_bf16 v[156:159], a[140:143], a[160:163], 0
  s_bitcmp1_b32 s24, 0
  s_cbranch_scc0 K_x2x
  v_swap_b32 v176, v224
  v_swap_b32 v177, v225
  v_swap_b32 v178, v226
  v_swap_b32 v179, v227
  v_swap_b32 v180, v228
  v_swap_b32 v181, v229
  v_swap_b32 v182, v230
  v_swap_b32 v183, v231
  v_swap_b32 v184, v232
  v_swap_b32 v185, v233
  v_swap_b32 v186, v234
  v_swap_b32 v187, v235
  v_swap_b32 v188, v236
  v_swap_b32 v189, v237
  v_swap_b32 v190, v238
  v_swap_b32 v191, v239
K_x2x:
  v_mfma_f32_16x16x32_bf16 v[156:159], a[136:139], a[164:167], v[156:159]
  ds_write_b128 v251, v[224:227] offset:0
  ds_read_b128 a[236:239], v248 offset:1664
  buffer_load_dwordx4 v7, s[16:19], s49 offen offset:3072 lds
  v_mfma_f32_16x16x32_bf16 v[156:159], a[132:135], a[168:171], v[156:159]
  ds_read_b128 a[240:243], v248 offset:2176
  v_mfma_f32_16x16x32_bf16 v[156:159], a[128:131], a[172:175], v[156:159]
  ds_write_b128 v251, v[228:231] offset:1024
  ds_read_b128 a[244:247], v248 offset:2688
  v_mfma_f32_16x16x32_bf16 v[160:163], a[128:131], a[176:179], 0
  ds_read_b128 a[248:251], v248 offset:3200
  v_mfma_f32_16x16x32_bf16 v[160:163], a[132:135], a[172:175], v[160:163]
  ds_write_b128 v251, v[232:235] offset:2048
  ds_read_b128 a[252:255], v248 offset:3712
  s_add_u32 m0, s32, 40960
  v_mfma_f32_16x16x32_bf16 v[160:163], a[136:139], a[168:171], v[160:163]
  v_mfma_f32_16x16x32_bf16 v[160:163], a[140:143], a[164:167], v[160:163]
  ds_write_b128 v251, v[236:239] offset:3072
  ds_read2_b32 a[196:197], v244 offset0:32 offset1:33
  v_mfma_f32_16x16x32_bf16 v[160:163], a[144:147], a[160:163], v[160:163]
  ds_read2_b32 a[198:199], v244 offset0:34 offset1:35
  v_mfma_f32_16x16x32_bf16 v[164:167], a[148:151], a[160:163], 0
  ds_read2_b32 a[200:201], v245 offset0:160 offset1:161
K_hA0_13:
  s_cbranch_execz K_hAr
  buffer_load_dwordx4 v8, s[16:19], s49 offen offset:0 lds
  v_mfma_f32_16x16x32_bf16 v[164:167], a[144:147], a[164:167], v[164:167]
  ds_read2_b32 a[202:203], v245 offset0:162 offset1:163
  v_mfma_f32_16x16x32_bf16 v[164:167], a[140:143], a[168:171], v[164:167]
  ds_read2_b32 a[204:205], v245 offset0:32 offset1:33
  v_mfma_f32_16x16x32_bf16 v[164:167], a[136:139], a[172:175], v[164:167]
  v_mfma_f32_16x16x32_bf16 v[164:167], a[132:135], a[176:179], v[164:167]
  ds_read2_b32 a[206:207], v245 offset0:34 offset1:35
  buffer_load_dwordx4 v9, s[16:19], s49 offen offset:1024 lds
  v_mfma_f32_16x16x32_bf16 v[164:167], a[128:131], a[180:183], v[164:167]
  ds_read2_b32 a[208:209], v246 offset0:160 offset1:161
  v_mfma_f32_16x16x32_bf16 v[168:171], a[128:131], a[184:187], 0
  ds_read2_b32 a[210:211], v246 offset0:162 offset1:163
  v_mfma_f32_16x16x32_bf16 v[168:171], a[132:135], a[180:183], v[168:171]
  ds_read2_b32 a[212:213], v246 offset0:32 offset1:33
  buffer_load_dwordx4 v10, s[16:19], s49 offen offset:2048 lds
  v_mfma_f32_16x16x32_bf16 v[168:171], a[136:139], a[176:179], v[168:171]
  s_waitcnt lgkmcnt(0)
  s_barrier
  v_mfma_f32_16x16x32_bf16 v[168:171], a[140:143], a[172:175], v[168:171]
  ds_read_b128 v[224:227], v255 offset:0
  ds_read2_b32 a[214:215], v246 offset0:34 offset1:35
  v_mfma_f32_16x16x32_bf16 v[168:171], a[144:147], a[168:171], v[168:171]
  ds_read_b128 v[228:231], v255 offset:1024
  ds_read2_b32 a[216:217], v247 offset0:160 offset1:161
  v_mfma_f32_16x16x32_bf16 v[168:171], a[148:151], a[164:167], v[168:171]
  ds_read_b128 v[232:235], v255 offset:2048
  ds_read2_b32 a[218:219], v247 offset0:162 offset1:163
  v_mfma_f32_16x16x32_bf16 v[168:171], a[152:155], a[160:163], v[168:171]
  ds_read_b128 v[236:239], v255 offset:3072
  ds_read2_b32 a[220:221], v247 offset0:32 offset1:33
  v_mfma_f32_16x16x32_bf16 v[172:175], a[156:159], a[160:163], 0
  ds_read2_b32 a[222:223], v247 offset0:34 offset1:35
  buffer_load_dwordx4 v11, s[16:19], s49 offen offset:3072 lds
  v_mfma_f32_16x16x32_bf16 v[172:175], a[152:155], a[164:167], v[172:175]
  v_mfma_f32_16x16x32_bf16 v[172:175], a[148:151], a[168:171], v[172:175]
  s_add_u32 m0, s32, 45056
  v_mfma_f32_16x16x32_bf16 v[172:175], a[144:147], a[172:175], v[172:175]
  v_mfma_f32_16x16x32_bf16 v[172:175], a[140:143], a[176:179], v[172:175]
  v_mfma_f32_16x16x32_bf16 v[172:175], a[136:139], a[180:183], v[172:175]
  v_mfma_f32_16x16x32_bf16 v[172:175], a[132:135], a[184:187], v[172:175]
  v_and_b32 v16, 0xffff0000, v25
  v_lshlrev_b32 v17, 16, v25
  v_mfma_f32_16x16x32_bf16 v[172:175], a[128:131], a[188:191], v[172:175]
  buffer_load_dwordx4 v12, s[16:19], s49 offen offset:0 lds
  s_waitcnt lgkmcnt(0)
  v_and_b32 v18, 0xffff0000, v24
  v_mfma_f32_16x16x32_bf16 v[144:147], a[192:195], a[224:227], v[144:147]
  v_lshlrev_b32 v19, 16, v24
  v_mfma_f32_16x16x32_bf16 v[148:151], a[196:199], a[224:227], v[148:151]
  ds_read2_b32 a[128:129], v244 offset0:144 offset1:145
  v_fmac_f32 v176, s95, v16
  v_mfma_f32_16x16x32_bf16 v[148:151], a[192:195], a[228:231], v[148:151]
  ds_read2_b32 a[130:131], v244 offset0:146 offset1:147
  s_add_u32 m0, s32, 73728
  v_fmac_f32 v177, s95, v17
  v_mfma_f32_16x16x32_bf16 v[152:155], a[192:195], a[232:235], v[152:155]
  ds_read_b128 a[160:163], v248 offset:64
  v_fmac_f32 v178, s95, v18
  v_mfma_f32_16x16x32_bf16 v[152:155], a[196:199], a[228:231], v[152:155]
  ds_read_b128 a[164:167], v248 offset:576
  v_fmac_f32 v179, s95, v19
  v_mfma_f32_16x16x32_bf16 v[152:155], a[200:203], a[224:227], v[152:155]
  v_add_f32 v176, v176, v224
  v_add_f32 v177, v177, v225
  v_mfma_f32_16x16x32_bf16 v[156:159], a[204:207], a[224:227], v[156:159]
  ds_read_b128 a[168:171], v248 offset:1088
  buffer_load_dwordx4 v4, s[16:19], s50 offen offset:0 lds
  v_add_f32 v178, v178, v226
  v_mfma_f32_16x16x32_bf16 v[156:159], a[200:203], a[228:231], v[156:159]
  ds_read_b128 a[172:175], v248 offset:1600
  v_add_f32 v179, v179, v227
  v_mfma_f32_16x16x32_bf16 v[156:159], a[196:199], a[232:235], v[156:159]
  ds_read_b128 a[176:179], v248 offset:2112
  v_cvt_pk_bf16_f32 v176, v176, v177
  v_mfma_f32_16x16x32_bf16 v[156:159], a[192:195], a[236:239], v[156:159]
  ds_read_b128 a[180:183], v248 offset:2624
  v_cvt_pk_bf16_f32 v177, v178, v179
  v_mfma_f32_16x16x32_bf16 v[160:163], a[192:195], a[240:243], v[160:163]
  ds_read_b128 a[184:187], v248 offset:3136
  v_and_b32 v20, 0xffff0000, v27
  v_mfma_f32_16x16x32_bf16 v[160:163], a[196:199], a[236:239], v[160:163]
  ds_read_b128 a[188:191], v248 offset:3648
  v_lshlrev_b32 v21, 16, v27
  v_mfma_f32_16x16x32_bf16 v[160:163], a[200:203], a[232:235], v[160:163]
  buffer_load_dwordx4 v5, s[16:19], s50 offen offset:1024 lds
  v_and_b32 v22, 0xffff0000, v26
  v_mfma_f32_16x16x32_bf16 v[160:163], a[204:207], a[228:231], v[160:163]
  v_lshlrev_b32 v23, 16, v26
  v_fmac_f32 v180, s95, v20
  v_mfma_f32_16x16x32_bf16 v[160:163], a[208:211], a[224:227], v[160:163]
  ds_read2_b32 a[132:133], v244 offset0:16 offset1:17
  buffer_load_dwordx4 v6, s[16:19], s50 offen offset:2048 lds
  v_fmac_f32 v181, s95, v21
  v_mfma_f32_16x16x32_bf16 v[164:167], a[212:215], a[224:227], v[164:167]
  ds_read2_b32 a[134:135], v244 offset0:18 offset1:19
  v_fmac_f32 v182, s95, v22
  v_mfma_f32_16x16x32_bf16 v[164:167], a[208:211], a[228:231], v[164:167]
  ds_read2_b32 a[136:137], v245 offset0:144 offset1:145
  v_fmac_f32 v183, s95, v23
  v_mfma_f32_16x16x32_bf16 v[164:167], a[204:207], a[232:235], v[164:167]
  ds_read2_b32 a[138:139], v245 offset0:146 offset1:147
  v_add_f32 v180, v180, v228
  v_mfma_f32_16x16x32_bf16 v[164:167], a[200:203], a[236:239], v[164:167]
  ds_read2_b32 a[140:141], v245 offset0:16 offset1:17
  buffer_load_dwordx4 v7, s[16:19], s50 offen offset:3072 lds
  v_add_f32 v181, v181, v229
  v_mfma_f32_16x16x32_bf16 v[164:167], a[196:199], a[240:243], v[164:167]
  ds_read2_b32 a[142:143], v245 offset0:18 offset1:19
  v_add_f32 v182, v182, v230
  v_mfma_f32_16x16x32_bf16 v[164:167], a[192:195], a[244:247], v[164:167]
  ds_read2_b32 a[144:145], v246 offset0:144 offset1:145
  v_add_f32 v183, v183, v231
  v_mfma_f32_16x16x32_bf16 v[168:171], a[192:195], a[248:251], v[168:171]
  s_add_u32 m0, s32, 77824
  v_cvt_pk_bf16_f32 v178, v180, v181
  v_cvt_pk_bf16_f32 v179, v182, v183
  v_mfma_f32_16x16x32_bf16 v[168:171], a[196:199], a[244:247], v[168:171]
  ds_read2_b32 a[146:147], v246 offset0:146 offset1:147
  v_permlane16_swap_b32 v176, v178
  v_mfma_f32_16x16x32_bf16 v[168:171], a[200:203], a[240:243], v[168:171]
  ds_read2_b32 a[148:149], v246 offset0:16 offset1:17
  v_permlane16_swap_b32 v177, v179
  v_mfma_f32_16x16x32_bf16 v[168:171], a[204:207], a[236:239], v[168:171]
  buffer_store_dwordx4 v[176:179], v250, s[20:23], s65 offen offset:0 sc1
  ds_read2_b32 a[150:151], v246 offset0:18 offset1:19
  buffer_load_dwordx4 v8, s[16:19], s50 offen offset:0 lds
  v_mfma_f32_16x16x32_bf16 v[168:171], a[208:211], a[232:235], v[168:171]
  ds_read2_b32 a[152:153], v247 offset0:144 offset1:145
  v_and_b32 v16, 0xffff0000, v29
  v_mfma_f32_16x16x32_bf16 v[168:171], a[212:215], a[228:231], v[168:171]
  ds_read2_b32 a[154:155], v247 offset0:146 offset1:147
  v_lshlrev_b32 v17, 16, v29
  v_mfma_f32_16x16x32_bf16 v[168:171], a[216:219], a[224:227], v[168:171]
  ds_read2_b32 a[156:157], v247 offset0:16 offset1:17
  v_and_b32 v18, 0xffff0000, v28
  v_mfma_f32_16x16x32_bf16 v[172:175], a[220:223], a[224:227], v[172:175]
  ds_read2_b32 a[158:159], v247 offset0:18 offset1:19
  v_lshlrev_b32 v19, 16, v28
  v_mfma_f32_16x16x32_bf16 v[172:175], a[216:219], a[228:231], v[172:175]
  v_fmac_f32 v184, s95, v16
  v_fmac_f32 v185, s95, v17
  v_mfma_f32_16x16x32_bf16 v[172:175], a[212:215], a[232:235], v[172:175]
  buffer_load_dwordx4 v9, s[16:19], s50 offen offset:1024 lds
  v_fmac_f32 v186, s95, v18
  v_mfma_f32_16x16x32_bf16 v[172:175], a[208:211], a[236:239], v[172:175]
  v_fmac_f32 v187, s95, v19
  v_mfma_f32_16x16x32_bf16 v[172:175], a[204:207], a[240:243], v[172:175]
  v_add_f32 v184, v184, v232
  v_mfma_f32_16x16x32_bf16 v[172:175], a[200:203], a[244:247], v[172:175]
  buffer_load_dwordx4 v10, s[16:19], s50 offen offset:2048 lds
  v_add_f32 v185, v185, v233
  v_mfma_f32_16x16x32_bf16 v[172:175], a[196:199], a[248:251], v[172:175]
  v_add_f32 v186, v186, v234
  v_mfma_f32_16x16x32_bf16 v[172:175], a[192:195], a[252:255], v[172:175]
  v_add_f32 v187, v187, v235
  s_waitcnt lgkmcnt(0)
  v_mfma_f32_16x16x32_bf16 v[144:147], a[128:131], a[160:163], v[144:147]
  buffer_load_dwordx4 v11, s[16:19], s50 offen offset:3072 lds
  v_cvt_pk_bf16_f32 v184, v184, v185
  v_mfma_f32_16x16x32_bf16 v[148:151], a[132:135], a[160:163], v[148:151]
  ds_read2_b32 a[192:193], v244 offset0:128 offset1:129
  v_cvt_pk_bf16_f32 v185, v186, v187
  v_mfma_f32_16x16x32_bf16 v[148:151], a[128:131], a[164:167], v[148:151]
  v_and_b32 v20, 0xffff0000, v31
  v_lshlrev_b32 v21, 16, v31
  v_mfma_f32_16x16x32_bf16 v[152:155], a[128:131], a[168:171], v[152:155]
  ds_read2_b32 a[194:195], v244 offset0:130 offset1:131
  v_and_b32 v22, 0xffff0000, v30
  v_mfma_f32_16x16x32_bf16 v[152:155], a[132:135], a[164:167], v[152:155]
  ds_read_b128 a[224:227], v248 offset:0
  v_lshlrev_b32 v23, 16, v30
  v_mfma_f32_16x16x32_bf16 v[152:155], a[136:139], a[160:163], v[152:155]
  ds_read_b128 a[228:231], v248 offset:512
  s_add_u32 m0, s32, 81920
  v_fmac_f32 v188, s95, v20
  v_mfma_f32_16x16x32_bf16 v[156:159], a[140:143], a[160:163], v[156:159]
  ds_read_b128 a[232:235], v248 offset:1024
  v_fmac_f32 v189, s95, v21
  v_mfma_f32_16x16x32_bf16 v[156:159], a[136:139], a[164:167], v[156:159]
  ds_read_b128 a[236:239], v248 offset:1536
  v_fmac_f32 v190, s95, v22
  v_mfma_f32_16x16x32_bf16 v[156:159], a[132:135], a[168:171], v[156:159]
  ds_read_b128 a[240:243], v248 offset:2048
  v_fmac_f32 v191, s95, v23
  v_mfma_f32_16x16x32_bf16 v[156:159], a[128:131], a[172:175], v[156:159]
  buffer_load_dwordx4 v12, s[16:19], s50 offen offset:0 lds
  v_add_f32 v188, v188, v236
  v_add_f32 v189, v189, v237
  v_mfma_f32_16x16x32_bf16 v[160:163], a[128:131], a[176:179], v[160:163]
  ds_read_b128 a[244:247], v248 offset:2560
  v_add_f32 v190, v190, v238
  v_mfma_f32_16x16x32_bf16 v[160:163], a[132:135], a[172:175], v[160:163]
  ds_read_b128 a[248:251], v248 offset:3072
  v_add_f32 v191, v191, v239
  v_mfma_f32_16x16x32_bf16 v[160:163], a[136:139], a[168:171], v[160:163]
  ds_read_b128 a[252:255], v248 offset:3584
  v_cvt_pk_bf16_f32 v186, v188, v189
  v_mfma_f32_16x16x32_bf16 v[160:163], a[140:143], a[164:167], v[160:163]
  ds_read2_b32 a[196:197], v244 offset0:0 offset1:1
  v_cvt_pk_bf16_f32 v187, v190, v191
  v_mfma_f32_16x16x32_bf16 v[160:163], a[144:147], a[160:163], v[160:163]
  ds_read2_b32 a[198:199], v244 offset0:2 offset1:3
  v_permlane16_swap_b32 v184, v186
  v_mfma_f32_16x16x32_bf16 v[164:167], a[148:151], a[160:163], v[164:167]
  ds_read2_b32 a[200:201], v245 offset0:128 offset1:129
  v_permlane16_swap_b32 v185, v187
  v_mfma_f32_16x16x32_bf16 v[164:167], a[144:147], a[164:167], v[164:167]
  buffer_store_dwordx4 v[184:187], v250, s[20:23], s65 offen offset:1024 sc1
  ds_read2_b32 a[202:203], v245 offset0:130 offset1:131
  v_mfma_f32_16x16x32_bf16 v[164:167], a[140:143], a[168:171], v[164:167]
  ds_read2_b32 a[204:205], v245 offset0:0 offset1:1
  v_mfma_f32_16x16x32_bf16 v[164:167], a[136:139], a[172:175], v[164:167]
  v_subrev_u32 v251, 26624, v251
  v_mfma_f32_16x16x32_bf16 v[164:167], a[132:135], a[176:179], v[164:167]
  ds_read2_b32 a[206:207], v245 offset0:2 offset1:3
  v_subrev_u32 v255, 26624, v255
  v_mfma_f32_16x16x32_bf16 v[164:167], a[128:131], a[180:183], v[164:167]
  ds_read2_b32 a[208:209], v246 offset0:128 offset1:129
  v_mfma_f32_16x16x32_bf16 v[168:171], a[128:131], a[184:187], v[168:171]
  s_mov_b32 s95, s0
  ds_read2_b32 a[210:211], v246 offset0:130 offset1:131
  v_mfma_f32_16x16x32_bf16 v[168:171], a[132:135], a[180:183], v[168:171]
  ds_read2_b32 a[212:213], v246 offset0:0 offset1:1
  v_mfma_f32_16x16x32_bf16 v[168:171], a[136:139], a[176:179], v[168:171]
  s_mov_b32 s65, s46
  ds_read2_b32 a[214:215], v246 offset0:2 offset1:3
  v_mfma_f32_16x16x32_bf16 v[168:171], a[140:143], a[172:175], v[168:171]
  v_mfma_f32_16x16x32_bf16 v[168:171], a[144:147], a[168:171], v[168:171]
  ds_read2_b32 a[216:217], v247 offset0:128 offset1:129
  v_lshrrev_b32 v3, 2, v0
  v_mfma_f32_16x16x32_bf16 v[168:171], a[148:151], a[164:167], v[168:171]
  ds_read2_b32 a[218:219], v247 offset0:130 offset1:131
  v_mfma_f32_16x16x32_bf16 v[168:171], a[152:155], a[160:163], v[168:171]
  ds_read2_b32 a[220:221], v247 offset0:0 offset1:1
  v_mul_u32_u24 v3, 288, v3
  v_mfma_f32_16x16x32_bf16 v[172:175], a[156:159], a[160:163], v[172:175]
  ds_read2_b32 a[222:223], v247 offset0:2 offset1:3
  v_mfma_f32_16x16x32_bf16 v[172:175], a[152:155], a[164:167], v[172:175]
  v_and_b32 v13, 3, v0
  v_mfma_f32_16x16x32_bf16 v[172:175], a[148:151], a[168:171], v[172:175]
  v_mfma_f32_16x16x32_bf16 v[172:175], a[144:147], a[172:175], v[172:175]
  v_lshl_add_u32 v240, v13, 3, v3
  v_mfma_f32_16x16x32_bf16 v[172:175], a[140:143], a[176:179], v[172:175]
  v_mfma_f32_16x16x32_bf16 v[172:175], a[136:139], a[180:183], v[172:175]
  v_add_u32 v241, 64512, v240
  v_mfma_f32_16x16x32_bf16 v[172:175], a[132:135], a[184:187], v[172:175]
  v_mfma_f32_16x16x32_bf16 v[172:175], a[128:131], a[188:191], v[172:175]
  v_add_u32 v242, 129024, v240
  s_waitcnt lgkmcnt(0)
  v_mfma_f32_16x16x32_bf16 v[144:147], a[192:195], a[224:227], v[144:147]
  v_mfma_f32_16x16x32_bf16 v[148:151], a[196:199], a[224:227], v[148:151]
  s_bitcmp1_b32 s65, 0
  s_cselect_b32 s27, 0, 16
  s_lshl_b32 s95, s95, s27
  v_mfma_f32_16x16x32_bf16 v[148:151], a[192:195], a[228:231], v[148:151]
  ds_read_b64 v[232:233], v249 offset:1536
  ds_read_b64 v[234:235], v249 offset:1024
  v_mfma_f32_16x16x32_bf16 v[152:155], a[192:195], a[232:235], v[152:155]
  s_and_b32 s95, s95, 0xffff0000
  ds_read_b64 v[236:237], v249 offset:512
  v_mfma_f32_16x16x32_bf16 v[152:155], a[196:199], a[228:231], v[152:155]
  ds_read_b64 v[238:239], v249 offset:0
  v_mfma_f32_16x16x32_bf16 v[152:155], a[200:203], a[224:227], v[152:155]
  s_lshl_b32 s65, s65, 12
  v_mfma_f32_16x16x32_bf16 v[156:159], a[204:207], a[224:227], v[156:159]
  v_mfma_f32_16x16x32_bf16 v[156:159], a[200:203], a[228:231], v[156:159]
  s_and_b32 s27, s24, 1
  s_lshl_b32 s27, s27, 11
  s_add_u32 s65, s65, s27
  v_mfma_f32_16x16x32_bf16 v[156:159], a[196:199], a[232:235], v[156:159]
  v_mfma_f32_16x16x32_bf16 v[156:159], a[192:195], a[236:239], v[156:159]
  s_add_u32 s65, s65, 62914560
  v_mfma_f32_16x16x32_bf16 v[160:163], a[192:195], a[240:243], v[160:163]
  v_mfma_f32_16x16x32_bf16 v[160:163], a[196:199], a[236:239], v[160:163]
  v_mfma_f32_16x16x32_bf16 v[160:163], a[200:203], a[232:235], v[160:163]
  v_mfma_f32_16x16x32_bf16 v[160:163], a[204:207], a[228:231], v[160:163]
  v_mfma_f32_16x16x32_bf16 v[160:163], a[208:211], a[224:227], v[160:163]
  s_waitcnt vmcnt(0)
  s_barrier
  v_mfma_f32_16x16x32_bf16 v[164:167], a[212:215], a[224:227], v[164:167]
  ds_read_b64_tr_b16 a[144:145], v240 offset:0
  v_mfma_f32_16x16x32_bf16 v[164:167], a[208:211], a[228:231], v[164:167]
  s_lshr_b32 s27, s3, 1
  s_lshl_b32 s27, s27, 7
  s_lshl_b32 s28, s24, 2
  s_add_u32 s27, s27, s28
  s_add_u32 s27, s27, 66322432
  buffer_store_dword v252, off, s[20:23], s27 sc1
  v_mfma_f32_16x16x32_bf16 v[164:167], a[204:207], a[232:235], v[164:167]
  ds_read_b64_tr_b16 a[146:147], v240 offset:4608
  v_mfma_f32_16x16x32_bf16 v[164:167], a[200:203], a[236:239], v[164:167]
  ds_read_b64_tr_b16 a[148:149], v240 offset:9216
  v_mfma_f32_16x16x32_bf16 v[164:167], a[196:199], a[240:243], v[164:167]
  ds_read_b64_tr_b16 a[150:151], v240 offset:13824
  v_mfma_f32_16x16x32_bf16 v[164:167], a[192:195], a[244:247], v[164:167]
  ds_read_b64_tr_b16 a[152:153], v240 offset:32
  v_mfma_f32_16x16x32_bf16 v[168:171], a[192:195], a[248:251], v[168:171]
  ds_read_b64_tr_b16 a[154:155], v240 offset:4640
  v_mfma_f32_16x16x32_bf16 v[168:171], a[196:199], a[244:247], v[168:171]
  v_mfma_f32_16x16x32_bf16 v[168:171], a[200:203], a[240:243], v[168:171]
  ds_read_b64_tr_b16 a[156:157], v240 offset:9248
  v_mfma_f32_16x16x32_bf16 v[168:171], a[204:207], a[236:239], v[168:171]
  ds_read_b64_tr_b16 a[158:159], v240 offset:13856
  v_mfma_f32_16x16x32_bf16 v[168:171], a[208:211], a[232:235], v[168:171]
  ds_read_b64_tr_b16 a[160:161], v240 offset:64
  v_mfma_f32_16x16x32_bf16 v[168:171], a[212:215], a[228:231], v[168:171]
  v_mfma_f32_16x16x32_bf16 v[168:171], a[216:219], a[224:227], v[168:171]
  ds_read_b64_tr_b16 a[162:163], v240 offset:4672
  v_mfma_f32_16x16x32_bf16 v[172:175], a[220:223], a[224:227], v[172:175]
  ds_read_b64_tr_b16 a[164:165], v240 offset:9280
  v_mfma_f32_16x16x32_bf16 v[172:175], a[216:219], a[228:231], v[172:175]
  ds_read_b64_tr_b16 a[166:167], v240 offset:13888
  v_mfma_f32_16x16x32_bf16 v[172:175], a[212:215], a[232:235], v[172:175]
  v_mfma_f32_16x16x32_bf16 v[172:175], a[208:211], a[236:239], v[172:175]
  ds_read_b64_tr_b16 a[168:169], v240 offset:96
  v_mfma_f32_16x16x32_bf16 v[172:175], a[204:207], a[240:243], v[172:175]
  ds_read_b64_tr_b16 a[170:171], v240 offset:4704
  v_mfma_f32_16x16x32_bf16 v[172:175], a[200:203], a[244:247], v[172:175]
  v_mfma_f32_16x16x32_bf16 v[172:175], a[196:199], a[248:251], v[172:175]
  v_mfma_f32_16x16x32_bf16 v[172:175], a[192:195], a[252:255], v[172:175]
  s_waitcnt lgkmcnt(10)
  s_branch K_J
K_PI_spin:
  s_mov_b32 s94, 100000
K_PI_spin2:
  s_sleep 16
  v_and_b32 v3, 28, v253
  v_lshlrev_b32 v3, 3, v3
  buffer_load_dword v3, v3, s[56:59], 0 offen sc1
  s_waitcnt vmcnt(0)
  v_cmp_gt_u32 vcc, 32, v3
  s_cbranch_vccz K_PI_ok
  s_sub_u32 s94, s94, 1
  s_cbranch_scc0 K_PI_spin2
  s_branch K_PI_ok
K_PK_spin:
  s_mov_b32 s94, 100000
K_PK_spin2:
  s_sleep 2
  s_and_b32 s27, s2, 7
  s_lshl_b32 s27, s27, 9
  s_add_u32 s27, s27, 66191360
  buffer_load_dword v3, v253, s[20:23], s27 offen sc1
  s_waitcnt vmcnt(0)
  v_cmp_ne_u32 vcc, 1, v3
  s_cbranch_vccz K_PK_ok
  s_sub_u32 s94, s94, 1
  s_cbranch_scc0 K_PK_spin2
  s_branch K_PK_ok
K_PV_spin:
  s_mov_b32 s94, 100000
K_PV_spin2:
  s_sleep 2
  s_lshl_b32 s27, s25, 7
  s_add_u32 s27, s27, 66195456
  v_and_b32 v3, 28, v253
  buffer_load_dword v3, v3, s[20:23], s27 offen sc1
  s_waitcnt vmcnt(0)
  v_cmp_ne_u32 vcc, 1, v3
  s_cbranch_vccz K_PV_ok
  s_sub_u32 s94, s94, 1
  s_cbranch_scc0 K_PV_spin2
  s_branch K_PV_ok
K_PC_spin:
  s_mov_b32 s94, 100000
K_PC_spin2:
  s_sleep 2
  v_and_b32 v3, 12, v253
  buffer_load_dword v3, v3, s[20:23], s31 offen sc1
  s_waitcnt vmcnt(0)
  v_cmp_ne_u32 vcc, 1, v3
  s_cbranch_vccz K_PC_ok
  s_sub_u32 s94, s94, 1
  s_cbranch_scc0 K_PC_spin2
  s_branch K_PC_ok
K_PY_spin:
  s_mov_b32 s94, 100000
K_PY_spin2:
  s_sleep 2
  buffer_load_dword v3, v175, s[20:23], 0 offen sc1
  s_waitcnt vmcnt(0)
  v_cmp_ne_u32 vcc, 1, v3
  s_cbranch_vccz K_PY_ok
  s_sub_u32 s94, s94, 1
  s_cbranch_scc0 K_PY_spin2
  s_branch K_PY_ok
K_PG_spin:
  s_mov_b32 s94, 100000
K_PG_spin2:
  s_sleep 16
  s_mov_b32 s27, 66195456
  v_lshlrev_b32 v3, 6, v0
  v_and_b32 v3, 0xf80, v3
  v_and_b32 v195, 16, v1
  v_add_u32 v3, v3, v195
  buffer_load_dwordx4 a[160:163], v3, s[20:23], s27 offen sc1
  s_waitcnt vmcnt(0)
  v_accvgpr_read_b32 v3, a160
  v_accvgpr_read_b32 v195, a161
  v_and_b32 v3, v3, v195
  v_accvgpr_read_b32 v195, a162
  v_and_b32 v3, v3, v195
  v_accvgpr_read_b32 v195, a163
  v_and_b32 v3, v3, v195
  v_cmp_ne_u32 vcc, 1, v3
  s_cbranch_vccz K_PG_ok
  s_sub_u32 s94, s94, 1
  s_cbranch_scc0 K_PG_spin2
  s_branch K_PG_ok
K_redo:
  s_mov_b32 s40, 1
  s_waitcnt vmcnt(0)
  s_lshl_b32 s27, s26, 7
  v_add_u32 v144, s27, v254
  v_add_u32 v145, 64, v144
  s_sub_u32 s27, 1920, s27
  v_add_u32 v146, s27, v254
  v_add_u32 v147, 64, v146
  v_mov_b32 v148, 0xff800000
  v_mov_b32 v208, 0xff800000
  v_mov_b32 v209, 0xff800000
  v_mov_b32 v210, 0xff800000
  v_mov_b32 v211, 0xff800000
  s_lshl_b32 s39, s26, 2
  s_sub_u32 s39, 63, s39
  s_lshl_b32 s36, s25, 19
  s_lshl_b32 s27, s24, 11
  s_add_u32 s36, s36, s27
  s_add_u32 s36, s36, 0
K_mloop:
  s_barrier
  s_lshl_b32 m0, s24, 11
  s_nop 0
  buffer_load_dwordx4 v1, s[20:23], s36 offen offset:0 sc1 lds
  buffer_load_dwordx4 v1, s[20:23], s36 offen offset:1024 sc1 lds
  s_add_u32 s36, s36, 8192
  s_waitcnt vmcnt(0)
  s_barrier
  ds_read_b128 a[192:195], v1 offset:0
  ds_read_b128 a[196:199], v1 offset:1024
  ds_read_b128 a[200:203], v1 offset:2048
  ds_read_b128 a[204:207], v1 offset:3072
  ds_read_b128 a[208:211], v1 offset:4096
  ds_read_b128 a[212:215], v1 offset:5120
  ds_read_b128 a[216:219], v1 offset:6144
  ds_read_b128 a[220:223], v1 offset:7168
  s_waitcnt lgkmcnt(0)
  v_mfma_f32_16x16x32_bf16 v[80:83], a[192:195], v[16:19], 0
  v_mfma_f32_16x16x32_bf16 v[88:91], a[192:195], v[32:35], 0
  v_mfma_f32_16x16x32_bf16 v[96:99], a[192:195], v[48:51], 0
  v_mfma_f32_16x16x32_bf16 v[104:107], a[192:195], v[64:67], 0
  v_mfma_f32_16x16x32_bf16 v[80:83], a[196:199], v[20:23], v[80:83]
  v_mfma_f32_16x16x32_bf16 v[88:91], a[196:199], v[36:39], v[88:91]
  v_mfma_f32_16x16x32_bf16 v[96:99], a[196:199], v[52:55], v[96:99]
  v_mfma_f32_16x16x32_bf16 v[104:107], a[196:199], v[68:71], v[104:107]
  v_mfma_f32_16x16x32_bf16 v[80:83], a[200:203], v[24:27], v[80:83]
  v_mfma_f32_16x16x32_bf16 v[88:91], a[200:203], v[40:43], v[88:91]
  v_mfma_f32_16x16x32_bf16 v[96:99], a[200:203], v[56:59], v[96:99]
  v_mfma_f32_16x16x32_bf16 v[104:107], a[200:203], v[72:75], v[104:107]
  v_mfma_f32_16x16x32_bf16 v[80:83], a[204:207], v[28:31], v[80:83]
  v_mfma_f32_16x16x32_bf16 v[88:91], a[204:207], v[44:47], v[88:91]
  v_mfma_f32_16x16x32_bf16 v[96:99], a[204:207], v[60:63], v[96:99]
  v_mfma_f32_16x16x32_bf16 v[104:107], a[204:207], v[76:79], v[104:107]
  v_mfma_f32_16x16x32_bf16 v[84:87], a[208:211], v[16:19], 0
  v_mfma_f32_16x16x32_bf16 v[92:95], a[208:211], v[32:35], 0
  v_mfma_f32_16x16x32_bf16 v[100:103], a[208:211], v[48:51], 0
  v_mfma_f32_16x16x32_bf16 v[108:111], a[208:211], v[64:67], 0
  v_mfma_f32_16x16x32_bf16 v[84:87], a[212:215], v[20:23], v[84:87]
  v_mfma_f32_16x16x32_bf16 v[92:95], a[212:215], v[36:39], v[92:95]
  v_mfma_f32_16x16x32_bf16 v[100:103], a[212:215], v[52:55], v[100:103]
  v_mfma_f32_16x16x32_bf16 v[108:111], a[212:215], v[68:71], v[108:111]
  v_mfma_f32_16x16x32_bf16 v[84:87], a[216:219], v[24:27], v[84:87]
  v_mfma_f32_16x16x32_bf16 v[92:95], a[216:219], v[40:43], v[92:95]
  v_mfma_f32_16x16x32_bf16 v[100:103], a[216:219], v[56:59], v[100:103]
  v_mfma_f32_16x16x32_bf16 v[108:111], a[216:219], v[72:75], v[108:111]
  v_mfma_f32_16x16x32_bf16 v[84:87], a[220:223], v[28:31], v[84:87]
  v_mfma_f32_16x16x32_bf16 v[92:95], a[220:223], v[44:47], v[92:95]
  v_mfma_f32_16x16x32_bf16 v[100:103], a[220:223], v[60:63], v[100:103]
  v_mfma_f32_16x16x32_bf16 v[108:111], a[220:223], v[76:79], v[108:111]
  v_cmp_gt_i32 vcc, 0, v144
  s_nop 1
  v_cndmask_b32 v3, v80, v148, vcc
  v_max_f32 v208, v208, v3
  v_cmp_gt_i32 vcc, 1, v144
  s_nop 1
  v_cndmask_b32 v3, v81, v148, vcc
  v_max_f32 v208, v208, v3
  v_cmp_gt_i32 vcc, 2, v144
  s_nop 1
  v_cndmask_b32 v3, v82, v148, vcc
  v_max_f32 v208, v208, v3
  v_cmp_gt_i32 vcc, 3, v144
  s_nop 1
  v_cndmask_b32 v3, v83, v148, vcc
  v_max_f32 v208, v208, v3
  v_cmp_gt_i32 vcc, 16, v144
  s_nop 1
  v_cndmask_b32 v3, v84, v148, vcc
  v_max_f32 v208, v208, v3
  v_cmp_gt_i32 vcc, 17, v144
  s_nop 1
  v_cndmask_b32 v3, v85, v148, vcc
  v_max_f32 v208, v208, v3
  v_cmp_gt_i32 vcc, 18, v144
  s_nop 1
  v_cndmask_b32 v3, v86, v148, vcc
  v_max_f32 v208, v208, v3
  v_cmp_gt_i32 vcc, 19, v144
  s_nop 1
  v_cndmask_b32 v3, v87, v148, vcc
  v_max_f32 v208, v208, v3
  v_subrev_u32 v144, 32, v144
  v_cmp_gt_i32 vcc, 0, v145
  s_nop 1
  v_cndmask_b32 v3, v88, v148, vcc
  v_max_f32 v209, v209, v3
  v_cmp_gt_i32 vcc, 1, v145
  s_nop 1
  v_cndmask_b32 v3, v89, v148, vcc
  v_max_f32 v209, v209, v3
  v_cmp_gt_i32 vcc, 2, v145
  s_nop 1
  v_cndmask_b32 v3, v90, v148, vcc
  v_max_f32 v209, v209, v3
  v_cmp_gt_i32 vcc, 3, v145
  s_nop 1
  v_cndmask_b32 v3, v91, v148, vcc
  v_max_f32 v209, v209, v3
  v_cmp_gt_i32 vcc, 16, v145
  s_nop 1
  v_cndmask_b32 v3, v92, v148, vcc
  v_max_f32 v209, v209, v3
  v_cmp_gt_i32 vcc, 17, v145
  s_nop 1
  v_cndmask_b32 v3, v93, v148, vcc
  v_max_f32 v209, v209, v3
  v_cmp_gt_i32 vcc, 18, v145
  s_nop 1
  v_cndmask_b32 v3, v94, v148, vcc
  v_max_f32 v209, v209, v3
  v_cmp_gt_i32 vcc, 19, v145
  s_nop 1
  v_cndmask_b32 v3, v95, v148, vcc
  v_max_f32 v209, v209, v3
  v_subrev_u32 v145, 32, v145
  v_cmp_gt_i32 vcc, 0, v146
  s_nop 1
  v_cndmask_b32 v3, v96, v148, vcc
  v_max_f32 v210, v210, v3
  v_cmp_gt_i32 vcc, 1, v146
  s_nop 1
  v_cndmask_b32 v3, v97, v148, vcc
  v_max_f32 v210, v210, v3
  v_cmp_gt_i32 vcc, 2, v146
  s_nop 1
  v_cndmask_b32 v3, v98, v148, vcc
  v_max_f32 v210, v210, v3
  v_cmp_gt_i32 vcc, 3, v146
  s_nop 1
  v_cndmask_b32 v3, v99, v148, vcc
  v_max_f32 v210, v210, v3
  v_cmp_gt_i32 vcc, 16, v146
  s_nop 1
  v_cndmask_b32 v3, v100, v148, vcc
  v_max_f32 v210, v210, v3
  v_cmp_gt_i32 vcc, 17, v146
  s_nop 1
  v_cndmask_b32 v3, v101, v148, vcc
  v_max_f32 v210, v210, v3
  v_cmp_gt_i32 vcc, 18, v146
  s_nop 1
  v_cndmask_b32 v3, v102, v148, vcc
  v_max_f32 v210, v210, v3
  v_cmp_gt_i32 vcc, 19, v146
  s_nop 1
  v_cndmask_b32 v3, v103, v148, vcc
  v_max_f32 v210, v210, v3
  v_subrev_u32 v146, 32, v146
  v_cmp_gt_i32 vcc, 0, v147
  s_nop 1
  v_cndmask_b32 v3, v104, v148, vcc
  v_max_f32 v211, v211, v3
  v_cmp_gt_i32 vcc, 1, v147
  s_nop 1
  v_cndmask_b32 v3, v105, v148, vcc
  v_max_f32 v211, v211, v3
  v_cmp_gt_i32 vcc, 2, v147
  s_nop 1
  v_cndmask_b32 v3, v106, v148, vcc
  v_max_f32 v211, v211, v3
  v_cmp_gt_i32 vcc, 3, v147
  s_nop 1
  v_cndmask_b32 v3, v107, v148, vcc
  v_max_f32 v211, v211, v3
  v_cmp_gt_i32 vcc, 16, v147
  s_nop 1
  v_cndmask_b32 v3, v108, v148, vcc
  v_max_f32 v211, v211, v3
  v_cmp_gt_i32 vcc, 17, v147
  s_nop 1
  v_cndmask_b32 v3, v109, v148, vcc
  v_max_f32 v211, v211, v3
  v_cmp_gt_i32 vcc, 18, v147
  s_nop 1
  v_cndmask_b32 v3, v110, v148, vcc
  v_max_f32 v211, v211, v3
  v_cmp_gt_i32 vcc, 19, v147
  s_nop 1
  v_cndmask_b32 v3, v111, v148, vcc
  v_max_f32 v211, v211, v3
  v_subrev_u32 v147, 32, v147
  s_sub_u32 s39, s39, 1
  s_cbranch_scc0 K_mloop
  v_mov_b32 v212, v208
  v_mov_b32 v213, v209
  v_mov_b32 v214, v210
  v_mov_b32 v215, v211
  v_permlane16_swap_b32 v208, v212
  v_permlane16_swap_b32 v209, v213
  v_permlane16_swap_b32 v210, v214
  v_permlane16_swap_b32 v211, v215
  v_max_f32 v208, v208, v212
  v_max_f32 v209, v209, v213
  v_max_f32 v210, v210, v214
  v_max_f32 v211, v211, v215
  v_mov_b32 v212, v208
  v_mov_b32 v213, v209
  v_mov_b32 v214, v210
  v_mov_b32 v215, v211
  v_permlane32_swap_b32 v208, v212
  v_permlane32_swap_b32 v209, v213
  v_permlane32_swap_b32 v210, v214
  v_permlane32_swap_b32 v211, v215
  v_max_f32 v208, v208, v212
  v_max_f32 v209, v209, v213
  v_max_f32 v210, v210, v214
  v_max_f32 v211, v211, v215
  v_sub_f32 v176, 0, v208
  v_sub_f32 v177, 0, v208
  v_sub_f32 v178, 0, v208
  v_sub_f32 v179, 0, v208
  v_sub_f32 v180, 0, v209
  v_sub_f32 v181, 0, v209
  v_sub_f32 v182, 0, v209
  v_sub_f32 v183, 0, v209
  v_sub_f32 v184, 0, v210
  v_sub_f32 v185, 0, v210
  v_sub_f32 v186, 0, v210
  v_sub_f32 v187, 0, v210
  v_sub_f32 v188, 0, v211
  v_sub_f32 v189, 0, v211
  v_sub_f32 v190, 0, v211
  v_sub_f32 v191, 0, v211
  s_barrier
  s_lshl_b32 s37, s24, 12
  s_add_u32 m0, s46, 65536
  s_add_u32 s36, s42, 0
  buffer_load_dwordx4 v1, s[20:23], s36 offen offset:0 sc1 lds
  buffer_load_dwordx4 v1, s[20:23], s36 offen offset:1024 sc1 lds
  buffer_load_dwordx4 v1, s[20:23], s36 offen offset:2048 sc1 lds
  buffer_load_dwordx4 v1, s[20:23], s36 offen offset:3072 sc1 lds
  s_add_u32 m0, s46, 98304
  s_add_u32 s36, s42, 16384
  buffer_load_dwordx4 v1, s[20:23], s36 offen offset:0 sc1 lds
  buffer_load_dwordx4 v1, s[20:23], s36 offen offset:1024 sc1 lds
  buffer_load_dwordx4 v1, s[20:23], s36 offen offset:2048 sc1 lds
  buffer_load_dwordx4 v1, s[20:23], s36 offen offset:3072 sc1 lds
  s_add_u32 m0, s46, 0
  s_add_u32 s36, s42, 32768
  buffer_load_dwordx4 v1, s[20:23], s36 offen offset:0 sc1 lds
  buffer_load_dwordx4 v1, s[20:23], s36 offen offset:1024 sc1 lds
  buffer_load_dwordx4 v1, s[20:23], s36 offen offset:2048 sc1 lds
  buffer_load_dwordx4 v1, s[20:23], s36 offen offset:3072 sc1 lds
  v_add_u32 v13, 8192, v1
  v_add_u32 v14, 16384, v1
  v_add_u32 v15, 24576, v1
  v_add_u32 v2, 0x10000, v1
  s_cmp_eq_u32 s26, 0
  s_cselect_b32 s27, -1, 0
  v_subrev_u32 v224, 0, v254
  v_ashrrev_i32 v224, 31, v224
  v_and_b32 v224, 0xff800000, v224
  v_subrev_u32 v225, 1, v254
  v_ashrrev_i32 v225, 31, v225
  v_and_b32 v225, 0xff800000, v225
  v_subrev_u32 v226, 2, v254
  v_ashrrev_i32 v226, 31, v226
  v_and_b32 v226, 0xff800000, v226
  v_subrev_u32 v227, 3, v254
  v_ashrrev_i32 v227, 31, v227
  v_and_b32 v227, 0xff800000, v227
  v_subrev_u32 v228, 16, v254
  v_ashrrev_i32 v228, 31, v228
  v_and_b32 v228, 0xff800000, v228
  v_subrev_u32 v229, 17, v254
  v_ashrrev_i32 v229, 31, v229
  v_and_b32 v229, 0xff800000, v229
  v_subrev_u32 v230, 18, v254
  v_ashrrev_i32 v230, 31, v230
  v_and_b32 v230, 0xff800000, v230
  v_subrev_u32 v231, 19, v254
  v_ashrrev_i32 v231, 31, v231
  v_and_b32 v231, 0xff800000, v231
  v_subrev_u32 v232, 32, v254
  v_ashrrev_i32 v232, 31, v232
  v_and_b32 v232, 0xff800000, v232
  v_subrev_u32 v233, 33, v254
  v_ashrrev_i32 v233, 31, v233
  v_and_b32 v233, 0xff800000, v233
  v_subrev_u32 v234, 34, v254
  v_ashrrev_i32 v234, 31, v234
  v_and_b32 v234, 0xff800000, v234
  v_subrev_u32 v235, 35, v254
  v_ashrrev_i32 v235, 31, v235
  v_and_b32 v235, 0xff800000, v235
  v_subrev_u32 v236, 48, v254
  v_ashrrev_i32 v236, 31, v236
  v_and_b32 v236, 0xff800000, v236
  v_subrev_u32 v237, 49, v254
  v_ashrrev_i32 v237, 31, v237
  v_and_b32 v237, 0xff800000, v237
  v_subrev_u32 v238, 50, v254
  v_ashrrev_i32 v238, 31, v238
  v_and_b32 v238, 0xff800000, v238
  v_subrev_u32 v239, 51, v254
  v_ashrrev_i32 v239, 31, v239
  v_and_b32 v239, 0xff800000, v239
  v_accvgpr_write_b32 a128, v224
  v_accvgpr_write_b32 a129, v225
  v_accvgpr_write_b32 a130, v226
  v_accvgpr_write_b32 a131, v227
  v_accvgpr_write_b32 a132, v228
  v_accvgpr_write_b32 a133, v229
  v_accvgpr_write_b32 a134, v230
  v_accvgpr_write_b32 a135, v231
  v_accvgpr_write_b32 a136, v232
  v_accvgpr_write_b32 a137, v233
  v_accvgpr_write_b32 a138, v234
  v_accvgpr_write_b32 a139, v235
  v_accvgpr_write_b32 a140, v236
  v_accvgpr_write_b32 a141, v237
  v_accvgpr_write_b32 a142, v238
  v_accvgpr_write_b32 a143, v239
  v_accvgpr_write_b32 a144, v4
  v_accvgpr_write_b32 a145, v5
  v_accvgpr_write_b32 a146, v6
  v_accvgpr_write_b32 a147, v7
  v_accvgpr_write_b32 a148, v8
  v_accvgpr_write_b32 a149, v9
  v_accvgpr_write_b32 a150, v10
  v_accvgpr_write_b32 a151, v11
  v_accvgpr_write_b32 a0, 0
  v_accvgpr_write_b32 a1, 0
  v_accvgpr_write_b32 a2, 0
  v_accvgpr_write_b32 a3, 0
  v_accvgpr_write_b32 a4, 0
  v_accvgpr_write_b32 a5, 0
  v_accvgpr_write_b32 a6, 0
  v_accvgpr_write_b32 a7, 0
  v_accvgpr_write_b32 a8, 0
  v_accvgpr_write_b32 a9, 0
  v_accvgpr_write_b32 a10, 0
  v_accvgpr_write_b32 a11, 0
  v_accvgpr_write_b32 a12, 0
  v_accvgpr_write_b32 a13, 0
  v_accvgpr_write_b32 a14, 0
  v_accvgpr_write_b32 a15, 0
  v_accvgpr_write_b32 a16, 0
  v_accvgpr_write_b32 a17, 0
  v_accvgpr_write_b32 a18, 0
  v_accvgpr_write_b32 a19, 0
  v_accvgpr_write_b32 a20, 0
  v_accvgpr_write_b32 a21, 0
  v_accvgpr_write_b32 a22, 0
  v_accvgpr_write_b32 a23, 0
  v_accvgpr_write_b32 a24, 0
  v_accvgpr_write_b32 a25, 0
  v_accvgpr_write_b32 a26, 0
  v_accvgpr_write_b32 a27, 0
  v_accvgpr_write_b32 a28, 0
  v_accvgpr_write_b32 a29, 0
  v_accvgpr_write_b32 a30, 0
  v_accvgpr_write_b32 a31, 0
  v_accvgpr_write_b32 a32, 0
  v_accvgpr_write_b32 a33, 0
  v_accvgpr_write_b32 a34, 0
  v_accvgpr_write_b32 a35, 0
  v_accvgpr_write_b32 a36, 0
  v_accvgpr_write_b32 a37, 0
  v_accvgpr_write_b32 a38, 0
  v_accvgpr_write_b32 a39, 0
  v_accvgpr_write_b32 a40, 0
  v_accvgpr_write_b32 a41, 0
  v_accvgpr_write_b32 a42, 0
  v_accvgpr_write_b32 a43, 0
  v_accvgpr_write_b32 a44, 0
  v_accvgpr_write_b32 a45, 0
  v_accvgpr_write_b32 a46, 0
  v_accvgpr_write_b32 a47, 0
  v_accvgpr_write_b32 a48, 0
  v_accvgpr_write_b32 a49, 0
  v_accvgpr_write_b32 a50, 0
  v_accvgpr_write_b32 a51, 0
  v_accvgpr_write_b32 a52, 0
  v_accvgpr_write_b32 a53, 0
  v_accvgpr_write_b32 a54, 0
  v_accvgpr_write_b32 a55, 0
  v_accvgpr_write_b32 a56, 0
  v_accvgpr_write_b32 a57, 0
  v_accvgpr_write_b32 a58, 0
  v_accvgpr_write_b32 a59, 0
  v_accvgpr_write_b32 a60, 0
  v_accvgpr_write_b32 a61, 0
  v_accvgpr_write_b32 a62, 0
  v_accvgpr_write_b32 a63, 0
  v_accvgpr_write_b32 a64, 0
  v_accvgpr_write_b32 a65, 0
  v_accvgpr_write_b32 a66, 0
  v_accvgpr_write_b32 a67, 0
  v_accvgpr_write_b32 a68, 0
  v_accvgpr_write_b32 a69, 0
  v_accvgpr_write_b32 a70, 0
  v_accvgpr_write_b32 a71, 0
  v_accvgpr_write_b32 a72, 0
  v_accvgpr_write_b32 a73, 0
  v_accvgpr_write_b32 a74, 0
  v_accvgpr_write_b32 a75, 0
  v_accvgpr_write_b32 a76, 0
  v_accvgpr_write_b32 a77, 0
  v_accvgpr_write_b32 a78, 0
  v_accvgpr_write_b32 a79, 0
  v_accvgpr_write_b32 a80, 0
  v_accvgpr_write_b32 a81, 0
  v_accvgpr_write_b32 a82, 0
  v_accvgpr_write_b32 a83, 0
  v_accvgpr_write_b32 a84, 0
  v_accvgpr_write_b32 a85, 0
  v_accvgpr_write_b32 a86, 0
  v_accvgpr_write_b32 a87, 0
  v_accvgpr_write_b32 a88, 0
  v_accvgpr_write_b32 a89, 0
  v_accvgpr_write_b32 a90, 0
  v_accvgpr_write_b32 a91, 0
  v_accvgpr_write_b32 a92, 0
  v_accvgpr_write_b32 a93, 0
  v_accvgpr_write_b32 a94, 0
  v_accvgpr_write_b32 a95, 0
  v_accvgpr_write_b32 a96, 0
  v_accvgpr_write_b32 a97, 0
  v_accvgpr_write_b32 a98, 0
  v_accvgpr_write_b32 a99, 0
  v_accvgpr_write_b32 a100, 0
  v_accvgpr_write_b32 a101, 0
  v_accvgpr_write_b32 a102, 0
  v_accvgpr_write_b32 a103, 0
  v_accvgpr_write_b32 a104, 0
  v_accvgpr_write_b32 a105, 0
  v_accvgpr_write_b32 a106, 0
  v_accvgpr_write_b32 a107, 0
  v_accvgpr_write_b32 a108, 0
  v_accvgpr_write_b32 a109, 0
  v_accvgpr_write_b32 a110, 0
  v_accvgpr_write_b32 a111, 0
  v_accvgpr_write_b32 a112, 0
  v_accvgpr_write_b32 a113, 0
  v_accvgpr_write_b32 a114, 0
  v_accvgpr_write_b32 a115, 0
  v_accvgpr_write_b32 a116, 0
  v_accvgpr_write_b32 a117, 0
  v_accvgpr_write_b32 a118, 0
  v_accvgpr_write_b32 a119, 0
  v_accvgpr_write_b32 a120, 0
  v_accvgpr_write_b32 a121, 0
  v_accvgpr_write_b32 a122, 0
  v_accvgpr_write_b32 a123, 0
  v_accvgpr_write_b32 a124, 0
  v_accvgpr_write_b32 a125, 0
  v_accvgpr_write_b32 a126, 0
  v_accvgpr_write_b32 a127, 0
  v_and_b32 v216, s27, v224
  v_add_f32 v216, v216, v176
  v_and_b32 v217, s27, v225
  v_add_f32 v217, v217, v177
  v_and_b32 v218, s27, v226
  v_add_f32 v218, v218, v178
  v_and_b32 v219, s27, v227
  v_add_f32 v219, v219, v179
  v_and_b32 v220, s27, v228
  v_add_f32 v220, v220, v176
  v_and_b32 v221, s27, v229
  v_add_f32 v221, v221, v177
  v_and_b32 v222, s27, v230
  v_add_f32 v222, v222, v178
  v_and_b32 v223, s27, v231
  v_add_f32 v223, v223, v179
  s_waitcnt vmcnt(0)
  s_barrier
  ds_read_b128 a[224:227], v2 offset:0
  ds_read_b128 a[228:231], v2 offset:1024
  ds_read_b128 a[232:235], v2 offset:2048
  ds_read_b128 a[236:239], v2 offset:3072
  ds_read_b128 a[240:243], v2 offset:4096
  ds_read_b128 a[244:247], v2 offset:5120
  ds_read_b128 a[248:251], v2 offset:6144
  ds_read_b128 a[252:255], v2 offset:7168
  s_waitcnt lgkmcnt(0)
  v_mfma_f32_16x16x32_bf16 v[80:83], a[224:227], v[16:19], v[216:219]
  ds_read_b128 a[192:195], v2 offset:16384
  s_lshl_b32 s36, s24, 11
  v_mfma_f32_16x16x32_bf16 v[88:91], a[224:227], v[32:35], v[180:183]
  s_add_u32 m0, s36, 122880
  v_mfma_f32_16x16x32_bf16 v[96:99], a[224:227], v[48:51], v[184:187]
  s_sub_u32 s36, s42, s36
  v_mfma_f32_16x16x32_bf16 v[104:107], a[224:227], v[64:67], v[188:191]
  v_mfma_f32_16x16x32_bf16 v[84:87], a[240:243], v[16:19], v[220:223]
  ds_read_b128 a[208:211], v2 offset:20480
  s_add_u32 s36, s36, 16777216
  v_mfma_f32_16x16x32_bf16 v[92:95], a[240:243], v[32:35], v[180:183]
  buffer_load_dwordx4 v1, s[20:23], s36 offen offset:0 sc1 lds
  v_mfma_f32_16x16x32_bf16 v[100:103], a[240:243], v[48:51], v[184:187]
  v_mfma_f32_16x16x32_bf16 v[108:111], a[240:243], v[64:67], v[188:191]
  buffer_load_dwordx4 v1, s[20:23], s36 offen offset:1024 sc1 lds
  v_mfma_f32_16x16x32_bf16 v[80:83], a[228:231], v[20:23], v[80:83]
  ds_read_b128 a[196:199], v2 offset:17408
  s_add_u32 m0, s46, 8192
  v_mfma_f32_16x16x32_bf16 v[88:91], a[228:231], v[36:39], v[88:91]
  s_add_u32 s36, s42, 16785408
  v_mfma_f32_16x16x32_bf16 v[96:99], a[228:231], v[52:55], v[96:99]
  v_mfma_f32_16x16x32_bf16 v[104:107], a[228:231], v[68:71], v[104:107]
  buffer_load_dwordx4 v1, s[20:23], s36 offen offset:0 sc1 lds
  v_mfma_f32_16x16x32_bf16 v[84:87], a[244:247], v[20:23], v[84:87]
  ds_read_b128 a[212:215], v2 offset:21504
  buffer_load_dwordx4 v1, s[20:23], s36 offen offset:1024 sc1 lds
  v_mfma_f32_16x16x32_bf16 v[92:95], a[244:247], v[36:39], v[92:95]
  v_mfma_f32_16x16x32_bf16 v[100:103], a[244:247], v[52:55], v[100:103]
  buffer_load_dwordx4 v1, s[20:23], s36 offen offset:2048 sc1 lds
  v_mfma_f32_16x16x32_bf16 v[108:111], a[244:247], v[68:71], v[108:111]
  buffer_load_dwordx4 v1, s[20:23], s36 offen offset:3072 sc1 lds
  v_mfma_f32_16x16x32_bf16 v[80:83], a[232:235], v[24:27], v[80:83]
  ds_read_b128 a[200:203], v2 offset:18432
  v_mfma_f32_16x16x32_bf16 v[88:91], a[232:235], v[40:43], v[88:91]
  s_add_u32 m0, s37, 32768
  v_mfma_f32_16x16x32_bf16 v[96:99], a[232:235], v[56:59], v[96:99]
  s_mov_b32 s36, s43
  v_mfma_f32_16x16x32_bf16 v[104:107], a[232:235], v[72:75], v[104:107]
  buffer_load_dwordx4 v1, s[20:23], s36 offen offset:0 sc1 lds
  v_mfma_f32_16x16x32_bf16 v[84:87], a[248:251], v[24:27], v[84:87]
  ds_read_b128 a[216:219], v2 offset:22528
  v_mfma_f32_16x16x32_bf16 v[92:95], a[248:251], v[40:43], v[92:95]
  buffer_load_dwordx4 v1, s[20:23], s36 offen offset:1024 sc1 lds
  v_mfma_f32_16x16x32_bf16 v[100:103], a[248:251], v[56:59], v[100:103]
  buffer_load_dwordx4 v1, s[20:23], s36 offen offset:2048 sc1 lds
  v_mfma_f32_16x16x32_bf16 v[108:111], a[248:251], v[72:75], v[108:111]
  v_mfma_f32_16x16x32_bf16 v[80:83], a[236:239], v[28:31], v[80:83]
  ds_read_b128 a[204:207], v2 offset:19456
  buffer_load_dwordx4 v1, s[20:23], s36 offen offset:3072 sc1 lds
  v_mfma_f32_16x16x32_bf16 v[88:91], a[236:239], v[44:47], v[88:91]
  s_xor_b32 s37, s37, 0x10000
  v_mfma_f32_16x16x32_bf16 v[96:99], a[236:239], v[60:63], v[96:99]
  v_mfma_f32_16x16x32_bf16 v[104:107], a[236:239], v[76:79], v[104:107]
  v_mfma_f32_16x16x32_bf16 v[84:87], a[252:255], v[28:31], v[84:87]
  ds_read_b128 a[220:223], v2 offset:23552
  v_mfma_f32_16x16x32_bf16 v[92:95], a[252:255], v[44:47], v[92:95]
  v_mfma_f32_16x16x32_bf16 v[100:103], a[252:255], v[60:63], v[100:103]
  v_mfma_f32_16x16x32_bf16 v[108:111], a[252:255], v[76:79], v[108:111]
  s_branch K_go
K_last:
.section .rodata,"a"
.p2align 6
.amdhsa_kernel gated_mix__ssm_conv_h3__compressed_kv_cla__prompt_kernel
  .amdhsa_next_free_vgpr 512
  .amdhsa_next_free_sgpr 102
  .amdhsa_accum_offset 256
  .amdhsa_group_segment_fixed_size 0
  .amdhsa_kernarg_size 128
  .amdhsa_user_sgpr_count 2
  .amdhsa_user_sgpr_kernarg_segment_ptr 1
  .amdhsa_system_sgpr_workgroup_id_x 1
  .amdhsa_float_denorm_mode_32 3
.end_amdhsa_kernel
```
